```python
import torch

def _softmax(x, axis=-1):
    return torch.softmax(x, dim=axis)

def _gelu(x):
    return torch.nn.functional.gelu(x, approximate='tanh')

def _silu(x):
    return torch.nn.functional.silu(x)

def _sigmoid(x):
    return torch.sigmoid(x)

def _layernorm(x, axis=-1, eps=1e-05):
    m = x.mean(dim=axis, keepdim=True)
    v = x.var(dim=axis, keepdim=True, unbiased=False)
    return (x - m) / torch.sqrt(v + eps)

def _scatter_add(tgt, idx, src, axis=0):
    return tgt.clone().index_add_(axis, idx, src)

def _segment_sum(src, seg, n):
    out = torch.zeros((n,) + src.shape[1:], dtype=src.dtype)
    return out.index_add_(0, seg, src)

def _pad(x, pw):
    flat = tuple((v for pair in reversed(pw) for v in pair))
    return torch.nn.functional.pad(x, flat)
kernel_name = 'sequential_preLN__memory_aug_recurrent_mem_tr__mixer_s_mlp__prompt'

def setup_inputs():

    _w = lambda a: (lambda t: t.to(torch.bfloat16) if t.is_floating_point() else t)(torch.as_tensor(a))

    def _A_setup():
        B, S, Dm = (1, 2048, 640)
        H, Dh = (32, 192)
        M, seg = (8, 32)
        seg = min(seg, S)
        S = S // seg * seg
        return {'x': _w((lambda *s: torch.randn(*s, dtype=torch.bfloat16) * 0.05)(B, S, Dm)), 'mem0': _w((lambda *s: torch.randn(*s, dtype=torch.bfloat16) * 0.2)(B, M, Dm)), 'Wq': _w((lambda *s: torch.randn(*s, dtype=torch.bfloat16) * 1.6)(Dm, H, Dh) * Dm ** (-0.5)), 'Wk': _w((lambda *s: torch.randn(*s, dtype=torch.bfloat16) * 1.6)(Dm, H, Dh) * Dm ** (-0.5)), 'Wv': _w((lambda *s: torch.randn(*s, dtype=torch.bfloat16) * 0.2)(Dm, H, Dh) * Dm ** (-0.5)), 'Wo': _w((lambda *s: torch.randn(*s, dtype=torch.bfloat16) * 0.2)(H, Dh, Dm) * (H * Dh) ** (-0.5)), 'seg_len': seg}
    _A_in = _A_setup()

    def _B_setup():
        B, S, D, F = (1, 2048, 640, 1536)
        return {'x': _w((lambda *s: torch.randn(*s, dtype=torch.bfloat16) * 0.05)(B, S, D)), 'w1': _w((lambda *s: torch.randn(*s, dtype=torch.bfloat16) * 0.8)(D, D) * D ** (-0.5)), 'w2': _w((lambda *s: torch.randn(*s, dtype=torch.bfloat16) * 0.8)(D, D) * D ** (-0.5)), 'w3': _w((lambda *s: torch.randn(*s, dtype=torch.bfloat16) * 0.8)(D, F) * D ** (-0.5)), 'w4': _w((lambda *s: torch.randn(*s, dtype=torch.bfloat16) * 0.8)(F, D) * F ** (-0.5))}
    _B_in = _B_setup()
    return {'A_x': _A_in['x'], 'A_mem0': _A_in['mem0'], 'A_Wq': _A_in['Wq'], 'A_Wk': _A_in['Wk'], 'A_Wv': _A_in['Wv'], 'A_Wo': _A_in['Wo'], 'A_seg_len': _A_in['seg_len'], 'B_x': _B_in['x'], 'B_w1': _B_in['w1'], 'B_w2': _B_in['w2'], 'B_w3': _B_in['w3'], 'B_w4': _B_in['w4']}

def reference(A_x, A_mem0, A_Wq, A_Wk, A_Wv, A_Wo, A_seg_len, B_x, B_w1, B_w2, B_w3, B_w4):

    def _A_ref(x, mem0, Wq, Wk, Wv, Wo, seg_len):
        B, S, Dm = x.shape
        H, Dh = (Wq.shape[1], Wq.shape[2])
        M = mem0.shape[1]
        scale = Dh ** (-0.5)
        n_seg = S // seg_len
        L = M + seg_len
        idx = torch.arange(L)
        mask = (idx[:, None] < M) | (idx[:, None] >= idx[None, :])
        mem = mem0
        outs = []
        for s in range(n_seg):
            xs = x[:, s * seg_len:(s + 1) * seg_len, :].clone()
            h = torch.concatenate([mem, xs], axis=1)
            q = torch.einsum('btd,dhe->bhte', h, Wq)
            k = torch.einsum('btd,dhe->bhte', h, Wk)
            v = torch.einsum('btd,dhe->bhte', h, Wv)
            scores = torch.einsum('bhqe,bhke->bhqk', q, k) * scale
            scores = torch.where(mask[None, None], scores, -1000000000.0)
            p = _softmax(scores, axis=-1)
            o = torch.einsum('bhqk,bhke->bhqe', p, v)
            o = torch.einsum('bhte,hed->btd', o, Wo)
            mem = o[:, :M, :].clone()
            outs.append(o[:, M:, :])
        return torch.concatenate(outs, axis=1)

    def _B_ref(x, w1, w2, w3, w4):
        B, S, D = x.shape
        h = _gelu(_layernorm(x, axis=-1) @ w1)
        c = D // 4
        g0 = _pad(h[:, :, 0 * c:1 * c], ((0, 0), (1, 0), (0, 0)))[:, :S, :]
        g1 = _pad(h[:, :, 1 * c:2 * c], ((0, 0), (0, 1), (0, 0)))[:, 1:, :]
        g2 = _pad(h[:, :, 2 * c:3 * c], ((0, 0), (2, 0), (0, 0)))[:, :S, :]
        g3 = _pad(h[:, :, 3 * c:], ((0, 0), (0, 2), (0, 0)))[:, 2:, :]
        hs = torch.concatenate([g0, g1, g2, g3], axis=-1) @ w2
        x1 = x + hs
        h2 = _gelu(_layernorm(x1, axis=-1) @ w3) @ w4
        return x1 + h2
    x = A_x
    h = x + _A_ref(_layernorm(x, axis=-1), A_mem0, A_Wq, A_Wk, A_Wv, A_Wo, A_seg_len)
    h2 = h + _B_ref(_layernorm(h, axis=-1), B_w1, B_w2, B_w3, B_w4)
    return h2
```

```asm
; @launch kernel=main_kernel grid=(256,1,1) block=(256,1,1) lds=147456
.amdgcn_target "amdgcn-amd-amdhsa--gfx950"
.text
.globl main_kernel
.p2align 8
.type main_kernel,@function
main_kernel:
    s_cmp_ge_u32 s2, 256
    s_cbranch_scc1 Lmain_end
    s_load_dwordx4 s[32:35], s[0:1], 104
    s_getreg_b32 s15, hwreg(HW_REG_XCC_ID)
    s_and_b32 s15, s15, 7
    v_lshrrev_b32 v1, 6, v0
    s_nop 0
    v_readfirstlane_b32 s14, v1
    v_and_b32 v0, 63, v0
    s_waitcnt lgkmcnt(0)
    s_mov_b32 s4, s34
    s_and_b32 s5, s35, 0xffff
    s_mov_b32 s6, 0x10000000
    s_mov_b32 s7, 0x20000
    s_mov_b32 s8, s32
    s_and_b32 s9, s33, 0xffff
    s_mov_b32 s10, 0x100
    s_mov_b32 s11, 0x20000
    s_mov_b32 s30, 0
    s_mov_b32 s31, 0x100000
    s_cmp_lg_u32 s14, 0
    s_cbranch_scc1 Lmain_w
    s_lshl_b32 s16, s15, 2
    v_mov_b32 v1, s16
    v_mov_b32 v3, 1
    s_mov_b64 exec, 1
    buffer_atomic_add v3, v1, s[8:11], 0 offen sc0
    s_mov_b64 exec, -1
    v_and_b32 v1, 7, v0
    v_lshlrev_b32 v1, 2, v1
    s_nop 1
Lmain_cen:
    buffer_load_dword v2, v1, s[8:11], 0 offen sc1
    s_waitcnt vmcnt(0)
    s_mov_b32 s20, 0
    s_mov_b32 s21, 0
    s_mov_b32 s22, 0
    v_readlane_b32 s23, v2, 0
    s_add_u32 s20, s20, s23
    s_cmp_gt_u32 s15, 0
    s_cselect_b32 s24, s23, 0
    s_add_u32 s21, s21, s24
    s_cmp_lg_u32 s23, 32
    s_cselect_b32 s24, 1, 0
    s_or_b32 s22, s22, s24
    v_readlane_b32 s23, v2, 1
    s_add_u32 s20, s20, s23
    s_cmp_gt_u32 s15, 1
    s_cselect_b32 s24, s23, 0
    s_add_u32 s21, s21, s24
    s_cmp_lg_u32 s23, 32
    s_cselect_b32 s24, 1, 0
    s_or_b32 s22, s22, s24
    v_readlane_b32 s23, v2, 2
    s_add_u32 s20, s20, s23
    s_cmp_gt_u32 s15, 2
    s_cselect_b32 s24, s23, 0
    s_add_u32 s21, s21, s24
    s_cmp_lg_u32 s23, 32
    s_cselect_b32 s24, 1, 0
    s_or_b32 s22, s22, s24
    v_readlane_b32 s23, v2, 3
    s_add_u32 s20, s20, s23
    s_cmp_gt_u32 s15, 3
    s_cselect_b32 s24, s23, 0
    s_add_u32 s21, s21, s24
    s_cmp_lg_u32 s23, 32
    s_cselect_b32 s24, 1, 0
    s_or_b32 s22, s22, s24
    v_readlane_b32 s23, v2, 4
    s_add_u32 s20, s20, s23
    s_cmp_gt_u32 s15, 4
    s_cselect_b32 s24, s23, 0
    s_add_u32 s21, s21, s24
    s_cmp_lg_u32 s23, 32
    s_cselect_b32 s24, 1, 0
    s_or_b32 s22, s22, s24
    v_readlane_b32 s23, v2, 5
    s_add_u32 s20, s20, s23
    s_cmp_gt_u32 s15, 5
    s_cselect_b32 s24, s23, 0
    s_add_u32 s21, s21, s24
    s_cmp_lg_u32 s23, 32
    s_cselect_b32 s24, 1, 0
    s_or_b32 s22, s22, s24
    v_readlane_b32 s23, v2, 6
    s_add_u32 s20, s20, s23
    s_cmp_gt_u32 s15, 6
    s_cselect_b32 s24, s23, 0
    s_add_u32 s21, s21, s24
    s_cmp_lg_u32 s23, 32
    s_cselect_b32 s24, 1, 0
    s_or_b32 s22, s22, s24
    v_readlane_b32 s23, v2, 7
    s_add_u32 s20, s20, s23
    s_cmp_gt_u32 s15, 7
    s_cselect_b32 s24, s23, 0
    s_add_u32 s21, s21, s24
    s_cmp_lg_u32 s23, 32
    s_cselect_b32 s24, 1, 0
    s_or_b32 s22, s22, s24
    s_cmp_ge_u32 s20, 256
    s_cbranch_scc1 Lmain_cd
    s_add_u32 s30, s30, 1
    s_cmp_lt_u32 s30, s31
    s_cbranch_scc1 Lmain_cen
Lmain_cd:
    v_readfirstlane_b32 s16, v3
    s_add_u32 s16, s16, s21
    s_lshl_b32 s22, s22, 8
    s_or_b32 s16, s16, s22
    v_mov_b32 v1, 0
    v_mov_b32 v2, s16
    ds_write_b32 v1, v2
    s_waitcnt lgkmcnt(0)
Lmain_w:
    s_barrier
    v_mov_b32 v1, 0
    ds_read_b32 v3, v1
    s_waitcnt lgkmcnt(0)
    v_readfirstlane_b32 s16, v3
    s_barrier
    s_lshr_b32 s3, s16, 8
    s_bfe_u32 s15, s16, 0x30005
    s_and_b32 s16, s16, 31
    s_cmp_ge_u32 s15, 4
    s_cbranch_scc1 Lmain_worker
    s_load_dwordx8 s[64:71], s[0:1], 16
    s_waitcnt lgkmcnt(0)
    s_mov_b32 s44, 0
    s_mov_b32 s56, s8
    s_mov_b32 s57, s9
    s_mov_b32 s58, s10
    s_mov_b32 s59, s11
    v_and_b32 v244, 15, v0
    v_lshrrev_b32 v245, 4, v0
    v_and_b32 v246, 7, v0
    s_lshr_b32 s18, s16, 2
    s_and_b32 s19, s16, 3
    s_lshl_b32 s26, s15, 3
    s_add_u32 s26, s26, s18
    s_mov_b32 s20, 0x00ff00ff
    s_mov_b32 s21, 0x00ff00ff
    s_mov_b32 s22, 0xff00ff00
    s_mov_b32 s23, 0xff00ff00
    s_and_b32 s18, s16, 1
    s_mov_b32 s24, -1
    s_cmp_eq_u32 s18, 0
    s_cselect_b32 s25, 0xffff, 0
    s_mov_b32 s38, 0
    s_mov_b32 s39, 0x00ff00ff
    s_mov_b32 s40, 0x00ff00ff
    s_mov_b32 s41, 0
    s_mov_b32 s48, 0x3dd53b95
    v_lshlrev_b32 v3, 4, v0
    s_mov_b32 s72, s68
    s_and_b32 s73, s69, 0xffff
    s_mov_b32 s74, 7864320
    s_mov_b32 s75, 0x20000
    s_mov_b32 s76, s70
    s_and_b32 s77, s71, 0xffff
    s_mov_b32 s78, 7864320
    s_mov_b32 s79, 0x20000
    s_mul_i32 s80, s26, 245760
    s_mul_i32 s81, s19, 320
    s_add_u32 s80, s80, s81
    s_lshl_b32 s81, s14, 6
    s_lshl_b32 s82, s14, 10
    v_add_u32 v129, s81, v0
    v_add_u32 v129, 0, v129
    v_mul_u32_u24 v130, 0xba3, v129
    v_lshrrev_b32 v130, 16, v130
    v_mul_u32_u24 v131, 22, v130
    v_sub_u32 v131, v129, v131
    v_min_u32 v131, 19, v131
    v_mul_u32_u24 v130, 1280, v130
    v_lshl_add_u32 v130, v131, 4, v130
    buffer_load_dwordx4 a[0:3], v130, s[76:79], s80 offen
    v_add_u32 v129, s81, v0
    v_add_u32 v129, 256, v129
    v_mul_u32_u24 v130, 0xba3, v129
    v_lshrrev_b32 v130, 16, v130
    v_mul_u32_u24 v131, 22, v130
    v_sub_u32 v131, v129, v131
    v_min_u32 v131, 19, v131
    v_mul_u32_u24 v130, 1280, v130
    v_lshl_add_u32 v130, v131, 4, v130
    buffer_load_dwordx4 a[4:7], v130, s[76:79], s80 offen
    v_add_u32 v129, s81, v0
    v_add_u32 v129, 512, v129
    v_mul_u32_u24 v130, 0xba3, v129
    v_lshrrev_b32 v130, 16, v130
    v_mul_u32_u24 v131, 22, v130
    v_sub_u32 v131, v129, v131
    v_min_u32 v131, 19, v131
    v_mul_u32_u24 v130, 1280, v130
    v_lshl_add_u32 v130, v131, 4, v130
    buffer_load_dwordx4 a[8:11], v130, s[76:79], s80 offen
    v_add_u32 v129, s81, v0
    v_add_u32 v129, 768, v129
    v_mul_u32_u24 v130, 0xba3, v129
    v_lshrrev_b32 v130, 16, v130
    v_mul_u32_u24 v131, 22, v130
    v_sub_u32 v131, v129, v131
    v_min_u32 v131, 19, v131
    v_mul_u32_u24 v130, 1280, v130
    v_lshl_add_u32 v130, v131, 4, v130
    buffer_load_dwordx4 a[12:15], v130, s[76:79], s80 offen
    v_add_u32 v129, s81, v0
    v_add_u32 v129, 1024, v129
    v_mul_u32_u24 v130, 0xba3, v129
    v_lshrrev_b32 v130, 16, v130
    v_mul_u32_u24 v131, 22, v130
    v_sub_u32 v131, v129, v131
    v_min_u32 v131, 19, v131
    v_mul_u32_u24 v130, 1280, v130
    v_lshl_add_u32 v130, v131, 4, v130
    buffer_load_dwordx4 a[16:19], v130, s[76:79], s80 offen
    v_add_u32 v129, s81, v0
    v_add_u32 v129, 1280, v129
    v_mul_u32_u24 v130, 0xba3, v129
    v_lshrrev_b32 v130, 16, v130
    v_mul_u32_u24 v131, 22, v130
    v_sub_u32 v131, v129, v131
    v_min_u32 v131, 19, v131
    v_mul_u32_u24 v130, 1280, v130
    v_lshl_add_u32 v130, v131, 4, v130
    buffer_load_dwordx4 a[20:23], v130, s[76:79], s80 offen
    v_add_u32 v129, s81, v0
    v_add_u32 v129, 1536, v129
    v_mul_u32_u24 v130, 0xba3, v129
    v_lshrrev_b32 v130, 16, v130
    v_mul_u32_u24 v131, 22, v130
    v_sub_u32 v131, v129, v131
    v_min_u32 v131, 19, v131
    v_mul_u32_u24 v130, 1280, v130
    v_lshl_add_u32 v130, v131, 4, v130
    buffer_load_dwordx4 a[24:27], v130, s[76:79], s80 offen
    v_add_u32 v129, s81, v0
    v_add_u32 v129, 1792, v129
    v_mul_u32_u24 v130, 0xba3, v129
    v_lshrrev_b32 v130, 16, v130
    v_mul_u32_u24 v131, 22, v130
    v_sub_u32 v131, v129, v131
    v_min_u32 v131, 19, v131
    v_mul_u32_u24 v130, 1280, v130
    v_lshl_add_u32 v130, v131, 4, v130
    buffer_load_dwordx4 a[28:31], v130, s[76:79], s80 offen
    v_add_u32 v129, s81, v0
    v_add_u32 v129, 2048, v129
    v_mul_u32_u24 v130, 0xba3, v129
    v_lshrrev_b32 v130, 16, v130
    v_mul_u32_u24 v131, 22, v130
    v_sub_u32 v131, v129, v131
    v_min_u32 v131, 19, v131
    v_mul_u32_u24 v130, 1280, v130
    v_lshl_add_u32 v130, v131, 4, v130
    buffer_load_dwordx4 a[32:35], v130, s[76:79], s80 offen
    v_add_u32 v129, s81, v0
    v_add_u32 v129, 2304, v129
    v_mul_u32_u24 v130, 0xba3, v129
    v_lshrrev_b32 v130, 16, v130
    v_mul_u32_u24 v131, 22, v130
    v_sub_u32 v131, v129, v131
    v_min_u32 v131, 19, v131
    v_mul_u32_u24 v130, 1280, v130
    v_lshl_add_u32 v130, v131, 4, v130
    buffer_load_dwordx4 a[36:39], v130, s[76:79], s80 offen
    v_add_u32 v129, s81, v0
    v_add_u32 v129, 2560, v129
    v_mul_u32_u24 v130, 0xba3, v129
    v_lshrrev_b32 v130, 16, v130
    v_mul_u32_u24 v131, 22, v130
    v_sub_u32 v131, v129, v131
    v_min_u32 v131, 19, v131
    v_mul_u32_u24 v130, 1280, v130
    v_lshl_add_u32 v130, v131, 4, v130
    buffer_load_dwordx4 a[40:43], v130, s[76:79], s80 offen
    v_add_u32 v129, s81, v0
    v_add_u32 v129, 2816, v129
    v_mul_u32_u24 v130, 0xba3, v129
    v_lshrrev_b32 v130, 16, v130
    v_mul_u32_u24 v131, 22, v130
    v_sub_u32 v131, v129, v131
    v_min_u32 v131, 19, v131
    v_mul_u32_u24 v130, 1280, v130
    v_lshl_add_u32 v130, v131, 4, v130
    buffer_load_dwordx4 a[44:47], v130, s[76:79], s80 offen
    v_add_u32 v129, s81, v0
    v_add_u32 v129, 3072, v129
    v_mul_u32_u24 v130, 0xba3, v129
    v_lshrrev_b32 v130, 16, v130
    v_mul_u32_u24 v131, 22, v130
    v_sub_u32 v131, v129, v131
    v_min_u32 v131, 19, v131
    v_mul_u32_u24 v130, 1280, v130
    v_lshl_add_u32 v130, v131, 4, v130
    buffer_load_dwordx4 a[48:51], v130, s[76:79], s80 offen
    v_add_u32 v129, s81, v0
    v_add_u32 v129, 3328, v129
    v_mul_u32_u24 v130, 0xba3, v129
    v_lshrrev_b32 v130, 16, v130
    v_mul_u32_u24 v131, 22, v130
    v_sub_u32 v131, v129, v131
    v_min_u32 v131, 19, v131
    v_mul_u32_u24 v130, 1280, v130
    v_lshl_add_u32 v130, v131, 4, v130
    buffer_load_dwordx4 a[52:55], v130, s[76:79], s80 offen
    v_add_u32 v129, s81, v0
    v_add_u32 v129, 3584, v129
    v_mul_u32_u24 v130, 0xba3, v129
    v_lshrrev_b32 v130, 16, v130
    v_mul_u32_u24 v131, 22, v130
    v_sub_u32 v131, v129, v131
    v_min_u32 v131, 19, v131
    v_mul_u32_u24 v130, 1280, v130
    v_lshl_add_u32 v130, v131, 4, v130
    buffer_load_dwordx4 a[56:59], v130, s[76:79], s80 offen
    v_add_u32 v129, s81, v0
    v_add_u32 v129, 3840, v129
    v_mul_u32_u24 v130, 0xba3, v129
    v_lshrrev_b32 v130, 16, v130
    v_mul_u32_u24 v131, 22, v130
    v_sub_u32 v131, v129, v131
    v_min_u32 v131, 19, v131
    v_mul_u32_u24 v130, 1280, v130
    v_lshl_add_u32 v130, v131, 4, v130
    buffer_load_dwordx4 a[60:63], v130, s[76:79], s80 offen
    v_add_u32 v129, s81, v0
    v_add_u32 v129, 4096, v129
    v_mul_u32_u24 v130, 0xba3, v129
    v_lshrrev_b32 v130, 16, v130
    v_mul_u32_u24 v131, 22, v130
    v_sub_u32 v131, v129, v131
    v_min_u32 v131, 19, v131
    v_mul_u32_u24 v130, 1280, v130
    v_lshl_add_u32 v130, v131, 4, v130
    buffer_load_dwordx4 a[64:67], v130, s[76:79], s80 offen
    v_mul_u32_u24 v120, 12288, v244
    v_lshl_add_u32 v120, v245, 4, v120
    v_lshlrev_b32 v121, 3, v245
    v_lshrrev_b32 v122, 2, v244
    v_add_u32 v121, v121, v122
    v_mul_u32_u24 v121, 352, v121
    v_and_b32 v122, 3, v244
    v_lshl_add_u32 v121, v122, 3, v121
    v_add_u32 v121, 61440, v121
    s_mul_i32 s83, s14, 1966080
    s_mul_i32 s84, s26, 384
    s_add_u32 s83, s83, s84
    s_mul_i32 s84, s14, 1310720
    s_mul_i32 s85, s26, 40
    s_mul_i32 s86, s19, 10
    s_add_u32 s85, s85, s86
    s_lshl_b32 s85, s85, 10
    s_add_u32 s84, s84, s85
    s_add_u32 s84, s84, 0x8400000
    s_lshl_b32 s85, s15, 10
    s_add_u32 s85, s85, 0xb20c000
    s_lshl_b32 s86, s16, 2
    s_add_u32 s86, s86, s85
    v_mov_b32 v122, s86
    v_and_b32 v128, 31, v0
    v_lshlrev_b32 v128, 2, v128
    v_add_u32 v128, s85, v128
    buffer_load_dwordx4 v[24:27], v120, s[72:75], s83 offen offset:0
    buffer_load_dwordx4 v[28:31], v120, s[72:75], s83 offen offset:64
    buffer_load_dwordx4 v[32:35], v120, s[72:75], s83 offen offset:128
    buffer_load_dwordx4 v[36:39], v120, s[72:75], s83 offen offset:192
    buffer_load_dwordx4 v[40:43], v120, s[72:75], s83 offen offset:256
    buffer_load_dwordx4 v[44:47], v120, s[72:75], s83 offen offset:320
    s_add_u32 s83, s83, 196608
    buffer_load_dwordx4 v[48:51], v120, s[72:75], s83 offen offset:0
    buffer_load_dwordx4 v[52:55], v120, s[72:75], s83 offen offset:64
    buffer_load_dwordx4 v[56:59], v120, s[72:75], s83 offen offset:128
    buffer_load_dwordx4 v[60:63], v120, s[72:75], s83 offen offset:192
    buffer_load_dwordx4 v[64:67], v120, s[72:75], s83 offen offset:256
    buffer_load_dwordx4 v[68:71], v120, s[72:75], s83 offen offset:320
    s_add_u32 s83, s83, 196608
    buffer_load_dwordx4 v[72:75], v120, s[72:75], s83 offen offset:0
    buffer_load_dwordx4 v[76:79], v120, s[72:75], s83 offen offset:64
    buffer_load_dwordx4 v[80:83], v120, s[72:75], s83 offen offset:128
    buffer_load_dwordx4 v[84:87], v120, s[72:75], s83 offen offset:192
    buffer_load_dwordx4 v[88:91], v120, s[72:75], s83 offen offset:256
    buffer_load_dwordx4 v[92:95], v120, s[72:75], s83 offen offset:320
    s_add_u32 s83, s83, 196608
    buffer_load_dwordx4 v[96:99], v120, s[72:75], s83 offen offset:0
    buffer_load_dwordx4 v[100:103], v120, s[72:75], s83 offen offset:64
    buffer_load_dwordx4 v[104:107], v120, s[72:75], s83 offen offset:128
    buffer_load_dwordx4 v[108:111], v120, s[72:75], s83 offen offset:192
    buffer_load_dwordx4 v[112:115], v120, s[72:75], s83 offen offset:256
    buffer_load_dwordx4 v[116:119], v120, s[72:75], s83 offen offset:320
    s_add_u32 s83, s83, 196608
    s_mul_i32 s27, s14, 15360
    v_add_u32 v247, 0, v0
    v_mul_u32_u24 v248, 0x2aab, v247
    v_lshrrev_b32 v248, 16, v248
    v_mul_u32_u24 v249, 6, v248
    v_sub_u32 v249, v247, v249
    v_mul_u32_u24 v248, 12288, v248
    v_lshl_add_u32 v132, v249, 4, v248
    v_add_u32 v247, 64, v0
    v_mul_u32_u24 v248, 0x2aab, v247
    v_lshrrev_b32 v248, 16, v248
    v_mul_u32_u24 v249, 6, v248
    v_sub_u32 v249, v247, v249
    v_mul_u32_u24 v248, 12288, v248
    v_lshl_add_u32 v133, v249, 4, v248
    v_add_u32 v247, 128, v0
    v_mul_u32_u24 v248, 0x2aab, v247
    v_lshrrev_b32 v248, 16, v248
    v_mul_u32_u24 v249, 6, v248
    v_sub_u32 v249, v247, v249
    v_mul_u32_u24 v248, 12288, v248
    v_lshl_add_u32 v134, v249, 4, v248
    s_mul_i32 s34, s14, 1966080
    s_mul_i32 s35, s26, 384
    s_add_u32 s34, s34, s35
    s_mul_i32 s35, s19, 96
    s_add_u32 s34, s34, s35
    s_add_u32 s32, s64, s34
    s_addc_u32 s33, s65, 0
    s_add_u32 m0, s27, 61440
    s_nop 0
    global_load_lds_dwordx4 v132, s[32:33]
    s_add_u32 m0, s27, 62464
    s_nop 0
    global_load_lds_dwordx4 v133, s[32:33]
    s_add_u32 m0, s27, 63488
    s_nop 0
    global_load_lds_dwordx4 v134, s[32:33]
    s_add_u32 s32, s32, 393216
    s_addc_u32 s33, s33, 0
    s_add_u32 m0, s27, 64512
    s_nop 0
    global_load_lds_dwordx4 v132, s[32:33]
    s_add_u32 m0, s27, 65536
    s_nop 0
    global_load_lds_dwordx4 v133, s[32:33]
    s_add_u32 m0, s27, 66560
    s_nop 0
    global_load_lds_dwordx4 v134, s[32:33]
    s_add_u32 s32, s32, 393216
    s_addc_u32 s33, s33, 0
    s_add_u32 m0, s27, 67584
    s_nop 0
    global_load_lds_dwordx4 v132, s[32:33]
    s_add_u32 m0, s27, 68608
    s_nop 0
    global_load_lds_dwordx4 v133, s[32:33]
    s_add_u32 m0, s27, 69632
    s_nop 0
    global_load_lds_dwordx4 v134, s[32:33]
    s_add_u32 s32, s32, 393216
    s_addc_u32 s33, s33, 0
    s_add_u32 m0, s27, 70656
    s_nop 0
    global_load_lds_dwordx4 v132, s[32:33]
    s_add_u32 m0, s27, 71680
    s_nop 0
    global_load_lds_dwordx4 v133, s[32:33]
    s_add_u32 m0, s27, 72704
    s_nop 0
    global_load_lds_dwordx4 v134, s[32:33]
    s_add_u32 s32, s32, 393216
    s_addc_u32 s33, s33, 0
    s_add_u32 m0, s27, 73728
    s_nop 0
    global_load_lds_dwordx4 v132, s[32:33]
    s_add_u32 m0, s27, 74752
    s_nop 0
    global_load_lds_dwordx4 v133, s[32:33]
    s_add_u32 m0, s27, 75776
    s_nop 0
    global_load_lds_dwordx4 v134, s[32:33]
    s_lshr_b32 s28, s16, 1
    s_mul_i32 s28, s28, 5
    s_mul_i32 s29, s18, 3
    s_add_u32 s28, s28, s29
    s_sub_u32 s45, 2, s18
    s_add_u32 s45, s45, s28
    s_lshl_b32 s29, s15, 3
    s_lshl_b32 s35, s14, 1
    s_add_u32 s29, s29, s35
    v_lshrrev_b32 v250, 3, v244
    v_add_u32 v250, s28, v250
    v_min_u32 v250, s45, v250
    v_lshrrev_b32 v248, 1, v250
    v_and_b32 v250, 1, v250
    v_and_b32 v249, 7, v244
    v_lshl_add_u32 v249, v250, 3, v249
    v_lshlrev_b32 v9, 10, v248
    v_lshl_add_u32 v9, v249, 4, v9
    v_lshl_add_u32 v9, v245, 8, v9
    s_mul_i32 s35, s29, 40960
    v_add_u32 v9, s35, v9
    v_add_u32 v247, 16, v246
    v_lshrrev_b32 v250, 3, v247
    v_add_u32 v250, s28, v250
    v_min_u32 v250, s45, v250
    v_lshrrev_b32 v248, 1, v250
    v_and_b32 v250, 1, v250
    v_and_b32 v249, 7, v247
    v_lshl_add_u32 v249, v250, 3, v249
    v_lshlrev_b32 v10, 10, v248
    v_lshl_add_u32 v10, v249, 4, v10
    v_lshl_add_u32 v10, v245, 8, v10
    s_mul_i32 s35, s29, 40960
    v_add_u32 v10, s35, v10
    v_lshrrev_b32 v251, 3, v244
    v_mul_u32_u24 v250, 40960, v251
    v_add_u32 v19, v10, v250
    v_add_u32 v18, 40960, v9
    s_mul_i32 s37, s14, 5
    v_lshlrev_b32 v248, 4, v246
    v_lshl_add_u32 v4, v245, 7, v248
    s_mul_i32 s46, s14, 2560
    s_mul_i32 s35, s15, 10240
    s_add_u32 s46, s46, s35
    s_mul_i32 s35, s14, 768
    s_add_u32 s36, s35, 32768
    v_add_u32 v11, s36, v4
    s_lshl_b32 s36, s14, 9
    v_lshlrev_b32 v5, 5, v244
    v_lshl_add_u32 v135, v245, 9, v5
    v_lshl_add_u32 v5, v245, 3, v5
    v_add_u32 v5, s36, v5
    v_lshrrev_b32 v251, 3, v244
    s_add_u32 s36, s35, 35840
    v_lshlrev_b32 v15, 4, v244
    v_and_b32 v249, 1, v245
    v_lshl_add_u32 v15, v249, 3, v15
    v_lshrrev_b32 v250, 1, v245
    v_lshl_add_u32 v15, v250, 2, v15
    v_add_u32 v15, s36, v15
    v_lshl_add_u32 v16, v251, 8, v15
    v_add_u32 v16, 256, v16
    v_lshl_add_u32 v6, v249, 3, v248
    v_lshl_add_u32 v6, v250, 7, v6
    s_sub_u32 s35, s14, 1
    s_lshl_b32 s35, s35, 8
    s_cmp_eq_u32 s14, 0
    s_cselect_b32 s35, 384, s35
    s_cmp_eq_u32 s14, 3
    s_cselect_b32 s35, 0, s35
    s_mul_i32 s36, s16, 640
    s_add_u32 s35, s35, s36
    s_mul_i32 s36, s15, 20480
    s_add_u32 s35, s35, s36
    v_add_u32 v6, s35, v6
    v_lshl_add_u32 v250, v251, 2, v245
    v_mul_u32_u24 v250, 640, v250
    v_add_u32 v7, v250, v248
    s_mul_i32 s35, s14, 5120
    s_add_u32 s35, s35, s36
    v_add_u32 v7, s35, v7
    v_lshlrev_b32 v249, 3, v246
    v_lshl_add_u32 v249, v245, 6, v249
    v_add_u32 v14, 38912, v249
    s_lshl_b32 s35, s15, 5
    s_add_u32 s35, s35, s16
    s_mul_i32 s36, s35, 768
    s_lshl_b32 s36, s35, 12
    v_add_u32 v17, s36, v3
    s_lshl_b32 s36, s26, 7
    s_lshl_b32 s37, s19, 2
    s_add_u32 s36, s36, s37
    s_add_u32 s36, s36, 0xb20a000
    v_mov_b32 v21, s36
    s_sub_u32 s35, s14, 1
    s_and_b32 s35, s35, 1
    s_mul_i32 s35, s35, 384
    s_mul_i32 s36, s26, 12
    s_add_u32 s35, s35, s36
    s_mul_i32 s37, s19, 3
    s_add_u32 s35, s35, s37
    s_lshl_b32 s35, s35, 9
    v_lshlrev_b32 v8, 3, v0
    v_add_u32 v8, s35, v8
    s_add_u32 s33, s28, s14
    s_lshr_b32 s35, s33, 2
    s_mul_i32 s36, s35, 0x3334
    s_lshr_b32 s36, s36, 16
    s_mul_i32 s37, s36, 5
    s_sub_u32 s37, s35, s37
    s_lshl_b32 s36, s36, 14
    s_lshl_b32 s37, s37, 10
    s_add_u32 s36, s36, s37
    s_and_b32 s35, s33, 3
    s_lshl_b32 s35, s35, 8
    s_add_u32 s35, s35, s36
    s_add_u32 s35, s35, s44
    v_lshlrev_b32 v12, 2, v0
    v_add_u32 v12, s35, v12
    v_lshlrev_b32 v13, 2, v0
    s_lshl_b32 s35, s14, 8
    s_add_u32 s35, s35, 32768
    v_add_u32 v13, s35, v13
    s_sub_u32 s24, 3, s18
    v_lshl_add_u32 v23, v251, 9, v4
    s_mul_i32 s35, s14, 5
    s_add_u32 s35, s35, 0
    s_mul_i32 s36, s35, 0x3334
    s_lshr_b32 s36, s36, 16
    s_mul_i32 s37, s36, 5
    s_sub_u32 s37, s35, s37
    s_lshl_b32 s36, s36, 14
    s_lshl_b32 s37, s37, 10
    s_add_u32 s36, s36, s37
    s_add_u32 s90, s36, s44
    s_mul_i32 s35, s14, 5
    s_add_u32 s35, s35, 1
    s_mul_i32 s36, s35, 0x3334
    s_lshr_b32 s36, s36, 16
    s_mul_i32 s37, s36, 5
    s_sub_u32 s37, s35, s37
    s_lshl_b32 s36, s36, 14
    s_lshl_b32 s37, s37, 10
    s_add_u32 s36, s36, s37
    s_add_u32 s91, s36, s44
    s_mul_i32 s35, s14, 5
    s_add_u32 s35, s35, 2
    s_mul_i32 s36, s35, 0x3334
    s_lshr_b32 s36, s36, 16
    s_mul_i32 s37, s36, 5
    s_sub_u32 s37, s35, s37
    s_lshl_b32 s36, s36, 14
    s_lshl_b32 s37, s37, 10
    s_add_u32 s36, s36, s37
    s_add_u32 s92, s36, s44
    s_mul_i32 s35, s14, 5
    s_add_u32 s35, s35, 3
    s_mul_i32 s36, s35, 0x3334
    s_lshr_b32 s36, s36, 16
    s_mul_i32 s37, s36, 5
    s_sub_u32 s37, s35, s37
    s_lshl_b32 s36, s36, 14
    s_lshl_b32 s37, s37, 10
    s_add_u32 s36, s36, s37
    s_add_u32 s93, s36, s44
    s_mul_i32 s35, s14, 5
    s_add_u32 s35, s35, 4
    s_mul_i32 s36, s35, 0x3334
    s_lshr_b32 s36, s36, 16
    s_mul_i32 s37, s36, 5
    s_sub_u32 s37, s35, s37
    s_lshl_b32 s36, s36, 14
    s_lshl_b32 s37, s37, 10
    s_add_u32 s36, s36, s37
    s_add_u32 s94, s36, s44
    s_mov_b32 s49, 0x07060302
    s_movk_i32 s47, 0x4080
    v_mov_b32 v250, 0
    v_cmp_eq_u32 vcc, 0, v244
    v_mov_b32 v247, 0x3f80
    s_nop 0
    v_cndmask_b32 v250, v250, v247, vcc
    v_cmp_eq_u32 vcc, 1, v244
    v_mov_b32 v247, 0x3f800000
    s_nop 0
    v_cndmask_b32 v250, v250, v247, vcc
    v_accvgpr_write_b32 a244, v250
    v_mov_b32 v250, 0
    v_cmp_eq_u32 vcc, 8, v244
    v_mov_b32 v247, 0x3f80
    s_nop 0
    v_cndmask_b32 v250, v250, v247, vcc
    v_cmp_eq_u32 vcc, 9, v244
    v_mov_b32 v247, 0x3f800000
    s_nop 0
    v_cndmask_b32 v250, v250, v247, vcc
    v_accvgpr_write_b32 a248, v250
    v_mov_b32 v250, 0
    v_cmp_eq_u32 vcc, 0, v244
    v_mov_b32 v247, 0x3f80
    s_nop 0
    v_cndmask_b32 v250, v250, v247, vcc
    v_cmp_eq_u32 vcc, 1, v244
    v_mov_b32 v247, 0x3f800000
    s_nop 0
    v_cndmask_b32 v250, v250, v247, vcc
    v_accvgpr_write_b32 a240, v250
    v_mov_b32 v250, 0
    v_cmp_eq_u32 vcc, 2, v244
    v_mov_b32 v247, 0x3f80
    s_nop 0
    v_cndmask_b32 v250, v250, v247, vcc
    v_cmp_eq_u32 vcc, 3, v244
    v_mov_b32 v247, 0x3f800000
    s_nop 0
    v_cndmask_b32 v250, v250, v247, vcc
    v_accvgpr_write_b32 a245, v250
    v_mov_b32 v250, 0
    v_cmp_eq_u32 vcc, 10, v244
    v_mov_b32 v247, 0x3f80
    s_nop 0
    v_cndmask_b32 v250, v250, v247, vcc
    v_cmp_eq_u32 vcc, 11, v244
    v_mov_b32 v247, 0x3f800000
    s_nop 0
    v_cndmask_b32 v250, v250, v247, vcc
    v_accvgpr_write_b32 a249, v250
    v_mov_b32 v250, 0
    v_cmp_eq_u32 vcc, 8, v244
    v_mov_b32 v247, 0x3f80
    s_nop 0
    v_cndmask_b32 v250, v250, v247, vcc
    v_cmp_eq_u32 vcc, 9, v244
    v_mov_b32 v247, 0x3f800000
    s_nop 0
    v_cndmask_b32 v250, v250, v247, vcc
    v_accvgpr_write_b32 a241, v250
    v_mov_b32 v250, 0
    v_cmp_eq_u32 vcc, 4, v244
    v_mov_b32 v247, 0x3f80
    s_nop 0
    v_cndmask_b32 v250, v250, v247, vcc
    v_cmp_eq_u32 vcc, 5, v244
    v_mov_b32 v247, 0x3f800000
    s_nop 0
    v_cndmask_b32 v250, v250, v247, vcc
    v_accvgpr_write_b32 a246, v250
    v_mov_b32 v250, 0
    v_cmp_eq_u32 vcc, 12, v244
    v_mov_b32 v247, 0x3f80
    s_nop 0
    v_cndmask_b32 v250, v250, v247, vcc
    v_cmp_eq_u32 vcc, 13, v244
    v_mov_b32 v247, 0x3f800000
    s_nop 0
    v_cndmask_b32 v250, v250, v247, vcc
    v_accvgpr_write_b32 a250, v250
    v_mov_b32 v250, 0
    v_cmp_eq_u32 vcc, 4, v244
    v_mov_b32 v247, 0x3f80
    s_nop 0
    v_cndmask_b32 v250, v250, v247, vcc
    v_cmp_eq_u32 vcc, 5, v244
    v_mov_b32 v247, 0x3f800000
    s_nop 0
    v_cndmask_b32 v250, v250, v247, vcc
    v_accvgpr_write_b32 a242, v250
    v_mov_b32 v250, 0
    v_cmp_eq_u32 vcc, 6, v244
    v_mov_b32 v247, 0x3f80
    s_nop 0
    v_cndmask_b32 v250, v250, v247, vcc
    v_cmp_eq_u32 vcc, 7, v244
    v_mov_b32 v247, 0x3f800000
    s_nop 0
    v_cndmask_b32 v250, v250, v247, vcc
    v_accvgpr_write_b32 a247, v250
    v_mov_b32 v250, 0
    v_cmp_eq_u32 vcc, 14, v244
    v_mov_b32 v247, 0x3f80
    s_nop 0
    v_cndmask_b32 v250, v250, v247, vcc
    v_cmp_eq_u32 vcc, 15, v244
    v_mov_b32 v247, 0x3f800000
    s_nop 0
    v_cndmask_b32 v250, v250, v247, vcc
    v_accvgpr_write_b32 a251, v250
    v_mov_b32 v250, 0
    v_cmp_eq_u32 vcc, 12, v244
    v_mov_b32 v247, 0x3f80
    s_nop 0
    v_cndmask_b32 v250, v250, v247, vcc
    v_cmp_eq_u32 vcc, 13, v244
    v_mov_b32 v247, 0x3f800000
    s_nop 0
    v_cndmask_b32 v250, v250, v247, vcc
    v_accvgpr_write_b32 a243, v250
    v_accvgpr_write_b32 a252, -1
    v_accvgpr_write_b32 a253, -1
    v_accvgpr_write_b32 a254, -1
    v_accvgpr_write_b32 a255, -1
    s_add_u32 s35, s14, 0
    s_and_b32 s35, s35, 3
    s_mul_i32 s35, s35, 2560
    s_add_u32 s8, s35, 12288
    s_add_u32 s35, s14, 1
    s_and_b32 s35, s35, 3
    s_mul_i32 s35, s35, 2560
    s_add_u32 s9, s35, 12288
    s_add_u32 s35, s14, 2
    s_and_b32 s35, s35, 3
    s_mul_i32 s35, s35, 2560
    s_add_u32 s10, s35, 12288
    s_add_u32 s35, s14, 3
    s_and_b32 s35, s35, 3
    s_mul_i32 s35, s35, 2560
    s_add_u32 s11, s35, 12288
    s_mov_b32 s50, -1
    s_mov_b32 s51, 0
    v_lshrrev_b32 v247, 2, v244
    v_lshl_add_u32 v247, v245, 2, v247
    v_mul_u32_u24 v247, 96, v247
    v_and_b32 v249, 3, v244
    v_mul_u32_u24 v249, 24, v249
    v_add3_u32 v247, v247, v249, s27
    v_mov_b32 v20, v247
    v_add_u32 v20, 61440, v20
    s_waitcnt vmcnt(0)
    ds_read_b64_tr_b16 v[136:137], v20 offset:0
    ds_read_b64_tr_b16 v[138:139], v20 offset:1536
    ds_read_b64_tr_b16 v[140:141], v20 offset:3072
    ds_read_b64_tr_b16 v[142:143], v20 offset:4608
    ds_read_b64_tr_b16 v[144:145], v20 offset:6144
    ds_read_b64_tr_b16 v[146:147], v20 offset:7680
    ds_read_b64_tr_b16 v[148:149], v20 offset:9216
    ds_read_b64_tr_b16 v[150:151], v20 offset:10752
    ds_read_b64_tr_b16 v[152:153], v20 offset:12288
    ds_read_b64_tr_b16 v[154:155], v20 offset:13824
    s_waitcnt lgkmcnt(0)
    ds_read_b64_tr_b16 v[156:157], v20 offset:8
    ds_read_b64_tr_b16 v[158:159], v20 offset:1544
    ds_read_b64_tr_b16 v[160:161], v20 offset:3080
    ds_read_b64_tr_b16 v[162:163], v20 offset:4616
    ds_read_b64_tr_b16 v[164:165], v20 offset:6152
    ds_read_b64_tr_b16 v[166:167], v20 offset:7688
    ds_read_b64_tr_b16 v[168:169], v20 offset:9224
    ds_read_b64_tr_b16 v[170:171], v20 offset:10760
    ds_read_b64_tr_b16 v[172:173], v20 offset:12296
    ds_read_b64_tr_b16 v[174:175], v20 offset:13832
    s_waitcnt lgkmcnt(0)
    ds_read_b64_tr_b16 v[176:177], v20 offset:16
    ds_read_b64_tr_b16 v[178:179], v20 offset:1552
    ds_read_b64_tr_b16 v[180:181], v20 offset:3088
    ds_read_b64_tr_b16 v[182:183], v20 offset:4624
    ds_read_b64_tr_b16 v[184:185], v20 offset:6160
    ds_read_b64_tr_b16 v[186:187], v20 offset:7696
    ds_read_b64_tr_b16 v[188:189], v20 offset:9232
    ds_read_b64_tr_b16 v[190:191], v20 offset:10768
    ds_read_b64_tr_b16 v[192:193], v20 offset:12304
    ds_read_b64_tr_b16 v[194:195], v20 offset:13840
    s_waitcnt lgkmcnt(0)
    v_subrev_u32 v20, 61440, v20
    s_barrier
    v_add_u32 v129, s81, v0
    v_add_u32 v129, 0, v129
    v_mul_u32_u24 v130, 0xba3, v129
    v_lshrrev_b32 v130, 16, v130
    v_mul_u32_u24 v131, 22, v130
    v_sub_u32 v131, v129, v131
    v_min_u32 v131, 19, v131
    v_mul_u32_u24 v130, 1280, v130
    v_lshl_add_u32 v130, v131, 4, v130
    s_add_u32 m0, s82, 61440
    s_nop 0
    buffer_load_dwordx4 v130, s[76:79], s80 offen lds
    v_add_u32 v129, s81, v0
    v_add_u32 v129, 256, v129
    v_mul_u32_u24 v130, 0xba3, v129
    v_lshrrev_b32 v130, 16, v130
    v_mul_u32_u24 v131, 22, v130
    v_sub_u32 v131, v129, v131
    v_min_u32 v131, 19, v131
    v_mul_u32_u24 v130, 1280, v130
    v_lshl_add_u32 v130, v131, 4, v130
    s_add_u32 m0, s82, 65536
    s_nop 0
    buffer_load_dwordx4 v130, s[76:79], s80 offen lds
    v_add_u32 v129, s81, v0
    v_add_u32 v129, 512, v129
    v_mul_u32_u24 v130, 0xba3, v129
    v_lshrrev_b32 v130, 16, v130
    v_mul_u32_u24 v131, 22, v130
    v_sub_u32 v131, v129, v131
    v_min_u32 v131, 19, v131
    v_mul_u32_u24 v130, 1280, v130
    v_lshl_add_u32 v130, v131, 4, v130
    s_add_u32 m0, s82, 69632
    s_nop 0
    buffer_load_dwordx4 v130, s[76:79], s80 offen lds
    v_add_u32 v129, s81, v0
    v_add_u32 v129, 768, v129
    v_mul_u32_u24 v130, 0xba3, v129
    v_lshrrev_b32 v130, 16, v130
    v_mul_u32_u24 v131, 22, v130
    v_sub_u32 v131, v129, v131
    v_min_u32 v131, 19, v131
    v_mul_u32_u24 v130, 1280, v130
    v_lshl_add_u32 v130, v131, 4, v130
    s_add_u32 m0, s82, 73728
    s_nop 0
    buffer_load_dwordx4 v130, s[76:79], s80 offen lds
    v_add_u32 v129, s81, v0
    v_add_u32 v129, 1024, v129
    v_mul_u32_u24 v130, 0xba3, v129
    v_lshrrev_b32 v130, 16, v130
    v_mul_u32_u24 v131, 22, v130
    v_sub_u32 v131, v129, v131
    v_min_u32 v131, 19, v131
    v_mul_u32_u24 v130, 1280, v130
    v_lshl_add_u32 v130, v131, 4, v130
    s_add_u32 m0, s82, 77824
    s_nop 0
    buffer_load_dwordx4 v130, s[76:79], s80 offen lds
    v_add_u32 v129, s81, v0
    v_add_u32 v129, 1280, v129
    v_mul_u32_u24 v130, 0xba3, v129
    v_lshrrev_b32 v130, 16, v130
    v_mul_u32_u24 v131, 22, v130
    v_sub_u32 v131, v129, v131
    v_min_u32 v131, 19, v131
    v_mul_u32_u24 v130, 1280, v130
    v_lshl_add_u32 v130, v131, 4, v130
    s_add_u32 m0, s82, 81920
    s_nop 0
    buffer_load_dwordx4 v130, s[76:79], s80 offen lds
    v_add_u32 v129, s81, v0
    v_add_u32 v129, 1536, v129
    v_mul_u32_u24 v130, 0xba3, v129
    v_lshrrev_b32 v130, 16, v130
    v_mul_u32_u24 v131, 22, v130
    v_sub_u32 v131, v129, v131
    v_min_u32 v131, 19, v131
    v_mul_u32_u24 v130, 1280, v130
    v_lshl_add_u32 v130, v131, 4, v130
    s_add_u32 m0, s82, 86016
    s_nop 0
    buffer_load_dwordx4 v130, s[76:79], s80 offen lds
    v_add_u32 v129, s81, v0
    v_add_u32 v129, 1792, v129
    v_mul_u32_u24 v130, 0xba3, v129
    v_lshrrev_b32 v130, 16, v130
    v_mul_u32_u24 v131, 22, v130
    v_sub_u32 v131, v129, v131
    v_min_u32 v131, 19, v131
    v_mul_u32_u24 v130, 1280, v130
    v_lshl_add_u32 v130, v131, 4, v130
    s_add_u32 m0, s82, 90112
    s_nop 0
    buffer_load_dwordx4 v130, s[76:79], s80 offen lds
    v_add_u32 v129, s81, v0
    v_add_u32 v129, 2048, v129
    v_mul_u32_u24 v130, 0xba3, v129
    v_lshrrev_b32 v130, 16, v130
    v_mul_u32_u24 v131, 22, v130
    v_sub_u32 v131, v129, v131
    v_min_u32 v131, 19, v131
    v_mul_u32_u24 v130, 1280, v130
    v_lshl_add_u32 v130, v131, 4, v130
    s_add_u32 m0, s82, 94208
    s_nop 0
    buffer_load_dwordx4 v130, s[76:79], s80 offen lds
    v_add_u32 v129, s81, v0
    v_add_u32 v129, 2304, v129
    v_mul_u32_u24 v130, 0xba3, v129
    v_lshrrev_b32 v130, 16, v130
    v_mul_u32_u24 v131, 22, v130
    v_sub_u32 v131, v129, v131
    v_min_u32 v131, 19, v131
    v_mul_u32_u24 v130, 1280, v130
    v_lshl_add_u32 v130, v131, 4, v130
    s_add_u32 m0, s82, 98304
    s_nop 0
    buffer_load_dwordx4 v130, s[76:79], s80 offen lds
    v_add_u32 v129, s81, v0
    v_add_u32 v129, 2560, v129
    v_mul_u32_u24 v130, 0xba3, v129
    v_lshrrev_b32 v130, 16, v130
    v_mul_u32_u24 v131, 22, v130
    v_sub_u32 v131, v129, v131
    v_min_u32 v131, 19, v131
    v_mul_u32_u24 v130, 1280, v130
    v_lshl_add_u32 v130, v131, 4, v130
    s_add_u32 m0, s82, 102400
    s_nop 0
    buffer_load_dwordx4 v130, s[76:79], s80 offen lds
    v_add_u32 v129, s81, v0
    v_add_u32 v129, 2816, v129
    v_mul_u32_u24 v130, 0xba3, v129
    v_lshrrev_b32 v130, 16, v130
    v_mul_u32_u24 v131, 22, v130
    v_sub_u32 v131, v129, v131
    v_min_u32 v131, 19, v131
    v_mul_u32_u24 v130, 1280, v130
    v_lshl_add_u32 v130, v131, 4, v130
    s_add_u32 m0, s82, 106496
    s_nop 0
    buffer_load_dwordx4 v130, s[76:79], s80 offen lds
    v_add_u32 v129, s81, v0
    v_add_u32 v129, 3072, v129
    v_mul_u32_u24 v130, 0xba3, v129
    v_lshrrev_b32 v130, 16, v130
    v_mul_u32_u24 v131, 22, v130
    v_sub_u32 v131, v129, v131
    v_min_u32 v131, 19, v131
    v_mul_u32_u24 v130, 1280, v130
    v_lshl_add_u32 v130, v131, 4, v130
    s_add_u32 m0, s82, 110592
    s_nop 0
    buffer_load_dwordx4 v130, s[76:79], s80 offen lds
    v_add_u32 v129, s81, v0
    v_add_u32 v129, 3328, v129
    v_mul_u32_u24 v130, 0xba3, v129
    v_lshrrev_b32 v130, 16, v130
    v_mul_u32_u24 v131, 22, v130
    v_sub_u32 v131, v129, v131
    v_min_u32 v131, 19, v131
    v_mul_u32_u24 v130, 1280, v130
    v_lshl_add_u32 v130, v131, 4, v130
    s_add_u32 m0, s82, 114688
    s_nop 0
    buffer_load_dwordx4 v130, s[76:79], s80 offen lds
    v_add_u32 v129, s81, v0
    v_add_u32 v129, 3584, v129
    v_mul_u32_u24 v130, 0xba3, v129
    v_lshrrev_b32 v130, 16, v130
    v_mul_u32_u24 v131, 22, v130
    v_sub_u32 v131, v129, v131
    v_min_u32 v131, 19, v131
    v_mul_u32_u24 v130, 1280, v130
    v_lshl_add_u32 v130, v131, 4, v130
    s_add_u32 m0, s82, 118784
    s_nop 0
    buffer_load_dwordx4 v130, s[76:79], s80 offen lds
    v_add_u32 v129, s81, v0
    v_add_u32 v129, 3840, v129
    v_mul_u32_u24 v130, 0xba3, v129
    v_lshrrev_b32 v130, 16, v130
    v_mul_u32_u24 v131, 22, v130
    v_sub_u32 v131, v129, v131
    v_min_u32 v131, 19, v131
    v_mul_u32_u24 v130, 1280, v130
    v_lshl_add_u32 v130, v131, 4, v130
    s_add_u32 m0, s82, 122880
    s_nop 0
    buffer_load_dwordx4 v130, s[76:79], s80 offen lds
    v_add_u32 v129, s81, v0
    v_add_u32 v129, 4096, v129
    v_mul_u32_u24 v130, 0xba3, v129
    v_lshrrev_b32 v130, 16, v130
    v_mul_u32_u24 v131, 22, v130
    v_sub_u32 v131, v129, v131
    v_min_u32 v131, 19, v131
    v_mul_u32_u24 v130, 1280, v130
    v_lshl_add_u32 v130, v131, 4, v130
    s_add_u32 m0, s82, 126976
    s_nop 0
    buffer_load_dwordx4 v130, s[76:79], s80 offen lds
    s_waitcnt vmcnt(0)
    s_barrier
    s_add_u32 s32, s66, s34
    s_addc_u32 s33, s67, 0
    s_add_u32 m0, s27, 0
    s_nop 0
    global_load_lds_dwordx4 v132, s[32:33]
    s_add_u32 m0, s27, 1024
    s_nop 0
    global_load_lds_dwordx4 v133, s[32:33]
    s_add_u32 m0, s27, 2048
    s_nop 0
    global_load_lds_dwordx4 v134, s[32:33]
    s_add_u32 s32, s32, 393216
    s_addc_u32 s33, s33, 0
    s_add_u32 m0, s27, 3072
    s_nop 0
    global_load_lds_dwordx4 v132, s[32:33]
    s_add_u32 m0, s27, 4096
    s_nop 0
    global_load_lds_dwordx4 v133, s[32:33]
    s_add_u32 m0, s27, 5120
    s_nop 0
    global_load_lds_dwordx4 v134, s[32:33]
    s_add_u32 s32, s32, 393216
    s_addc_u32 s33, s33, 0
    s_add_u32 m0, s27, 6144
    s_nop 0
    global_load_lds_dwordx4 v132, s[32:33]
    s_add_u32 m0, s27, 7168
    s_nop 0
    global_load_lds_dwordx4 v133, s[32:33]
    s_add_u32 m0, s27, 8192
    s_nop 0
    global_load_lds_dwordx4 v134, s[32:33]
    s_add_u32 s32, s32, 393216
    s_addc_u32 s33, s33, 0
    s_add_u32 m0, s27, 9216
    s_nop 0
    global_load_lds_dwordx4 v132, s[32:33]
    s_add_u32 m0, s27, 10240
    s_nop 0
    global_load_lds_dwordx4 v133, s[32:33]
    s_add_u32 m0, s27, 11264
    s_nop 0
    global_load_lds_dwordx4 v134, s[32:33]
    s_add_u32 s32, s32, 393216
    s_addc_u32 s33, s33, 0
    s_add_u32 m0, s27, 12288
    s_nop 0
    global_load_lds_dwordx4 v132, s[32:33]
    s_add_u32 m0, s27, 13312
    s_nop 0
    global_load_lds_dwordx4 v133, s[32:33]
    s_add_u32 m0, s27, 14336
    s_nop 0
    global_load_lds_dwordx4 v134, s[32:33]
    s_call_b64 s[12:13], Lbc0_50001
    v_mov_b32 v124, 32
    s_mov_b64 exec, 1
    s_nop 0
Lwp_50003:
    buffer_load_dword v125, v124, s[56:59], 0 offen sc1
    s_waitcnt vmcnt(0)
    v_cmp_gt_u32 vcc, 32, v125
    s_nop 0
    s_cbranch_vccz Lwpd_50004
    s_sleep 4
    s_add_u32 s30, s30, 1
    s_cmp_lt_u32 s30, s31
    s_cbranch_scc1 Lwp_50003
Lwpd_50004:
    s_mov_b64 exec, -1
    s_waitcnt vmcnt(0)
    s_barrier
    s_cmp_lg_u32 s14, 0
    s_cbranch_scc1 Lar_50005
    v_mov_b32 v123, 1
    s_mov_b64 exec, 1
    s_cmp_lg_u32 s3, 0
    s_cbranch_scc1 Lls_50006
    buffer_store_dword v123, v122, s[4:7], 0 offen offset:0
Lle_50007:
    s_mov_b64 exec, -1
Lar_50005:
    buffer_load_dwordx4 v[24:27], v120, s[72:75], s83 offen offset:0
    buffer_load_dwordx4 v[28:31], v120, s[72:75], s83 offen offset:64
    buffer_load_dwordx4 v[32:35], v120, s[72:75], s83 offen offset:128
    buffer_load_dwordx4 v[36:39], v120, s[72:75], s83 offen offset:192
    buffer_load_dwordx4 v[40:43], v120, s[72:75], s83 offen offset:256
    buffer_load_dwordx4 v[44:47], v120, s[72:75], s83 offen offset:320
    s_add_u32 s83, s83, 196608
    buffer_load_dwordx4 v[48:51], v120, s[72:75], s83 offen offset:0
    buffer_load_dwordx4 v[52:55], v120, s[72:75], s83 offen offset:64
    buffer_load_dwordx4 v[56:59], v120, s[72:75], s83 offen offset:128
    buffer_load_dwordx4 v[60:63], v120, s[72:75], s83 offen offset:192
    buffer_load_dwordx4 v[64:67], v120, s[72:75], s83 offen offset:256
    buffer_load_dwordx4 v[68:71], v120, s[72:75], s83 offen offset:320
    s_add_u32 s83, s83, 196608
    s_call_b64 s[12:13], Lbc1_50002
    v_add_u32 v124, 0, v128
    s_nop 1
Lwp_50008:
    buffer_load_dword v125, v124, s[4:7], 0 offen sc1
    s_waitcnt vmcnt(0)
    v_cmp_gt_u32 vcc, 1, v125
    s_nop 0
    s_cbranch_vccz Lwpd_50009
    s_sleep 1
    s_add_u32 s30, s30, 1
    s_cmp_lt_u32 s30, s31
    s_cbranch_scc1 Lwp_50008
Lwpd_50009:
    s_add_u32 s35, s14, 0
    s_and_b32 s35, s35, 3
    s_add_u32 s35, s35, 0
    s_mul_i32 s35, s35, 1310720
    s_add_u32 s35, s35, 138412032
    buffer_load_dwordx4 a[0:3], v9, s[4:7], s35 offen sc1
    buffer_load_dwordx4 a[80:83], v18, s[4:7], s35 offen sc1
    buffer_load_dwordx4 a[160:163], v19, s[4:7], s35 offen sc1
    s_add_u32 s35, s14, 1
    s_and_b32 s35, s35, 3
    s_add_u32 s35, s35, 0
    s_mul_i32 s35, s35, 1310720
    s_add_u32 s35, s35, 138412032
    buffer_load_dwordx4 a[20:23], v9, s[4:7], s35 offen sc1
    buffer_load_dwordx4 a[100:103], v18, s[4:7], s35 offen sc1
    buffer_load_dwordx4 a[180:183], v19, s[4:7], s35 offen sc1
    s_add_u32 s35, s14, 2
    s_and_b32 s35, s35, 3
    s_add_u32 s35, s35, 0
    s_mul_i32 s35, s35, 1310720
    s_add_u32 s35, s35, 138412032
    buffer_load_dwordx4 a[40:43], v9, s[4:7], s35 offen sc1
    buffer_load_dwordx4 a[120:123], v18, s[4:7], s35 offen sc1
    buffer_load_dwordx4 a[200:203], v19, s[4:7], s35 offen sc1
    s_add_u32 s35, s14, 3
    s_and_b32 s35, s35, 3
    s_add_u32 s35, s35, 0
    s_mul_i32 s35, s35, 1310720
    s_add_u32 s35, s35, 138412032
    buffer_load_dwordx4 a[60:63], v9, s[4:7], s35 offen sc1
    buffer_load_dwordx4 a[140:143], v18, s[4:7], s35 offen sc1
    buffer_load_dwordx4 a[220:223], v19, s[4:7], s35 offen sc1
    s_waitcnt vmcnt(0)
    s_barrier
    s_cmp_lg_u32 s14, 0
    s_cbranch_scc1 Lar_50010
    v_mov_b32 v123, 1
    s_mov_b64 exec, 1
    s_cmp_lg_u32 s3, 0
    s_cbranch_scc1 Lls_50011
    buffer_store_dword v123, v122, s[4:7], 0 offen offset:128
Lle_50012:
    s_mov_b64 exec, -1
Lar_50010:
    buffer_load_dwordx4 v[72:75], v120, s[72:75], s83 offen offset:0
    buffer_load_dwordx4 v[76:79], v120, s[72:75], s83 offen offset:64
    buffer_load_dwordx4 v[80:83], v120, s[72:75], s83 offen offset:128
    buffer_load_dwordx4 v[84:87], v120, s[72:75], s83 offen offset:192
    buffer_load_dwordx4 v[88:91], v120, s[72:75], s83 offen offset:256
    buffer_load_dwordx4 v[92:95], v120, s[72:75], s83 offen offset:320
    s_add_u32 s83, s83, 196608
    buffer_load_dwordx4 v[96:99], v120, s[72:75], s83 offen offset:0
    buffer_load_dwordx4 v[100:103], v120, s[72:75], s83 offen offset:64
    buffer_load_dwordx4 v[104:107], v120, s[72:75], s83 offen offset:128
    buffer_load_dwordx4 v[108:111], v120, s[72:75], s83 offen offset:192
    buffer_load_dwordx4 v[112:115], v120, s[72:75], s83 offen offset:256
    buffer_load_dwordx4 v[116:119], v120, s[72:75], s83 offen offset:320
    s_add_u32 s83, s83, 196608
    v_add_u32 v124, 128, v128
    s_nop 1
Lwp_50013:
    buffer_load_dword v125, v124, s[4:7], 0 offen sc1
    s_waitcnt vmcnt(0)
    v_cmp_gt_u32 vcc, 1, v125
    s_nop 0
    s_cbranch_vccz Lwpd_50014
    s_sleep 1
    s_add_u32 s30, s30, 1
    s_cmp_lt_u32 s30, s31
    s_cbranch_scc1 Lwp_50013
Lwpd_50014:
    s_add_u32 s35, s14, 0
    s_and_b32 s35, s35, 3
    s_add_u32 s35, s35, 4
    s_mul_i32 s35, s35, 1310720
    s_add_u32 s35, s35, 138412032
    buffer_load_dwordx4 a[4:7], v9, s[4:7], s35 offen sc1
    buffer_load_dwordx4 a[84:87], v18, s[4:7], s35 offen sc1
    buffer_load_dwordx4 a[164:167], v19, s[4:7], s35 offen sc1
    s_add_u32 s35, s14, 1
    s_and_b32 s35, s35, 3
    s_add_u32 s35, s35, 4
    s_mul_i32 s35, s35, 1310720
    s_add_u32 s35, s35, 138412032
    buffer_load_dwordx4 a[24:27], v9, s[4:7], s35 offen sc1
    buffer_load_dwordx4 a[104:107], v18, s[4:7], s35 offen sc1
    buffer_load_dwordx4 a[184:187], v19, s[4:7], s35 offen sc1
    s_add_u32 s35, s14, 2
    s_and_b32 s35, s35, 3
    s_add_u32 s35, s35, 4
    s_mul_i32 s35, s35, 1310720
    s_add_u32 s35, s35, 138412032
    buffer_load_dwordx4 a[44:47], v9, s[4:7], s35 offen sc1
    buffer_load_dwordx4 a[124:127], v18, s[4:7], s35 offen sc1
    buffer_load_dwordx4 a[204:207], v19, s[4:7], s35 offen sc1
    s_add_u32 s35, s14, 3
    s_and_b32 s35, s35, 3
    s_add_u32 s35, s35, 4
    s_mul_i32 s35, s35, 1310720
    s_add_u32 s35, s35, 138412032
    buffer_load_dwordx4 a[64:67], v9, s[4:7], s35 offen sc1
    buffer_load_dwordx4 a[144:147], v18, s[4:7], s35 offen sc1
    buffer_load_dwordx4 a[224:227], v19, s[4:7], s35 offen sc1
    s_call_b64 s[12:13], Lbc0_50001
    s_waitcnt vmcnt(0)
    s_barrier
    s_cmp_lg_u32 s14, 0
    s_cbranch_scc1 Lar_50015
    v_mov_b32 v123, 1
    s_mov_b64 exec, 1
    s_cmp_lg_u32 s3, 0
    s_cbranch_scc1 Lls_50016
    buffer_store_dword v123, v122, s[4:7], 0 offen offset:256
Lle_50017:
    s_mov_b64 exec, -1
Lar_50015:
    buffer_load_dwordx4 v[24:27], v120, s[72:75], s83 offen offset:0
    buffer_load_dwordx4 v[28:31], v120, s[72:75], s83 offen offset:64
    buffer_load_dwordx4 v[32:35], v120, s[72:75], s83 offen offset:128
    buffer_load_dwordx4 v[36:39], v120, s[72:75], s83 offen offset:192
    buffer_load_dwordx4 v[40:43], v120, s[72:75], s83 offen offset:256
    buffer_load_dwordx4 v[44:47], v120, s[72:75], s83 offen offset:320
    s_add_u32 s83, s83, 196608
    buffer_load_dwordx4 v[48:51], v120, s[72:75], s83 offen offset:0
    buffer_load_dwordx4 v[52:55], v120, s[72:75], s83 offen offset:64
    buffer_load_dwordx4 v[56:59], v120, s[72:75], s83 offen offset:128
    buffer_load_dwordx4 v[60:63], v120, s[72:75], s83 offen offset:192
    buffer_load_dwordx4 v[64:67], v120, s[72:75], s83 offen offset:256
    buffer_load_dwordx4 v[68:71], v120, s[72:75], s83 offen offset:320
    s_add_u32 s83, s83, 196608
    v_add_u32 v124, 256, v128
    s_nop 1
Lwp_50018:
    buffer_load_dword v125, v124, s[4:7], 0 offen sc1
    s_waitcnt vmcnt(0)
    v_cmp_gt_u32 vcc, 1, v125
    s_nop 0
    s_cbranch_vccz Lwpd_50019
    s_sleep 1
    s_add_u32 s30, s30, 1
    s_cmp_lt_u32 s30, s31
    s_cbranch_scc1 Lwp_50018
Lwpd_50019:
    s_add_u32 s35, s14, 0
    s_and_b32 s35, s35, 3
    s_add_u32 s35, s35, 0
    s_mul_i32 s35, s35, 1310720
    s_add_u32 s35, s35, 138412032
    buffer_load_dwordx4 a[8:11], v9, s[4:7], s35 offen sc1
    buffer_load_dwordx4 a[88:91], v18, s[4:7], s35 offen sc1
    buffer_load_dwordx4 a[168:171], v19, s[4:7], s35 offen sc1
    s_add_u32 s35, s14, 1
    s_and_b32 s35, s35, 3
    s_add_u32 s35, s35, 0
    s_mul_i32 s35, s35, 1310720
    s_add_u32 s35, s35, 138412032
    buffer_load_dwordx4 a[28:31], v9, s[4:7], s35 offen sc1
    buffer_load_dwordx4 a[108:111], v18, s[4:7], s35 offen sc1
    buffer_load_dwordx4 a[188:191], v19, s[4:7], s35 offen sc1
    s_add_u32 s35, s14, 2
    s_and_b32 s35, s35, 3
    s_add_u32 s35, s35, 0
    s_mul_i32 s35, s35, 1310720
    s_add_u32 s35, s35, 138412032
    buffer_load_dwordx4 a[48:51], v9, s[4:7], s35 offen sc1
    buffer_load_dwordx4 a[128:131], v18, s[4:7], s35 offen sc1
    buffer_load_dwordx4 a[208:211], v19, s[4:7], s35 offen sc1
    s_add_u32 s35, s14, 3
    s_and_b32 s35, s35, 3
    s_add_u32 s35, s35, 0
    s_mul_i32 s35, s35, 1310720
    s_add_u32 s35, s35, 138412032
    buffer_load_dwordx4 a[68:71], v9, s[4:7], s35 offen sc1
    buffer_load_dwordx4 a[148:151], v18, s[4:7], s35 offen sc1
    buffer_load_dwordx4 a[228:231], v19, s[4:7], s35 offen sc1
    s_call_b64 s[12:13], Lbc1_50002
    s_waitcnt vmcnt(0)
    s_barrier
    s_cmp_lg_u32 s14, 0
    s_cbranch_scc1 Lar_50020
    v_mov_b32 v123, 1
    s_mov_b64 exec, 1
    s_cmp_lg_u32 s3, 0
    s_cbranch_scc1 Lls_50021
    buffer_store_dword v123, v122, s[4:7], 0 offen offset:384
Lle_50022:
    s_mov_b64 exec, -1
Lar_50020:
    v_add_u32 v124, 384, v128
    s_nop 1
Lwp_50023:
    buffer_load_dword v125, v124, s[4:7], 0 offen sc1
    s_waitcnt vmcnt(0)
    v_cmp_gt_u32 vcc, 1, v125
    s_nop 0
    s_cbranch_vccz Lwpd_50024
    s_sleep 1
    s_add_u32 s30, s30, 1
    s_cmp_lt_u32 s30, s31
    s_cbranch_scc1 Lwp_50023
Lwpd_50024:
    s_add_u32 s35, s14, 0
    s_and_b32 s35, s35, 3
    s_add_u32 s35, s35, 4
    s_mul_i32 s35, s35, 1310720
    s_add_u32 s35, s35, 138412032
    buffer_load_dwordx4 a[12:15], v9, s[4:7], s35 offen sc1
    buffer_load_dwordx4 a[92:95], v18, s[4:7], s35 offen sc1
    buffer_load_dwordx4 a[172:175], v19, s[4:7], s35 offen sc1
    s_add_u32 s35, s14, 1
    s_and_b32 s35, s35, 3
    s_add_u32 s35, s35, 4
    s_mul_i32 s35, s35, 1310720
    s_add_u32 s35, s35, 138412032
    buffer_load_dwordx4 a[32:35], v9, s[4:7], s35 offen sc1
    buffer_load_dwordx4 a[112:115], v18, s[4:7], s35 offen sc1
    buffer_load_dwordx4 a[192:195], v19, s[4:7], s35 offen sc1
    s_add_u32 s35, s14, 2
    s_and_b32 s35, s35, 3
    s_add_u32 s35, s35, 4
    s_mul_i32 s35, s35, 1310720
    s_add_u32 s35, s35, 138412032
    buffer_load_dwordx4 a[52:55], v9, s[4:7], s35 offen sc1
    buffer_load_dwordx4 a[132:135], v18, s[4:7], s35 offen sc1
    buffer_load_dwordx4 a[212:215], v19, s[4:7], s35 offen sc1
    s_add_u32 s35, s14, 3
    s_and_b32 s35, s35, 3
    s_add_u32 s35, s35, 4
    s_mul_i32 s35, s35, 1310720
    s_add_u32 s35, s35, 138412032
    buffer_load_dwordx4 a[72:75], v9, s[4:7], s35 offen sc1
    buffer_load_dwordx4 a[152:155], v18, s[4:7], s35 offen sc1
    buffer_load_dwordx4 a[232:235], v19, s[4:7], s35 offen sc1
    s_call_b64 s[12:13], Lbc0_50001
    s_waitcnt vmcnt(0)
    s_barrier
    s_cmp_lg_u32 s14, 0
    s_cbranch_scc1 Lar_50025
    v_mov_b32 v123, 1
    s_mov_b64 exec, 1
    s_cmp_lg_u32 s3, 0
    s_cbranch_scc1 Lls_50026
    buffer_store_dword v123, v122, s[4:7], 0 offen offset:512
Lle_50027:
    s_mov_b64 exec, -1
Lar_50025:
    ds_read_b64_tr_b16 v[196:197], v20 offset:0
    ds_read_b64_tr_b16 v[198:199], v20 offset:1536
    ds_read_b64_tr_b16 v[200:201], v20 offset:3072
    ds_read_b64_tr_b16 v[202:203], v20 offset:4608
    ds_read_b64_tr_b16 v[204:205], v20 offset:6144
    ds_read_b64_tr_b16 v[206:207], v20 offset:7680
    ds_read_b64_tr_b16 v[208:209], v20 offset:9216
    ds_read_b64_tr_b16 v[210:211], v20 offset:10752
    ds_read_b64_tr_b16 v[212:213], v20 offset:12288
    ds_read_b64_tr_b16 v[214:215], v20 offset:13824
    s_waitcnt lgkmcnt(0)
    ds_read_b64_tr_b16 v[216:217], v20 offset:8
    ds_read_b64_tr_b16 v[218:219], v20 offset:1544
    ds_read_b64_tr_b16 v[220:221], v20 offset:3080
    ds_read_b64_tr_b16 v[222:223], v20 offset:4616
    ds_read_b64_tr_b16 v[224:225], v20 offset:6152
    ds_read_b64_tr_b16 v[226:227], v20 offset:7688
    ds_read_b64_tr_b16 v[228:229], v20 offset:9224
    ds_read_b64_tr_b16 v[230:231], v20 offset:10760
    ds_read_b64_tr_b16 v[232:233], v20 offset:12296
    ds_read_b64_tr_b16 v[234:235], v20 offset:13832
    s_waitcnt lgkmcnt(0)
    ds_read_b64_tr_b16 v[236:237], v20 offset:16
    ds_read_b64_tr_b16 v[238:239], v20 offset:1552
    ds_read_b64_tr_b16 v[240:241], v20 offset:3088
    ds_read_b64_tr_b16 v[242:243], v20 offset:4624
    ds_read_b64_tr_b16 v[244:245], v20 offset:6160
    ds_read_b64_tr_b16 v[246:247], v20 offset:7696
    ds_read_b64_tr_b16 v[248:249], v20 offset:9232
    ds_read_b64_tr_b16 v[250:251], v20 offset:10768
    ds_read_b64_tr_b16 v[252:253], v20 offset:12304
    ds_read_b64_tr_b16 v[254:255], v20 offset:13840
    s_waitcnt lgkmcnt(0)
    v_add_u32 v124, 512, v128
    s_nop 1
Lwp_50028:
    buffer_load_dword v125, v124, s[4:7], 0 offen sc1
    s_waitcnt vmcnt(0)
    v_cmp_gt_u32 vcc, 1, v125
    s_nop 0
    s_cbranch_vccz Lwpd_50029
    s_sleep 1
    s_add_u32 s30, s30, 1
    s_cmp_lt_u32 s30, s31
    s_cbranch_scc1 Lwp_50028
Lwpd_50029:
    s_add_u32 s35, s14, 0
    s_and_b32 s35, s35, 3
    s_add_u32 s35, s35, 0
    s_mul_i32 s35, s35, 1310720
    s_add_u32 s35, s35, 138412032
    buffer_load_dwordx4 a[16:19], v9, s[4:7], s35 offen sc1
    buffer_load_dwordx4 a[96:99], v18, s[4:7], s35 offen sc1
    buffer_load_dwordx4 a[176:179], v19, s[4:7], s35 offen sc1
    s_add_u32 s35, s14, 1
    s_and_b32 s35, s35, 3
    s_add_u32 s35, s35, 0
    s_mul_i32 s35, s35, 1310720
    s_add_u32 s35, s35, 138412032
    buffer_load_dwordx4 a[36:39], v9, s[4:7], s35 offen sc1
    buffer_load_dwordx4 a[116:119], v18, s[4:7], s35 offen sc1
    buffer_load_dwordx4 a[196:199], v19, s[4:7], s35 offen sc1
    s_add_u32 s35, s14, 2
    s_and_b32 s35, s35, 3
    s_add_u32 s35, s35, 0
    s_mul_i32 s35, s35, 1310720
    s_add_u32 s35, s35, 138412032
    buffer_load_dwordx4 a[56:59], v9, s[4:7], s35 offen sc1
    buffer_load_dwordx4 a[136:139], v18, s[4:7], s35 offen sc1
    buffer_load_dwordx4 a[216:219], v19, s[4:7], s35 offen sc1
    s_add_u32 s35, s14, 3
    s_and_b32 s35, s35, 3
    s_add_u32 s35, s35, 0
    s_mul_i32 s35, s35, 1310720
    s_add_u32 s35, s35, 138412032
    buffer_load_dwordx4 a[76:79], v9, s[4:7], s35 offen sc1
    buffer_load_dwordx4 a[156:159], v18, s[4:7], s35 offen sc1
    buffer_load_dwordx4 a[236:239], v19, s[4:7], s35 offen sc1
    s_waitcnt vmcnt(0)
    v_mov_b32 v124, 40
    s_nop 1
Lwp_50030:
    buffer_load_dword v125, v124, s[56:59], 0 offen sc1
    s_waitcnt vmcnt(0)
    v_cmp_gt_u32 vcc, 1, v125
    s_nop 0
    s_cbranch_vccz Lwpd_50031
    s_sleep 4
    s_add_u32 s30, s30, 1
    s_cmp_lt_u32 s30, s31
    s_cbranch_scc1 Lwp_50030
Lwpd_50031:
    v_readfirstlane_b32 s44, v125
    s_and_b32 s44, s44, 8192
    s_nop 0
    v_add_u32 v12, s44, v12
    s_add_u32 s90, s90, s44
    s_add_u32 s91, s91, s44
    s_add_u32 s92, s92, s44
    s_add_u32 s93, s93, s44
    s_add_u32 s94, s94, s44
    v_bfe_u32 v18, v0, 3, 1
    v_lshl_add_u32 v18, v18, 3, v4
    v_add_u32 v18, s8, v18
    s_barrier
    s_mov_b32 s17, 0
    s_mov_b32 s52, 4194304
    s_lshl_b32 s34, s15, 7
    s_add_u32 s34, s34, 0xb201000
    v_lshrrev_b32 v80, 2, v3
    v_add_u32 v80, s34, v80
    s_mov_b64 exec, 0xffff
    s_nop 0
Lwp_50032:
    buffer_load_dword v81, v80, s[4:7], 0 offen sc1
    s_waitcnt vmcnt(0)
    v_cmp_gt_u32 vcc, 2, v81
    s_nop 0
    s_cbranch_vccz Lwpd_50033
    s_sleep 2
    s_add_u32 s30, s30, 1
    s_cmp_lt_u32 s30, s31
    s_cbranch_scc1 Lwp_50032
Lwpd_50033:
    s_mov_b64 exec, -1
    buffer_load_dwordx2 v[110:111], v8, s[4:7], s52 offen offset:0 sc1
    buffer_load_dwordx2 v[112:113], v8, s[4:7], s52 offen offset:512 sc1
    buffer_load_dwordx2 v[114:115], v8, s[4:7], s52 offen offset:1024 sc1
    s_add_u32 s55, s90, 192937984
    s_add_u32 s43, s91, 192937984
    s_add_u32 s58, s92, 192937984
    s_add_u32 s59, s93, 192937984
    s_add_u32 s46, s94, 192937984
Lstep_50034:
    buffer_load_dwordx4 v[80:83], v23, s[4:7], s55 offen sc1
    buffer_load_dwordx4 v[84:87], v23, s[4:7], s43 offen sc1
    buffer_load_dwordx4 v[88:91], v23, s[4:7], s58 offen sc1
    buffer_load_dwordx4 v[92:95], v23, s[4:7], s59 offen sc1
    buffer_load_dwordx4 v[96:99], v23, s[4:7], s46 offen sc1
    s_and_b32 s53, s17, 3
    s_add_u32 s54, s17, 2
    s_and_b32 s54, s54, 3
    s_mul_i32 s56, s53, 81920
    s_add_u32 s56, s56, 191889408
    s_mul_i32 s57, s54, 81920
    s_add_u32 s57, s57, 191889408
    s_add_u32 s60, s17, 1
    s_and_b32 s60, s60, 3
    s_lshl_b32 s60, s60, 18
    s_add_u32 s60, s60, 192937984
    s_add_u32 s61, s17, 3
    s_and_b32 s61, s61, 3
    s_lshl_b32 s61, s61, 18
    s_add_u32 s61, s61, 192937984
    s_mul_i32 s62, s17, 1310720
    s_add_u32 s62, s62, 54525952
    s_add_u32 s63, s62, 40960
    s_sub_u32 s42, s17, 1
    s_min_u32 s42, s42, 64
    s_lshl_b32 s42, s42, 19
    s_add_u32 s42, s42, 201326592
    s_add_u32 s52, s52, 393216
Lma_50035:
    s_waitcnt vmcnt(0)
    v_bitop3_b32 v1, v80, v81, v82 bitop3:0x80
    v_bitop3_b32 v2, v83, v84, v85 bitop3:0x80
    v_bitop3_b32 v1, v1, v86, v87 bitop3:0x80
    v_bitop3_b32 v2, v2, v88, v89 bitop3:0x80
    v_bitop3_b32 v1, v1, v90, v91 bitop3:0x80
    v_bitop3_b32 v2, v2, v92, v93 bitop3:0x80
    v_bitop3_b32 v1, v1, v94, v95 bitop3:0x80
    v_bitop3_b32 v2, v2, v96, v97 bitop3:0x80
    v_bitop3_b32 v1, v1, v98, v99 bitop3:0x80
    v_bitop3_b32 v1, v1, v2, s47 bitop3:0x80
    v_cmp_ne_u32 vcc, s47, v1
    s_cbranch_vccz Lpd_50036
    s_mov_b64 exec, vcc
    buffer_load_dwordx4 v[80:83], v23, s[4:7], s55 offen sc1
    buffer_load_dwordx4 v[84:87], v23, s[4:7], s43 offen sc1
    buffer_load_dwordx4 v[88:91], v23, s[4:7], s58 offen sc1
    buffer_load_dwordx4 v[92:95], v23, s[4:7], s59 offen sc1
    buffer_load_dwordx4 v[96:99], v23, s[4:7], s46 offen sc1
    s_add_u32 s30, s30, 1
    s_cmp_lt_u32 s30, s31
    s_cbranch_scc1 Lma_50035
    s_waitcnt vmcnt(0)
Lpd_50036:
    s_mov_b64 exec, -1
    v_perm_b32 v24, v81, v80, s49
    v_perm_b32 v25, v83, v82, s49
    v_perm_b32 v28, v85, v84, s49
    v_perm_b32 v29, v87, v86, s49
    v_mov_b32_dpp v26, v24 row_ror:8 row_mask:0xf bank_mask:0xf
    v_mov_b32_dpp v27, v25 row_ror:8 row_mask:0xf bank_mask:0xf
    s_nop 1
    v_mfma_f32_16x16x32_bf16 v[56:59], v[196:199], v[24:27], 0
    v_mov_b32_dpp v30, v28 row_ror:8 row_mask:0xf bank_mask:0xf
    v_mov_b32_dpp v31, v29 row_ror:8 row_mask:0xf bank_mask:0xf
    v_mfma_f32_16x16x32_bf16 v[44:47], v[136:139], v[24:27], 0
    v_perm_b32 v32, v89, v88, s49
    v_perm_b32 v33, v91, v90, s49
    v_mfma_f32_16x16x32_bf16 v[56:59], v[200:203], v[28:31], v[56:59]
    v_perm_b32 v36, v93, v92, s49
    v_perm_b32 v37, v95, v94, s49
    v_mfma_f32_16x16x32_bf16 v[44:47], v[140:143], v[28:31], v[44:47]
    v_mov_b32_dpp v34, v32 row_ror:8 row_mask:0xf bank_mask:0xf
    v_mov_b32_dpp v35, v33 row_ror:8 row_mask:0xf bank_mask:0xf
    v_perm_b32 v40, v97, v96, s49
    v_perm_b32 v41, v99, v98, s49
    v_mfma_f32_16x16x32_bf16 v[56:59], v[204:207], v[32:35], v[56:59]
    v_mov_b32_dpp v38, v36 row_ror:8 row_mask:0xf bank_mask:0xf
    v_mov_b32_dpp v39, v37 row_ror:8 row_mask:0xf bank_mask:0xf
    v_mfma_f32_16x16x32_bf16 v[44:47], v[144:147], v[32:35], v[44:47]
    v_mov_b32_dpp v42, v40 row_ror:8 row_mask:0xf bank_mask:0xf
    v_mov_b32_dpp v43, v41 row_ror:8 row_mask:0xf bank_mask:0xf
    ds_write_b64 v18, v[24:25] offset:0
    v_mfma_f32_16x16x32_bf16 v[56:59], v[208:211], v[36:39], v[56:59]
    v_mfma_f32_16x16x32_bf16 v[44:47], v[148:151], v[36:39], v[44:47]
    ds_write_b64 v18, v[28:29] offset:512
    v_mfma_f32_16x16x32_bf16 v[56:59], v[212:215], v[40:43], v[56:59]
    v_mfma_f32_16x16x32_bf16 v[44:47], v[152:155], v[40:43], v[44:47]
    ds_write_b64 v18, v[32:33] offset:1024
    buffer_load_dwordx4 v[116:119], v9, s[4:7], s62 offen sc1
    v_mfma_f32_16x16x32_bf16 v[60:63], v[216:219], v[24:27], 0
    buffer_load_dwordx4 v[120:123], v9, s[4:7], s63 offen sc1
    v_mfma_f32_16x16x32_bf16 v[48:51], v[156:159], v[24:27], 0
    ds_write_b64 v18, v[36:37] offset:1536
    buffer_load_dwordx4 v[124:127], v10, s[4:7], s62 offen sc1
    v_mfma_f32_16x16x32_bf16 v[60:63], v[220:223], v[28:31], v[60:63]
    buffer_load_dwordx4 v[128:131], v10, s[4:7], s63 offen sc1
    s_cmp_eq_u32 s14, 0
    s_cbranch_scc1 Lr0_50037
    s_cmp_eq_u32 s14, 3
    s_cbranch_scc1 Lr3_50038
    v_cvt_pk_bf16_f32 v96, v56, v57
    v_cvt_pk_bf16_f32 v97, v58, v59
    v_mfma_f32_16x16x32_bf16 v[48:51], v[160:163], v[28:31], v[48:51]
    v_cvt_pk_bf16_f32 v132, v44, v45
    v_cvt_pk_bf16_f32 v133, v46, v47
    v_mfma_f32_16x16x32_bf16 v[60:63], v[224:227], v[32:35], v[60:63]
    v_mov_b32_dpp v132, v96 row_shr:8 row_mask:0xf bank_mask:0xc
    v_mov_b32_dpp v133, v97 row_shr:8 row_mask:0xf bank_mask:0xc
    ds_write_b64 v5, v[132:133] offset:0
    v_mfma_f32_16x16x32_bf16 v[48:51], v[164:167], v[32:35], v[48:51]
    v_mfma_f32_16x16x32_bf16 v[60:63], v[228:231], v[36:39], v[60:63]
    ds_write_b64 v18, v[40:41] offset:2048
    v_mfma_f32_16x16x32_bf16 v[48:51], v[168:171], v[36:39], v[48:51]
    s_waitcnt lgkmcnt(1)
    s_barrier
    ds_read_b128 v[80:83], v135 offset:0
    ds_read_b128 v[84:87], v135 offset:16
    v_mfma_f32_16x16x32_bf16 v[60:63], v[232:235], v[40:43], v[60:63]
    v_mfma_f32_16x16x32_bf16 v[48:51], v[172:175], v[40:43], v[48:51]
    v_mfma_f32_16x16x32_bf16 v[64:67], v[236:239], v[24:27], 0
    s_nop 1
    v_mfma_f32_16x16x32_bf16 v[52:55], v[176:179], v[24:27], 0
    s_nop 1
    v_mfma_f32_16x16x32_bf16 v[64:67], v[240:243], v[28:31], v[64:67]
    v_cvt_pk_bf16_f32 v96, v60, v61
    v_cvt_pk_bf16_f32 v97, v62, v63
    v_mfma_f32_16x16x32_bf16 v[52:55], v[180:183], v[28:31], v[52:55]
    v_cvt_pk_bf16_f32 v132, v48, v49
    v_cvt_pk_bf16_f32 v133, v50, v51
    v_mfma_f32_16x16x32_bf16 v[64:67], v[244:247], v[32:35], v[64:67]
    v_mov_b32_dpp v132, v96 row_shr:8 row_mask:0xf bank_mask:0xc
    v_mov_b32_dpp v133, v97 row_shr:8 row_mask:0xf bank_mask:0xc
    ds_write_b64 v5, v[132:133] offset:2048
    v_mfma_f32_16x16x32_bf16 v[52:55], v[184:187], v[32:35], v[52:55]
    s_waitcnt lgkmcnt(1)
    v_mfma_f32_16x16x32_bf16 v[44:47], a[244:247], v[80:83], 0
    v_mfma_f32_16x16x32_bf16 v[64:67], v[248:251], v[36:39], v[64:67]
    v_mfma_f32_16x16x32_bf16 v[44:47], a[248:251], v[84:87], v[44:47]
    v_mfma_f32_16x16x32_bf16 v[52:55], v[188:191], v[36:39], v[52:55]
    s_waitcnt lgkmcnt(0)
    s_barrier
    ds_read_b128 v[88:91], v135 offset:2048
    ds_read_b128 v[92:95], v135 offset:2064
    v_mfma_f32_16x16x32_bf16 v[64:67], v[252:255], v[40:43], v[64:67]
    v_mfma_f32_16x16x32_bf16 v[52:55], v[192:195], v[40:43], v[52:55]
    v_mfma_f32_16x16x32_bf16 v[68:71], v[24:27], a[0:3], 0
    s_nop 0
    v_cvt_pk_bf16_f32 v104, v44, v45
    v_cvt_pk_bf16_f32 v105, v46, v47
    v_mfma_f32_16x16x32_bf16 v[72:75], v[24:27], a[80:83], 0
    s_nop 1
    v_mfma_f32_16x16x32_bf16 v[76:79], v[24:27], a[160:163], 0
    v_cvt_pk_bf16_f32 v96, v64, v65
    v_cvt_pk_bf16_f32 v97, v66, v67
    v_cvt_pk_bf16_f32 v132, v52, v53
    v_cvt_pk_bf16_f32 v133, v54, v55
    s_nop 0
    v_mov_b32_dpp v132, v96 row_shr:8 row_mask:0xf bank_mask:0xc
    v_mov_b32_dpp v133, v97 row_shr:8 row_mask:0xf bank_mask:0xc
    ds_write_b64 v5, v[132:133] offset:4096
    s_waitcnt lgkmcnt(1)
    v_mfma_f32_16x16x32_bf16 v[48:51], a[244:247], v[88:91], 0
    v_mfma_f32_16x16x32_bf16 v[68:71], v[28:31], a[4:7], v[68:71]
    v_mfma_f32_16x16x32_bf16 v[48:51], a[248:251], v[92:95], v[48:51]
    s_waitcnt lgkmcnt(0)
    s_barrier
    ds_read_b128 v[80:83], v135 offset:4096
    ds_read_b128 v[84:87], v135 offset:4112
    v_mfma_f32_16x16x16_bf16 v[64:67], v[110:111], v[104:105], 0
    v_mfma_f32_16x16x32_bf16 v[72:75], v[28:31], a[84:87], v[72:75]
    v_mfma_f32_16x16x32_bf16 v[76:79], v[28:31], a[164:167], v[76:79]
    s_nop 1
    v_cvt_pk_bf16_f32 v106, v48, v49
    v_cvt_pk_bf16_f32 v107, v50, v51
    v_mfma_f32_16x16x32_bf16 v[68:71], v[32:35], a[8:11], v[68:71]
    s_waitcnt lgkmcnt(0)
    v_mfma_f32_16x16x32_bf16 v[52:55], a[244:247], v[80:83], 0
    v_mfma_f32_16x16x16_bf16 v[64:67], v[112:113], v[106:107], v[64:67]
    v_mfma_f32_16x16x32_bf16 v[52:55], a[248:251], v[84:87], v[52:55]
    v_mfma_f32_16x16x32_bf16 v[72:75], v[32:35], a[88:91], v[72:75]
    s_nop 1
    v_mfma_f32_16x16x32_bf16 v[76:79], v[32:35], a[168:171], v[76:79]
    s_nop 1
    v_mfma_f32_16x16x32_bf16 v[68:71], v[36:39], a[12:15], v[68:71]
    s_nop 0
    v_cvt_pk_bf16_f32 v108, v52, v53
    v_cvt_pk_bf16_f32 v109, v54, v55
    v_mfma_f32_16x16x32_bf16 v[72:75], v[36:39], a[92:95], v[72:75]
    s_nop 0
    v_mfma_f32_16x16x16_bf16 v[64:67], v[114:115], v[108:109], v[64:67]
    v_mfma_f32_16x16x32_bf16 v[76:79], v[36:39], a[172:175], v[76:79]
    v_mfma_f32_16x16x32_bf16 v[68:71], v[40:43], a[16:19], v[68:71]
    v_add_u32 v2, s9, v4
    ds_read_b128 v[60:63], v2 offset:0
    ds_read_b128 v[100:103], v2 offset:512
    ds_read_b128 v[44:47], v2 offset:1024
    s_mov_b64 exec, s[20:21]
    s_nop 0
    v_cvt_pk_bf16_f32 v132, v64, v65
    v_cvt_pk_bf16_f32 v133, v66, v67
    s_cmp_lg_u32 s3, 0
    s_cbranch_scc1 Lls_50040
    buffer_store_dwordx2 v[132:133], v6, s[4:7], s56 offen
    buffer_store_dwordx2 a[252:253], v6, s[4:7], s57 offen
Lle_50041:
    s_mov_b64 exec, -1
    v_mfma_f32_16x16x32_bf16 v[72:75], v[40:43], a[96:99], v[72:75]
    v_mfma_f32_16x16x32_bf16 v[76:79], v[40:43], a[176:179], v[76:79]
    s_nop 6
    s_branch Lb_50039
Lr0_50037:
    v_cvt_pk_bf16_f32 v96, v56, v57
    v_cvt_pk_bf16_f32 v97, v58, v59
    v_mfma_f32_16x16x32_bf16 v[48:51], v[160:163], v[28:31], v[48:51]
    v_cvt_pk_bf16_f32 v132, v44, v45
    v_cvt_pk_bf16_f32 v133, v46, v47
    v_mfma_f32_16x16x32_bf16 v[60:63], v[224:227], v[32:35], v[60:63]
    v_mov_b32_dpp v132, v96 row_shr:8 row_mask:0xf bank_mask:0xc
    v_mov_b32_dpp v133, v97 row_shr:8 row_mask:0xf bank_mask:0xc
    ds_write_b64 v5, v[132:133] offset:0
    v_mfma_f32_16x16x32_bf16 v[48:51], v[164:167], v[32:35], v[48:51]
    v_mfma_f32_16x16x32_bf16 v[60:63], v[228:231], v[36:39], v[60:63]
    ds_write_b64 v18, v[40:41] offset:2048
    v_mfma_f32_16x16x32_bf16 v[48:51], v[168:171], v[36:39], v[48:51]
    s_waitcnt lgkmcnt(1)
    s_barrier
    ds_read_b128 v[80:83], v135 offset:0
    ds_read_b128 v[84:87], v135 offset:16
    v_mfma_f32_16x16x32_bf16 v[60:63], v[232:235], v[40:43], v[60:63]
    v_mfma_f32_16x16x32_bf16 v[48:51], v[172:175], v[40:43], v[48:51]
    v_mfma_f32_16x16x32_bf16 v[64:67], v[236:239], v[24:27], 0
    s_nop 1
    v_mfma_f32_16x16x32_bf16 v[52:55], v[176:179], v[24:27], 0
    s_nop 1
    v_mfma_f32_16x16x32_bf16 v[64:67], v[240:243], v[28:31], v[64:67]
    v_cvt_pk_bf16_f32 v96, v60, v61
    v_cvt_pk_bf16_f32 v97, v62, v63
    v_mfma_f32_16x16x32_bf16 v[52:55], v[180:183], v[28:31], v[52:55]
    v_cvt_pk_bf16_f32 v132, v48, v49
    v_cvt_pk_bf16_f32 v133, v50, v51
    v_mfma_f32_16x16x32_bf16 v[64:67], v[244:247], v[32:35], v[64:67]
    v_mov_b32_dpp v132, v96 row_shr:8 row_mask:0xf bank_mask:0xc
    v_mov_b32_dpp v133, v97 row_shr:8 row_mask:0xf bank_mask:0xc
    ds_write_b64 v5, v[132:133] offset:2048
    v_mfma_f32_16x16x32_bf16 v[52:55], v[184:187], v[32:35], v[52:55]
    s_waitcnt lgkmcnt(1)
    v_mfma_f32_16x16x32_bf16 v[44:47], a[244:247], v[80:83], 0
    v_mfma_f32_16x16x32_bf16 v[64:67], v[248:251], v[36:39], v[64:67]
    v_mfma_f32_16x16x32_bf16 v[44:47], a[248:251], v[84:87], v[44:47]
    v_mfma_f32_16x16x32_bf16 v[52:55], v[188:191], v[36:39], v[52:55]
    s_waitcnt lgkmcnt(0)
    s_barrier
    ds_read_b128 v[88:91], v135 offset:2048
    ds_read_b128 v[92:95], v135 offset:2064
    v_mfma_f32_16x16x32_bf16 v[64:67], v[252:255], v[40:43], v[64:67]
    v_mfma_f32_16x16x32_bf16 v[52:55], v[192:195], v[40:43], v[52:55]
    v_mfma_f32_16x16x32_bf16 v[68:71], v[24:27], a[0:3], 0
    s_nop 0
    v_cvt_pk_bf16_f32 v104, v44, v45
    v_cvt_pk_bf16_f32 v105, v46, v47
    v_mfma_f32_16x16x32_bf16 v[72:75], v[24:27], a[80:83], 0
    s_nop 1
    v_mfma_f32_16x16x32_bf16 v[76:79], v[24:27], a[160:163], 0
    v_cvt_pk_bf16_f32 v96, v64, v65
    v_cvt_pk_bf16_f32 v97, v66, v67
    v_cvt_pk_bf16_f32 v132, v52, v53
    v_cvt_pk_bf16_f32 v133, v54, v55
    s_nop 0
    v_mov_b32_dpp v132, v96 row_shr:8 row_mask:0xf bank_mask:0xc
    v_mov_b32_dpp v133, v97 row_shr:8 row_mask:0xf bank_mask:0xc
    ds_write_b64 v5, v[132:133] offset:4096
    s_waitcnt lgkmcnt(1)
    v_mfma_f32_16x16x32_bf16 v[48:51], a[244:247], v[88:91], 0
    v_mfma_f32_16x16x32_bf16 v[68:71], v[28:31], a[4:7], v[68:71]
    v_mfma_f32_16x16x32_bf16 v[48:51], a[248:251], v[92:95], v[48:51]
    s_waitcnt lgkmcnt(0)
    s_barrier
    ds_read_b128 v[80:83], v135 offset:4096
    ds_read_b128 v[84:87], v135 offset:4112
    v_mfma_f32_16x16x16_bf16 v[64:67], v[104:105], v[104:105], 0
    v_mfma_f32_16x16x32_bf16 v[72:75], v[28:31], a[84:87], v[72:75]
    v_mfma_f32_16x16x32_bf16 v[76:79], v[28:31], a[164:167], v[76:79]
    s_nop 1
    v_cvt_pk_bf16_f32 v106, v48, v49
    v_cvt_pk_bf16_f32 v107, v50, v51
    v_mfma_f32_16x16x32_bf16 v[68:71], v[32:35], a[8:11], v[68:71]
    s_waitcnt lgkmcnt(0)
    v_mfma_f32_16x16x32_bf16 v[52:55], a[244:247], v[80:83], 0
    v_mfma_f32_16x16x16_bf16 v[64:67], v[106:107], v[106:107], v[64:67]
    v_mfma_f32_16x16x32_bf16 v[52:55], a[248:251], v[84:87], v[52:55]
    v_mfma_f32_16x16x32_bf16 v[72:75], v[32:35], a[88:91], v[72:75]
    s_nop 1
    v_mfma_f32_16x16x32_bf16 v[76:79], v[32:35], a[168:171], v[76:79]
    s_nop 1
    v_mfma_f32_16x16x32_bf16 v[68:71], v[36:39], a[12:15], v[68:71]
    s_nop 0
    v_cvt_pk_bf16_f32 v108, v52, v53
    v_cvt_pk_bf16_f32 v109, v54, v55
    v_mfma_f32_16x16x32_bf16 v[72:75], v[36:39], a[92:95], v[72:75]
    s_nop 0
    v_mfma_f32_16x16x16_bf16 v[64:67], v[108:109], v[108:109], v[64:67]
    v_mfma_f32_16x16x32_bf16 v[76:79], v[36:39], a[172:175], v[76:79]
    v_mfma_f32_16x16x32_bf16 v[68:71], v[40:43], a[16:19], v[68:71]
    v_add_u32 v2, s9, v4
    ds_read_b128 v[60:63], v2 offset:0
    ds_read_b128 v[100:103], v2 offset:512
    ds_read_b128 v[44:47], v2 offset:1024
    s_mov_b64 exec, s[38:39]
    s_nop 0
    v_cvt_pk_bf16_f32 v132, v64, v65
    v_cvt_pk_bf16_f32 v133, v66, v67
    s_cmp_lg_u32 s3, 0
    s_cbranch_scc1 Lls_50042
    buffer_store_dwordx2 v[132:133], v6, s[4:7], s56 offen
    buffer_store_dwordx2 a[252:253], v6, s[4:7], s57 offen
Lle_50043:
    s_mov_b64 exec, -1
    v_mfma_f32_16x16x32_bf16 v[72:75], v[40:43], a[96:99], v[72:75]
    v_mfma_f32_16x16x32_bf16 v[76:79], v[40:43], a[176:179], v[76:79]
    s_nop 6
    s_branch Lb_50039
Lr3_50038:
    v_cvt_pk_bf16_f32 v96, v56, v57
    v_cvt_pk_bf16_f32 v97, v58, v59
    v_mfma_f32_16x16x32_bf16 v[48:51], v[160:163], v[28:31], v[48:51]
    v_cvt_pk_bf16_f32 v132, v44, v45
    v_cvt_pk_bf16_f32 v133, v46, v47
    v_mfma_f32_16x16x32_bf16 v[60:63], v[224:227], v[32:35], v[60:63]
    v_mov_b32_dpp v132, v96 row_shr:8 row_mask:0xf bank_mask:0xc
    v_mov_b32_dpp v133, v97 row_shr:8 row_mask:0xf bank_mask:0xc
    ds_write_b64 v5, v[132:133] offset:0
    v_mfma_f32_16x16x32_bf16 v[48:51], v[164:167], v[32:35], v[48:51]
    v_mfma_f32_16x16x32_bf16 v[60:63], v[228:231], v[36:39], v[60:63]
    ds_write_b64 v18, v[40:41] offset:2048
    v_mfma_f32_16x16x32_bf16 v[48:51], v[168:171], v[36:39], v[48:51]
    s_waitcnt lgkmcnt(1)
    s_barrier
    v_mfma_f32_16x16x32_bf16 v[60:63], v[232:235], v[40:43], v[60:63]
    ds_read_b128 v[80:83], v3 offset:35840
    ds_read_b128 v[84:87], v3 offset:36864
    v_mfma_f32_16x16x32_bf16 v[48:51], v[172:175], v[40:43], v[48:51]
    ds_read_b128 v[88:91], v3 offset:37888
    ds_read_b128 v[92:95], v3 offset:38912
    v_mfma_f32_16x16x32_bf16 v[64:67], v[236:239], v[24:27], 0
    s_nop 1
    v_mfma_f32_16x16x32_bf16 v[52:55], v[176:179], v[24:27], 0
    s_nop 1
    v_mfma_f32_16x16x32_bf16 v[64:67], v[240:243], v[28:31], v[64:67]
    v_cvt_pk_bf16_f32 v96, v60, v61
    v_cvt_pk_bf16_f32 v97, v62, v63
    v_mfma_f32_16x16x32_bf16 v[52:55], v[180:183], v[28:31], v[52:55]
    v_cvt_pk_bf16_f32 v132, v48, v49
    v_cvt_pk_bf16_f32 v133, v50, v51
    v_mfma_f32_16x16x32_bf16 v[64:67], v[244:247], v[32:35], v[64:67]
    v_mov_b32_dpp v132, v96 row_shr:8 row_mask:0xf bank_mask:0xc
    v_mov_b32_dpp v133, v97 row_shr:8 row_mask:0xf bank_mask:0xc
    ds_write_b64 v5, v[132:133] offset:2048
    v_mfma_f32_16x16x32_bf16 v[52:55], v[184:187], v[32:35], v[52:55]
    s_waitcnt lgkmcnt(1)
    buffer_store_dwordx4 v[80:83], v17, s[4:7], s42 offen offset:0 sc1
    buffer_store_dwordx4 v[84:87], v17, s[4:7], s42 offen offset:1024 sc1
    v_mfma_f32_16x16x32_bf16 v[64:67], v[248:251], v[36:39], v[64:67]
    buffer_store_dwordx4 v[88:91], v17, s[4:7], s42 offen offset:2048 sc1
    buffer_store_dwordx4 v[92:95], v17, s[4:7], s42 offen offset:3072 sc1
    v_mfma_f32_16x16x32_bf16 v[52:55], v[188:191], v[36:39], v[52:55]
    s_waitcnt lgkmcnt(0)
    s_barrier
    v_mfma_f32_16x16x32_bf16 v[64:67], v[252:255], v[40:43], v[64:67]
    v_mfma_f32_16x16x32_bf16 v[52:55], v[192:195], v[40:43], v[52:55]
    v_mfma_f32_16x16x32_bf16 v[68:71], v[24:27], a[0:3], 0
    s_nop 1
    v_mfma_f32_16x16x32_bf16 v[72:75], v[24:27], a[80:83], 0
    s_nop 1
    v_mfma_f32_16x16x32_bf16 v[76:79], v[24:27], a[160:163], 0
    v_cvt_pk_bf16_f32 v96, v64, v65
    v_cvt_pk_bf16_f32 v97, v66, v67
    v_cvt_pk_bf16_f32 v132, v52, v53
    v_cvt_pk_bf16_f32 v133, v54, v55
    s_nop 0
    v_mov_b32_dpp v132, v96 row_shr:8 row_mask:0xf bank_mask:0xc
    v_mov_b32_dpp v133, v97 row_shr:8 row_mask:0xf bank_mask:0xc
    ds_write_b64 v5, v[132:133] offset:4096
    v_mfma_f32_16x16x32_bf16 v[68:71], v[28:31], a[4:7], v[68:71]
    v_mfma_f32_16x16x32_bf16 v[72:75], v[28:31], a[84:87], v[72:75]
    v_mfma_f32_16x16x32_bf16 v[76:79], v[28:31], a[164:167], v[76:79]
    s_waitcnt lgkmcnt(0)
    s_barrier
    s_lshl_b32 s34, s15, 7
    s_add_u32 s34, s34, 0xb201000
    v_lshrrev_b32 v100, 2, v3
    v_add_u32 v100, s34, v100
    buffer_load_dword v22, v100, s[4:7], 0 offen sc1
    v_add_u32 v2, s9, v4
    ds_read_b128 v[60:63], v2 offset:0
    ds_read_b128 v[100:103], v2 offset:512
    ds_read_b128 v[44:47], v2 offset:1024
    v_mfma_f32_16x16x32_bf16 v[68:71], v[32:35], a[8:11], v[68:71]
    v_mfma_f32_16x16x32_bf16 v[72:75], v[32:35], a[88:91], v[72:75]
    v_mfma_f32_16x16x32_bf16 v[76:79], v[32:35], a[168:171], v[76:79]
    v_mfma_f32_16x16x32_bf16 v[68:71], v[36:39], a[12:15], v[68:71]
    v_mfma_f32_16x16x32_bf16 v[72:75], v[36:39], a[92:95], v[72:75]
    v_mfma_f32_16x16x32_bf16 v[76:79], v[36:39], a[172:175], v[76:79]
    v_mfma_f32_16x16x32_bf16 v[68:71], v[40:43], a[16:19], v[68:71]
    v_mfma_f32_16x16x32_bf16 v[72:75], v[40:43], a[96:99], v[72:75]
    v_mfma_f32_16x16x32_bf16 v[76:79], v[40:43], a[176:179], v[76:79]
    s_nop 7
Lb_50039:
    ds_read_b128 v[56:59], v2 offset:1536
    s_waitcnt lgkmcnt(3)
    v_mfma_f32_16x16x32_bf16 v[68:71], v[60:63], a[20:23], v[68:71]
    v_mfma_f32_16x16x32_bf16 v[72:75], v[60:63], a[100:103], v[72:75]
    v_mfma_f32_16x16x32_bf16 v[76:79], v[60:63], a[180:183], v[76:79]
    ds_read_b128 v[60:63], v2 offset:2048
    s_waitcnt lgkmcnt(3)
    v_mfma_f32_16x16x32_bf16 v[68:71], v[100:103], a[24:27], v[68:71]
    v_mfma_f32_16x16x32_bf16 v[72:75], v[100:103], a[104:107], v[72:75]
    v_mfma_f32_16x16x32_bf16 v[76:79], v[100:103], a[184:187], v[76:79]
    v_add_u32 v2, s10, v4
    ds_read_b128 v[100:103], v2 offset:0
    s_waitcnt lgkmcnt(3)
    v_mfma_f32_16x16x32_bf16 v[68:71], v[44:47], a[28:31], v[68:71]
    v_mfma_f32_16x16x32_bf16 v[72:75], v[44:47], a[108:111], v[72:75]
    v_mfma_f32_16x16x32_bf16 v[76:79], v[44:47], a[188:191], v[76:79]
    ds_read_b128 v[44:47], v2 offset:512
    s_waitcnt lgkmcnt(3)
    v_mfma_f32_16x16x32_bf16 v[68:71], v[56:59], a[32:35], v[68:71]
    v_mfma_f32_16x16x32_bf16 v[72:75], v[56:59], a[112:115], v[72:75]
    v_mfma_f32_16x16x32_bf16 v[76:79], v[56:59], a[192:195], v[76:79]
    ds_read_b128 v[56:59], v2 offset:1024
    s_waitcnt lgkmcnt(3)
    v_mfma_f32_16x16x32_bf16 v[68:71], v[60:63], a[36:39], v[68:71]
    v_mfma_f32_16x16x32_bf16 v[72:75], v[60:63], a[116:119], v[72:75]
    v_mfma_f32_16x16x32_bf16 v[76:79], v[60:63], a[196:199], v[76:79]
    ds_read_b128 v[60:63], v2 offset:1536
    s_waitcnt lgkmcnt(3)
    v_mfma_f32_16x16x32_bf16 v[68:71], v[100:103], a[40:43], v[68:71]
    v_mfma_f32_16x16x32_bf16 v[72:75], v[100:103], a[120:123], v[72:75]
    v_mfma_f32_16x16x32_bf16 v[76:79], v[100:103], a[200:203], v[76:79]
    ds_read_b128 v[100:103], v2 offset:2048
    s_waitcnt lgkmcnt(3)
    v_mfma_f32_16x16x32_bf16 v[68:71], v[44:47], a[44:47], v[68:71]
    v_mfma_f32_16x16x32_bf16 v[72:75], v[44:47], a[124:127], v[72:75]
    v_mfma_f32_16x16x32_bf16 v[76:79], v[44:47], a[204:207], v[76:79]
    v_add_u32 v2, s11, v4
    ds_read_b128 v[44:47], v2 offset:0
    s_waitcnt lgkmcnt(3)
    v_mfma_f32_16x16x32_bf16 v[68:71], v[56:59], a[48:51], v[68:71]
    buffer_load_dwordx4 v[80:83], v7, s[4:7], s56 offen offset:0 sc1
    v_mfma_f32_16x16x32_bf16 v[72:75], v[56:59], a[128:131], v[72:75]
    buffer_load_dwordx4 v[84:87], v7, s[4:7], s56 offen offset:128 sc1
    v_mfma_f32_16x16x32_bf16 v[76:79], v[56:59], a[208:211], v[76:79]
    buffer_load_dwordx4 v[88:91], v7, s[4:7], s56 offen offset:256 sc1
    ds_read_b128 v[56:59], v2 offset:512
    s_waitcnt lgkmcnt(3)
    v_mfma_f32_16x16x32_bf16 v[68:71], v[60:63], a[52:55], v[68:71]
    buffer_load_dwordx4 v[92:95], v7, s[4:7], s56 offen offset:384 sc1
    v_mfma_f32_16x16x32_bf16 v[72:75], v[60:63], a[132:135], v[72:75]
    buffer_load_dwordx4 v[96:99], v7, s[4:7], s56 offen offset:512 sc1
    v_mfma_f32_16x16x32_bf16 v[76:79], v[60:63], a[212:215], v[76:79]
    ds_read_b128 v[60:63], v2 offset:1024
    s_waitcnt lgkmcnt(3)
    v_mfma_f32_16x16x32_bf16 v[68:71], v[100:103], a[56:59], v[68:71]
    v_mfma_f32_16x16x32_bf16 v[72:75], v[100:103], a[136:139], v[72:75]
    v_mfma_f32_16x16x32_bf16 v[76:79], v[100:103], a[216:219], v[76:79]
    ds_read_b128 v[100:103], v2 offset:1536
    s_waitcnt lgkmcnt(3)
    v_mfma_f32_16x16x32_bf16 v[68:71], v[44:47], a[60:63], v[68:71]
    v_mfma_f32_16x16x32_bf16 v[72:75], v[44:47], a[140:143], v[72:75]
    v_mfma_f32_16x16x32_bf16 v[76:79], v[44:47], a[220:223], v[76:79]
    ds_read_b128 v[44:47], v2 offset:2048
    s_waitcnt lgkmcnt(3)
    v_mfma_f32_16x16x32_bf16 v[68:71], v[56:59], a[64:67], v[68:71]
    v_mfma_f32_16x16x32_bf16 v[72:75], v[56:59], a[144:147], v[72:75]
    v_mfma_f32_16x16x32_bf16 v[76:79], v[56:59], a[224:227], v[76:79]
    s_waitcnt lgkmcnt(2)
    v_mfma_f32_16x16x32_bf16 v[68:71], v[60:63], a[68:71], v[68:71]
    v_mfma_f32_16x16x32_bf16 v[72:75], v[60:63], a[148:151], v[72:75]
    v_mfma_f32_16x16x32_bf16 v[76:79], v[60:63], a[228:231], v[76:79]
    s_waitcnt lgkmcnt(1)
    v_mfma_f32_16x16x32_bf16 v[68:71], v[100:103], a[72:75], v[68:71]
    v_mfma_f32_16x16x32_bf16 v[72:75], v[100:103], a[152:155], v[72:75]
    v_mfma_f32_16x16x32_bf16 v[76:79], v[100:103], a[232:235], v[76:79]
    s_waitcnt lgkmcnt(0)
    v_mfma_f32_16x16x32_bf16 v[68:71], v[44:47], a[76:79], v[68:71]
    v_mfma_f32_16x16x32_bf16 v[72:75], v[44:47], a[156:159], v[72:75]
    v_mfma_f32_16x16x32_bf16 v[76:79], v[44:47], a[236:239], v[76:79]
    s_cmp_lg_u32 s14, 0
    s_cbranch_scc1 Lkm_50044
    s_mov_b64 exec, s[22:23]
    ds_write_b64 v14, v[104:105] offset:0
    ds_write_b64 v14, v[106:107] offset:256
    ds_write_b64 v14, v[108:109] offset:512
    s_mov_b64 exec, -1
Lkm_50044:
    s_cmp_eq_u32 s17, 63
    s_cbranch_scc1 Llast_50045
Lea_50047:
Lq_e1_50048:
    s_waitcnt vmcnt(0)
    v_max3_u32 v1, v83, v87, v91
    v_max3_u32 v1, v1, v95, v99
    v_cmp_eq_u32 vcc, -1, v1
    s_cbranch_vccz Lqd_e1_50049
    s_mov_b64 exec, vcc
    buffer_load_dwordx4 v[80:83], v7, s[4:7], s56 offen offset:0 sc1
    buffer_load_dwordx4 v[84:87], v7, s[4:7], s56 offen offset:128 sc1
    buffer_load_dwordx4 v[88:91], v7, s[4:7], s56 offen offset:256 sc1
    buffer_load_dwordx4 v[92:95], v7, s[4:7], s56 offen offset:384 sc1
    buffer_load_dwordx4 v[96:99], v7, s[4:7], s56 offen offset:512 sc1
    s_add_u32 s30, s30, 1
    s_cmp_lt_u32 s30, s31
    s_cbranch_scc1 Lq_e1_50048
    s_waitcnt vmcnt(0)
Lqd_e1_50049:
    s_mov_b64 exec, -1
    v_mfma_f32_16x16x32_bf16 v[44:47], a[244:247], v[80:83], 0
    v_cvt_pk_bf16_f32 v62, v68, v69
    v_cvt_pk_bf16_f32 v100, v70, v71
    v_mfma_f32_16x16x32_bf16 v[48:51], a[244:247], v[88:91], 0
    v_cvt_pk_bf16_f32 v63, v72, v73
    v_cvt_pk_bf16_f32 v101, v74, v75
    v_mfma_f32_16x16x32_bf16 v[52:55], a[240:243], v[96:99], 0
    v_cvt_pk_bf16_f32 v64, v76, v77
    v_cvt_pk_bf16_f32 v102, v78, v79
    v_mfma_f32_16x16x32_bf16 v[44:47], a[248:251], v[84:87], v[44:47]
    v_permlane32_swap_b32 v62, v100
    v_permlane32_swap_b32 v63, v101
    v_mfma_f32_16x16x32_bf16 v[48:51], a[248:251], v[92:95], v[48:51]
    v_permlane32_swap_b32 v64, v102
    s_nop 1
    v_mov_b32_dpp v65, v64 row_ror:8 row_mask:0xf bank_mask:0xf
    s_nop 0
    v_add_f32 v2, v52, v44
    v_max3_f32 v1, v52, v53, v44
    v_max3_f32 v1, v1, v45, v46
    v_cmp_u_f32 vcc, v2, v48
    v_max3_f32 v1, v1, v47, v48
    v_max3_f32 v1, v1, v49, v50
    s_cbranch_vccnz Lng_50050
Lnc_50051:
    v_max_f32 v1, v1, v51
    v_mov_b32 v2, v1
    s_nop 1
    v_permlane16_swap_b32 v1, v2
    v_max_f32 v1, v1, v2
    v_mov_b32 v2, v1
    s_nop 1
    v_permlane32_swap_b32 v1, v2
    v_max_f32 v1, v1, v2
    v_mul_f32 v100, s48, v1
    v_pk_fma_f32 v[44:45], v[44:45], s[48:49], v[100:101] op_sel_hi:[1,0,0] neg_lo:[0,0,1] neg_hi:[0,0,1]
    v_pk_fma_f32 v[46:47], v[46:47], s[48:49], v[100:101] op_sel_hi:[1,0,0] neg_lo:[0,0,1] neg_hi:[0,0,1]
    v_exp_f32 v44, v44
    v_exp_f32 v45, v45
    v_pk_fma_f32 v[48:49], v[48:49], s[48:49], v[100:101] op_sel_hi:[1,0,0] neg_lo:[0,0,1] neg_hi:[0,0,1]
    v_exp_f32 v46, v46
    v_exp_f32 v47, v47
    v_pk_fma_f32 v[50:51], v[50:51], s[48:49], v[100:101] op_sel_hi:[1,0,0] neg_lo:[0,0,1] neg_hi:[0,0,1]
    v_exp_f32 v48, v48
    v_exp_f32 v49, v49
    v_pk_fma_f32 v[52:53], v[52:53], s[48:49], v[100:101] op_sel_hi:[1,0,0] neg_lo:[0,0,1] neg_hi:[0,0,1]
    v_exp_f32 v50, v50
    v_exp_f32 v51, v51
    v_exp_f32 v52, v52
    v_exp_f32 v53, v53
    v_pk_add_f32 v[100:101], v[44:45], v[46:47]
    v_pk_add_f32 v[102:103], v[48:49], v[50:51]
    v_pk_add_f32 v[100:101], v[100:101], v[102:103]
    v_pk_add_f32 v[100:101], v[100:101], v[52:53]
    v_add_f32 v1, v100, v101
    v_mov_b32 v2, v1
    s_nop 1
    v_permlane16_swap_b32 v1, v2
    v_add_f32 v1, v1, v2
    v_mov_b32 v2, v1
    s_nop 1
    v_permlane32_swap_b32 v1, v2
    v_add_f32 v1, v1, v2
    v_rcp_f32 v100, v1
    s_nop 0
    v_pk_mul_f32 v[44:45], v[44:45], v[100:101] op_sel_hi:[1,0]
    v_pk_mul_f32 v[46:47], v[46:47], v[100:101] op_sel_hi:[1,0]
    v_pk_mul_f32 v[48:49], v[48:49], v[100:101] op_sel_hi:[1,0]
    v_pk_mul_f32 v[50:51], v[50:51], v[100:101] op_sel_hi:[1,0]
    v_pk_mul_f32 v[52:53], v[52:53], v[100:101] op_sel_hi:[1,0]
    v_cvt_pk_bf16_f32 v56, v44, v45
    v_cvt_pk_bf16_f32 v57, v46, v47
    v_cvt_pk_bf16_f32 v58, v48, v49
    v_cvt_pk_bf16_f32 v59, v50, v51
    v_cvt_pk_bf16_f32 v60, v52, v53
    s_nop 0
    v_mfma_f32_16x16x32_bf16 v[68:71], v[116:119], v[56:59], 0
    v_mov_b32_dpp v61, v60 row_ror:8 row_mask:0xf bank_mask:0xf
    v_mov_b32_dpp v80, v56 row_ror:8 row_mask:0xf bank_mask:0xf
    v_mfma_f32_16x16x32_bf16 v[72:75], v[124:127], v[56:59], 0
    v_mov_b32_dpp v81, v57 row_ror:8 row_mask:0xf bank_mask:0xf
    v_mov_b32_dpp v82, v58 row_ror:8 row_mask:0xf bank_mask:0xf
    v_mfma_f32_16x16x16_bf16 v[68:71], v[62:63], v[60:61], v[68:71]
    v_mov_b32_dpp v83, v59 row_ror:8 row_mask:0xf bank_mask:0xf
    v_mfma_f32_16x16x16_bf16 v[72:75], v[64:65], v[60:61], v[72:75]
    s_nop 0
    v_mfma_f32_16x16x32_bf16 v[68:71], v[120:123], v[80:83], v[68:71]
    v_mfma_f32_16x16x32_bf16 v[72:75], v[128:131], v[80:83], v[72:75]
    ds_write_b32 v15, v62
    ds_write_b32 v15, v63 offset:384
    ds_write_b32 v16, v64
    buffer_load_dwordx2 v[110:111], v8, s[4:7], s52 offen offset:0 sc1
    buffer_load_dwordx2 v[112:113], v8, s[4:7], s52 offen offset:512 sc1
    buffer_load_dwordx2 v[114:115], v8, s[4:7], s52 offen offset:1024 sc1
    s_cmp_lg_u32 s14, 3
    s_cbranch_scc1 Lnf_50052
    v_mov_b32 v2, s17
    s_mov_b64 exec, 1
    buffer_store_dword v2, v21, s[4:7], 0 offen sc1
    s_mov_b64 exec, -1
Lnf_50052:
    s_nop 0
    s_mov_b64 exec, s[20:21]
    ds_write_b128 v11, v[68:71]
    s_mov_b64 exec, s[40:41]
    ds_write_b128 v11, v[72:75] offset:512
    s_mov_b64 exec, -1
    s_cmp_lg_u32 s14, 3
    s_cbranch_scc1 Lpg_50053
    s_add_u32 s35, s17, 3
    s_min_u32 s35, s35, 64
    v_cmp_gt_u32 vcc, s35, v22
    s_and_b64 vcc, vcc, 0xffff
    s_cbranch_scc0 Lpg_50053
    s_lshl_b32 s34, s15, 7
    s_add_u32 s34, s34, 0xb201000
    v_lshrrev_b32 v100, 2, v3
    v_add_u32 v100, s34, v100
    s_mov_b64 exec, 0xffff
    s_nop 0
Lwp_50054:
    buffer_load_dword v101, v100, s[4:7], 0 offen sc1
    s_waitcnt vmcnt(0)
    v_cmp_gt_u32 vcc, s35, v101
    s_nop 0
    s_cbranch_vccz Lwpd_50055
    s_sleep 2
    s_add_u32 s30, s30, 1
    s_cmp_lt_u32 s30, s31
    s_cbranch_scc1 Lwp_50054
Lwpd_50055:
    s_mov_b64 exec, -1
Lpg_50053:
    s_waitcnt lgkmcnt(0)
    s_barrier
    s_cmp_eq_u32 s14, 3
    s_cbranch_scc1 Lw3b_50059
    s_cmp_ge_u32 s14, s24
    s_cbranch_scc1 Loth_50058
    s_cmp_eq_u32 s17, 63
    s_cbranch_scc1 Loth_50058
    ds_read_b32 v80, v13 offset:0
    ds_read_b32 v81, v13 offset:768
    ds_read_b32 v82, v13 offset:1536
    ds_read_b32 v83, v13 offset:2304
    v_mov_b32 v84, 0
    s_waitcnt lgkmcnt(2)
    v_add_f32 v80, v80, v81
    s_waitcnt lgkmcnt(0)
    v_add_f32 v82, v82, v83
    v_add_f32 v80, v80, v82
    v_cvt_pk_bf16_f32 v80, 1.0, v80
    buffer_atomic_pk_add_bf16 v80, v12, s[4:7], s60 offen
    s_cmp_lg_u32 s15, 0
    s_cbranch_scc1 Loth_50058
    buffer_store_dword v84, v12, s[4:7], s61 offen sc1
Loth_50058:
    s_branch Lskip_50057
Lw3b_50059:
Lskip_50057:
    s_add_u32 s55, s90, s60
    s_add_u32 s43, s91, s60
    s_add_u32 s58, s92, s60
    s_add_u32 s59, s93, s60
    s_add_u32 s46, s94, s60
    s_cmp_eq_u32 s17, 63
    s_cbranch_scc1 Lns_50056
    s_sleep 12
Lns_50056:
    s_add_u32 s17, s17, 1
    s_cmp_lt_u32 s17, 64
    s_cbranch_scc1 Lstep_50034
Lexit_50046:
    s_cmp_lg_u32 s14, 3
    s_cbranch_scc1 Lfin_50061
    s_mov_b32 s42, 234356736
    ds_read_b128 v[80:83], v3 offset:35840
    ds_read_b128 v[84:87], v3 offset:36864
    ds_read_b128 v[88:91], v3 offset:37888
    ds_read_b128 v[92:95], v3 offset:38912
    s_waitcnt lgkmcnt(0)
    buffer_store_dwordx4 v[80:83], v17, s[4:7], s42 offen offset:0 sc1
    buffer_store_dwordx4 v[84:87], v17, s[4:7], s42 offen offset:1024 sc1
    buffer_store_dwordx4 v[88:91], v17, s[4:7], s42 offen offset:2048 sc1
    buffer_store_dwordx4 v[92:95], v17, s[4:7], s42 offen offset:3072 sc1
    v_mov_b32 v2, s17
    s_waitcnt vmcnt(0)
    s_mov_b64 exec, 1
    buffer_store_dword v2, v21, s[4:7], 0 offen sc1
    s_mov_b64 exec, -1
Lfin_50061:
    s_lshl_b32 s26, s15, 5
    s_add_u32 s26, s26, s16
    s_mov_b32 s16, 4
    s_branch Lmain_hop
Lbc0_50001:
    s_add_u32 s86, s84, 0
    s_add_u32 s87, s86, 4096
    s_add_u32 s88, s86, 8192
    ds_read_b64_tr_b16 v[196:197], v121 offset:0
    ds_read_b64_tr_b16 v[198:199], v121 offset:1408
    ds_read_b64_tr_b16 v[200:201], v121 offset:11264
    ds_read_b64_tr_b16 v[202:203], v121 offset:12672
    ds_read_b64_tr_b16 v[204:205], v121 offset:22528
    ds_read_b64_tr_b16 v[206:207], v121 offset:23936
    ds_read_b64_tr_b16 v[208:209], v121 offset:33792
    ds_read_b64_tr_b16 v[210:211], v121 offset:35200
    ds_read_b64_tr_b16 v[212:213], v121 offset:45056
    ds_read_b64_tr_b16 v[214:215], v121 offset:46464
    ds_read_b64_tr_b16 v[216:217], v121 offset:56320
    ds_read_b64_tr_b16 v[218:219], v121 offset:57728
    s_waitcnt lgkmcnt(10)
    v_mfma_f32_16x16x32_bf16 v[220:223], v[24:27], v[196:199], 0
    v_mfma_f32_16x16x32_bf16 v[224:227], v[48:51], v[196:199], 0
    ds_read_b64_tr_b16 v[196:197], v121 offset:32
    ds_read_b64_tr_b16 v[198:199], v121 offset:1440
    s_waitcnt lgkmcnt(10)
    v_mfma_f32_16x16x32_bf16 v[220:223], v[28:31], v[200:203], v[220:223]
    v_mfma_f32_16x16x32_bf16 v[224:227], v[52:55], v[200:203], v[224:227]
    ds_read_b64_tr_b16 v[200:201], v121 offset:11296
    ds_read_b64_tr_b16 v[202:203], v121 offset:12704
    s_waitcnt lgkmcnt(10)
    v_mfma_f32_16x16x32_bf16 v[220:223], v[32:35], v[204:207], v[220:223]
    v_mfma_f32_16x16x32_bf16 v[224:227], v[56:59], v[204:207], v[224:227]
    ds_read_b64_tr_b16 v[204:205], v121 offset:22560
    ds_read_b64_tr_b16 v[206:207], v121 offset:23968
    s_waitcnt lgkmcnt(10)
    v_mfma_f32_16x16x32_bf16 v[220:223], v[36:39], v[208:211], v[220:223]
    v_mfma_f32_16x16x32_bf16 v[224:227], v[60:63], v[208:211], v[224:227]
    ds_read_b64_tr_b16 v[208:209], v121 offset:33824
    ds_read_b64_tr_b16 v[210:211], v121 offset:35232
    s_waitcnt lgkmcnt(10)
    v_mfma_f32_16x16x32_bf16 v[220:223], v[40:43], v[212:215], v[220:223]
    v_mfma_f32_16x16x32_bf16 v[224:227], v[64:67], v[212:215], v[224:227]
    ds_read_b64_tr_b16 v[212:213], v121 offset:45088
    ds_read_b64_tr_b16 v[214:215], v121 offset:46496
    s_waitcnt lgkmcnt(10)
    v_mfma_f32_16x16x32_bf16 v[220:223], v[44:47], v[216:219], v[220:223]
    v_mfma_f32_16x16x32_bf16 v[224:227], v[68:71], v[216:219], v[224:227]
    ds_read_b64_tr_b16 v[216:217], v121 offset:56352
    ds_read_b64_tr_b16 v[218:219], v121 offset:57760
    s_waitcnt lgkmcnt(10)
    v_mfma_f32_16x16x32_bf16 v[228:231], v[24:27], v[196:199], 0
    v_mfma_f32_16x16x32_bf16 v[232:235], v[48:51], v[196:199], 0
    ds_read_b64_tr_b16 v[196:197], v121 offset:64
    ds_read_b64_tr_b16 v[198:199], v121 offset:1472
    s_waitcnt lgkmcnt(10)
    v_mfma_f32_16x16x32_bf16 v[228:231], v[28:31], v[200:203], v[228:231]
    v_mfma_f32_16x16x32_bf16 v[232:235], v[52:55], v[200:203], v[232:235]
    ds_read_b64_tr_b16 v[200:201], v121 offset:11328
    ds_read_b64_tr_b16 v[202:203], v121 offset:12736
    s_waitcnt lgkmcnt(10)
    v_mfma_f32_16x16x32_bf16 v[228:231], v[32:35], v[204:207], v[228:231]
    v_mfma_f32_16x16x32_bf16 v[232:235], v[56:59], v[204:207], v[232:235]
    ds_read_b64_tr_b16 v[204:205], v121 offset:22592
    ds_read_b64_tr_b16 v[206:207], v121 offset:24000
    v_cvt_pk_bf16_f32 v236, v220, v221
    v_cvt_pk_bf16_f32 v237, v222, v223
    s_waitcnt lgkmcnt(10)
    v_mfma_f32_16x16x32_bf16 v[228:231], v[36:39], v[208:211], v[228:231]
    v_mfma_f32_16x16x32_bf16 v[232:235], v[60:63], v[208:211], v[232:235]
    ds_read_b64_tr_b16 v[208:209], v121 offset:33856
    ds_read_b64_tr_b16 v[210:211], v121 offset:35264
    v_cvt_pk_bf16_f32 v238, v224, v225
    v_cvt_pk_bf16_f32 v239, v226, v227
    s_waitcnt lgkmcnt(10)
    v_mfma_f32_16x16x32_bf16 v[228:231], v[40:43], v[212:215], v[228:231]
    v_mfma_f32_16x16x32_bf16 v[232:235], v[64:67], v[212:215], v[232:235]
    ds_read_b64_tr_b16 v[212:213], v121 offset:45120
    ds_read_b64_tr_b16 v[214:215], v121 offset:46528
    s_cmp_lg_u32 s3, 0
    s_cbranch_scc1 Lls_50062
    buffer_store_dwordx4 v[236:239], v3, s[4:7], s86 offen offset:0
Lle_50063:
    s_waitcnt lgkmcnt(10)
    v_mfma_f32_16x16x32_bf16 v[228:231], v[44:47], v[216:219], v[228:231]
    v_mfma_f32_16x16x32_bf16 v[232:235], v[68:71], v[216:219], v[232:235]
    ds_read_b64_tr_b16 v[216:217], v121 offset:56384
    ds_read_b64_tr_b16 v[218:219], v121 offset:57792
    s_waitcnt lgkmcnt(10)
    v_mfma_f32_16x16x32_bf16 v[220:223], v[24:27], v[196:199], 0
    v_mfma_f32_16x16x32_bf16 v[224:227], v[48:51], v[196:199], 0
    ds_read_b64_tr_b16 v[196:197], v121 offset:96
    ds_read_b64_tr_b16 v[198:199], v121 offset:1504
    s_waitcnt lgkmcnt(10)
    v_mfma_f32_16x16x32_bf16 v[220:223], v[28:31], v[200:203], v[220:223]
    v_mfma_f32_16x16x32_bf16 v[224:227], v[52:55], v[200:203], v[224:227]
    ds_read_b64_tr_b16 v[200:201], v121 offset:11360
    ds_read_b64_tr_b16 v[202:203], v121 offset:12768
    s_waitcnt lgkmcnt(10)
    v_mfma_f32_16x16x32_bf16 v[220:223], v[32:35], v[204:207], v[220:223]
    v_mfma_f32_16x16x32_bf16 v[224:227], v[56:59], v[204:207], v[224:227]
    ds_read_b64_tr_b16 v[204:205], v121 offset:22624
    ds_read_b64_tr_b16 v[206:207], v121 offset:24032
    v_cvt_pk_bf16_f32 v240, v228, v229
    v_cvt_pk_bf16_f32 v241, v230, v231
    s_waitcnt lgkmcnt(10)
    v_mfma_f32_16x16x32_bf16 v[220:223], v[36:39], v[208:211], v[220:223]
    v_mfma_f32_16x16x32_bf16 v[224:227], v[60:63], v[208:211], v[224:227]
    ds_read_b64_tr_b16 v[208:209], v121 offset:33888
    ds_read_b64_tr_b16 v[210:211], v121 offset:35296
    v_cvt_pk_bf16_f32 v242, v232, v233
    v_cvt_pk_bf16_f32 v243, v234, v235
    s_waitcnt lgkmcnt(10)
    v_mfma_f32_16x16x32_bf16 v[220:223], v[40:43], v[212:215], v[220:223]
    v_mfma_f32_16x16x32_bf16 v[224:227], v[64:67], v[212:215], v[224:227]
    ds_read_b64_tr_b16 v[212:213], v121 offset:45152
    ds_read_b64_tr_b16 v[214:215], v121 offset:46560
    s_cmp_lg_u32 s3, 0
    s_cbranch_scc1 Lls_50064
    buffer_store_dwordx4 v[240:243], v3, s[4:7], s86 offen offset:1024
Lle_50065:
    s_waitcnt lgkmcnt(10)
    v_mfma_f32_16x16x32_bf16 v[220:223], v[44:47], v[216:219], v[220:223]
    v_mfma_f32_16x16x32_bf16 v[224:227], v[68:71], v[216:219], v[224:227]
    ds_read_b64_tr_b16 v[216:217], v121 offset:56416
    ds_read_b64_tr_b16 v[218:219], v121 offset:57824
    s_waitcnt lgkmcnt(10)
    v_mfma_f32_16x16x32_bf16 v[228:231], v[24:27], v[196:199], 0
    v_mfma_f32_16x16x32_bf16 v[232:235], v[48:51], v[196:199], 0
    ds_read_b64_tr_b16 v[196:197], v121 offset:128
    ds_read_b64_tr_b16 v[198:199], v121 offset:1536
    s_waitcnt lgkmcnt(10)
    v_mfma_f32_16x16x32_bf16 v[228:231], v[28:31], v[200:203], v[228:231]
    v_mfma_f32_16x16x32_bf16 v[232:235], v[52:55], v[200:203], v[232:235]
    ds_read_b64_tr_b16 v[200:201], v121 offset:11392
    ds_read_b64_tr_b16 v[202:203], v121 offset:12800
    s_waitcnt lgkmcnt(10)
    v_mfma_f32_16x16x32_bf16 v[228:231], v[32:35], v[204:207], v[228:231]
    v_mfma_f32_16x16x32_bf16 v[232:235], v[56:59], v[204:207], v[232:235]
    ds_read_b64_tr_b16 v[204:205], v121 offset:22656
    ds_read_b64_tr_b16 v[206:207], v121 offset:24064
    v_cvt_pk_bf16_f32 v236, v220, v221
    v_cvt_pk_bf16_f32 v237, v222, v223
    s_waitcnt lgkmcnt(10)
    v_mfma_f32_16x16x32_bf16 v[228:231], v[36:39], v[208:211], v[228:231]
    v_mfma_f32_16x16x32_bf16 v[232:235], v[60:63], v[208:211], v[232:235]
    ds_read_b64_tr_b16 v[208:209], v121 offset:33920
    ds_read_b64_tr_b16 v[210:211], v121 offset:35328
    v_cvt_pk_bf16_f32 v238, v224, v225
    v_cvt_pk_bf16_f32 v239, v226, v227
    s_waitcnt lgkmcnt(10)
    v_mfma_f32_16x16x32_bf16 v[228:231], v[40:43], v[212:215], v[228:231]
    v_mfma_f32_16x16x32_bf16 v[232:235], v[64:67], v[212:215], v[232:235]
    ds_read_b64_tr_b16 v[212:213], v121 offset:45184
    ds_read_b64_tr_b16 v[214:215], v121 offset:46592
    s_cmp_lg_u32 s3, 0
    s_cbranch_scc1 Lls_50066
    buffer_store_dwordx4 v[236:239], v3, s[4:7], s86 offen offset:2048
Lle_50067:
    s_waitcnt lgkmcnt(10)
    v_mfma_f32_16x16x32_bf16 v[228:231], v[44:47], v[216:219], v[228:231]
    v_mfma_f32_16x16x32_bf16 v[232:235], v[68:71], v[216:219], v[232:235]
    ds_read_b64_tr_b16 v[216:217], v121 offset:56448
    ds_read_b64_tr_b16 v[218:219], v121 offset:57856
    s_waitcnt lgkmcnt(10)
    v_mfma_f32_16x16x32_bf16 v[220:223], v[24:27], v[196:199], 0
    v_mfma_f32_16x16x32_bf16 v[224:227], v[48:51], v[196:199], 0
    ds_read_b64_tr_b16 v[196:197], v121 offset:160
    ds_read_b64_tr_b16 v[198:199], v121 offset:1568
    s_waitcnt lgkmcnt(10)
    v_mfma_f32_16x16x32_bf16 v[220:223], v[28:31], v[200:203], v[220:223]
    v_mfma_f32_16x16x32_bf16 v[224:227], v[52:55], v[200:203], v[224:227]
    ds_read_b64_tr_b16 v[200:201], v121 offset:11424
    ds_read_b64_tr_b16 v[202:203], v121 offset:12832
    s_waitcnt lgkmcnt(10)
    v_mfma_f32_16x16x32_bf16 v[220:223], v[32:35], v[204:207], v[220:223]
    v_mfma_f32_16x16x32_bf16 v[224:227], v[56:59], v[204:207], v[224:227]
    ds_read_b64_tr_b16 v[204:205], v121 offset:22688
    ds_read_b64_tr_b16 v[206:207], v121 offset:24096
    v_cvt_pk_bf16_f32 v240, v228, v229
    v_cvt_pk_bf16_f32 v241, v230, v231
    s_waitcnt lgkmcnt(10)
    v_mfma_f32_16x16x32_bf16 v[220:223], v[36:39], v[208:211], v[220:223]
    v_mfma_f32_16x16x32_bf16 v[224:227], v[60:63], v[208:211], v[224:227]
    ds_read_b64_tr_b16 v[208:209], v121 offset:33952
    ds_read_b64_tr_b16 v[210:211], v121 offset:35360
    v_cvt_pk_bf16_f32 v242, v232, v233
    v_cvt_pk_bf16_f32 v243, v234, v235
    s_waitcnt lgkmcnt(10)
    v_mfma_f32_16x16x32_bf16 v[220:223], v[40:43], v[212:215], v[220:223]
    v_mfma_f32_16x16x32_bf16 v[224:227], v[64:67], v[212:215], v[224:227]
    ds_read_b64_tr_b16 v[212:213], v121 offset:45216
    ds_read_b64_tr_b16 v[214:215], v121 offset:46624
    s_cmp_lg_u32 s3, 0
    s_cbranch_scc1 Lls_50068
    buffer_store_dwordx4 v[240:243], v3, s[4:7], s86 offen offset:3072
Lle_50069:
    s_waitcnt lgkmcnt(10)
    v_mfma_f32_16x16x32_bf16 v[220:223], v[44:47], v[216:219], v[220:223]
    v_mfma_f32_16x16x32_bf16 v[224:227], v[68:71], v[216:219], v[224:227]
    ds_read_b64_tr_b16 v[216:217], v121 offset:56480
    ds_read_b64_tr_b16 v[218:219], v121 offset:57888
    s_waitcnt lgkmcnt(10)
    v_mfma_f32_16x16x32_bf16 v[228:231], v[24:27], v[196:199], 0
    v_mfma_f32_16x16x32_bf16 v[232:235], v[48:51], v[196:199], 0
    ds_read_b64_tr_b16 v[196:197], v121 offset:192
    ds_read_b64_tr_b16 v[198:199], v121 offset:1600
    s_waitcnt lgkmcnt(10)
    v_mfma_f32_16x16x32_bf16 v[228:231], v[28:31], v[200:203], v[228:231]
    v_mfma_f32_16x16x32_bf16 v[232:235], v[52:55], v[200:203], v[232:235]
    ds_read_b64_tr_b16 v[200:201], v121 offset:11456
    ds_read_b64_tr_b16 v[202:203], v121 offset:12864
    s_waitcnt lgkmcnt(10)
    v_mfma_f32_16x16x32_bf16 v[228:231], v[32:35], v[204:207], v[228:231]
    v_mfma_f32_16x16x32_bf16 v[232:235], v[56:59], v[204:207], v[232:235]
    ds_read_b64_tr_b16 v[204:205], v121 offset:22720
    ds_read_b64_tr_b16 v[206:207], v121 offset:24128
    v_cvt_pk_bf16_f32 v236, v220, v221
    v_cvt_pk_bf16_f32 v237, v222, v223
    s_waitcnt lgkmcnt(10)
    v_mfma_f32_16x16x32_bf16 v[228:231], v[36:39], v[208:211], v[228:231]
    v_mfma_f32_16x16x32_bf16 v[232:235], v[60:63], v[208:211], v[232:235]
    ds_read_b64_tr_b16 v[208:209], v121 offset:33984
    ds_read_b64_tr_b16 v[210:211], v121 offset:35392
    v_cvt_pk_bf16_f32 v238, v224, v225
    v_cvt_pk_bf16_f32 v239, v226, v227
    s_waitcnt lgkmcnt(10)
    v_mfma_f32_16x16x32_bf16 v[228:231], v[40:43], v[212:215], v[228:231]
    v_mfma_f32_16x16x32_bf16 v[232:235], v[64:67], v[212:215], v[232:235]
    ds_read_b64_tr_b16 v[212:213], v121 offset:45248
    ds_read_b64_tr_b16 v[214:215], v121 offset:46656
    s_cmp_lg_u32 s3, 0
    s_cbranch_scc1 Lls_50070
    buffer_store_dwordx4 v[236:239], v3, s[4:7], s87 offen offset:0
Lle_50071:
    s_waitcnt lgkmcnt(10)
    v_mfma_f32_16x16x32_bf16 v[228:231], v[44:47], v[216:219], v[228:231]
    v_mfma_f32_16x16x32_bf16 v[232:235], v[68:71], v[216:219], v[232:235]
    ds_read_b64_tr_b16 v[216:217], v121 offset:56512
    ds_read_b64_tr_b16 v[218:219], v121 offset:57920
    s_waitcnt lgkmcnt(10)
    v_mfma_f32_16x16x32_bf16 v[220:223], v[24:27], v[196:199], 0
    v_mfma_f32_16x16x32_bf16 v[224:227], v[48:51], v[196:199], 0
    ds_read_b64_tr_b16 v[196:197], v121 offset:224
    ds_read_b64_tr_b16 v[198:199], v121 offset:1632
    s_waitcnt lgkmcnt(10)
    v_mfma_f32_16x16x32_bf16 v[220:223], v[28:31], v[200:203], v[220:223]
    v_mfma_f32_16x16x32_bf16 v[224:227], v[52:55], v[200:203], v[224:227]
    ds_read_b64_tr_b16 v[200:201], v121 offset:11488
    ds_read_b64_tr_b16 v[202:203], v121 offset:12896
    s_waitcnt lgkmcnt(10)
    v_mfma_f32_16x16x32_bf16 v[220:223], v[32:35], v[204:207], v[220:223]
    v_mfma_f32_16x16x32_bf16 v[224:227], v[56:59], v[204:207], v[224:227]
    ds_read_b64_tr_b16 v[204:205], v121 offset:22752
    ds_read_b64_tr_b16 v[206:207], v121 offset:24160
    v_cvt_pk_bf16_f32 v240, v228, v229
    v_cvt_pk_bf16_f32 v241, v230, v231
    s_waitcnt lgkmcnt(10)
    v_mfma_f32_16x16x32_bf16 v[220:223], v[36:39], v[208:211], v[220:223]
    v_mfma_f32_16x16x32_bf16 v[224:227], v[60:63], v[208:211], v[224:227]
    ds_read_b64_tr_b16 v[208:209], v121 offset:34016
    ds_read_b64_tr_b16 v[210:211], v121 offset:35424
    v_cvt_pk_bf16_f32 v242, v232, v233
    v_cvt_pk_bf16_f32 v243, v234, v235
    s_waitcnt lgkmcnt(10)
    v_mfma_f32_16x16x32_bf16 v[220:223], v[40:43], v[212:215], v[220:223]
    v_mfma_f32_16x16x32_bf16 v[224:227], v[64:67], v[212:215], v[224:227]
    ds_read_b64_tr_b16 v[212:213], v121 offset:45280
    ds_read_b64_tr_b16 v[214:215], v121 offset:46688
    s_cmp_lg_u32 s3, 0
    s_cbranch_scc1 Lls_50072
    buffer_store_dwordx4 v[240:243], v3, s[4:7], s87 offen offset:1024
Lle_50073:
    s_waitcnt lgkmcnt(10)
    v_mfma_f32_16x16x32_bf16 v[220:223], v[44:47], v[216:219], v[220:223]
    v_mfma_f32_16x16x32_bf16 v[224:227], v[68:71], v[216:219], v[224:227]
    ds_read_b64_tr_b16 v[216:217], v121 offset:56544
    ds_read_b64_tr_b16 v[218:219], v121 offset:57952
    s_waitcnt lgkmcnt(10)
    v_mfma_f32_16x16x32_bf16 v[228:231], v[24:27], v[196:199], 0
    v_mfma_f32_16x16x32_bf16 v[232:235], v[48:51], v[196:199], 0
    ds_read_b64_tr_b16 v[196:197], v121 offset:256
    ds_read_b64_tr_b16 v[198:199], v121 offset:1664
    s_waitcnt lgkmcnt(10)
    v_mfma_f32_16x16x32_bf16 v[228:231], v[28:31], v[200:203], v[228:231]
    v_mfma_f32_16x16x32_bf16 v[232:235], v[52:55], v[200:203], v[232:235]
    ds_read_b64_tr_b16 v[200:201], v121 offset:11520
    ds_read_b64_tr_b16 v[202:203], v121 offset:12928
    s_waitcnt lgkmcnt(10)
    v_mfma_f32_16x16x32_bf16 v[228:231], v[32:35], v[204:207], v[228:231]
    v_mfma_f32_16x16x32_bf16 v[232:235], v[56:59], v[204:207], v[232:235]
    ds_read_b64_tr_b16 v[204:205], v121 offset:22784
    ds_read_b64_tr_b16 v[206:207], v121 offset:24192
    v_cvt_pk_bf16_f32 v236, v220, v221
    v_cvt_pk_bf16_f32 v237, v222, v223
    s_waitcnt lgkmcnt(10)
    v_mfma_f32_16x16x32_bf16 v[228:231], v[36:39], v[208:211], v[228:231]
    v_mfma_f32_16x16x32_bf16 v[232:235], v[60:63], v[208:211], v[232:235]
    ds_read_b64_tr_b16 v[208:209], v121 offset:34048
    ds_read_b64_tr_b16 v[210:211], v121 offset:35456
    v_cvt_pk_bf16_f32 v238, v224, v225
    v_cvt_pk_bf16_f32 v239, v226, v227
    s_waitcnt lgkmcnt(10)
    v_mfma_f32_16x16x32_bf16 v[228:231], v[40:43], v[212:215], v[228:231]
    v_mfma_f32_16x16x32_bf16 v[232:235], v[64:67], v[212:215], v[232:235]
    ds_read_b64_tr_b16 v[212:213], v121 offset:45312
    ds_read_b64_tr_b16 v[214:215], v121 offset:46720
    s_cmp_lg_u32 s3, 0
    s_cbranch_scc1 Lls_50074
    buffer_store_dwordx4 v[236:239], v3, s[4:7], s87 offen offset:2048
Lle_50075:
    s_waitcnt lgkmcnt(10)
    v_mfma_f32_16x16x32_bf16 v[228:231], v[44:47], v[216:219], v[228:231]
    v_mfma_f32_16x16x32_bf16 v[232:235], v[68:71], v[216:219], v[232:235]
    ds_read_b64_tr_b16 v[216:217], v121 offset:56576
    ds_read_b64_tr_b16 v[218:219], v121 offset:57984
    s_waitcnt lgkmcnt(10)
    v_mfma_f32_16x16x32_bf16 v[220:223], v[24:27], v[196:199], 0
    v_mfma_f32_16x16x32_bf16 v[224:227], v[48:51], v[196:199], 0
    ds_read_b64_tr_b16 v[196:197], v121 offset:288
    ds_read_b64_tr_b16 v[198:199], v121 offset:1696
    s_waitcnt lgkmcnt(10)
    v_mfma_f32_16x16x32_bf16 v[220:223], v[28:31], v[200:203], v[220:223]
    v_mfma_f32_16x16x32_bf16 v[224:227], v[52:55], v[200:203], v[224:227]
    ds_read_b64_tr_b16 v[200:201], v121 offset:11552
    ds_read_b64_tr_b16 v[202:203], v121 offset:12960
    s_waitcnt lgkmcnt(10)
    v_mfma_f32_16x16x32_bf16 v[220:223], v[32:35], v[204:207], v[220:223]
    v_mfma_f32_16x16x32_bf16 v[224:227], v[56:59], v[204:207], v[224:227]
    ds_read_b64_tr_b16 v[204:205], v121 offset:22816
    ds_read_b64_tr_b16 v[206:207], v121 offset:24224
    v_cvt_pk_bf16_f32 v240, v228, v229
    v_cvt_pk_bf16_f32 v241, v230, v231
    s_waitcnt lgkmcnt(10)
    v_mfma_f32_16x16x32_bf16 v[220:223], v[36:39], v[208:211], v[220:223]
    v_mfma_f32_16x16x32_bf16 v[224:227], v[60:63], v[208:211], v[224:227]
    ds_read_b64_tr_b16 v[208:209], v121 offset:34080
    ds_read_b64_tr_b16 v[210:211], v121 offset:35488
    v_cvt_pk_bf16_f32 v242, v232, v233
    v_cvt_pk_bf16_f32 v243, v234, v235
    s_waitcnt lgkmcnt(10)
    v_mfma_f32_16x16x32_bf16 v[220:223], v[40:43], v[212:215], v[220:223]
    v_mfma_f32_16x16x32_bf16 v[224:227], v[64:67], v[212:215], v[224:227]
    ds_read_b64_tr_b16 v[212:213], v121 offset:45344
    ds_read_b64_tr_b16 v[214:215], v121 offset:46752
    s_cmp_lg_u32 s3, 0
    s_cbranch_scc1 Lls_50076
    buffer_store_dwordx4 v[240:243], v3, s[4:7], s87 offen offset:3072
Lle_50077:
    s_waitcnt lgkmcnt(10)
    v_mfma_f32_16x16x32_bf16 v[220:223], v[44:47], v[216:219], v[220:223]
    v_mfma_f32_16x16x32_bf16 v[224:227], v[68:71], v[216:219], v[224:227]
    ds_read_b64_tr_b16 v[216:217], v121 offset:56608
    ds_read_b64_tr_b16 v[218:219], v121 offset:58016
    s_waitcnt lgkmcnt(10)
    v_mfma_f32_16x16x32_bf16 v[228:231], v[24:27], v[196:199], 0
    v_mfma_f32_16x16x32_bf16 v[232:235], v[48:51], v[196:199], 0
    s_waitcnt lgkmcnt(8)
    v_mfma_f32_16x16x32_bf16 v[228:231], v[28:31], v[200:203], v[228:231]
    v_mfma_f32_16x16x32_bf16 v[232:235], v[52:55], v[200:203], v[232:235]
    s_waitcnt lgkmcnt(6)
    v_mfma_f32_16x16x32_bf16 v[228:231], v[32:35], v[204:207], v[228:231]
    v_mfma_f32_16x16x32_bf16 v[232:235], v[56:59], v[204:207], v[232:235]
    v_cvt_pk_bf16_f32 v236, v220, v221
    v_cvt_pk_bf16_f32 v237, v222, v223
    s_waitcnt lgkmcnt(4)
    v_mfma_f32_16x16x32_bf16 v[228:231], v[36:39], v[208:211], v[228:231]
    v_mfma_f32_16x16x32_bf16 v[232:235], v[60:63], v[208:211], v[232:235]
    v_cvt_pk_bf16_f32 v238, v224, v225
    v_cvt_pk_bf16_f32 v239, v226, v227
    s_waitcnt lgkmcnt(2)
    v_mfma_f32_16x16x32_bf16 v[228:231], v[40:43], v[212:215], v[228:231]
    v_mfma_f32_16x16x32_bf16 v[232:235], v[64:67], v[212:215], v[232:235]
    s_cmp_lg_u32 s3, 0
    s_cbranch_scc1 Lls_50078
    buffer_store_dwordx4 v[236:239], v3, s[4:7], s88 offen offset:0
Lle_50079:
    s_waitcnt lgkmcnt(0)
    v_mfma_f32_16x16x32_bf16 v[228:231], v[44:47], v[216:219], v[228:231]
    v_mfma_f32_16x16x32_bf16 v[232:235], v[68:71], v[216:219], v[232:235]
    s_nop 6
    v_cvt_pk_bf16_f32 v240, v228, v229
    v_cvt_pk_bf16_f32 v241, v230, v231
    v_cvt_pk_bf16_f32 v242, v232, v233
    v_cvt_pk_bf16_f32 v243, v234, v235
    s_cmp_lg_u32 s3, 0
    s_cbranch_scc1 Lls_50080
    buffer_store_dwordx4 v[240:243], v3, s[4:7], s88 offen offset:1024
Lle_50081:
    s_nop 1
    s_setpc_b64 s[12:13]
Lbc1_50002:
    s_add_u32 s86, s84, 5242880
    s_add_u32 s87, s86, 4096
    s_add_u32 s88, s86, 8192
    ds_read_b64_tr_b16 v[196:197], v121 offset:0
    ds_read_b64_tr_b16 v[198:199], v121 offset:1408
    ds_read_b64_tr_b16 v[200:201], v121 offset:11264
    ds_read_b64_tr_b16 v[202:203], v121 offset:12672
    ds_read_b64_tr_b16 v[204:205], v121 offset:22528
    ds_read_b64_tr_b16 v[206:207], v121 offset:23936
    ds_read_b64_tr_b16 v[208:209], v121 offset:33792
    ds_read_b64_tr_b16 v[210:211], v121 offset:35200
    ds_read_b64_tr_b16 v[212:213], v121 offset:45056
    ds_read_b64_tr_b16 v[214:215], v121 offset:46464
    ds_read_b64_tr_b16 v[216:217], v121 offset:56320
    ds_read_b64_tr_b16 v[218:219], v121 offset:57728
    s_waitcnt lgkmcnt(10)
    v_mfma_f32_16x16x32_bf16 v[220:223], v[72:75], v[196:199], 0
    v_mfma_f32_16x16x32_bf16 v[224:227], v[96:99], v[196:199], 0
    ds_read_b64_tr_b16 v[196:197], v121 offset:32
    ds_read_b64_tr_b16 v[198:199], v121 offset:1440
    s_waitcnt lgkmcnt(10)
    v_mfma_f32_16x16x32_bf16 v[220:223], v[76:79], v[200:203], v[220:223]
    v_mfma_f32_16x16x32_bf16 v[224:227], v[100:103], v[200:203], v[224:227]
    ds_read_b64_tr_b16 v[200:201], v121 offset:11296
    ds_read_b64_tr_b16 v[202:203], v121 offset:12704
    s_waitcnt lgkmcnt(10)
    v_mfma_f32_16x16x32_bf16 v[220:223], v[80:83], v[204:207], v[220:223]
    v_mfma_f32_16x16x32_bf16 v[224:227], v[104:107], v[204:207], v[224:227]
    ds_read_b64_tr_b16 v[204:205], v121 offset:22560
    ds_read_b64_tr_b16 v[206:207], v121 offset:23968
    s_waitcnt lgkmcnt(10)
    v_mfma_f32_16x16x32_bf16 v[220:223], v[84:87], v[208:211], v[220:223]
    v_mfma_f32_16x16x32_bf16 v[224:227], v[108:111], v[208:211], v[224:227]
    ds_read_b64_tr_b16 v[208:209], v121 offset:33824
    ds_read_b64_tr_b16 v[210:211], v121 offset:35232
    s_waitcnt lgkmcnt(10)
    v_mfma_f32_16x16x32_bf16 v[220:223], v[88:91], v[212:215], v[220:223]
    v_mfma_f32_16x16x32_bf16 v[224:227], v[112:115], v[212:215], v[224:227]
    ds_read_b64_tr_b16 v[212:213], v121 offset:45088
    ds_read_b64_tr_b16 v[214:215], v121 offset:46496
    s_waitcnt lgkmcnt(10)
    v_mfma_f32_16x16x32_bf16 v[220:223], v[92:95], v[216:219], v[220:223]
    v_mfma_f32_16x16x32_bf16 v[224:227], v[116:119], v[216:219], v[224:227]
    ds_read_b64_tr_b16 v[216:217], v121 offset:56352
    ds_read_b64_tr_b16 v[218:219], v121 offset:57760
    s_waitcnt lgkmcnt(10)
    v_mfma_f32_16x16x32_bf16 v[228:231], v[72:75], v[196:199], 0
    v_mfma_f32_16x16x32_bf16 v[232:235], v[96:99], v[196:199], 0
    ds_read_b64_tr_b16 v[196:197], v121 offset:64
    ds_read_b64_tr_b16 v[198:199], v121 offset:1472
    s_waitcnt lgkmcnt(10)
    v_mfma_f32_16x16x32_bf16 v[228:231], v[76:79], v[200:203], v[228:231]
    v_mfma_f32_16x16x32_bf16 v[232:235], v[100:103], v[200:203], v[232:235]
    ds_read_b64_tr_b16 v[200:201], v121 offset:11328
    ds_read_b64_tr_b16 v[202:203], v121 offset:12736
    s_waitcnt lgkmcnt(10)
    v_mfma_f32_16x16x32_bf16 v[228:231], v[80:83], v[204:207], v[228:231]
    v_mfma_f32_16x16x32_bf16 v[232:235], v[104:107], v[204:207], v[232:235]
    ds_read_b64_tr_b16 v[204:205], v121 offset:22592
    ds_read_b64_tr_b16 v[206:207], v121 offset:24000
    v_cvt_pk_bf16_f32 v236, v220, v221
    v_cvt_pk_bf16_f32 v237, v222, v223
    s_waitcnt lgkmcnt(10)
    v_mfma_f32_16x16x32_bf16 v[228:231], v[84:87], v[208:211], v[228:231]
    v_mfma_f32_16x16x32_bf16 v[232:235], v[108:111], v[208:211], v[232:235]
    ds_read_b64_tr_b16 v[208:209], v121 offset:33856
    ds_read_b64_tr_b16 v[210:211], v121 offset:35264
    v_cvt_pk_bf16_f32 v238, v224, v225
    v_cvt_pk_bf16_f32 v239, v226, v227
    s_waitcnt lgkmcnt(10)
    v_mfma_f32_16x16x32_bf16 v[228:231], v[88:91], v[212:215], v[228:231]
    v_mfma_f32_16x16x32_bf16 v[232:235], v[112:115], v[212:215], v[232:235]
    ds_read_b64_tr_b16 v[212:213], v121 offset:45120
    ds_read_b64_tr_b16 v[214:215], v121 offset:46528
    s_cmp_lg_u32 s3, 0
    s_cbranch_scc1 Lls_50082
    buffer_store_dwordx4 v[236:239], v3, s[4:7], s86 offen offset:0
Lle_50083:
    s_waitcnt lgkmcnt(10)
    v_mfma_f32_16x16x32_bf16 v[228:231], v[92:95], v[216:219], v[228:231]
    v_mfma_f32_16x16x32_bf16 v[232:235], v[116:119], v[216:219], v[232:235]
    ds_read_b64_tr_b16 v[216:217], v121 offset:56384
    ds_read_b64_tr_b16 v[218:219], v121 offset:57792
    s_waitcnt lgkmcnt(10)
    v_mfma_f32_16x16x32_bf16 v[220:223], v[72:75], v[196:199], 0
    v_mfma_f32_16x16x32_bf16 v[224:227], v[96:99], v[196:199], 0
    ds_read_b64_tr_b16 v[196:197], v121 offset:96
    ds_read_b64_tr_b16 v[198:199], v121 offset:1504
    s_waitcnt lgkmcnt(10)
    v_mfma_f32_16x16x32_bf16 v[220:223], v[76:79], v[200:203], v[220:223]
    v_mfma_f32_16x16x32_bf16 v[224:227], v[100:103], v[200:203], v[224:227]
    ds_read_b64_tr_b16 v[200:201], v121 offset:11360
    ds_read_b64_tr_b16 v[202:203], v121 offset:12768
    s_waitcnt lgkmcnt(10)
    v_mfma_f32_16x16x32_bf16 v[220:223], v[80:83], v[204:207], v[220:223]
    v_mfma_f32_16x16x32_bf16 v[224:227], v[104:107], v[204:207], v[224:227]
    ds_read_b64_tr_b16 v[204:205], v121 offset:22624
    ds_read_b64_tr_b16 v[206:207], v121 offset:24032
    v_cvt_pk_bf16_f32 v240, v228, v229
    v_cvt_pk_bf16_f32 v241, v230, v231
    s_waitcnt lgkmcnt(10)
    v_mfma_f32_16x16x32_bf16 v[220:223], v[84:87], v[208:211], v[220:223]
    v_mfma_f32_16x16x32_bf16 v[224:227], v[108:111], v[208:211], v[224:227]
    ds_read_b64_tr_b16 v[208:209], v121 offset:33888
    ds_read_b64_tr_b16 v[210:211], v121 offset:35296
    v_cvt_pk_bf16_f32 v242, v232, v233
    v_cvt_pk_bf16_f32 v243, v234, v235
    s_waitcnt lgkmcnt(10)
    v_mfma_f32_16x16x32_bf16 v[220:223], v[88:91], v[212:215], v[220:223]
    v_mfma_f32_16x16x32_bf16 v[224:227], v[112:115], v[212:215], v[224:227]
    ds_read_b64_tr_b16 v[212:213], v121 offset:45152
    ds_read_b64_tr_b16 v[214:215], v121 offset:46560
    s_cmp_lg_u32 s3, 0
    s_cbranch_scc1 Lls_50084
    buffer_store_dwordx4 v[240:243], v3, s[4:7], s86 offen offset:1024
Lle_50085:
    s_waitcnt lgkmcnt(10)
    v_mfma_f32_16x16x32_bf16 v[220:223], v[92:95], v[216:219], v[220:223]
    v_mfma_f32_16x16x32_bf16 v[224:227], v[116:119], v[216:219], v[224:227]
    ds_read_b64_tr_b16 v[216:217], v121 offset:56416
    ds_read_b64_tr_b16 v[218:219], v121 offset:57824
    s_waitcnt lgkmcnt(10)
    v_mfma_f32_16x16x32_bf16 v[228:231], v[72:75], v[196:199], 0
    v_mfma_f32_16x16x32_bf16 v[232:235], v[96:99], v[196:199], 0
    ds_read_b64_tr_b16 v[196:197], v121 offset:128
    ds_read_b64_tr_b16 v[198:199], v121 offset:1536
    s_waitcnt lgkmcnt(10)
    v_mfma_f32_16x16x32_bf16 v[228:231], v[76:79], v[200:203], v[228:231]
    v_mfma_f32_16x16x32_bf16 v[232:235], v[100:103], v[200:203], v[232:235]
    ds_read_b64_tr_b16 v[200:201], v121 offset:11392
    ds_read_b64_tr_b16 v[202:203], v121 offset:12800
    s_waitcnt lgkmcnt(10)
    v_mfma_f32_16x16x32_bf16 v[228:231], v[80:83], v[204:207], v[228:231]
    v_mfma_f32_16x16x32_bf16 v[232:235], v[104:107], v[204:207], v[232:235]
    ds_read_b64_tr_b16 v[204:205], v121 offset:22656
    ds_read_b64_tr_b16 v[206:207], v121 offset:24064
    v_cvt_pk_bf16_f32 v236, v220, v221
    v_cvt_pk_bf16_f32 v237, v222, v223
    s_waitcnt lgkmcnt(10)
    v_mfma_f32_16x16x32_bf16 v[228:231], v[84:87], v[208:211], v[228:231]
    v_mfma_f32_16x16x32_bf16 v[232:235], v[108:111], v[208:211], v[232:235]
    ds_read_b64_tr_b16 v[208:209], v121 offset:33920
    ds_read_b64_tr_b16 v[210:211], v121 offset:35328
    v_cvt_pk_bf16_f32 v238, v224, v225
    v_cvt_pk_bf16_f32 v239, v226, v227
    s_waitcnt lgkmcnt(10)
    v_mfma_f32_16x16x32_bf16 v[228:231], v[88:91], v[212:215], v[228:231]
    v_mfma_f32_16x16x32_bf16 v[232:235], v[112:115], v[212:215], v[232:235]
    ds_read_b64_tr_b16 v[212:213], v121 offset:45184
    ds_read_b64_tr_b16 v[214:215], v121 offset:46592
    s_cmp_lg_u32 s3, 0
    s_cbranch_scc1 Lls_50086
    buffer_store_dwordx4 v[236:239], v3, s[4:7], s86 offen offset:2048
Lle_50087:
    s_waitcnt lgkmcnt(10)
    v_mfma_f32_16x16x32_bf16 v[228:231], v[92:95], v[216:219], v[228:231]
    v_mfma_f32_16x16x32_bf16 v[232:235], v[116:119], v[216:219], v[232:235]
    ds_read_b64_tr_b16 v[216:217], v121 offset:56448
    ds_read_b64_tr_b16 v[218:219], v121 offset:57856
    s_waitcnt lgkmcnt(10)
    v_mfma_f32_16x16x32_bf16 v[220:223], v[72:75], v[196:199], 0
    v_mfma_f32_16x16x32_bf16 v[224:227], v[96:99], v[196:199], 0
    ds_read_b64_tr_b16 v[196:197], v121 offset:160
    ds_read_b64_tr_b16 v[198:199], v121 offset:1568
    s_waitcnt lgkmcnt(10)
    v_mfma_f32_16x16x32_bf16 v[220:223], v[76:79], v[200:203], v[220:223]
    v_mfma_f32_16x16x32_bf16 v[224:227], v[100:103], v[200:203], v[224:227]
    ds_read_b64_tr_b16 v[200:201], v121 offset:11424
    ds_read_b64_tr_b16 v[202:203], v121 offset:12832
    s_waitcnt lgkmcnt(10)
    v_mfma_f32_16x16x32_bf16 v[220:223], v[80:83], v[204:207], v[220:223]
    v_mfma_f32_16x16x32_bf16 v[224:227], v[104:107], v[204:207], v[224:227]
    ds_read_b64_tr_b16 v[204:205], v121 offset:22688
    ds_read_b64_tr_b16 v[206:207], v121 offset:24096
    v_cvt_pk_bf16_f32 v240, v228, v229
    v_cvt_pk_bf16_f32 v241, v230, v231
    s_waitcnt lgkmcnt(10)
    v_mfma_f32_16x16x32_bf16 v[220:223], v[84:87], v[208:211], v[220:223]
    v_mfma_f32_16x16x32_bf16 v[224:227], v[108:111], v[208:211], v[224:227]
    ds_read_b64_tr_b16 v[208:209], v121 offset:33952
    ds_read_b64_tr_b16 v[210:211], v121 offset:35360
    v_cvt_pk_bf16_f32 v242, v232, v233
    v_cvt_pk_bf16_f32 v243, v234, v235
    s_waitcnt lgkmcnt(10)
    v_mfma_f32_16x16x32_bf16 v[220:223], v[88:91], v[212:215], v[220:223]
    v_mfma_f32_16x16x32_bf16 v[224:227], v[112:115], v[212:215], v[224:227]
    ds_read_b64_tr_b16 v[212:213], v121 offset:45216
    ds_read_b64_tr_b16 v[214:215], v121 offset:46624
    s_cmp_lg_u32 s3, 0
    s_cbranch_scc1 Lls_50088
    buffer_store_dwordx4 v[240:243], v3, s[4:7], s86 offen offset:3072
Lle_50089:
    s_waitcnt lgkmcnt(10)
    v_mfma_f32_16x16x32_bf16 v[220:223], v[92:95], v[216:219], v[220:223]
    v_mfma_f32_16x16x32_bf16 v[224:227], v[116:119], v[216:219], v[224:227]
    ds_read_b64_tr_b16 v[216:217], v121 offset:56480
    ds_read_b64_tr_b16 v[218:219], v121 offset:57888
    s_waitcnt lgkmcnt(10)
    v_mfma_f32_16x16x32_bf16 v[228:231], v[72:75], v[196:199], 0
    v_mfma_f32_16x16x32_bf16 v[232:235], v[96:99], v[196:199], 0
    ds_read_b64_tr_b16 v[196:197], v121 offset:192
    ds_read_b64_tr_b16 v[198:199], v121 offset:1600
    s_waitcnt lgkmcnt(10)
    v_mfma_f32_16x16x32_bf16 v[228:231], v[76:79], v[200:203], v[228:231]
    v_mfma_f32_16x16x32_bf16 v[232:235], v[100:103], v[200:203], v[232:235]
    ds_read_b64_tr_b16 v[200:201], v121 offset:11456
    ds_read_b64_tr_b16 v[202:203], v121 offset:12864
    s_waitcnt lgkmcnt(10)
    v_mfma_f32_16x16x32_bf16 v[228:231], v[80:83], v[204:207], v[228:231]
    v_mfma_f32_16x16x32_bf16 v[232:235], v[104:107], v[204:207], v[232:235]
    ds_read_b64_tr_b16 v[204:205], v121 offset:22720
    ds_read_b64_tr_b16 v[206:207], v121 offset:24128
    v_cvt_pk_bf16_f32 v236, v220, v221
    v_cvt_pk_bf16_f32 v237, v222, v223
    s_waitcnt lgkmcnt(10)
    v_mfma_f32_16x16x32_bf16 v[228:231], v[84:87], v[208:211], v[228:231]
    v_mfma_f32_16x16x32_bf16 v[232:235], v[108:111], v[208:211], v[232:235]
    ds_read_b64_tr_b16 v[208:209], v121 offset:33984
    ds_read_b64_tr_b16 v[210:211], v121 offset:35392
    v_cvt_pk_bf16_f32 v238, v224, v225
    v_cvt_pk_bf16_f32 v239, v226, v227
    s_waitcnt lgkmcnt(10)
    v_mfma_f32_16x16x32_bf16 v[228:231], v[88:91], v[212:215], v[228:231]
    v_mfma_f32_16x16x32_bf16 v[232:235], v[112:115], v[212:215], v[232:235]
    ds_read_b64_tr_b16 v[212:213], v121 offset:45248
    ds_read_b64_tr_b16 v[214:215], v121 offset:46656
    s_cmp_lg_u32 s3, 0
    s_cbranch_scc1 Lls_50090
    buffer_store_dwordx4 v[236:239], v3, s[4:7], s87 offen offset:0
Lle_50091:
    s_waitcnt lgkmcnt(10)
    v_mfma_f32_16x16x32_bf16 v[228:231], v[92:95], v[216:219], v[228:231]
    v_mfma_f32_16x16x32_bf16 v[232:235], v[116:119], v[216:219], v[232:235]
    ds_read_b64_tr_b16 v[216:217], v121 offset:56512
    ds_read_b64_tr_b16 v[218:219], v121 offset:57920
    s_waitcnt lgkmcnt(10)
    v_mfma_f32_16x16x32_bf16 v[220:223], v[72:75], v[196:199], 0
    v_mfma_f32_16x16x32_bf16 v[224:227], v[96:99], v[196:199], 0
    ds_read_b64_tr_b16 v[196:197], v121 offset:224
    ds_read_b64_tr_b16 v[198:199], v121 offset:1632
    s_waitcnt lgkmcnt(10)
    v_mfma_f32_16x16x32_bf16 v[220:223], v[76:79], v[200:203], v[220:223]
    v_mfma_f32_16x16x32_bf16 v[224:227], v[100:103], v[200:203], v[224:227]
    ds_read_b64_tr_b16 v[200:201], v121 offset:11488
    ds_read_b64_tr_b16 v[202:203], v121 offset:12896
    s_waitcnt lgkmcnt(10)
    v_mfma_f32_16x16x32_bf16 v[220:223], v[80:83], v[204:207], v[220:223]
    v_mfma_f32_16x16x32_bf16 v[224:227], v[104:107], v[204:207], v[224:227]
    ds_read_b64_tr_b16 v[204:205], v121 offset:22752
    ds_read_b64_tr_b16 v[206:207], v121 offset:24160
    v_cvt_pk_bf16_f32 v240, v228, v229
    v_cvt_pk_bf16_f32 v241, v230, v231
    s_waitcnt lgkmcnt(10)
    v_mfma_f32_16x16x32_bf16 v[220:223], v[84:87], v[208:211], v[220:223]
    v_mfma_f32_16x16x32_bf16 v[224:227], v[108:111], v[208:211], v[224:227]
    ds_read_b64_tr_b16 v[208:209], v121 offset:34016
    ds_read_b64_tr_b16 v[210:211], v121 offset:35424
    v_cvt_pk_bf16_f32 v242, v232, v233
    v_cvt_pk_bf16_f32 v243, v234, v235
    s_waitcnt lgkmcnt(10)
    v_mfma_f32_16x16x32_bf16 v[220:223], v[88:91], v[212:215], v[220:223]
    v_mfma_f32_16x16x32_bf16 v[224:227], v[112:115], v[212:215], v[224:227]
    ds_read_b64_tr_b16 v[212:213], v121 offset:45280
    ds_read_b64_tr_b16 v[214:215], v121 offset:46688
    s_cmp_lg_u32 s3, 0
    s_cbranch_scc1 Lls_50092
    buffer_store_dwordx4 v[240:243], v3, s[4:7], s87 offen offset:1024
Lle_50093:
    s_waitcnt lgkmcnt(10)
    v_mfma_f32_16x16x32_bf16 v[220:223], v[92:95], v[216:219], v[220:223]
    v_mfma_f32_16x16x32_bf16 v[224:227], v[116:119], v[216:219], v[224:227]
    ds_read_b64_tr_b16 v[216:217], v121 offset:56544
    ds_read_b64_tr_b16 v[218:219], v121 offset:57952
    s_waitcnt lgkmcnt(10)
    v_mfma_f32_16x16x32_bf16 v[228:231], v[72:75], v[196:199], 0
    v_mfma_f32_16x16x32_bf16 v[232:235], v[96:99], v[196:199], 0
    ds_read_b64_tr_b16 v[196:197], v121 offset:256
    ds_read_b64_tr_b16 v[198:199], v121 offset:1664
    s_waitcnt lgkmcnt(10)
    v_mfma_f32_16x16x32_bf16 v[228:231], v[76:79], v[200:203], v[228:231]
    v_mfma_f32_16x16x32_bf16 v[232:235], v[100:103], v[200:203], v[232:235]
    ds_read_b64_tr_b16 v[200:201], v121 offset:11520
    ds_read_b64_tr_b16 v[202:203], v121 offset:12928
    s_waitcnt lgkmcnt(10)
    v_mfma_f32_16x16x32_bf16 v[228:231], v[80:83], v[204:207], v[228:231]
    v_mfma_f32_16x16x32_bf16 v[232:235], v[104:107], v[204:207], v[232:235]
    ds_read_b64_tr_b16 v[204:205], v121 offset:22784
    ds_read_b64_tr_b16 v[206:207], v121 offset:24192
    v_cvt_pk_bf16_f32 v236, v220, v221
    v_cvt_pk_bf16_f32 v237, v222, v223
    s_waitcnt lgkmcnt(10)
    v_mfma_f32_16x16x32_bf16 v[228:231], v[84:87], v[208:211], v[228:231]
    v_mfma_f32_16x16x32_bf16 v[232:235], v[108:111], v[208:211], v[232:235]
    ds_read_b64_tr_b16 v[208:209], v121 offset:34048
    ds_read_b64_tr_b16 v[210:211], v121 offset:35456
    v_cvt_pk_bf16_f32 v238, v224, v225
    v_cvt_pk_bf16_f32 v239, v226, v227
    s_waitcnt lgkmcnt(10)
    v_mfma_f32_16x16x32_bf16 v[228:231], v[88:91], v[212:215], v[228:231]
    v_mfma_f32_16x16x32_bf16 v[232:235], v[112:115], v[212:215], v[232:235]
    ds_read_b64_tr_b16 v[212:213], v121 offset:45312
    ds_read_b64_tr_b16 v[214:215], v121 offset:46720
    s_cmp_lg_u32 s3, 0
    s_cbranch_scc1 Lls_50094
    buffer_store_dwordx4 v[236:239], v3, s[4:7], s87 offen offset:2048
Lle_50095:
    s_waitcnt lgkmcnt(10)
    v_mfma_f32_16x16x32_bf16 v[228:231], v[92:95], v[216:219], v[228:231]
    v_mfma_f32_16x16x32_bf16 v[232:235], v[116:119], v[216:219], v[232:235]
    ds_read_b64_tr_b16 v[216:217], v121 offset:56576
    ds_read_b64_tr_b16 v[218:219], v121 offset:57984
    s_waitcnt lgkmcnt(10)
    v_mfma_f32_16x16x32_bf16 v[220:223], v[72:75], v[196:199], 0
    v_mfma_f32_16x16x32_bf16 v[224:227], v[96:99], v[196:199], 0
    ds_read_b64_tr_b16 v[196:197], v121 offset:288
    ds_read_b64_tr_b16 v[198:199], v121 offset:1696
    s_waitcnt lgkmcnt(10)
    v_mfma_f32_16x16x32_bf16 v[220:223], v[76:79], v[200:203], v[220:223]
    v_mfma_f32_16x16x32_bf16 v[224:227], v[100:103], v[200:203], v[224:227]
    ds_read_b64_tr_b16 v[200:201], v121 offset:11552
    ds_read_b64_tr_b16 v[202:203], v121 offset:12960
    s_waitcnt lgkmcnt(10)
    v_mfma_f32_16x16x32_bf16 v[220:223], v[80:83], v[204:207], v[220:223]
    v_mfma_f32_16x16x32_bf16 v[224:227], v[104:107], v[204:207], v[224:227]
    ds_read_b64_tr_b16 v[204:205], v121 offset:22816
    ds_read_b64_tr_b16 v[206:207], v121 offset:24224
    v_cvt_pk_bf16_f32 v240, v228, v229
    v_cvt_pk_bf16_f32 v241, v230, v231
    s_waitcnt lgkmcnt(10)
    v_mfma_f32_16x16x32_bf16 v[220:223], v[84:87], v[208:211], v[220:223]
    v_mfma_f32_16x16x32_bf16 v[224:227], v[108:111], v[208:211], v[224:227]
    ds_read_b64_tr_b16 v[208:209], v121 offset:34080
    ds_read_b64_tr_b16 v[210:211], v121 offset:35488
    v_cvt_pk_bf16_f32 v242, v232, v233
    v_cvt_pk_bf16_f32 v243, v234, v235
    s_waitcnt lgkmcnt(10)
    v_mfma_f32_16x16x32_bf16 v[220:223], v[88:91], v[212:215], v[220:223]
    v_mfma_f32_16x16x32_bf16 v[224:227], v[112:115], v[212:215], v[224:227]
    ds_read_b64_tr_b16 v[212:213], v121 offset:45344
    ds_read_b64_tr_b16 v[214:215], v121 offset:46752
    s_cmp_lg_u32 s3, 0
    s_cbranch_scc1 Lls_50096
    buffer_store_dwordx4 v[240:243], v3, s[4:7], s87 offen offset:3072
Lle_50097:
    s_waitcnt lgkmcnt(10)
    v_mfma_f32_16x16x32_bf16 v[220:223], v[92:95], v[216:219], v[220:223]
    v_mfma_f32_16x16x32_bf16 v[224:227], v[116:119], v[216:219], v[224:227]
    ds_read_b64_tr_b16 v[216:217], v121 offset:56608
    ds_read_b64_tr_b16 v[218:219], v121 offset:58016
    s_waitcnt lgkmcnt(10)
    v_mfma_f32_16x16x32_bf16 v[228:231], v[72:75], v[196:199], 0
    v_mfma_f32_16x16x32_bf16 v[232:235], v[96:99], v[196:199], 0
    s_waitcnt lgkmcnt(8)
    v_mfma_f32_16x16x32_bf16 v[228:231], v[76:79], v[200:203], v[228:231]
    v_mfma_f32_16x16x32_bf16 v[232:235], v[100:103], v[200:203], v[232:235]
    s_waitcnt lgkmcnt(6)
    v_mfma_f32_16x16x32_bf16 v[228:231], v[80:83], v[204:207], v[228:231]
    v_mfma_f32_16x16x32_bf16 v[232:235], v[104:107], v[204:207], v[232:235]
    v_cvt_pk_bf16_f32 v236, v220, v221
    v_cvt_pk_bf16_f32 v237, v222, v223
    s_waitcnt lgkmcnt(4)
    v_mfma_f32_16x16x32_bf16 v[228:231], v[84:87], v[208:211], v[228:231]
    v_mfma_f32_16x16x32_bf16 v[232:235], v[108:111], v[208:211], v[232:235]
    v_cvt_pk_bf16_f32 v238, v224, v225
    v_cvt_pk_bf16_f32 v239, v226, v227
    s_waitcnt lgkmcnt(2)
    v_mfma_f32_16x16x32_bf16 v[228:231], v[88:91], v[212:215], v[228:231]
    v_mfma_f32_16x16x32_bf16 v[232:235], v[112:115], v[212:215], v[232:235]
    s_cmp_lg_u32 s3, 0
    s_cbranch_scc1 Lls_50098
    buffer_store_dwordx4 v[236:239], v3, s[4:7], s88 offen offset:0
Lle_50099:
    s_waitcnt lgkmcnt(0)
    v_mfma_f32_16x16x32_bf16 v[228:231], v[92:95], v[216:219], v[228:231]
    v_mfma_f32_16x16x32_bf16 v[232:235], v[116:119], v[216:219], v[232:235]
    s_nop 6
    v_cvt_pk_bf16_f32 v240, v228, v229
    v_cvt_pk_bf16_f32 v241, v230, v231
    v_cvt_pk_bf16_f32 v242, v232, v233
    v_cvt_pk_bf16_f32 v243, v234, v235
    s_cmp_lg_u32 s3, 0
    s_cbranch_scc1 Lls_50100
    buffer_store_dwordx4 v[240:243], v3, s[4:7], s88 offen offset:1024
Lle_50101:
    s_nop 1
    s_setpc_b64 s[12:13]
Lls_50006:
    s_nop 4
    buffer_store_dword v123, v122, s[4:7], 0 offen offset:0 sc1
    s_branch Lle_50007
Lls_50011:
    s_nop 4
    buffer_store_dword v123, v122, s[4:7], 0 offen offset:128 sc1
    s_branch Lle_50012
Lls_50016:
    s_nop 4
    buffer_store_dword v123, v122, s[4:7], 0 offen offset:256 sc1
    s_branch Lle_50017
Lls_50021:
    s_nop 4
    buffer_store_dword v123, v122, s[4:7], 0 offen offset:384 sc1
    s_branch Lle_50022
Lls_50026:
    s_nop 4
    buffer_store_dword v123, v122, s[4:7], 0 offen offset:512 sc1
    s_branch Lle_50027
Lls_50040:
    s_nop 4
    buffer_store_dwordx2 v[132:133], v6, s[4:7], s56 offen sc1
    buffer_store_dwordx2 a[252:253], v6, s[4:7], s57 offen sc1
    s_branch Lle_50041
Lls_50042:
    s_nop 4
    buffer_store_dwordx2 v[132:133], v6, s[4:7], s56 offen sc1
    buffer_store_dwordx2 a[252:253], v6, s[4:7], s57 offen sc1
    s_branch Lle_50043
Llast_50045:
    s_nop 7
    s_cmp_lg_u32 s14, 3
    s_cbranch_scc1 Llq_50102
    s_waitcnt vmcnt(0)
    v_mov_b32 v2, s17
    s_mov_b64 exec, 1
    buffer_store_dword v2, v21, s[4:7], 0 offen sc1
    s_mov_b64 exec, -1
Llq_50102:
    v_cvt_pk_bf16_f32 v62, v68, v69
    v_cvt_pk_bf16_f32 v100, v70, v71
    v_cvt_pk_bf16_f32 v63, v72, v73
    v_cvt_pk_bf16_f32 v101, v74, v75
    v_cvt_pk_bf16_f32 v64, v76, v77
    v_cvt_pk_bf16_f32 v102, v78, v79
    v_permlane32_swap_b32 v62, v100
    v_permlane32_swap_b32 v63, v101
    v_permlane32_swap_b32 v64, v102
    ds_write_b32 v15, v62
    ds_write_b32 v15, v63 offset:384
    ds_write_b32 v16, v64
    v_mov_b32_dpp v65, v64 row_ror:8 row_mask:0xf bank_mask:0xf
    s_waitcnt lgkmcnt(0)
    s_barrier
    s_add_u32 s17, s17, 1
    s_branch Lexit_50046
Lng_50050:
    s_nop 15
    s_mov_b64 exec, -1
    v_max3_u32 v2, v80, v81, v82
    v_max3_u32 v2, v2, v83, v84
    v_max3_u32 v2, v2, v85, v86
    v_max3_u32 v2, v2, v87, v88
    v_max3_u32 v2, v2, v89, v90
    v_max3_u32 v2, v2, v91, v92
    v_max3_u32 v2, v2, v93, v94
    v_max3_u32 v2, v2, v95, v96
    v_max3_u32 v2, v2, v97, v98
    v_max_u32 v2, v2, v99
    v_cmp_eq_u32 vcc, -1, v2
    s_nop 0
    s_cbranch_vccz Lgive_50103
    s_add_u32 s30, s30, 1
    s_cmp_ge_u32 s30, s31
    s_cbranch_scc1 Lgive_50103
    s_mov_b64 exec, vcc
    buffer_load_dwordx4 v[80:83], v7, s[4:7], s56 offen offset:0 sc1
    buffer_load_dwordx4 v[84:87], v7, s[4:7], s56 offen offset:128 sc1
    buffer_load_dwordx4 v[88:91], v7, s[4:7], s56 offen offset:256 sc1
    buffer_load_dwordx4 v[92:95], v7, s[4:7], s56 offen offset:384 sc1
    buffer_load_dwordx4 v[96:99], v7, s[4:7], s56 offen offset:512 sc1
    s_mov_b64 exec, -1
    s_branch Lea_50047
Lgive_50103:
    s_mov_b64 exec, -1
    s_branch Lnc_50051
Lls_50062:
    s_nop 4
    buffer_store_dwordx4 v[236:239], v3, s[4:7], s86 offen offset:0 sc1
    s_nop 0
    s_branch Lle_50063
Lls_50064:
    s_nop 4
    buffer_store_dwordx4 v[240:243], v3, s[4:7], s86 offen offset:1024 sc1
    s_nop 0
    s_branch Lle_50065
Lls_50066:
    s_nop 4
    buffer_store_dwordx4 v[236:239], v3, s[4:7], s86 offen offset:2048 sc1
    s_nop 0
    s_branch Lle_50067
Lls_50068:
    s_nop 4
    buffer_store_dwordx4 v[240:243], v3, s[4:7], s86 offen offset:3072 sc1
    s_nop 0
    s_branch Lle_50069
Lls_50070:
    s_nop 4
    buffer_store_dwordx4 v[236:239], v3, s[4:7], s87 offen offset:0 sc1
    s_nop 0
    s_branch Lle_50071
Lls_50072:
    s_nop 4
    buffer_store_dwordx4 v[240:243], v3, s[4:7], s87 offen offset:1024 sc1
    s_nop 0
    s_branch Lle_50073
Lls_50074:
    s_nop 4
    buffer_store_dwordx4 v[236:239], v3, s[4:7], s87 offen offset:2048 sc1
    s_nop 0
    s_branch Lle_50075
Lls_50076:
    s_nop 4
    buffer_store_dwordx4 v[240:243], v3, s[4:7], s87 offen offset:3072 sc1
    s_nop 0
    s_branch Lle_50077
Lls_50078:
    s_nop 4
    buffer_store_dwordx4 v[236:239], v3, s[4:7], s88 offen offset:0 sc1
    s_nop 0
    s_branch Lle_50079
Lls_50080:
    s_nop 4
    buffer_store_dwordx4 v[240:243], v3, s[4:7], s88 offen offset:1024 sc1
    s_nop 0
    s_branch Lle_50081
Lls_50082:
    s_nop 4
    buffer_store_dwordx4 v[236:239], v3, s[4:7], s86 offen offset:0 sc1
    s_nop 0
    s_branch Lle_50083
Lls_50084:
    s_nop 4
    buffer_store_dwordx4 v[240:243], v3, s[4:7], s86 offen offset:1024 sc1
    s_nop 0
    s_branch Lle_50085
Lls_50086:
    s_nop 4
    buffer_store_dwordx4 v[236:239], v3, s[4:7], s86 offen offset:2048 sc1
    s_nop 0
    s_branch Lle_50087
Lls_50088:
    s_nop 4
    buffer_store_dwordx4 v[240:243], v3, s[4:7], s86 offen offset:3072 sc1
    s_nop 0
    s_branch Lle_50089
Lls_50090:
    s_nop 4
    buffer_store_dwordx4 v[236:239], v3, s[4:7], s87 offen offset:0 sc1
    s_nop 0
    s_branch Lle_50091
Lls_50092:
    s_nop 4
    buffer_store_dwordx4 v[240:243], v3, s[4:7], s87 offen offset:1024 sc1
    s_nop 0
    s_branch Lle_50093
Lls_50094:
    s_nop 4
    buffer_store_dwordx4 v[236:239], v3, s[4:7], s87 offen offset:2048 sc1
    s_nop 0
    s_branch Lle_50095
Lls_50096:
    s_nop 4
    buffer_store_dwordx4 v[240:243], v3, s[4:7], s87 offen offset:3072 sc1
    s_nop 0
    s_branch Lle_50097
Lls_50098:
    s_nop 4
    buffer_store_dwordx4 v[236:239], v3, s[4:7], s88 offen offset:0 sc1
    s_nop 0
    s_branch Lle_50099
Lls_50100:
    s_nop 4
    buffer_store_dwordx4 v[240:243], v3, s[4:7], s88 offen offset:1024 sc1
    s_nop 0
    s_branch Lle_50101
Lmain_worker:
    s_load_dwordx8 s[48:55], s[0:1], 16
    s_mov_b32 s64, s8
    s_mov_b32 s65, s9
    s_mov_b32 s66, s10
    s_mov_b32 s67, s11
    s_sub_u32 s15, s15, 4
    s_lshl_b32 s26, s15, 3
    s_lshr_b32 s17, s16, 2
    s_add_u32 s26, s26, s17
    s_lshl_b32 s47, s15, 7
    s_lshl_b32 s17, s17, 2
    s_add_u32 s47, s47, s17
    s_add_u32 s47, s47, 0xb201000
    s_and_b32 s16, s16, 3
    s_mov_b32 s17, 0
    s_mov_b32 s18, 64
    s_waitcnt lgkmcnt(0)
    s_mov_b32 s68, s26
    s_mov_b32 s61, s30
    s_mov_b32 s69, s16
    s_load_dwordx4 s[8:11], s[0:1], 0
    s_load_dwordx8 s[16:23], s[0:1], 64
    v_mov_b32 v2, v0
    s_lshl_b32 s24, s14, 6
    v_add_u32 v0, s24, v0
    s_waitcnt lgkmcnt(0)
    s_cmp_lg_u32 s69, 3
    s_cbranch_scc1 Lmain_ln
    s_mov_b32 s60, s68
    s_add_u32 s2, s60, 298
    s_call_b64 s[62:63], Lprep_sub
Lpt_50104:
    s_add_u32 s2, s60, 330
    s_cmp_ge_u32 s2, 335
    s_cbranch_scc1 Lpt_50105
    s_call_b64 s[62:63], Lprep_sub
Lpt_50105:
    s_waitcnt vmcnt(0)
    s_barrier
    s_cmp_lg_u32 s14, 0
    s_cbranch_scc1 Lpd_50106
    v_mov_b32 v3, 32
    v_mov_b32 v4, 1
    s_mov_b64 exec, 1
    buffer_atomic_add v4, v3, s[64:67], 0 offen
    s_mov_b64 exec, -1
Lpd_50106:
Lmain_ln:
    s_lshl_b32 s60, s68, 2
    s_add_u32 s60, s60, s69
    s_add_u32 s2, s60, 0
    s_call_b64 s[62:63], Lprep_sub
Lpt_50107:
    s_waitcnt vmcnt(0)
    s_barrier
    s_cmp_lg_u32 s14, 0
    s_cbranch_scc1 Lpd_50108
    v_mov_b32 v3, 36
    v_mov_b32 v4, 1
    s_mov_b64 exec, 1
    buffer_atomic_add v4, v3, s[64:67], 0 offen
    s_mov_b64 exec, -1
Lpd_50108:
    s_waitcnt vmcnt(0)
    s_barrier
    v_mov_b32 v0, v2
    s_mov_b32 s26, s68
    s_mov_b32 s30, s61
    s_mov_b32 s31, 0x100000
    s_mov_b32 s16, s69
    s_mov_b32 s17, 0
    s_mov_b32 s18, 64
    s_cmp_eq_u32 s16, 2
    s_cbranch_scc1 Lmain_u
    s_cmp_eq_u32 s16, 3
    s_cbranch_scc1 Lmain_q
    s_mov_b32 s8, s50
    s_mov_b32 s9, s51
    s_mov_b32 s19, 0x400000
    s_add_u32 s47, s47, 32
    s_cmp_eq_u32 s16, 0
    s_cbranch_scc1 Lmain_p
    s_mov_b32 s8, s52
    s_mov_b32 s9, s53
    s_mov_b32 s19, 0x1c00000
    s_lshl_b32 s47, s26, 7
    s_add_u32 s47, s47, 0xb201400
Lmain_p:
    s_lshl_b32 s27, s14, 10
    s_lshl_b32 s29, s14, 6
    v_add_u32 v40, s29, v0
    v_add_u32 v40, 0, v40
    v_mul_u32_u24 v41, 0xaab, v40
    v_lshrrev_b32 v41, 16, v41
    v_mul_u32_u24 v42, 24, v41
    v_sub_u32 v42, v40, v42
    v_mul_u32_u24 v41, 12288, v41
    v_lshl_add_u32 v43, v42, 4, v41
    v_add_u32 v40, s29, v0
    v_add_u32 v40, 256, v40
    v_mul_u32_u24 v41, 0xaab, v40
    v_lshrrev_b32 v41, 16, v41
    v_mul_u32_u24 v42, 24, v41
    v_sub_u32 v42, v40, v42
    v_mul_u32_u24 v41, 12288, v41
    v_lshl_add_u32 v44, v42, 4, v41
    v_add_u32 v40, s29, v0
    v_add_u32 v40, 512, v40
    v_mul_u32_u24 v41, 0xaab, v40
    v_lshrrev_b32 v41, 16, v41
    v_mul_u32_u24 v42, 24, v41
    v_sub_u32 v42, v40, v42
    v_mul_u32_u24 v41, 12288, v41
    v_lshl_add_u32 v45, v42, 4, v41
    s_mul_i32 s28, s26, 384
    s_add_u32 s32, s8, s28
    s_addc_u32 s33, s9, 0
    v_lshrrev_b32 v40, 4, v0
    v_bfe_u32 v41, v0, 2, 2
    v_lshl_add_u32 v40, v40, 2, v41
    v_mul_u32_u24 v40, 384, v40
    v_and_b32 v41, 3, v0
    v_mul_u32_u24 v41, 24, v41
    s_mul_i32 s29, s14, 96
    v_add3_u32 v40, v40, v41, s29
    v_add_u32 v41, 61440, v40
    s_add_u32 m0, s27, 0
    s_nop 0
    global_load_lds_dwordx4 v43, s[32:33]
    s_add_u32 m0, s27, 4096
    s_nop 0
    global_load_lds_dwordx4 v44, s[32:33]
    s_add_u32 m0, s27, 8192
    s_nop 0
    global_load_lds_dwordx4 v45, s[32:33]
    s_add_u32 s32, s32, 393216
    s_addc_u32 s33, s33, 0
    s_add_u32 m0, s27, 12288
    s_nop 0
    global_load_lds_dwordx4 v43, s[32:33]
    s_add_u32 m0, s27, 16384
    s_nop 0
    global_load_lds_dwordx4 v44, s[32:33]
    s_add_u32 m0, s27, 20480
    s_nop 0
    global_load_lds_dwordx4 v45, s[32:33]
    s_add_u32 s32, s32, 393216
    s_addc_u32 s33, s33, 0
    s_add_u32 m0, s27, 24576
    s_nop 0
    global_load_lds_dwordx4 v43, s[32:33]
    s_add_u32 m0, s27, 28672
    s_nop 0
    global_load_lds_dwordx4 v44, s[32:33]
    s_add_u32 m0, s27, 32768
    s_nop 0
    global_load_lds_dwordx4 v45, s[32:33]
    s_add_u32 s32, s32, 393216
    s_addc_u32 s33, s33, 0
    s_add_u32 m0, s27, 36864
    s_nop 0
    global_load_lds_dwordx4 v43, s[32:33]
    s_add_u32 m0, s27, 40960
    s_nop 0
    global_load_lds_dwordx4 v44, s[32:33]
    s_add_u32 m0, s27, 45056
    s_nop 0
    global_load_lds_dwordx4 v45, s[32:33]
    s_add_u32 s32, s32, 393216
    s_addc_u32 s33, s33, 0
    s_add_u32 m0, s27, 49152
    s_nop 0
    global_load_lds_dwordx4 v43, s[32:33]
    s_add_u32 m0, s27, 53248
    s_nop 0
    global_load_lds_dwordx4 v44, s[32:33]
    s_add_u32 m0, s27, 57344
    s_nop 0
    global_load_lds_dwordx4 v45, s[32:33]
    s_add_u32 s32, s32, 393216
    s_addc_u32 s33, s33, 0
    s_add_u32 m0, s27, 61440
    s_nop 0
    global_load_lds_dwordx4 v43, s[32:33]
    s_add_u32 m0, s27, 65536
    s_nop 0
    global_load_lds_dwordx4 v44, s[32:33]
    s_add_u32 m0, s27, 69632
    s_nop 0
    global_load_lds_dwordx4 v45, s[32:33]
    s_add_u32 s32, s32, 393216
    s_addc_u32 s33, s33, 0
    s_add_u32 m0, s27, 73728
    s_nop 0
    global_load_lds_dwordx4 v43, s[32:33]
    s_add_u32 m0, s27, 77824
    s_nop 0
    global_load_lds_dwordx4 v44, s[32:33]
    s_add_u32 m0, s27, 81920
    s_nop 0
    global_load_lds_dwordx4 v45, s[32:33]
    s_add_u32 s32, s32, 393216
    s_addc_u32 s33, s33, 0
    s_add_u32 m0, s27, 86016
    s_nop 0
    global_load_lds_dwordx4 v43, s[32:33]
    s_add_u32 m0, s27, 90112
    s_nop 0
    global_load_lds_dwordx4 v44, s[32:33]
    s_add_u32 m0, s27, 94208
    s_nop 0
    global_load_lds_dwordx4 v45, s[32:33]
    s_add_u32 s32, s32, 393216
    s_addc_u32 s33, s33, 0
    s_add_u32 m0, s27, 98304
    s_nop 0
    global_load_lds_dwordx4 v43, s[32:33]
    s_add_u32 m0, s27, 102400
    s_nop 0
    global_load_lds_dwordx4 v44, s[32:33]
    s_add_u32 m0, s27, 106496
    s_nop 0
    global_load_lds_dwordx4 v45, s[32:33]
    s_add_u32 s32, s32, 393216
    s_addc_u32 s33, s33, 0
    s_add_u32 m0, s27, 110592
    s_nop 0
    global_load_lds_dwordx4 v43, s[32:33]
    s_add_u32 m0, s27, 114688
    s_nop 0
    global_load_lds_dwordx4 v44, s[32:33]
    s_add_u32 m0, s27, 118784
    s_nop 0
    global_load_lds_dwordx4 v45, s[32:33]
    s_add_u32 s32, s32, 393216
    s_addc_u32 s33, s33, 0
    s_waitcnt vmcnt(0)
    s_barrier
    ds_read_b64_tr_b16 a[0:1], v40 offset:0
    ds_read_b64_tr_b16 a[2:3], v40 offset:6144
    ds_read_b64_tr_b16 a[4:5], v40 offset:12288
    ds_read_b64_tr_b16 a[6:7], v40 offset:18432
    ds_read_b64_tr_b16 a[8:9], v40 offset:24576
    ds_read_b64_tr_b16 a[10:11], v40 offset:30720
    ds_read_b64_tr_b16 a[12:13], v40 offset:36864
    ds_read_b64_tr_b16 a[14:15], v40 offset:43008
    ds_read_b64_tr_b16 a[16:17], v40 offset:49152
    ds_read_b64_tr_b16 a[18:19], v40 offset:55296
    s_waitcnt lgkmcnt(0)
    ds_read_b64_tr_b16 a[20:21], v41 offset:0
    ds_read_b64_tr_b16 a[22:23], v41 offset:6144
    ds_read_b64_tr_b16 a[24:25], v41 offset:12288
    ds_read_b64_tr_b16 a[26:27], v41 offset:18432
    ds_read_b64_tr_b16 a[28:29], v41 offset:24576
    ds_read_b64_tr_b16 a[30:31], v41 offset:30720
    ds_read_b64_tr_b16 a[32:33], v41 offset:36864
    ds_read_b64_tr_b16 a[34:35], v41 offset:43008
    ds_read_b64_tr_b16 a[36:37], v41 offset:49152
    ds_read_b64_tr_b16 a[38:39], v41 offset:55296
    s_waitcnt lgkmcnt(0)
    ds_read_b64_tr_b16 a[80:81], v40 offset:8
    ds_read_b64_tr_b16 a[82:83], v40 offset:6152
    ds_read_b64_tr_b16 a[84:85], v40 offset:12296
    ds_read_b64_tr_b16 a[86:87], v40 offset:18440
    ds_read_b64_tr_b16 a[88:89], v40 offset:24584
    ds_read_b64_tr_b16 a[90:91], v40 offset:30728
    ds_read_b64_tr_b16 a[92:93], v40 offset:36872
    ds_read_b64_tr_b16 a[94:95], v40 offset:43016
    ds_read_b64_tr_b16 a[96:97], v40 offset:49160
    ds_read_b64_tr_b16 a[98:99], v40 offset:55304
    s_waitcnt lgkmcnt(0)
    ds_read_b64_tr_b16 a[100:101], v41 offset:8
    ds_read_b64_tr_b16 a[102:103], v41 offset:6152
    ds_read_b64_tr_b16 a[104:105], v41 offset:12296
    ds_read_b64_tr_b16 a[106:107], v41 offset:18440
    ds_read_b64_tr_b16 a[108:109], v41 offset:24584
    ds_read_b64_tr_b16 a[110:111], v41 offset:30728
    ds_read_b64_tr_b16 a[112:113], v41 offset:36872
    ds_read_b64_tr_b16 a[114:115], v41 offset:43016
    ds_read_b64_tr_b16 a[116:117], v41 offset:49160
    ds_read_b64_tr_b16 a[118:119], v41 offset:55304
    s_waitcnt lgkmcnt(0)
    ds_read_b64_tr_b16 a[160:161], v40 offset:16
    ds_read_b64_tr_b16 a[162:163], v40 offset:6160
    ds_read_b64_tr_b16 a[164:165], v40 offset:12304
    ds_read_b64_tr_b16 a[166:167], v40 offset:18448
    ds_read_b64_tr_b16 a[168:169], v40 offset:24592
    ds_read_b64_tr_b16 a[170:171], v40 offset:30736
    ds_read_b64_tr_b16 a[172:173], v40 offset:36880
    ds_read_b64_tr_b16 a[174:175], v40 offset:43024
    ds_read_b64_tr_b16 a[176:177], v40 offset:49168
    ds_read_b64_tr_b16 a[178:179], v40 offset:55312
    s_waitcnt lgkmcnt(0)
    ds_read_b64_tr_b16 a[180:181], v41 offset:16
    ds_read_b64_tr_b16 a[182:183], v41 offset:6160
    ds_read_b64_tr_b16 a[184:185], v41 offset:12304
    ds_read_b64_tr_b16 a[186:187], v41 offset:18448
    ds_read_b64_tr_b16 a[188:189], v41 offset:24592
    ds_read_b64_tr_b16 a[190:191], v41 offset:30736
    ds_read_b64_tr_b16 a[192:193], v41 offset:36880
    ds_read_b64_tr_b16 a[194:195], v41 offset:43024
    ds_read_b64_tr_b16 a[196:197], v41 offset:49168
    ds_read_b64_tr_b16 a[198:199], v41 offset:55312
    s_waitcnt lgkmcnt(0)
    s_barrier
    s_add_u32 m0, s27, 0
    s_nop 0
    global_load_lds_dwordx4 v43, s[32:33]
    s_add_u32 m0, s27, 4096
    s_nop 0
    global_load_lds_dwordx4 v44, s[32:33]
    s_add_u32 m0, s27, 8192
    s_nop 0
    global_load_lds_dwordx4 v45, s[32:33]
    s_add_u32 s32, s32, 393216
    s_addc_u32 s33, s33, 0
    s_add_u32 m0, s27, 12288
    s_nop 0
    global_load_lds_dwordx4 v43, s[32:33]
    s_add_u32 m0, s27, 16384
    s_nop 0
    global_load_lds_dwordx4 v44, s[32:33]
    s_add_u32 m0, s27, 20480
    s_nop 0
    global_load_lds_dwordx4 v45, s[32:33]
    s_add_u32 s32, s32, 393216
    s_addc_u32 s33, s33, 0
    s_add_u32 m0, s27, 24576
    s_nop 0
    global_load_lds_dwordx4 v43, s[32:33]
    s_add_u32 m0, s27, 28672
    s_nop 0
    global_load_lds_dwordx4 v44, s[32:33]
    s_add_u32 m0, s27, 32768
    s_nop 0
    global_load_lds_dwordx4 v45, s[32:33]
    s_add_u32 s32, s32, 393216
    s_addc_u32 s33, s33, 0
    s_add_u32 m0, s27, 36864
    s_nop 0
    global_load_lds_dwordx4 v43, s[32:33]
    s_add_u32 m0, s27, 40960
    s_nop 0
    global_load_lds_dwordx4 v44, s[32:33]
    s_add_u32 m0, s27, 45056
    s_nop 0
    global_load_lds_dwordx4 v45, s[32:33]
    s_add_u32 s32, s32, 393216
    s_addc_u32 s33, s33, 0
    s_add_u32 m0, s27, 49152
    s_nop 0
    global_load_lds_dwordx4 v43, s[32:33]
    s_add_u32 m0, s27, 53248
    s_nop 0
    global_load_lds_dwordx4 v44, s[32:33]
    s_add_u32 m0, s27, 57344
    s_nop 0
    global_load_lds_dwordx4 v45, s[32:33]
    s_add_u32 s32, s32, 393216
    s_addc_u32 s33, s33, 0
    s_add_u32 m0, s27, 61440
    s_nop 0
    global_load_lds_dwordx4 v43, s[32:33]
    s_add_u32 m0, s27, 65536
    s_nop 0
    global_load_lds_dwordx4 v44, s[32:33]
    s_add_u32 m0, s27, 69632
    s_nop 0
    global_load_lds_dwordx4 v45, s[32:33]
    s_add_u32 s32, s32, 393216
    s_addc_u32 s33, s33, 0
    s_add_u32 m0, s27, 73728
    s_nop 0
    global_load_lds_dwordx4 v43, s[32:33]
    s_add_u32 m0, s27, 77824
    s_nop 0
    global_load_lds_dwordx4 v44, s[32:33]
    s_add_u32 m0, s27, 81920
    s_nop 0
    global_load_lds_dwordx4 v45, s[32:33]
    s_add_u32 s32, s32, 393216
    s_addc_u32 s33, s33, 0
    s_add_u32 m0, s27, 86016
    s_nop 0
    global_load_lds_dwordx4 v43, s[32:33]
    s_add_u32 m0, s27, 90112
    s_nop 0
    global_load_lds_dwordx4 v44, s[32:33]
    s_add_u32 m0, s27, 94208
    s_nop 0
    global_load_lds_dwordx4 v45, s[32:33]
    s_add_u32 s32, s32, 393216
    s_addc_u32 s33, s33, 0
    s_add_u32 m0, s27, 98304
    s_nop 0
    global_load_lds_dwordx4 v43, s[32:33]
    s_add_u32 m0, s27, 102400
    s_nop 0
    global_load_lds_dwordx4 v44, s[32:33]
    s_add_u32 m0, s27, 106496
    s_nop 0
    global_load_lds_dwordx4 v45, s[32:33]
    s_add_u32 s32, s32, 393216
    s_addc_u32 s33, s33, 0
    s_add_u32 m0, s27, 110592
    s_nop 0
    global_load_lds_dwordx4 v43, s[32:33]
    s_add_u32 m0, s27, 114688
    s_nop 0
    global_load_lds_dwordx4 v44, s[32:33]
    s_add_u32 m0, s27, 118784
    s_nop 0
    global_load_lds_dwordx4 v45, s[32:33]
    s_add_u32 s32, s32, 393216
    s_addc_u32 s33, s33, 0
    s_waitcnt vmcnt(0)
    s_barrier
    ds_read_b64_tr_b16 a[40:41], v40 offset:0
    ds_read_b64_tr_b16 a[42:43], v40 offset:6144
    ds_read_b64_tr_b16 a[44:45], v40 offset:12288
    ds_read_b64_tr_b16 a[46:47], v40 offset:18432
    ds_read_b64_tr_b16 a[48:49], v40 offset:24576
    ds_read_b64_tr_b16 a[50:51], v40 offset:30720
    ds_read_b64_tr_b16 a[52:53], v40 offset:36864
    ds_read_b64_tr_b16 a[54:55], v40 offset:43008
    ds_read_b64_tr_b16 a[56:57], v40 offset:49152
    ds_read_b64_tr_b16 a[58:59], v40 offset:55296
    s_waitcnt lgkmcnt(0)
    ds_read_b64_tr_b16 a[60:61], v41 offset:0
    ds_read_b64_tr_b16 a[62:63], v41 offset:6144
    ds_read_b64_tr_b16 a[64:65], v41 offset:12288
    ds_read_b64_tr_b16 a[66:67], v41 offset:18432
    ds_read_b64_tr_b16 a[68:69], v41 offset:24576
    ds_read_b64_tr_b16 a[70:71], v41 offset:30720
    ds_read_b64_tr_b16 a[72:73], v41 offset:36864
    ds_read_b64_tr_b16 a[74:75], v41 offset:43008
    ds_read_b64_tr_b16 a[76:77], v41 offset:49152
    ds_read_b64_tr_b16 a[78:79], v41 offset:55296
    s_waitcnt lgkmcnt(0)
    ds_read_b64_tr_b16 a[120:121], v40 offset:8
    ds_read_b64_tr_b16 a[122:123], v40 offset:6152
    ds_read_b64_tr_b16 a[124:125], v40 offset:12296
    ds_read_b64_tr_b16 a[126:127], v40 offset:18440
    ds_read_b64_tr_b16 a[128:129], v40 offset:24584
    ds_read_b64_tr_b16 a[130:131], v40 offset:30728
    ds_read_b64_tr_b16 a[132:133], v40 offset:36872
    ds_read_b64_tr_b16 a[134:135], v40 offset:43016
    ds_read_b64_tr_b16 a[136:137], v40 offset:49160
    ds_read_b64_tr_b16 a[138:139], v40 offset:55304
    s_waitcnt lgkmcnt(0)
    ds_read_b64_tr_b16 a[140:141], v41 offset:8
    ds_read_b64_tr_b16 a[142:143], v41 offset:6152
    ds_read_b64_tr_b16 a[144:145], v41 offset:12296
    ds_read_b64_tr_b16 a[146:147], v41 offset:18440
    ds_read_b64_tr_b16 a[148:149], v41 offset:24584
    ds_read_b64_tr_b16 a[150:151], v41 offset:30728
    ds_read_b64_tr_b16 a[152:153], v41 offset:36872
    ds_read_b64_tr_b16 a[154:155], v41 offset:43016
    ds_read_b64_tr_b16 a[156:157], v41 offset:49160
    ds_read_b64_tr_b16 a[158:159], v41 offset:55304
    s_waitcnt lgkmcnt(0)
    ds_read_b64_tr_b16 a[200:201], v40 offset:16
    ds_read_b64_tr_b16 a[202:203], v40 offset:6160
    ds_read_b64_tr_b16 a[204:205], v40 offset:12304
    ds_read_b64_tr_b16 a[206:207], v40 offset:18448
    ds_read_b64_tr_b16 a[208:209], v40 offset:24592
    ds_read_b64_tr_b16 a[210:211], v40 offset:30736
    ds_read_b64_tr_b16 a[212:213], v40 offset:36880
    ds_read_b64_tr_b16 a[214:215], v40 offset:43024
    ds_read_b64_tr_b16 a[216:217], v40 offset:49168
    ds_read_b64_tr_b16 a[218:219], v40 offset:55312
    s_waitcnt lgkmcnt(0)
    ds_read_b64_tr_b16 a[220:221], v41 offset:16
    ds_read_b64_tr_b16 a[222:223], v41 offset:6160
    ds_read_b64_tr_b16 a[224:225], v41 offset:12304
    ds_read_b64_tr_b16 a[226:227], v41 offset:18448
    ds_read_b64_tr_b16 a[228:229], v41 offset:24592
    ds_read_b64_tr_b16 a[230:231], v41 offset:30736
    ds_read_b64_tr_b16 a[232:233], v41 offset:36880
    ds_read_b64_tr_b16 a[234:235], v41 offset:43024
    ds_read_b64_tr_b16 a[236:237], v41 offset:49168
    ds_read_b64_tr_b16 a[238:239], v41 offset:55312
    s_waitcnt lgkmcnt(0)
    v_mov_b32 v4, 36
    s_movk_i32 s24, 128
    s_mov_b64 exec, 1
Lwp_50109:
    buffer_load_dword v5, v4, s[64:67], 0 offen sc1
    s_waitcnt vmcnt(0)
    v_cmp_gt_u32 vcc, s24, v5
    s_nop 0
    s_cbranch_vccz Lwpd_50110
    s_sleep 6
    s_add_u32 s30, s30, 1
    s_cmp_lt_u32 s30, s31
    s_cbranch_scc1 Lwp_50109
Lwpd_50110:
    s_mov_b64 exec, -1
    s_barrier
    v_lshlrev_b32 v1, 4, v0
    v_lshlrev_b32 v2, 3, v0
    s_mul_i32 s20, s26, 12
    s_mul_i32 s21, s14, 3
    s_add_u32 s20, s20, s21
    s_lshl_b32 s20, s20, 9
    s_add_u32 s19, s19, s20
    s_mul_i32 s22, s14, 10240
    s_mov_b32 s34, 0
    s_mov_b32 s35, 40960
    s_mov_b32 s36, 81920
    s_mul_i32 s23, s17, 40960
    s_add_u32 s23, s23, s22
    s_add_u32 s24, s34, s22
    s_mov_b32 m0, s24
    s_nop 0
    buffer_load_dwordx4 v1, s[4:7], s23 offen offset:0 sc1 lds
    buffer_load_dwordx4 v1, s[4:7], s23 offen offset:1024 sc1 lds
    buffer_load_dwordx4 v1, s[4:7], s23 offen offset:2048 sc1 lds
    buffer_load_dwordx4 v1, s[4:7], s23 offen offset:3072 sc1 lds
    s_add_u32 s23, s23, 4096
    s_add_u32 s24, s24, 4096
    s_mov_b32 m0, s24
    s_nop 0
    buffer_load_dwordx4 v1, s[4:7], s23 offen offset:0 sc1 lds
    buffer_load_dwordx4 v1, s[4:7], s23 offen offset:1024 sc1 lds
    buffer_load_dwordx4 v1, s[4:7], s23 offen offset:2048 sc1 lds
    buffer_load_dwordx4 v1, s[4:7], s23 offen offset:3072 sc1 lds
    s_add_u32 s23, s23, 4096
    s_add_u32 s24, s24, 4096
    s_mov_b32 m0, s24
    s_nop 0
    buffer_load_dwordx4 v1, s[4:7], s23 offen offset:0 sc1 lds
    buffer_load_dwordx4 v1, s[4:7], s23 offen offset:1024 sc1 lds
    s_add_u32 s25, s17, 1
    s_mul_i32 s23, s25, 40960
    s_add_u32 s23, s23, s22
    s_add_u32 s24, s35, s22
    s_mov_b32 m0, s24
    s_nop 0
    buffer_load_dwordx4 v1, s[4:7], s23 offen offset:0 sc1 lds
    buffer_load_dwordx4 v1, s[4:7], s23 offen offset:1024 sc1 lds
    buffer_load_dwordx4 v1, s[4:7], s23 offen offset:2048 sc1 lds
    buffer_load_dwordx4 v1, s[4:7], s23 offen offset:3072 sc1 lds
    s_add_u32 s23, s23, 4096
    s_add_u32 s24, s24, 4096
    s_mov_b32 m0, s24
    s_nop 0
    buffer_load_dwordx4 v1, s[4:7], s23 offen offset:0 sc1 lds
    buffer_load_dwordx4 v1, s[4:7], s23 offen offset:1024 sc1 lds
    buffer_load_dwordx4 v1, s[4:7], s23 offen offset:2048 sc1 lds
    buffer_load_dwordx4 v1, s[4:7], s23 offen offset:3072 sc1 lds
    s_add_u32 s23, s23, 4096
    s_add_u32 s24, s24, 4096
    s_mov_b32 m0, s24
    s_nop 0
    buffer_load_dwordx4 v1, s[4:7], s23 offen offset:0 sc1 lds
    buffer_load_dwordx4 v1, s[4:7], s23 offen offset:1024 sc1 lds
    s_waitcnt vmcnt(10)
    s_barrier
    s_add_u32 s25, s17, 2
    s_mul_i32 s23, s25, 40960
    s_add_u32 s23, s23, s22
    s_add_u32 s24, s36, s22
    s_sub_u32 s25, s17, 1
    s_mul_i32 s37, s25, 393216
    s_add_u32 s37, s37, s19
    s_add_u32 s38, s37, 196608
    v_add_u32 v3, s34, v1
    ds_read_b128 v[8:11], v3 offset:0
    ds_read_b128 v[12:15], v3 offset:20480
    ds_read_b128 v[16:19], v3 offset:1024
    ds_read_b128 v[20:23], v3 offset:21504
    s_waitcnt lgkmcnt(3)
    v_mfma_f32_16x16x32_bf16 v[24:27], a[0:3], v[8:11], 0
    v_mfma_f32_16x16x32_bf16 v[28:31], a[80:83], v[8:11], 0
    v_mfma_f32_16x16x32_bf16 v[32:35], a[160:163], v[8:11], 0
    s_mov_b32 m0, s24
    s_nop 0
    buffer_load_dwordx4 v1, s[4:7], s23 offen offset:0 sc1 lds
    ds_read_b128 v[8:11], v3 offset:2048
    s_waitcnt lgkmcnt(3)
    v_mfma_f32_16x16x32_bf16 v[36:39], a[0:3], v[12:15], 0
    v_mfma_f32_16x16x32_bf16 v[40:43], a[80:83], v[12:15], 0
    v_mfma_f32_16x16x32_bf16 v[44:47], a[160:163], v[12:15], 0
    buffer_load_dwordx4 v1, s[4:7], s23 offen offset:1024 sc1 lds
    ds_read_b128 v[12:15], v3 offset:22528
    s_waitcnt lgkmcnt(3)
    v_mfma_f32_16x16x32_bf16 v[24:27], a[4:7], v[16:19], v[24:27]
    v_mfma_f32_16x16x32_bf16 v[28:31], a[84:87], v[16:19], v[28:31]
    v_mfma_f32_16x16x32_bf16 v[32:35], a[164:167], v[16:19], v[32:35]
    buffer_load_dwordx4 v1, s[4:7], s23 offen offset:2048 sc1 lds
    ds_read_b128 v[16:19], v3 offset:3072
    s_waitcnt lgkmcnt(3)
    v_mfma_f32_16x16x32_bf16 v[36:39], a[4:7], v[20:23], v[36:39]
    v_mfma_f32_16x16x32_bf16 v[40:43], a[84:87], v[20:23], v[40:43]
    v_mfma_f32_16x16x32_bf16 v[44:47], a[164:167], v[20:23], v[44:47]
    buffer_load_dwordx4 v1, s[4:7], s23 offen offset:3072 sc1 lds
    ds_read_b128 v[20:23], v3 offset:23552
    s_waitcnt lgkmcnt(3)
    v_mfma_f32_16x16x32_bf16 v[24:27], a[8:11], v[8:11], v[24:27]
    v_mfma_f32_16x16x32_bf16 v[28:31], a[88:91], v[8:11], v[28:31]
    v_mfma_f32_16x16x32_bf16 v[32:35], a[168:171], v[8:11], v[32:35]
    s_add_u32 s23, s23, 4096
    s_add_u32 s24, s24, 4096
    s_mov_b32 m0, s24
    s_nop 0
    buffer_load_dwordx4 v1, s[4:7], s23 offen offset:0 sc1 lds
    ds_read_b128 v[8:11], v3 offset:4096
    s_waitcnt lgkmcnt(3)
    v_mfma_f32_16x16x32_bf16 v[36:39], a[8:11], v[12:15], v[36:39]
    v_mfma_f32_16x16x32_bf16 v[40:43], a[88:91], v[12:15], v[40:43]
    v_mfma_f32_16x16x32_bf16 v[44:47], a[168:171], v[12:15], v[44:47]
    buffer_load_dwordx4 v1, s[4:7], s23 offen offset:1024 sc1 lds
    ds_read_b128 v[12:15], v3 offset:24576
    s_waitcnt lgkmcnt(3)
    v_mfma_f32_16x16x32_bf16 v[24:27], a[12:15], v[16:19], v[24:27]
    v_mfma_f32_16x16x32_bf16 v[28:31], a[92:95], v[16:19], v[28:31]
    v_mfma_f32_16x16x32_bf16 v[32:35], a[172:175], v[16:19], v[32:35]
    buffer_load_dwordx4 v1, s[4:7], s23 offen offset:2048 sc1 lds
    ds_read_b128 v[16:19], v3 offset:5120
    s_waitcnt lgkmcnt(3)
    v_mfma_f32_16x16x32_bf16 v[36:39], a[12:15], v[20:23], v[36:39]
    v_mfma_f32_16x16x32_bf16 v[40:43], a[92:95], v[20:23], v[40:43]
    v_mfma_f32_16x16x32_bf16 v[44:47], a[172:175], v[20:23], v[44:47]
    buffer_load_dwordx4 v1, s[4:7], s23 offen offset:3072 sc1 lds
    ds_read_b128 v[20:23], v3 offset:25600
    s_waitcnt lgkmcnt(3)
    v_mfma_f32_16x16x32_bf16 v[24:27], a[16:19], v[8:11], v[24:27]
    v_mfma_f32_16x16x32_bf16 v[28:31], a[96:99], v[8:11], v[28:31]
    v_mfma_f32_16x16x32_bf16 v[32:35], a[176:179], v[8:11], v[32:35]
    s_add_u32 s23, s23, 4096
    s_add_u32 s24, s24, 4096
    s_mov_b32 m0, s24
    s_nop 0
    buffer_load_dwordx4 v1, s[4:7], s23 offen offset:0 sc1 lds
    ds_read_b128 v[8:11], v3 offset:6144
    s_waitcnt lgkmcnt(3)
    v_mfma_f32_16x16x32_bf16 v[36:39], a[16:19], v[12:15], v[36:39]
    v_mfma_f32_16x16x32_bf16 v[40:43], a[96:99], v[12:15], v[40:43]
    v_mfma_f32_16x16x32_bf16 v[44:47], a[176:179], v[12:15], v[44:47]
    buffer_load_dwordx4 v1, s[4:7], s23 offen offset:1024 sc1 lds
    ds_read_b128 v[12:15], v3 offset:26624
    s_waitcnt lgkmcnt(3)
    v_mfma_f32_16x16x32_bf16 v[24:27], a[20:23], v[16:19], v[24:27]
    v_mfma_f32_16x16x32_bf16 v[28:31], a[100:103], v[16:19], v[28:31]
    v_mfma_f32_16x16x32_bf16 v[32:35], a[180:183], v[16:19], v[32:35]
    ds_read_b128 v[16:19], v3 offset:7168
    s_waitcnt lgkmcnt(3)
    v_mfma_f32_16x16x32_bf16 v[36:39], a[20:23], v[20:23], v[36:39]
    v_mfma_f32_16x16x32_bf16 v[40:43], a[100:103], v[20:23], v[40:43]
    v_mfma_f32_16x16x32_bf16 v[44:47], a[180:183], v[20:23], v[44:47]
    ds_read_b128 v[20:23], v3 offset:27648
    s_waitcnt lgkmcnt(3)
    v_mfma_f32_16x16x32_bf16 v[24:27], a[24:27], v[8:11], v[24:27]
    v_mfma_f32_16x16x32_bf16 v[28:31], a[104:107], v[8:11], v[28:31]
    v_mfma_f32_16x16x32_bf16 v[32:35], a[184:187], v[8:11], v[32:35]
    ds_read_b128 v[8:11], v3 offset:8192
    s_waitcnt lgkmcnt(3)
    v_mfma_f32_16x16x32_bf16 v[36:39], a[24:27], v[12:15], v[36:39]
    v_mfma_f32_16x16x32_bf16 v[40:43], a[104:107], v[12:15], v[40:43]
    v_mfma_f32_16x16x32_bf16 v[44:47], a[184:187], v[12:15], v[44:47]
    ds_read_b128 v[12:15], v3 offset:28672
    s_waitcnt lgkmcnt(3)
    v_mfma_f32_16x16x32_bf16 v[24:27], a[28:31], v[16:19], v[24:27]
    v_mfma_f32_16x16x32_bf16 v[28:31], a[108:111], v[16:19], v[28:31]
    v_mfma_f32_16x16x32_bf16 v[32:35], a[188:191], v[16:19], v[32:35]
    ds_read_b128 v[16:19], v3 offset:9216
    s_waitcnt lgkmcnt(3)
    v_mfma_f32_16x16x32_bf16 v[36:39], a[28:31], v[20:23], v[36:39]
    v_mfma_f32_16x16x32_bf16 v[40:43], a[108:111], v[20:23], v[40:43]
    v_mfma_f32_16x16x32_bf16 v[44:47], a[188:191], v[20:23], v[44:47]
    ds_read_b128 v[20:23], v3 offset:29696
    s_waitcnt lgkmcnt(3)
    v_mfma_f32_16x16x32_bf16 v[24:27], a[32:35], v[8:11], v[24:27]
    v_mfma_f32_16x16x32_bf16 v[28:31], a[112:115], v[8:11], v[28:31]
    v_mfma_f32_16x16x32_bf16 v[32:35], a[192:195], v[8:11], v[32:35]
    ds_read_b128 v[8:11], v3 offset:10240
    s_waitcnt lgkmcnt(3)
    v_mfma_f32_16x16x32_bf16 v[36:39], a[32:35], v[12:15], v[36:39]
    v_mfma_f32_16x16x32_bf16 v[40:43], a[112:115], v[12:15], v[40:43]
    v_mfma_f32_16x16x32_bf16 v[44:47], a[192:195], v[12:15], v[44:47]
    ds_read_b128 v[12:15], v3 offset:30720
    s_waitcnt lgkmcnt(3)
    v_mfma_f32_16x16x32_bf16 v[24:27], a[36:39], v[16:19], v[24:27]
    v_mfma_f32_16x16x32_bf16 v[28:31], a[116:119], v[16:19], v[28:31]
    v_mfma_f32_16x16x32_bf16 v[32:35], a[196:199], v[16:19], v[32:35]
    ds_read_b128 v[16:19], v3 offset:11264
    s_waitcnt lgkmcnt(3)
    v_mfma_f32_16x16x32_bf16 v[36:39], a[36:39], v[20:23], v[36:39]
    v_mfma_f32_16x16x32_bf16 v[40:43], a[116:119], v[20:23], v[40:43]
    v_mfma_f32_16x16x32_bf16 v[44:47], a[196:199], v[20:23], v[44:47]
    ds_read_b128 v[20:23], v3 offset:31744
    s_waitcnt lgkmcnt(3)
    v_mfma_f32_16x16x32_bf16 v[24:27], a[40:43], v[8:11], v[24:27]
    v_mfma_f32_16x16x32_bf16 v[28:31], a[120:123], v[8:11], v[28:31]
    v_mfma_f32_16x16x32_bf16 v[32:35], a[200:203], v[8:11], v[32:35]
    ds_read_b128 v[8:11], v3 offset:12288
    s_waitcnt lgkmcnt(3)
    v_mfma_f32_16x16x32_bf16 v[36:39], a[40:43], v[12:15], v[36:39]
    v_mfma_f32_16x16x32_bf16 v[40:43], a[120:123], v[12:15], v[40:43]
    v_mfma_f32_16x16x32_bf16 v[44:47], a[200:203], v[12:15], v[44:47]
    ds_read_b128 v[12:15], v3 offset:32768
    s_waitcnt lgkmcnt(3)
    v_mfma_f32_16x16x32_bf16 v[24:27], a[44:47], v[16:19], v[24:27]
    v_mfma_f32_16x16x32_bf16 v[28:31], a[124:127], v[16:19], v[28:31]
    v_mfma_f32_16x16x32_bf16 v[32:35], a[204:207], v[16:19], v[32:35]
    ds_read_b128 v[16:19], v3 offset:13312
    s_waitcnt lgkmcnt(3)
    v_mfma_f32_16x16x32_bf16 v[36:39], a[44:47], v[20:23], v[36:39]
    v_mfma_f32_16x16x32_bf16 v[40:43], a[124:127], v[20:23], v[40:43]
    v_mfma_f32_16x16x32_bf16 v[44:47], a[204:207], v[20:23], v[44:47]
    ds_read_b128 v[20:23], v3 offset:33792
    s_waitcnt lgkmcnt(3)
    v_mfma_f32_16x16x32_bf16 v[24:27], a[48:51], v[8:11], v[24:27]
    v_mfma_f32_16x16x32_bf16 v[28:31], a[128:131], v[8:11], v[28:31]
    v_mfma_f32_16x16x32_bf16 v[32:35], a[208:211], v[8:11], v[32:35]
    ds_read_b128 v[8:11], v3 offset:14336
    s_waitcnt lgkmcnt(3)
    v_mfma_f32_16x16x32_bf16 v[36:39], a[48:51], v[12:15], v[36:39]
    v_mfma_f32_16x16x32_bf16 v[40:43], a[128:131], v[12:15], v[40:43]
    v_mfma_f32_16x16x32_bf16 v[44:47], a[208:211], v[12:15], v[44:47]
    ds_read_b128 v[12:15], v3 offset:34816
    s_waitcnt lgkmcnt(3)
    v_mfma_f32_16x16x32_bf16 v[24:27], a[52:55], v[16:19], v[24:27]
    v_mfma_f32_16x16x32_bf16 v[28:31], a[132:135], v[16:19], v[28:31]
    v_mfma_f32_16x16x32_bf16 v[32:35], a[212:215], v[16:19], v[32:35]
    ds_read_b128 v[16:19], v3 offset:15360
    s_waitcnt lgkmcnt(3)
    v_mfma_f32_16x16x32_bf16 v[36:39], a[52:55], v[20:23], v[36:39]
    v_mfma_f32_16x16x32_bf16 v[40:43], a[132:135], v[20:23], v[40:43]
    v_mfma_f32_16x16x32_bf16 v[44:47], a[212:215], v[20:23], v[44:47]
    ds_read_b128 v[20:23], v3 offset:35840
    s_waitcnt lgkmcnt(3)
    v_mfma_f32_16x16x32_bf16 v[24:27], a[56:59], v[8:11], v[24:27]
    v_mfma_f32_16x16x32_bf16 v[28:31], a[136:139], v[8:11], v[28:31]
    v_mfma_f32_16x16x32_bf16 v[32:35], a[216:219], v[8:11], v[32:35]
    ds_read_b128 v[8:11], v3 offset:16384
    s_waitcnt lgkmcnt(3)
    v_mfma_f32_16x16x32_bf16 v[36:39], a[56:59], v[12:15], v[36:39]
    v_mfma_f32_16x16x32_bf16 v[40:43], a[136:139], v[12:15], v[40:43]
    v_mfma_f32_16x16x32_bf16 v[44:47], a[216:219], v[12:15], v[44:47]
    ds_read_b128 v[12:15], v3 offset:36864
    s_waitcnt lgkmcnt(3)
    v_mfma_f32_16x16x32_bf16 v[24:27], a[60:63], v[16:19], v[24:27]
    v_mfma_f32_16x16x32_bf16 v[28:31], a[140:143], v[16:19], v[28:31]
    v_mfma_f32_16x16x32_bf16 v[32:35], a[220:223], v[16:19], v[32:35]
    ds_read_b128 v[16:19], v3 offset:17408
    s_waitcnt lgkmcnt(3)
    v_mfma_f32_16x16x32_bf16 v[36:39], a[60:63], v[20:23], v[36:39]
    v_mfma_f32_16x16x32_bf16 v[40:43], a[140:143], v[20:23], v[40:43]
    v_mfma_f32_16x16x32_bf16 v[44:47], a[220:223], v[20:23], v[44:47]
    ds_read_b128 v[20:23], v3 offset:37888
    s_waitcnt lgkmcnt(3)
    v_mfma_f32_16x16x32_bf16 v[24:27], a[64:67], v[8:11], v[24:27]
    v_mfma_f32_16x16x32_bf16 v[28:31], a[144:147], v[8:11], v[28:31]
    v_mfma_f32_16x16x32_bf16 v[32:35], a[224:227], v[8:11], v[32:35]
    ds_read_b128 v[8:11], v3 offset:18432
    s_waitcnt lgkmcnt(3)
    v_mfma_f32_16x16x32_bf16 v[36:39], a[64:67], v[12:15], v[36:39]
    v_mfma_f32_16x16x32_bf16 v[40:43], a[144:147], v[12:15], v[40:43]
    v_mfma_f32_16x16x32_bf16 v[44:47], a[224:227], v[12:15], v[44:47]
    ds_read_b128 v[12:15], v3 offset:38912
    s_waitcnt lgkmcnt(3)
    v_mfma_f32_16x16x32_bf16 v[24:27], a[68:71], v[16:19], v[24:27]
    v_mfma_f32_16x16x32_bf16 v[28:31], a[148:151], v[16:19], v[28:31]
    v_mfma_f32_16x16x32_bf16 v[32:35], a[228:231], v[16:19], v[32:35]
    ds_read_b128 v[16:19], v3 offset:19456
    s_waitcnt lgkmcnt(3)
    v_mfma_f32_16x16x32_bf16 v[36:39], a[68:71], v[20:23], v[36:39]
    v_mfma_f32_16x16x32_bf16 v[40:43], a[148:151], v[20:23], v[40:43]
    v_mfma_f32_16x16x32_bf16 v[44:47], a[228:231], v[20:23], v[44:47]
    ds_read_b128 v[20:23], v3 offset:39936
    s_waitcnt lgkmcnt(3)
    v_mfma_f32_16x16x32_bf16 v[24:27], a[72:75], v[8:11], v[24:27]
    v_mfma_f32_16x16x32_bf16 v[28:31], a[152:155], v[8:11], v[28:31]
    v_mfma_f32_16x16x32_bf16 v[32:35], a[232:235], v[8:11], v[32:35]
    s_waitcnt lgkmcnt(2)
    v_mfma_f32_16x16x32_bf16 v[36:39], a[72:75], v[12:15], v[36:39]
    v_mfma_f32_16x16x32_bf16 v[40:43], a[152:155], v[12:15], v[40:43]
    v_mfma_f32_16x16x32_bf16 v[44:47], a[232:235], v[12:15], v[44:47]
    s_waitcnt lgkmcnt(1)
    v_mfma_f32_16x16x32_bf16 v[24:27], a[76:79], v[16:19], v[24:27]
    v_mfma_f32_16x16x32_bf16 v[28:31], a[156:159], v[16:19], v[28:31]
    v_mfma_f32_16x16x32_bf16 v[32:35], a[236:239], v[16:19], v[32:35]
    s_waitcnt lgkmcnt(0)
    v_mfma_f32_16x16x32_bf16 v[36:39], a[76:79], v[20:23], v[36:39]
    v_mfma_f32_16x16x32_bf16 v[40:43], a[156:159], v[20:23], v[40:43]
    v_mfma_f32_16x16x32_bf16 v[44:47], a[236:239], v[20:23], v[44:47]
    s_mov_b32 s25, s34
    s_mov_b32 s34, s35
    s_mov_b32 s35, s36
    s_mov_b32 s36, s25
    s_add_u32 s17, s17, 1
    s_cmp_ge_u32 s17, s18
    s_nop 0
    s_cbranch_scc1 Lp_e0_50113
    s_waitcnt vmcnt(0)
    s_barrier
    s_cmp_lg_u32 s14, 0
    s_cbranch_scc1 Lsig_50115
    s_sub_u32 s46, s17, 1
    v_mov_b32 v4, s46
    v_mov_b32 v5, s47
    s_mov_b64 exec, 1
    buffer_store_dword v4, v5, s[4:7], 0 offen sc1
    s_mov_b64 exec, -1
Lsig_50115:
    s_add_u32 s25, s17, 2
    s_mul_i32 s23, s25, 40960
    s_add_u32 s23, s23, s22
    s_add_u32 s24, s36, s22
    s_sub_u32 s25, s17, 1
    s_mul_i32 s37, s25, 393216
    s_add_u32 s37, s37, s19
    s_add_u32 s38, s37, 196608
    v_add_u32 v3, s34, v1
    ds_read_b128 v[8:11], v3 offset:0
    ds_read_b128 v[12:15], v3 offset:20480
    ds_read_b128 v[16:19], v3 offset:1024
    ds_read_b128 v[20:23], v3 offset:21504
    s_waitcnt lgkmcnt(3)
    v_mfma_f32_16x16x32_bf16 v[48:51], a[0:3], v[8:11], 0
    v_mfma_f32_16x16x32_bf16 v[52:55], a[80:83], v[8:11], 0
    v_mfma_f32_16x16x32_bf16 v[56:59], a[160:163], v[8:11], 0
    s_mov_b32 m0, s24
    s_nop 0
    buffer_load_dwordx4 v1, s[4:7], s23 offen offset:0 sc1 lds
    ds_read_b128 v[8:11], v3 offset:2048
    s_waitcnt lgkmcnt(3)
    v_mfma_f32_16x16x32_bf16 v[60:63], a[0:3], v[12:15], 0
    v_mfma_f32_16x16x32_bf16 v[64:67], a[80:83], v[12:15], 0
    v_mfma_f32_16x16x32_bf16 v[68:71], a[160:163], v[12:15], 0
    buffer_load_dwordx4 v1, s[4:7], s23 offen offset:1024 sc1 lds
    ds_read_b128 v[12:15], v3 offset:22528
    s_waitcnt lgkmcnt(3)
    v_mfma_f32_16x16x32_bf16 v[48:51], a[4:7], v[16:19], v[48:51]
    v_mfma_f32_16x16x32_bf16 v[52:55], a[84:87], v[16:19], v[52:55]
    v_mfma_f32_16x16x32_bf16 v[56:59], a[164:167], v[16:19], v[56:59]
    buffer_load_dwordx4 v1, s[4:7], s23 offen offset:2048 sc1 lds
    ds_read_b128 v[16:19], v3 offset:3072
    s_waitcnt lgkmcnt(3)
    v_mfma_f32_16x16x32_bf16 v[60:63], a[4:7], v[20:23], v[60:63]
    v_mfma_f32_16x16x32_bf16 v[64:67], a[84:87], v[20:23], v[64:67]
    v_mfma_f32_16x16x32_bf16 v[68:71], a[164:167], v[20:23], v[68:71]
    buffer_load_dwordx4 v1, s[4:7], s23 offen offset:3072 sc1 lds
    ds_read_b128 v[20:23], v3 offset:23552
    s_waitcnt lgkmcnt(3)
    v_mfma_f32_16x16x32_bf16 v[48:51], a[8:11], v[8:11], v[48:51]
    v_mfma_f32_16x16x32_bf16 v[52:55], a[88:91], v[8:11], v[52:55]
    v_mfma_f32_16x16x32_bf16 v[56:59], a[168:171], v[8:11], v[56:59]
    v_cvt_pk_bf16_f32 v72, v24, v25
    s_add_u32 s23, s23, 4096
    s_add_u32 s24, s24, 4096
    s_mov_b32 m0, s24
    s_nop 0
    buffer_load_dwordx4 v1, s[4:7], s23 offen offset:0 sc1 lds
    ds_read_b128 v[8:11], v3 offset:4096
    s_waitcnt lgkmcnt(3)
    v_mfma_f32_16x16x32_bf16 v[60:63], a[8:11], v[12:15], v[60:63]
    v_mfma_f32_16x16x32_bf16 v[64:67], a[88:91], v[12:15], v[64:67]
    v_mfma_f32_16x16x32_bf16 v[68:71], a[168:171], v[12:15], v[68:71]
    v_cvt_pk_bf16_f32 v73, v26, v27
    buffer_load_dwordx4 v1, s[4:7], s23 offen offset:1024 sc1 lds
    ds_read_b128 v[12:15], v3 offset:24576
    s_waitcnt lgkmcnt(3)
    v_mfma_f32_16x16x32_bf16 v[48:51], a[12:15], v[16:19], v[48:51]
    v_mfma_f32_16x16x32_bf16 v[52:55], a[92:95], v[16:19], v[52:55]
    v_mfma_f32_16x16x32_bf16 v[56:59], a[172:175], v[16:19], v[56:59]
    buffer_store_dwordx2 v[72:73], v2, s[4:7], s37 offen offset:0 sc1
    buffer_load_dwordx4 v1, s[4:7], s23 offen offset:2048 sc1 lds
    ds_read_b128 v[16:19], v3 offset:5120
    s_waitcnt lgkmcnt(3)
    v_mfma_f32_16x16x32_bf16 v[60:63], a[12:15], v[20:23], v[60:63]
    v_mfma_f32_16x16x32_bf16 v[64:67], a[92:95], v[20:23], v[64:67]
    v_mfma_f32_16x16x32_bf16 v[68:71], a[172:175], v[20:23], v[68:71]
    v_cvt_pk_bf16_f32 v74, v28, v29
    buffer_load_dwordx4 v1, s[4:7], s23 offen offset:3072 sc1 lds
    ds_read_b128 v[20:23], v3 offset:25600
    s_waitcnt lgkmcnt(3)
    v_mfma_f32_16x16x32_bf16 v[48:51], a[16:19], v[8:11], v[48:51]
    v_mfma_f32_16x16x32_bf16 v[52:55], a[96:99], v[8:11], v[52:55]
    v_mfma_f32_16x16x32_bf16 v[56:59], a[176:179], v[8:11], v[56:59]
    v_cvt_pk_bf16_f32 v75, v30, v31
    s_add_u32 s23, s23, 4096
    s_add_u32 s24, s24, 4096
    s_mov_b32 m0, s24
    s_nop 0
    buffer_load_dwordx4 v1, s[4:7], s23 offen offset:0 sc1 lds
    ds_read_b128 v[8:11], v3 offset:6144
    s_waitcnt lgkmcnt(3)
    v_mfma_f32_16x16x32_bf16 v[60:63], a[16:19], v[12:15], v[60:63]
    v_mfma_f32_16x16x32_bf16 v[64:67], a[96:99], v[12:15], v[64:67]
    v_mfma_f32_16x16x32_bf16 v[68:71], a[176:179], v[12:15], v[68:71]
    buffer_store_dwordx2 v[74:75], v2, s[4:7], s37 offen offset:512 sc1
    buffer_load_dwordx4 v1, s[4:7], s23 offen offset:1024 sc1 lds
    ds_read_b128 v[12:15], v3 offset:26624
    s_waitcnt lgkmcnt(3)
    v_mfma_f32_16x16x32_bf16 v[48:51], a[20:23], v[16:19], v[48:51]
    v_mfma_f32_16x16x32_bf16 v[52:55], a[100:103], v[16:19], v[52:55]
    v_mfma_f32_16x16x32_bf16 v[56:59], a[180:183], v[16:19], v[56:59]
    v_cvt_pk_bf16_f32 v76, v32, v33
    ds_read_b128 v[16:19], v3 offset:7168
    s_waitcnt lgkmcnt(3)
    v_mfma_f32_16x16x32_bf16 v[60:63], a[20:23], v[20:23], v[60:63]
    v_mfma_f32_16x16x32_bf16 v[64:67], a[100:103], v[20:23], v[64:67]
    v_mfma_f32_16x16x32_bf16 v[68:71], a[180:183], v[20:23], v[68:71]
    v_cvt_pk_bf16_f32 v77, v34, v35
    ds_read_b128 v[20:23], v3 offset:27648
    s_waitcnt lgkmcnt(3)
    v_mfma_f32_16x16x32_bf16 v[48:51], a[24:27], v[8:11], v[48:51]
    v_mfma_f32_16x16x32_bf16 v[52:55], a[104:107], v[8:11], v[52:55]
    v_mfma_f32_16x16x32_bf16 v[56:59], a[184:187], v[8:11], v[56:59]
    buffer_store_dwordx2 v[76:77], v2, s[4:7], s37 offen offset:1024 sc1
    ds_read_b128 v[8:11], v3 offset:8192
    s_waitcnt lgkmcnt(3)
    v_mfma_f32_16x16x32_bf16 v[60:63], a[24:27], v[12:15], v[60:63]
    v_mfma_f32_16x16x32_bf16 v[64:67], a[104:107], v[12:15], v[64:67]
    v_mfma_f32_16x16x32_bf16 v[68:71], a[184:187], v[12:15], v[68:71]
    v_cvt_pk_bf16_f32 v78, v36, v37
    ds_read_b128 v[12:15], v3 offset:28672
    s_waitcnt lgkmcnt(3)
    v_mfma_f32_16x16x32_bf16 v[48:51], a[28:31], v[16:19], v[48:51]
    v_mfma_f32_16x16x32_bf16 v[52:55], a[108:111], v[16:19], v[52:55]
    v_mfma_f32_16x16x32_bf16 v[56:59], a[188:191], v[16:19], v[56:59]
    v_cvt_pk_bf16_f32 v79, v38, v39
    ds_read_b128 v[16:19], v3 offset:9216
    s_waitcnt lgkmcnt(3)
    v_mfma_f32_16x16x32_bf16 v[60:63], a[28:31], v[20:23], v[60:63]
    v_mfma_f32_16x16x32_bf16 v[64:67], a[108:111], v[20:23], v[64:67]
    v_mfma_f32_16x16x32_bf16 v[68:71], a[188:191], v[20:23], v[68:71]
    buffer_store_dwordx2 v[78:79], v2, s[4:7], s38 offen offset:0 sc1
    ds_read_b128 v[20:23], v3 offset:29696
    s_waitcnt lgkmcnt(3)
    v_mfma_f32_16x16x32_bf16 v[48:51], a[32:35], v[8:11], v[48:51]
    v_mfma_f32_16x16x32_bf16 v[52:55], a[112:115], v[8:11], v[52:55]
    v_mfma_f32_16x16x32_bf16 v[56:59], a[192:195], v[8:11], v[56:59]
    v_cvt_pk_bf16_f32 v80, v40, v41
    ds_read_b128 v[8:11], v3 offset:10240
    s_waitcnt lgkmcnt(3)
    v_mfma_f32_16x16x32_bf16 v[60:63], a[32:35], v[12:15], v[60:63]
    v_mfma_f32_16x16x32_bf16 v[64:67], a[112:115], v[12:15], v[64:67]
    v_mfma_f32_16x16x32_bf16 v[68:71], a[192:195], v[12:15], v[68:71]
    v_cvt_pk_bf16_f32 v81, v42, v43
    ds_read_b128 v[12:15], v3 offset:30720
    s_waitcnt lgkmcnt(3)
    v_mfma_f32_16x16x32_bf16 v[48:51], a[36:39], v[16:19], v[48:51]
    v_mfma_f32_16x16x32_bf16 v[52:55], a[116:119], v[16:19], v[52:55]
    v_mfma_f32_16x16x32_bf16 v[56:59], a[196:199], v[16:19], v[56:59]
    buffer_store_dwordx2 v[80:81], v2, s[4:7], s38 offen offset:512 sc1
    ds_read_b128 v[16:19], v3 offset:11264
    s_waitcnt lgkmcnt(3)
    v_mfma_f32_16x16x32_bf16 v[60:63], a[36:39], v[20:23], v[60:63]
    v_mfma_f32_16x16x32_bf16 v[64:67], a[116:119], v[20:23], v[64:67]
    v_mfma_f32_16x16x32_bf16 v[68:71], a[196:199], v[20:23], v[68:71]
    v_cvt_pk_bf16_f32 v82, v44, v45
    ds_read_b128 v[20:23], v3 offset:31744
    s_waitcnt lgkmcnt(3)
    v_mfma_f32_16x16x32_bf16 v[48:51], a[40:43], v[8:11], v[48:51]
    v_mfma_f32_16x16x32_bf16 v[52:55], a[120:123], v[8:11], v[52:55]
    v_mfma_f32_16x16x32_bf16 v[56:59], a[200:203], v[8:11], v[56:59]
    v_cvt_pk_bf16_f32 v83, v46, v47
    ds_read_b128 v[8:11], v3 offset:12288
    s_waitcnt lgkmcnt(3)
    v_mfma_f32_16x16x32_bf16 v[60:63], a[40:43], v[12:15], v[60:63]
    v_mfma_f32_16x16x32_bf16 v[64:67], a[120:123], v[12:15], v[64:67]
    v_mfma_f32_16x16x32_bf16 v[68:71], a[200:203], v[12:15], v[68:71]
    buffer_store_dwordx2 v[82:83], v2, s[4:7], s38 offen offset:1024 sc1
    ds_read_b128 v[12:15], v3 offset:32768
    s_waitcnt lgkmcnt(3)
    v_mfma_f32_16x16x32_bf16 v[48:51], a[44:47], v[16:19], v[48:51]
    v_mfma_f32_16x16x32_bf16 v[52:55], a[124:127], v[16:19], v[52:55]
    v_mfma_f32_16x16x32_bf16 v[56:59], a[204:207], v[16:19], v[56:59]
    ds_read_b128 v[16:19], v3 offset:13312
    s_waitcnt lgkmcnt(3)
    v_mfma_f32_16x16x32_bf16 v[60:63], a[44:47], v[20:23], v[60:63]
    v_mfma_f32_16x16x32_bf16 v[64:67], a[124:127], v[20:23], v[64:67]
    v_mfma_f32_16x16x32_bf16 v[68:71], a[204:207], v[20:23], v[68:71]
    ds_read_b128 v[20:23], v3 offset:33792
    s_waitcnt lgkmcnt(3)
    v_mfma_f32_16x16x32_bf16 v[48:51], a[48:51], v[8:11], v[48:51]
    v_mfma_f32_16x16x32_bf16 v[52:55], a[128:131], v[8:11], v[52:55]
    v_mfma_f32_16x16x32_bf16 v[56:59], a[208:211], v[8:11], v[56:59]
    ds_read_b128 v[8:11], v3 offset:14336
    s_waitcnt lgkmcnt(3)
    v_mfma_f32_16x16x32_bf16 v[60:63], a[48:51], v[12:15], v[60:63]
    v_mfma_f32_16x16x32_bf16 v[64:67], a[128:131], v[12:15], v[64:67]
    v_mfma_f32_16x16x32_bf16 v[68:71], a[208:211], v[12:15], v[68:71]
    ds_read_b128 v[12:15], v3 offset:34816
    s_waitcnt lgkmcnt(3)
    v_mfma_f32_16x16x32_bf16 v[48:51], a[52:55], v[16:19], v[48:51]
    v_mfma_f32_16x16x32_bf16 v[52:55], a[132:135], v[16:19], v[52:55]
    v_mfma_f32_16x16x32_bf16 v[56:59], a[212:215], v[16:19], v[56:59]
    ds_read_b128 v[16:19], v3 offset:15360
    s_waitcnt lgkmcnt(3)
    v_mfma_f32_16x16x32_bf16 v[60:63], a[52:55], v[20:23], v[60:63]
    v_mfma_f32_16x16x32_bf16 v[64:67], a[132:135], v[20:23], v[64:67]
    v_mfma_f32_16x16x32_bf16 v[68:71], a[212:215], v[20:23], v[68:71]
    ds_read_b128 v[20:23], v3 offset:35840
    s_waitcnt lgkmcnt(3)
    v_mfma_f32_16x16x32_bf16 v[48:51], a[56:59], v[8:11], v[48:51]
    v_mfma_f32_16x16x32_bf16 v[52:55], a[136:139], v[8:11], v[52:55]
    v_mfma_f32_16x16x32_bf16 v[56:59], a[216:219], v[8:11], v[56:59]
    ds_read_b128 v[8:11], v3 offset:16384
    s_waitcnt lgkmcnt(3)
    v_mfma_f32_16x16x32_bf16 v[60:63], a[56:59], v[12:15], v[60:63]
    v_mfma_f32_16x16x32_bf16 v[64:67], a[136:139], v[12:15], v[64:67]
    v_mfma_f32_16x16x32_bf16 v[68:71], a[216:219], v[12:15], v[68:71]
    ds_read_b128 v[12:15], v3 offset:36864
    s_waitcnt lgkmcnt(3)
    v_mfma_f32_16x16x32_bf16 v[48:51], a[60:63], v[16:19], v[48:51]
    v_mfma_f32_16x16x32_bf16 v[52:55], a[140:143], v[16:19], v[52:55]
    v_mfma_f32_16x16x32_bf16 v[56:59], a[220:223], v[16:19], v[56:59]
    ds_read_b128 v[16:19], v3 offset:17408
    s_waitcnt lgkmcnt(3)
    v_mfma_f32_16x16x32_bf16 v[60:63], a[60:63], v[20:23], v[60:63]
    v_mfma_f32_16x16x32_bf16 v[64:67], a[140:143], v[20:23], v[64:67]
    v_mfma_f32_16x16x32_bf16 v[68:71], a[220:223], v[20:23], v[68:71]
    ds_read_b128 v[20:23], v3 offset:37888
    s_waitcnt lgkmcnt(3)
    v_mfma_f32_16x16x32_bf16 v[48:51], a[64:67], v[8:11], v[48:51]
    v_mfma_f32_16x16x32_bf16 v[52:55], a[144:147], v[8:11], v[52:55]
    v_mfma_f32_16x16x32_bf16 v[56:59], a[224:227], v[8:11], v[56:59]
    ds_read_b128 v[8:11], v3 offset:18432
    s_waitcnt lgkmcnt(3)
    v_mfma_f32_16x16x32_bf16 v[60:63], a[64:67], v[12:15], v[60:63]
    v_mfma_f32_16x16x32_bf16 v[64:67], a[144:147], v[12:15], v[64:67]
    v_mfma_f32_16x16x32_bf16 v[68:71], a[224:227], v[12:15], v[68:71]
    ds_read_b128 v[12:15], v3 offset:38912
    s_waitcnt lgkmcnt(3)
    v_mfma_f32_16x16x32_bf16 v[48:51], a[68:71], v[16:19], v[48:51]
    v_mfma_f32_16x16x32_bf16 v[52:55], a[148:151], v[16:19], v[52:55]
    v_mfma_f32_16x16x32_bf16 v[56:59], a[228:231], v[16:19], v[56:59]
    ds_read_b128 v[16:19], v3 offset:19456
    s_waitcnt lgkmcnt(3)
    v_mfma_f32_16x16x32_bf16 v[60:63], a[68:71], v[20:23], v[60:63]
    v_mfma_f32_16x16x32_bf16 v[64:67], a[148:151], v[20:23], v[64:67]
    v_mfma_f32_16x16x32_bf16 v[68:71], a[228:231], v[20:23], v[68:71]
    ds_read_b128 v[20:23], v3 offset:39936
    s_waitcnt lgkmcnt(3)
    v_mfma_f32_16x16x32_bf16 v[48:51], a[72:75], v[8:11], v[48:51]
    v_mfma_f32_16x16x32_bf16 v[52:55], a[152:155], v[8:11], v[52:55]
    v_mfma_f32_16x16x32_bf16 v[56:59], a[232:235], v[8:11], v[56:59]
    s_waitcnt lgkmcnt(2)
    v_mfma_f32_16x16x32_bf16 v[60:63], a[72:75], v[12:15], v[60:63]
    v_mfma_f32_16x16x32_bf16 v[64:67], a[152:155], v[12:15], v[64:67]
    v_mfma_f32_16x16x32_bf16 v[68:71], a[232:235], v[12:15], v[68:71]
    s_waitcnt lgkmcnt(1)
    v_mfma_f32_16x16x32_bf16 v[48:51], a[76:79], v[16:19], v[48:51]
    v_mfma_f32_16x16x32_bf16 v[52:55], a[156:159], v[16:19], v[52:55]
    v_mfma_f32_16x16x32_bf16 v[56:59], a[236:239], v[16:19], v[56:59]
    s_waitcnt lgkmcnt(0)
    v_mfma_f32_16x16x32_bf16 v[60:63], a[76:79], v[20:23], v[60:63]
    v_mfma_f32_16x16x32_bf16 v[64:67], a[156:159], v[20:23], v[64:67]
    v_mfma_f32_16x16x32_bf16 v[68:71], a[236:239], v[20:23], v[68:71]
    s_mov_b32 s25, s34
    s_mov_b32 s34, s35
    s_mov_b32 s35, s36
    s_mov_b32 s36, s25
    s_add_u32 s17, s17, 1
    s_cmp_ge_u32 s17, s18
    s_nop 0
    s_cbranch_scc1 Lp_e1_50114
Lp_loop_50111:
    s_waitcnt vmcnt(0)
    s_barrier
    s_cmp_lg_u32 s14, 0
    s_cbranch_scc1 Lsig_50116
    s_sub_u32 s46, s17, 1
    v_mov_b32 v4, s46
    v_mov_b32 v5, s47
    s_mov_b64 exec, 1
    buffer_store_dword v4, v5, s[4:7], 0 offen sc1
    s_mov_b64 exec, -1
Lsig_50116:
    s_add_u32 s25, s17, 2
    s_mul_i32 s23, s25, 40960
    s_add_u32 s23, s23, s22
    s_add_u32 s24, s36, s22
    s_sub_u32 s25, s17, 1
    s_mul_i32 s37, s25, 393216
    s_add_u32 s37, s37, s19
    s_add_u32 s38, s37, 196608
    v_add_u32 v3, s34, v1
    ds_read_b128 v[8:11], v3 offset:0
    ds_read_b128 v[12:15], v3 offset:20480
    ds_read_b128 v[16:19], v3 offset:1024
    ds_read_b128 v[20:23], v3 offset:21504
    s_waitcnt lgkmcnt(3)
    v_mfma_f32_16x16x32_bf16 v[24:27], a[0:3], v[8:11], 0
    v_mfma_f32_16x16x32_bf16 v[28:31], a[80:83], v[8:11], 0
    v_mfma_f32_16x16x32_bf16 v[32:35], a[160:163], v[8:11], 0
    s_mov_b32 m0, s24
    s_nop 0
    buffer_load_dwordx4 v1, s[4:7], s23 offen offset:0 sc1 lds
    ds_read_b128 v[8:11], v3 offset:2048
    s_waitcnt lgkmcnt(3)
    v_mfma_f32_16x16x32_bf16 v[36:39], a[0:3], v[12:15], 0
    v_mfma_f32_16x16x32_bf16 v[40:43], a[80:83], v[12:15], 0
    v_mfma_f32_16x16x32_bf16 v[44:47], a[160:163], v[12:15], 0
    buffer_load_dwordx4 v1, s[4:7], s23 offen offset:1024 sc1 lds
    ds_read_b128 v[12:15], v3 offset:22528
    s_waitcnt lgkmcnt(3)
    v_mfma_f32_16x16x32_bf16 v[24:27], a[4:7], v[16:19], v[24:27]
    v_mfma_f32_16x16x32_bf16 v[28:31], a[84:87], v[16:19], v[28:31]
    v_mfma_f32_16x16x32_bf16 v[32:35], a[164:167], v[16:19], v[32:35]
    buffer_load_dwordx4 v1, s[4:7], s23 offen offset:2048 sc1 lds
    ds_read_b128 v[16:19], v3 offset:3072
    s_waitcnt lgkmcnt(3)
    v_mfma_f32_16x16x32_bf16 v[36:39], a[4:7], v[20:23], v[36:39]
    v_mfma_f32_16x16x32_bf16 v[40:43], a[84:87], v[20:23], v[40:43]
    v_mfma_f32_16x16x32_bf16 v[44:47], a[164:167], v[20:23], v[44:47]
    buffer_load_dwordx4 v1, s[4:7], s23 offen offset:3072 sc1 lds
    ds_read_b128 v[20:23], v3 offset:23552
    s_waitcnt lgkmcnt(3)
    v_mfma_f32_16x16x32_bf16 v[24:27], a[8:11], v[8:11], v[24:27]
    v_mfma_f32_16x16x32_bf16 v[28:31], a[88:91], v[8:11], v[28:31]
    v_mfma_f32_16x16x32_bf16 v[32:35], a[168:171], v[8:11], v[32:35]
    v_cvt_pk_bf16_f32 v72, v48, v49
    s_add_u32 s23, s23, 4096
    s_add_u32 s24, s24, 4096
    s_mov_b32 m0, s24
    s_nop 0
    buffer_load_dwordx4 v1, s[4:7], s23 offen offset:0 sc1 lds
    ds_read_b128 v[8:11], v3 offset:4096
    s_waitcnt lgkmcnt(3)
    v_mfma_f32_16x16x32_bf16 v[36:39], a[8:11], v[12:15], v[36:39]
    v_mfma_f32_16x16x32_bf16 v[40:43], a[88:91], v[12:15], v[40:43]
    v_mfma_f32_16x16x32_bf16 v[44:47], a[168:171], v[12:15], v[44:47]
    v_cvt_pk_bf16_f32 v73, v50, v51
    buffer_load_dwordx4 v1, s[4:7], s23 offen offset:1024 sc1 lds
    ds_read_b128 v[12:15], v3 offset:24576
    s_waitcnt lgkmcnt(3)
    v_mfma_f32_16x16x32_bf16 v[24:27], a[12:15], v[16:19], v[24:27]
    v_mfma_f32_16x16x32_bf16 v[28:31], a[92:95], v[16:19], v[28:31]
    v_mfma_f32_16x16x32_bf16 v[32:35], a[172:175], v[16:19], v[32:35]
    buffer_store_dwordx2 v[72:73], v2, s[4:7], s37 offen offset:0 sc1
    buffer_load_dwordx4 v1, s[4:7], s23 offen offset:2048 sc1 lds
    ds_read_b128 v[16:19], v3 offset:5120
    s_waitcnt lgkmcnt(3)
    v_mfma_f32_16x16x32_bf16 v[36:39], a[12:15], v[20:23], v[36:39]
    v_mfma_f32_16x16x32_bf16 v[40:43], a[92:95], v[20:23], v[40:43]
    v_mfma_f32_16x16x32_bf16 v[44:47], a[172:175], v[20:23], v[44:47]
    v_cvt_pk_bf16_f32 v74, v52, v53
    buffer_load_dwordx4 v1, s[4:7], s23 offen offset:3072 sc1 lds
    ds_read_b128 v[20:23], v3 offset:25600
    s_waitcnt lgkmcnt(3)
    v_mfma_f32_16x16x32_bf16 v[24:27], a[16:19], v[8:11], v[24:27]
    v_mfma_f32_16x16x32_bf16 v[28:31], a[96:99], v[8:11], v[28:31]
    v_mfma_f32_16x16x32_bf16 v[32:35], a[176:179], v[8:11], v[32:35]
    v_cvt_pk_bf16_f32 v75, v54, v55
    s_add_u32 s23, s23, 4096
    s_add_u32 s24, s24, 4096
    s_mov_b32 m0, s24
    s_nop 0
    buffer_load_dwordx4 v1, s[4:7], s23 offen offset:0 sc1 lds
    ds_read_b128 v[8:11], v3 offset:6144
    s_waitcnt lgkmcnt(3)
    v_mfma_f32_16x16x32_bf16 v[36:39], a[16:19], v[12:15], v[36:39]
    v_mfma_f32_16x16x32_bf16 v[40:43], a[96:99], v[12:15], v[40:43]
    v_mfma_f32_16x16x32_bf16 v[44:47], a[176:179], v[12:15], v[44:47]
    buffer_store_dwordx2 v[74:75], v2, s[4:7], s37 offen offset:512 sc1
    buffer_load_dwordx4 v1, s[4:7], s23 offen offset:1024 sc1 lds
    ds_read_b128 v[12:15], v3 offset:26624
    s_waitcnt lgkmcnt(3)
    v_mfma_f32_16x16x32_bf16 v[24:27], a[20:23], v[16:19], v[24:27]
    v_mfma_f32_16x16x32_bf16 v[28:31], a[100:103], v[16:19], v[28:31]
    v_mfma_f32_16x16x32_bf16 v[32:35], a[180:183], v[16:19], v[32:35]
    v_cvt_pk_bf16_f32 v76, v56, v57
    ds_read_b128 v[16:19], v3 offset:7168
    s_waitcnt lgkmcnt(3)
    v_mfma_f32_16x16x32_bf16 v[36:39], a[20:23], v[20:23], v[36:39]
    v_mfma_f32_16x16x32_bf16 v[40:43], a[100:103], v[20:23], v[40:43]
    v_mfma_f32_16x16x32_bf16 v[44:47], a[180:183], v[20:23], v[44:47]
    v_cvt_pk_bf16_f32 v77, v58, v59
    ds_read_b128 v[20:23], v3 offset:27648
    s_waitcnt lgkmcnt(3)
    v_mfma_f32_16x16x32_bf16 v[24:27], a[24:27], v[8:11], v[24:27]
    v_mfma_f32_16x16x32_bf16 v[28:31], a[104:107], v[8:11], v[28:31]
    v_mfma_f32_16x16x32_bf16 v[32:35], a[184:187], v[8:11], v[32:35]
    buffer_store_dwordx2 v[76:77], v2, s[4:7], s37 offen offset:1024 sc1
    ds_read_b128 v[8:11], v3 offset:8192
    s_waitcnt lgkmcnt(3)
    v_mfma_f32_16x16x32_bf16 v[36:39], a[24:27], v[12:15], v[36:39]
    v_mfma_f32_16x16x32_bf16 v[40:43], a[104:107], v[12:15], v[40:43]
    v_mfma_f32_16x16x32_bf16 v[44:47], a[184:187], v[12:15], v[44:47]
    v_cvt_pk_bf16_f32 v78, v60, v61
    ds_read_b128 v[12:15], v3 offset:28672
    s_waitcnt lgkmcnt(3)
    v_mfma_f32_16x16x32_bf16 v[24:27], a[28:31], v[16:19], v[24:27]
    v_mfma_f32_16x16x32_bf16 v[28:31], a[108:111], v[16:19], v[28:31]
    v_mfma_f32_16x16x32_bf16 v[32:35], a[188:191], v[16:19], v[32:35]
    v_cvt_pk_bf16_f32 v79, v62, v63
    ds_read_b128 v[16:19], v3 offset:9216
    s_waitcnt lgkmcnt(3)
    v_mfma_f32_16x16x32_bf16 v[36:39], a[28:31], v[20:23], v[36:39]
    v_mfma_f32_16x16x32_bf16 v[40:43], a[108:111], v[20:23], v[40:43]
    v_mfma_f32_16x16x32_bf16 v[44:47], a[188:191], v[20:23], v[44:47]
    buffer_store_dwordx2 v[78:79], v2, s[4:7], s38 offen offset:0 sc1
    ds_read_b128 v[20:23], v3 offset:29696
    s_waitcnt lgkmcnt(3)
    v_mfma_f32_16x16x32_bf16 v[24:27], a[32:35], v[8:11], v[24:27]
    v_mfma_f32_16x16x32_bf16 v[28:31], a[112:115], v[8:11], v[28:31]
    v_mfma_f32_16x16x32_bf16 v[32:35], a[192:195], v[8:11], v[32:35]
    v_cvt_pk_bf16_f32 v80, v64, v65
    ds_read_b128 v[8:11], v3 offset:10240
    s_waitcnt lgkmcnt(3)
    v_mfma_f32_16x16x32_bf16 v[36:39], a[32:35], v[12:15], v[36:39]
    v_mfma_f32_16x16x32_bf16 v[40:43], a[112:115], v[12:15], v[40:43]
    v_mfma_f32_16x16x32_bf16 v[44:47], a[192:195], v[12:15], v[44:47]
    v_cvt_pk_bf16_f32 v81, v66, v67
    ds_read_b128 v[12:15], v3 offset:30720
    s_waitcnt lgkmcnt(3)
    v_mfma_f32_16x16x32_bf16 v[24:27], a[36:39], v[16:19], v[24:27]
    v_mfma_f32_16x16x32_bf16 v[28:31], a[116:119], v[16:19], v[28:31]
    v_mfma_f32_16x16x32_bf16 v[32:35], a[196:199], v[16:19], v[32:35]
    buffer_store_dwordx2 v[80:81], v2, s[4:7], s38 offen offset:512 sc1
    ds_read_b128 v[16:19], v3 offset:11264
    s_waitcnt lgkmcnt(3)
    v_mfma_f32_16x16x32_bf16 v[36:39], a[36:39], v[20:23], v[36:39]
    v_mfma_f32_16x16x32_bf16 v[40:43], a[116:119], v[20:23], v[40:43]
    v_mfma_f32_16x16x32_bf16 v[44:47], a[196:199], v[20:23], v[44:47]
    v_cvt_pk_bf16_f32 v82, v68, v69
    ds_read_b128 v[20:23], v3 offset:31744
    s_waitcnt lgkmcnt(3)
    v_mfma_f32_16x16x32_bf16 v[24:27], a[40:43], v[8:11], v[24:27]
    v_mfma_f32_16x16x32_bf16 v[28:31], a[120:123], v[8:11], v[28:31]
    v_mfma_f32_16x16x32_bf16 v[32:35], a[200:203], v[8:11], v[32:35]
    v_cvt_pk_bf16_f32 v83, v70, v71
    ds_read_b128 v[8:11], v3 offset:12288
    s_waitcnt lgkmcnt(3)
    v_mfma_f32_16x16x32_bf16 v[36:39], a[40:43], v[12:15], v[36:39]
    v_mfma_f32_16x16x32_bf16 v[40:43], a[120:123], v[12:15], v[40:43]
    v_mfma_f32_16x16x32_bf16 v[44:47], a[200:203], v[12:15], v[44:47]
    buffer_store_dwordx2 v[82:83], v2, s[4:7], s38 offen offset:1024 sc1
    ds_read_b128 v[12:15], v3 offset:32768
    s_waitcnt lgkmcnt(3)
    v_mfma_f32_16x16x32_bf16 v[24:27], a[44:47], v[16:19], v[24:27]
    v_mfma_f32_16x16x32_bf16 v[28:31], a[124:127], v[16:19], v[28:31]
    v_mfma_f32_16x16x32_bf16 v[32:35], a[204:207], v[16:19], v[32:35]
    ds_read_b128 v[16:19], v3 offset:13312
    s_waitcnt lgkmcnt(3)
    v_mfma_f32_16x16x32_bf16 v[36:39], a[44:47], v[20:23], v[36:39]
    v_mfma_f32_16x16x32_bf16 v[40:43], a[124:127], v[20:23], v[40:43]
    v_mfma_f32_16x16x32_bf16 v[44:47], a[204:207], v[20:23], v[44:47]
    ds_read_b128 v[20:23], v3 offset:33792
    s_waitcnt lgkmcnt(3)
    v_mfma_f32_16x16x32_bf16 v[24:27], a[48:51], v[8:11], v[24:27]
    v_mfma_f32_16x16x32_bf16 v[28:31], a[128:131], v[8:11], v[28:31]
    v_mfma_f32_16x16x32_bf16 v[32:35], a[208:211], v[8:11], v[32:35]
    ds_read_b128 v[8:11], v3 offset:14336
    s_waitcnt lgkmcnt(3)
    v_mfma_f32_16x16x32_bf16 v[36:39], a[48:51], v[12:15], v[36:39]
    v_mfma_f32_16x16x32_bf16 v[40:43], a[128:131], v[12:15], v[40:43]
    v_mfma_f32_16x16x32_bf16 v[44:47], a[208:211], v[12:15], v[44:47]
    ds_read_b128 v[12:15], v3 offset:34816
    s_waitcnt lgkmcnt(3)
    v_mfma_f32_16x16x32_bf16 v[24:27], a[52:55], v[16:19], v[24:27]
    v_mfma_f32_16x16x32_bf16 v[28:31], a[132:135], v[16:19], v[28:31]
    v_mfma_f32_16x16x32_bf16 v[32:35], a[212:215], v[16:19], v[32:35]
    ds_read_b128 v[16:19], v3 offset:15360
    s_waitcnt lgkmcnt(3)
    v_mfma_f32_16x16x32_bf16 v[36:39], a[52:55], v[20:23], v[36:39]
    v_mfma_f32_16x16x32_bf16 v[40:43], a[132:135], v[20:23], v[40:43]
    v_mfma_f32_16x16x32_bf16 v[44:47], a[212:215], v[20:23], v[44:47]
    ds_read_b128 v[20:23], v3 offset:35840
    s_waitcnt lgkmcnt(3)
    v_mfma_f32_16x16x32_bf16 v[24:27], a[56:59], v[8:11], v[24:27]
    v_mfma_f32_16x16x32_bf16 v[28:31], a[136:139], v[8:11], v[28:31]
    v_mfma_f32_16x16x32_bf16 v[32:35], a[216:219], v[8:11], v[32:35]
    ds_read_b128 v[8:11], v3 offset:16384
    s_waitcnt lgkmcnt(3)
    v_mfma_f32_16x16x32_bf16 v[36:39], a[56:59], v[12:15], v[36:39]
    v_mfma_f32_16x16x32_bf16 v[40:43], a[136:139], v[12:15], v[40:43]
    v_mfma_f32_16x16x32_bf16 v[44:47], a[216:219], v[12:15], v[44:47]
    ds_read_b128 v[12:15], v3 offset:36864
    s_waitcnt lgkmcnt(3)
    v_mfma_f32_16x16x32_bf16 v[24:27], a[60:63], v[16:19], v[24:27]
    v_mfma_f32_16x16x32_bf16 v[28:31], a[140:143], v[16:19], v[28:31]
    v_mfma_f32_16x16x32_bf16 v[32:35], a[220:223], v[16:19], v[32:35]
    ds_read_b128 v[16:19], v3 offset:17408
    s_waitcnt lgkmcnt(3)
    v_mfma_f32_16x16x32_bf16 v[36:39], a[60:63], v[20:23], v[36:39]
    v_mfma_f32_16x16x32_bf16 v[40:43], a[140:143], v[20:23], v[40:43]
    v_mfma_f32_16x16x32_bf16 v[44:47], a[220:223], v[20:23], v[44:47]
    ds_read_b128 v[20:23], v3 offset:37888
    s_waitcnt lgkmcnt(3)
    v_mfma_f32_16x16x32_bf16 v[24:27], a[64:67], v[8:11], v[24:27]
    v_mfma_f32_16x16x32_bf16 v[28:31], a[144:147], v[8:11], v[28:31]
    v_mfma_f32_16x16x32_bf16 v[32:35], a[224:227], v[8:11], v[32:35]
    ds_read_b128 v[8:11], v3 offset:18432
    s_waitcnt lgkmcnt(3)
    v_mfma_f32_16x16x32_bf16 v[36:39], a[64:67], v[12:15], v[36:39]
    v_mfma_f32_16x16x32_bf16 v[40:43], a[144:147], v[12:15], v[40:43]
    v_mfma_f32_16x16x32_bf16 v[44:47], a[224:227], v[12:15], v[44:47]
    ds_read_b128 v[12:15], v3 offset:38912
    s_waitcnt lgkmcnt(3)
    v_mfma_f32_16x16x32_bf16 v[24:27], a[68:71], v[16:19], v[24:27]
    v_mfma_f32_16x16x32_bf16 v[28:31], a[148:151], v[16:19], v[28:31]
    v_mfma_f32_16x16x32_bf16 v[32:35], a[228:231], v[16:19], v[32:35]
    ds_read_b128 v[16:19], v3 offset:19456
    s_waitcnt lgkmcnt(3)
    v_mfma_f32_16x16x32_bf16 v[36:39], a[68:71], v[20:23], v[36:39]
    v_mfma_f32_16x16x32_bf16 v[40:43], a[148:151], v[20:23], v[40:43]
    v_mfma_f32_16x16x32_bf16 v[44:47], a[228:231], v[20:23], v[44:47]
    ds_read_b128 v[20:23], v3 offset:39936
    s_waitcnt lgkmcnt(3)
    v_mfma_f32_16x16x32_bf16 v[24:27], a[72:75], v[8:11], v[24:27]
    v_mfma_f32_16x16x32_bf16 v[28:31], a[152:155], v[8:11], v[28:31]
    v_mfma_f32_16x16x32_bf16 v[32:35], a[232:235], v[8:11], v[32:35]
    s_waitcnt lgkmcnt(2)
    v_mfma_f32_16x16x32_bf16 v[36:39], a[72:75], v[12:15], v[36:39]
    v_mfma_f32_16x16x32_bf16 v[40:43], a[152:155], v[12:15], v[40:43]
    v_mfma_f32_16x16x32_bf16 v[44:47], a[232:235], v[12:15], v[44:47]
    s_waitcnt lgkmcnt(1)
    v_mfma_f32_16x16x32_bf16 v[24:27], a[76:79], v[16:19], v[24:27]
    v_mfma_f32_16x16x32_bf16 v[28:31], a[156:159], v[16:19], v[28:31]
    v_mfma_f32_16x16x32_bf16 v[32:35], a[236:239], v[16:19], v[32:35]
    s_waitcnt lgkmcnt(0)
    v_mfma_f32_16x16x32_bf16 v[36:39], a[76:79], v[20:23], v[36:39]
    v_mfma_f32_16x16x32_bf16 v[40:43], a[156:159], v[20:23], v[40:43]
    v_mfma_f32_16x16x32_bf16 v[44:47], a[236:239], v[20:23], v[44:47]
    s_mov_b32 s25, s34
    s_mov_b32 s34, s35
    s_mov_b32 s35, s36
    s_mov_b32 s36, s25
    s_add_u32 s17, s17, 1
    s_cmp_ge_u32 s17, s18
    s_nop 0
    s_cbranch_scc1 Lp_e0_50113
    s_waitcnt vmcnt(0)
    s_barrier
    s_cmp_lg_u32 s14, 0
    s_cbranch_scc1 Lsig_50117
    s_sub_u32 s46, s17, 1
    v_mov_b32 v4, s46
    v_mov_b32 v5, s47
    s_mov_b64 exec, 1
    buffer_store_dword v4, v5, s[4:7], 0 offen sc1
    s_mov_b64 exec, -1
Lsig_50117:
    s_add_u32 s25, s17, 2
    s_mul_i32 s23, s25, 40960
    s_add_u32 s23, s23, s22
    s_add_u32 s24, s36, s22
    s_sub_u32 s25, s17, 1
    s_mul_i32 s37, s25, 393216
    s_add_u32 s37, s37, s19
    s_add_u32 s38, s37, 196608
    v_add_u32 v3, s34, v1
    ds_read_b128 v[8:11], v3 offset:0
    ds_read_b128 v[12:15], v3 offset:20480
    ds_read_b128 v[16:19], v3 offset:1024
    ds_read_b128 v[20:23], v3 offset:21504
    s_waitcnt lgkmcnt(3)
    v_mfma_f32_16x16x32_bf16 v[48:51], a[0:3], v[8:11], 0
    v_mfma_f32_16x16x32_bf16 v[52:55], a[80:83], v[8:11], 0
    v_mfma_f32_16x16x32_bf16 v[56:59], a[160:163], v[8:11], 0
    s_mov_b32 m0, s24
    s_nop 0
    buffer_load_dwordx4 v1, s[4:7], s23 offen offset:0 sc1 lds
    ds_read_b128 v[8:11], v3 offset:2048
    s_waitcnt lgkmcnt(3)
    v_mfma_f32_16x16x32_bf16 v[60:63], a[0:3], v[12:15], 0
    v_mfma_f32_16x16x32_bf16 v[64:67], a[80:83], v[12:15], 0
    v_mfma_f32_16x16x32_bf16 v[68:71], a[160:163], v[12:15], 0
    buffer_load_dwordx4 v1, s[4:7], s23 offen offset:1024 sc1 lds
    ds_read_b128 v[12:15], v3 offset:22528
    s_waitcnt lgkmcnt(3)
    v_mfma_f32_16x16x32_bf16 v[48:51], a[4:7], v[16:19], v[48:51]
    v_mfma_f32_16x16x32_bf16 v[52:55], a[84:87], v[16:19], v[52:55]
    v_mfma_f32_16x16x32_bf16 v[56:59], a[164:167], v[16:19], v[56:59]
    buffer_load_dwordx4 v1, s[4:7], s23 offen offset:2048 sc1 lds
    ds_read_b128 v[16:19], v3 offset:3072
    s_waitcnt lgkmcnt(3)
    v_mfma_f32_16x16x32_bf16 v[60:63], a[4:7], v[20:23], v[60:63]
    v_mfma_f32_16x16x32_bf16 v[64:67], a[84:87], v[20:23], v[64:67]
    v_mfma_f32_16x16x32_bf16 v[68:71], a[164:167], v[20:23], v[68:71]
    buffer_load_dwordx4 v1, s[4:7], s23 offen offset:3072 sc1 lds
    ds_read_b128 v[20:23], v3 offset:23552
    s_waitcnt lgkmcnt(3)
    v_mfma_f32_16x16x32_bf16 v[48:51], a[8:11], v[8:11], v[48:51]
    v_mfma_f32_16x16x32_bf16 v[52:55], a[88:91], v[8:11], v[52:55]
    v_mfma_f32_16x16x32_bf16 v[56:59], a[168:171], v[8:11], v[56:59]
    v_cvt_pk_bf16_f32 v72, v24, v25
    s_add_u32 s23, s23, 4096
    s_add_u32 s24, s24, 4096
    s_mov_b32 m0, s24
    s_nop 0
    buffer_load_dwordx4 v1, s[4:7], s23 offen offset:0 sc1 lds
    ds_read_b128 v[8:11], v3 offset:4096
    s_waitcnt lgkmcnt(3)
    v_mfma_f32_16x16x32_bf16 v[60:63], a[8:11], v[12:15], v[60:63]
    v_mfma_f32_16x16x32_bf16 v[64:67], a[88:91], v[12:15], v[64:67]
    v_mfma_f32_16x16x32_bf16 v[68:71], a[168:171], v[12:15], v[68:71]
    v_cvt_pk_bf16_f32 v73, v26, v27
    buffer_load_dwordx4 v1, s[4:7], s23 offen offset:1024 sc1 lds
    ds_read_b128 v[12:15], v3 offset:24576
    s_waitcnt lgkmcnt(3)
    v_mfma_f32_16x16x32_bf16 v[48:51], a[12:15], v[16:19], v[48:51]
    v_mfma_f32_16x16x32_bf16 v[52:55], a[92:95], v[16:19], v[52:55]
    v_mfma_f32_16x16x32_bf16 v[56:59], a[172:175], v[16:19], v[56:59]
    buffer_store_dwordx2 v[72:73], v2, s[4:7], s37 offen offset:0 sc1
    buffer_load_dwordx4 v1, s[4:7], s23 offen offset:2048 sc1 lds
    ds_read_b128 v[16:19], v3 offset:5120
    s_waitcnt lgkmcnt(3)
    v_mfma_f32_16x16x32_bf16 v[60:63], a[12:15], v[20:23], v[60:63]
    v_mfma_f32_16x16x32_bf16 v[64:67], a[92:95], v[20:23], v[64:67]
    v_mfma_f32_16x16x32_bf16 v[68:71], a[172:175], v[20:23], v[68:71]
    v_cvt_pk_bf16_f32 v74, v28, v29
    buffer_load_dwordx4 v1, s[4:7], s23 offen offset:3072 sc1 lds
    ds_read_b128 v[20:23], v3 offset:25600
    s_waitcnt lgkmcnt(3)
    v_mfma_f32_16x16x32_bf16 v[48:51], a[16:19], v[8:11], v[48:51]
    v_mfma_f32_16x16x32_bf16 v[52:55], a[96:99], v[8:11], v[52:55]
    v_mfma_f32_16x16x32_bf16 v[56:59], a[176:179], v[8:11], v[56:59]
    v_cvt_pk_bf16_f32 v75, v30, v31
    s_add_u32 s23, s23, 4096
    s_add_u32 s24, s24, 4096
    s_mov_b32 m0, s24
    s_nop 0
    buffer_load_dwordx4 v1, s[4:7], s23 offen offset:0 sc1 lds
    ds_read_b128 v[8:11], v3 offset:6144
    s_waitcnt lgkmcnt(3)
    v_mfma_f32_16x16x32_bf16 v[60:63], a[16:19], v[12:15], v[60:63]
    v_mfma_f32_16x16x32_bf16 v[64:67], a[96:99], v[12:15], v[64:67]
    v_mfma_f32_16x16x32_bf16 v[68:71], a[176:179], v[12:15], v[68:71]
    buffer_store_dwordx2 v[74:75], v2, s[4:7], s37 offen offset:512 sc1
    buffer_load_dwordx4 v1, s[4:7], s23 offen offset:1024 sc1 lds
    ds_read_b128 v[12:15], v3 offset:26624
    s_waitcnt lgkmcnt(3)
    v_mfma_f32_16x16x32_bf16 v[48:51], a[20:23], v[16:19], v[48:51]
    v_mfma_f32_16x16x32_bf16 v[52:55], a[100:103], v[16:19], v[52:55]
    v_mfma_f32_16x16x32_bf16 v[56:59], a[180:183], v[16:19], v[56:59]
    v_cvt_pk_bf16_f32 v76, v32, v33
    ds_read_b128 v[16:19], v3 offset:7168
    s_waitcnt lgkmcnt(3)
    v_mfma_f32_16x16x32_bf16 v[60:63], a[20:23], v[20:23], v[60:63]
    v_mfma_f32_16x16x32_bf16 v[64:67], a[100:103], v[20:23], v[64:67]
    v_mfma_f32_16x16x32_bf16 v[68:71], a[180:183], v[20:23], v[68:71]
    v_cvt_pk_bf16_f32 v77, v34, v35
    ds_read_b128 v[20:23], v3 offset:27648
    s_waitcnt lgkmcnt(3)
    v_mfma_f32_16x16x32_bf16 v[48:51], a[24:27], v[8:11], v[48:51]
    v_mfma_f32_16x16x32_bf16 v[52:55], a[104:107], v[8:11], v[52:55]
    v_mfma_f32_16x16x32_bf16 v[56:59], a[184:187], v[8:11], v[56:59]
    buffer_store_dwordx2 v[76:77], v2, s[4:7], s37 offen offset:1024 sc1
    ds_read_b128 v[8:11], v3 offset:8192
    s_waitcnt lgkmcnt(3)
    v_mfma_f32_16x16x32_bf16 v[60:63], a[24:27], v[12:15], v[60:63]
    v_mfma_f32_16x16x32_bf16 v[64:67], a[104:107], v[12:15], v[64:67]
    v_mfma_f32_16x16x32_bf16 v[68:71], a[184:187], v[12:15], v[68:71]
    v_cvt_pk_bf16_f32 v78, v36, v37
    ds_read_b128 v[12:15], v3 offset:28672
    s_waitcnt lgkmcnt(3)
    v_mfma_f32_16x16x32_bf16 v[48:51], a[28:31], v[16:19], v[48:51]
    v_mfma_f32_16x16x32_bf16 v[52:55], a[108:111], v[16:19], v[52:55]
    v_mfma_f32_16x16x32_bf16 v[56:59], a[188:191], v[16:19], v[56:59]
    v_cvt_pk_bf16_f32 v79, v38, v39
    ds_read_b128 v[16:19], v3 offset:9216
    s_waitcnt lgkmcnt(3)
    v_mfma_f32_16x16x32_bf16 v[60:63], a[28:31], v[20:23], v[60:63]
    v_mfma_f32_16x16x32_bf16 v[64:67], a[108:111], v[20:23], v[64:67]
    v_mfma_f32_16x16x32_bf16 v[68:71], a[188:191], v[20:23], v[68:71]
    buffer_store_dwordx2 v[78:79], v2, s[4:7], s38 offen offset:0 sc1
    ds_read_b128 v[20:23], v3 offset:29696
    s_waitcnt lgkmcnt(3)
    v_mfma_f32_16x16x32_bf16 v[48:51], a[32:35], v[8:11], v[48:51]
    v_mfma_f32_16x16x32_bf16 v[52:55], a[112:115], v[8:11], v[52:55]
    v_mfma_f32_16x16x32_bf16 v[56:59], a[192:195], v[8:11], v[56:59]
    v_cvt_pk_bf16_f32 v80, v40, v41
    ds_read_b128 v[8:11], v3 offset:10240
    s_waitcnt lgkmcnt(3)
    v_mfma_f32_16x16x32_bf16 v[60:63], a[32:35], v[12:15], v[60:63]
    v_mfma_f32_16x16x32_bf16 v[64:67], a[112:115], v[12:15], v[64:67]
    v_mfma_f32_16x16x32_bf16 v[68:71], a[192:195], v[12:15], v[68:71]
    v_cvt_pk_bf16_f32 v81, v42, v43
    ds_read_b128 v[12:15], v3 offset:30720
    s_waitcnt lgkmcnt(3)
    v_mfma_f32_16x16x32_bf16 v[48:51], a[36:39], v[16:19], v[48:51]
    v_mfma_f32_16x16x32_bf16 v[52:55], a[116:119], v[16:19], v[52:55]
    v_mfma_f32_16x16x32_bf16 v[56:59], a[196:199], v[16:19], v[56:59]
    buffer_store_dwordx2 v[80:81], v2, s[4:7], s38 offen offset:512 sc1
    ds_read_b128 v[16:19], v3 offset:11264
    s_waitcnt lgkmcnt(3)
    v_mfma_f32_16x16x32_bf16 v[60:63], a[36:39], v[20:23], v[60:63]
    v_mfma_f32_16x16x32_bf16 v[64:67], a[116:119], v[20:23], v[64:67]
    v_mfma_f32_16x16x32_bf16 v[68:71], a[196:199], v[20:23], v[68:71]
    v_cvt_pk_bf16_f32 v82, v44, v45
    ds_read_b128 v[20:23], v3 offset:31744
    s_waitcnt lgkmcnt(3)
    v_mfma_f32_16x16x32_bf16 v[48:51], a[40:43], v[8:11], v[48:51]
    v_mfma_f32_16x16x32_bf16 v[52:55], a[120:123], v[8:11], v[52:55]
    v_mfma_f32_16x16x32_bf16 v[56:59], a[200:203], v[8:11], v[56:59]
    v_cvt_pk_bf16_f32 v83, v46, v47
    ds_read_b128 v[8:11], v3 offset:12288
    s_waitcnt lgkmcnt(3)
    v_mfma_f32_16x16x32_bf16 v[60:63], a[40:43], v[12:15], v[60:63]
    v_mfma_f32_16x16x32_bf16 v[64:67], a[120:123], v[12:15], v[64:67]
    v_mfma_f32_16x16x32_bf16 v[68:71], a[200:203], v[12:15], v[68:71]
    buffer_store_dwordx2 v[82:83], v2, s[4:7], s38 offen offset:1024 sc1
    ds_read_b128 v[12:15], v3 offset:32768
    s_waitcnt lgkmcnt(3)
    v_mfma_f32_16x16x32_bf16 v[48:51], a[44:47], v[16:19], v[48:51]
    v_mfma_f32_16x16x32_bf16 v[52:55], a[124:127], v[16:19], v[52:55]
    v_mfma_f32_16x16x32_bf16 v[56:59], a[204:207], v[16:19], v[56:59]
    ds_read_b128 v[16:19], v3 offset:13312
    s_waitcnt lgkmcnt(3)
    v_mfma_f32_16x16x32_bf16 v[60:63], a[44:47], v[20:23], v[60:63]
    v_mfma_f32_16x16x32_bf16 v[64:67], a[124:127], v[20:23], v[64:67]
    v_mfma_f32_16x16x32_bf16 v[68:71], a[204:207], v[20:23], v[68:71]
    ds_read_b128 v[20:23], v3 offset:33792
    s_waitcnt lgkmcnt(3)
    v_mfma_f32_16x16x32_bf16 v[48:51], a[48:51], v[8:11], v[48:51]
    v_mfma_f32_16x16x32_bf16 v[52:55], a[128:131], v[8:11], v[52:55]
    v_mfma_f32_16x16x32_bf16 v[56:59], a[208:211], v[8:11], v[56:59]
    ds_read_b128 v[8:11], v3 offset:14336
    s_waitcnt lgkmcnt(3)
    v_mfma_f32_16x16x32_bf16 v[60:63], a[48:51], v[12:15], v[60:63]
    v_mfma_f32_16x16x32_bf16 v[64:67], a[128:131], v[12:15], v[64:67]
    v_mfma_f32_16x16x32_bf16 v[68:71], a[208:211], v[12:15], v[68:71]
    ds_read_b128 v[12:15], v3 offset:34816
    s_waitcnt lgkmcnt(3)
    v_mfma_f32_16x16x32_bf16 v[48:51], a[52:55], v[16:19], v[48:51]
    v_mfma_f32_16x16x32_bf16 v[52:55], a[132:135], v[16:19], v[52:55]
    v_mfma_f32_16x16x32_bf16 v[56:59], a[212:215], v[16:19], v[56:59]
    ds_read_b128 v[16:19], v3 offset:15360
    s_waitcnt lgkmcnt(3)
    v_mfma_f32_16x16x32_bf16 v[60:63], a[52:55], v[20:23], v[60:63]
    v_mfma_f32_16x16x32_bf16 v[64:67], a[132:135], v[20:23], v[64:67]
    v_mfma_f32_16x16x32_bf16 v[68:71], a[212:215], v[20:23], v[68:71]
    ds_read_b128 v[20:23], v3 offset:35840
    s_waitcnt lgkmcnt(3)
    v_mfma_f32_16x16x32_bf16 v[48:51], a[56:59], v[8:11], v[48:51]
    v_mfma_f32_16x16x32_bf16 v[52:55], a[136:139], v[8:11], v[52:55]
    v_mfma_f32_16x16x32_bf16 v[56:59], a[216:219], v[8:11], v[56:59]
    ds_read_b128 v[8:11], v3 offset:16384
    s_waitcnt lgkmcnt(3)
    v_mfma_f32_16x16x32_bf16 v[60:63], a[56:59], v[12:15], v[60:63]
    v_mfma_f32_16x16x32_bf16 v[64:67], a[136:139], v[12:15], v[64:67]
    v_mfma_f32_16x16x32_bf16 v[68:71], a[216:219], v[12:15], v[68:71]
    ds_read_b128 v[12:15], v3 offset:36864
    s_waitcnt lgkmcnt(3)
    v_mfma_f32_16x16x32_bf16 v[48:51], a[60:63], v[16:19], v[48:51]
    v_mfma_f32_16x16x32_bf16 v[52:55], a[140:143], v[16:19], v[52:55]
    v_mfma_f32_16x16x32_bf16 v[56:59], a[220:223], v[16:19], v[56:59]
    ds_read_b128 v[16:19], v3 offset:17408
    s_waitcnt lgkmcnt(3)
    v_mfma_f32_16x16x32_bf16 v[60:63], a[60:63], v[20:23], v[60:63]
    v_mfma_f32_16x16x32_bf16 v[64:67], a[140:143], v[20:23], v[64:67]
    v_mfma_f32_16x16x32_bf16 v[68:71], a[220:223], v[20:23], v[68:71]
    ds_read_b128 v[20:23], v3 offset:37888
    s_waitcnt lgkmcnt(3)
    v_mfma_f32_16x16x32_bf16 v[48:51], a[64:67], v[8:11], v[48:51]
    v_mfma_f32_16x16x32_bf16 v[52:55], a[144:147], v[8:11], v[52:55]
    v_mfma_f32_16x16x32_bf16 v[56:59], a[224:227], v[8:11], v[56:59]
    ds_read_b128 v[8:11], v3 offset:18432
    s_waitcnt lgkmcnt(3)
    v_mfma_f32_16x16x32_bf16 v[60:63], a[64:67], v[12:15], v[60:63]
    v_mfma_f32_16x16x32_bf16 v[64:67], a[144:147], v[12:15], v[64:67]
    v_mfma_f32_16x16x32_bf16 v[68:71], a[224:227], v[12:15], v[68:71]
    ds_read_b128 v[12:15], v3 offset:38912
    s_waitcnt lgkmcnt(3)
    v_mfma_f32_16x16x32_bf16 v[48:51], a[68:71], v[16:19], v[48:51]
    v_mfma_f32_16x16x32_bf16 v[52:55], a[148:151], v[16:19], v[52:55]
    v_mfma_f32_16x16x32_bf16 v[56:59], a[228:231], v[16:19], v[56:59]
    ds_read_b128 v[16:19], v3 offset:19456
    s_waitcnt lgkmcnt(3)
    v_mfma_f32_16x16x32_bf16 v[60:63], a[68:71], v[20:23], v[60:63]
    v_mfma_f32_16x16x32_bf16 v[64:67], a[148:151], v[20:23], v[64:67]
    v_mfma_f32_16x16x32_bf16 v[68:71], a[228:231], v[20:23], v[68:71]
    ds_read_b128 v[20:23], v3 offset:39936
    s_waitcnt lgkmcnt(3)
    v_mfma_f32_16x16x32_bf16 v[48:51], a[72:75], v[8:11], v[48:51]
    v_mfma_f32_16x16x32_bf16 v[52:55], a[152:155], v[8:11], v[52:55]
    v_mfma_f32_16x16x32_bf16 v[56:59], a[232:235], v[8:11], v[56:59]
    s_waitcnt lgkmcnt(2)
    v_mfma_f32_16x16x32_bf16 v[60:63], a[72:75], v[12:15], v[60:63]
    v_mfma_f32_16x16x32_bf16 v[64:67], a[152:155], v[12:15], v[64:67]
    v_mfma_f32_16x16x32_bf16 v[68:71], a[232:235], v[12:15], v[68:71]
    s_waitcnt lgkmcnt(1)
    v_mfma_f32_16x16x32_bf16 v[48:51], a[76:79], v[16:19], v[48:51]
    v_mfma_f32_16x16x32_bf16 v[52:55], a[156:159], v[16:19], v[52:55]
    v_mfma_f32_16x16x32_bf16 v[56:59], a[236:239], v[16:19], v[56:59]
    s_waitcnt lgkmcnt(0)
    v_mfma_f32_16x16x32_bf16 v[60:63], a[76:79], v[20:23], v[60:63]
    v_mfma_f32_16x16x32_bf16 v[64:67], a[156:159], v[20:23], v[64:67]
    v_mfma_f32_16x16x32_bf16 v[68:71], a[236:239], v[20:23], v[68:71]
    s_mov_b32 s25, s34
    s_mov_b32 s34, s35
    s_mov_b32 s35, s36
    s_mov_b32 s36, s25
    s_add_u32 s17, s17, 1
    s_cmp_lt_u32 s17, s18
    s_nop 0
    s_cbranch_scc1 Lp_loop_50111
    s_branch Lp_e1_50114
Lp_e0_50113:
    s_sub_u32 s25, s17, 1
    s_mul_i32 s37, s25, 393216
    s_add_u32 s37, s37, s19
    s_add_u32 s38, s37, 196608
    v_cvt_pk_bf16_f32 v72, v24, v25
    v_cvt_pk_bf16_f32 v73, v26, v27
    buffer_store_dwordx2 v[72:73], v2, s[4:7], s37 offen offset:0 sc1
    v_cvt_pk_bf16_f32 v74, v28, v29
    v_cvt_pk_bf16_f32 v75, v30, v31
    buffer_store_dwordx2 v[74:75], v2, s[4:7], s37 offen offset:512 sc1
    v_cvt_pk_bf16_f32 v76, v32, v33
    v_cvt_pk_bf16_f32 v77, v34, v35
    buffer_store_dwordx2 v[76:77], v2, s[4:7], s37 offen offset:1024 sc1
    v_cvt_pk_bf16_f32 v78, v36, v37
    v_cvt_pk_bf16_f32 v79, v38, v39
    buffer_store_dwordx2 v[78:79], v2, s[4:7], s38 offen offset:0 sc1
    v_cvt_pk_bf16_f32 v80, v40, v41
    v_cvt_pk_bf16_f32 v81, v42, v43
    buffer_store_dwordx2 v[80:81], v2, s[4:7], s38 offen offset:512 sc1
    v_cvt_pk_bf16_f32 v82, v44, v45
    v_cvt_pk_bf16_f32 v83, v46, v47
    buffer_store_dwordx2 v[82:83], v2, s[4:7], s38 offen offset:1024 sc1
    s_branch Lp_end_50112
Lp_e1_50114:
    s_sub_u32 s25, s17, 1
    s_mul_i32 s37, s25, 393216
    s_add_u32 s37, s37, s19
    s_add_u32 s38, s37, 196608
    v_cvt_pk_bf16_f32 v72, v48, v49
    v_cvt_pk_bf16_f32 v73, v50, v51
    buffer_store_dwordx2 v[72:73], v2, s[4:7], s37 offen offset:0 sc1
    v_cvt_pk_bf16_f32 v74, v52, v53
    v_cvt_pk_bf16_f32 v75, v54, v55
    buffer_store_dwordx2 v[74:75], v2, s[4:7], s37 offen offset:512 sc1
    v_cvt_pk_bf16_f32 v76, v56, v57
    v_cvt_pk_bf16_f32 v77, v58, v59
    buffer_store_dwordx2 v[76:77], v2, s[4:7], s37 offen offset:1024 sc1
    v_cvt_pk_bf16_f32 v78, v60, v61
    v_cvt_pk_bf16_f32 v79, v62, v63
    buffer_store_dwordx2 v[78:79], v2, s[4:7], s38 offen offset:0 sc1
    v_cvt_pk_bf16_f32 v80, v64, v65
    v_cvt_pk_bf16_f32 v81, v66, v67
    buffer_store_dwordx2 v[80:81], v2, s[4:7], s38 offen offset:512 sc1
    v_cvt_pk_bf16_f32 v82, v68, v69
    v_cvt_pk_bf16_f32 v83, v70, v71
    buffer_store_dwordx2 v[82:83], v2, s[4:7], s38 offen offset:1024 sc1
    s_branch Lp_end_50112
Lp_end_50112:
    s_waitcnt vmcnt(0)
    s_barrier
    s_cmp_lg_u32 s14, 0
    s_cbranch_scc1 Lsig_50118
    s_add_u32 s46, s17, 0
    v_mov_b32 v4, s46
    v_mov_b32 v5, s47
    s_mov_b64 exec, 1
    buffer_store_dword v4, v5, s[4:7], 0 offen sc1
    s_mov_b64 exec, -1
Lsig_50118:
    s_branch Lmain_tasks
Lmain_hop:
    s_branch Lmain_tasks
Lmain_u:
    s_mul_i32 s27, s14, 30720
    s_mul_i32 s28, s26, 245760
    s_add_u32 s28, s28, s27
    s_add_u32 s32, s54, s28
    s_addc_u32 s33, s55, 0
    v_lshlrev_b32 v42, 4, v0
    v_lshrrev_b32 v40, 4, v0
    v_mul_u32_u24 v40, 12, v40
    v_bfe_u32 v41, v0, 2, 2
    v_add_u32 v40, v40, v41
    v_mul_u32_u24 v40, 1280, v40
    v_and_b32 v41, 3, v0
    v_lshlrev_b32 v41, 3, v41
    s_mul_i32 s29, s14, 320
    v_add3_u32 v40, v40, v41, s29
    v_add_u32 v41, 61440, v40
    s_add_u32 m0, s27, 0
    s_nop 0
    global_load_lds_dwordx4 v42, s[32:33] offset:0
    global_load_lds_dwordx4 v42, s[32:33] offset:1024
    global_load_lds_dwordx4 v42, s[32:33] offset:2048
    s_add_u32 s32, s32, 3072
    s_addc_u32 s33, s33, 0
    s_add_u32 m0, s27, 3072
    s_nop 0
    global_load_lds_dwordx4 v42, s[32:33] offset:0
    global_load_lds_dwordx4 v42, s[32:33] offset:1024
    global_load_lds_dwordx4 v42, s[32:33] offset:2048
    s_add_u32 s32, s32, 3072
    s_addc_u32 s33, s33, 0
    s_add_u32 m0, s27, 6144
    s_nop 0
    global_load_lds_dwordx4 v42, s[32:33] offset:0
    global_load_lds_dwordx4 v42, s[32:33] offset:1024
    global_load_lds_dwordx4 v42, s[32:33] offset:2048
    s_add_u32 s32, s32, 3072
    s_addc_u32 s33, s33, 0
    s_add_u32 m0, s27, 9216
    s_nop 0
    global_load_lds_dwordx4 v42, s[32:33] offset:0
    global_load_lds_dwordx4 v42, s[32:33] offset:1024
    global_load_lds_dwordx4 v42, s[32:33] offset:2048
    s_add_u32 s32, s32, 3072
    s_addc_u32 s33, s33, 0
    s_add_u32 m0, s27, 12288
    s_nop 0
    global_load_lds_dwordx4 v42, s[32:33] offset:0
    global_load_lds_dwordx4 v42, s[32:33] offset:1024
    global_load_lds_dwordx4 v42, s[32:33] offset:2048
    s_add_u32 s32, s32, 3072
    s_addc_u32 s33, s33, 0
    s_add_u32 m0, s27, 15360
    s_nop 0
    global_load_lds_dwordx4 v42, s[32:33] offset:0
    global_load_lds_dwordx4 v42, s[32:33] offset:1024
    global_load_lds_dwordx4 v42, s[32:33] offset:2048
    s_add_u32 s32, s32, 3072
    s_addc_u32 s33, s33, 0
    s_add_u32 m0, s27, 18432
    s_nop 0
    global_load_lds_dwordx4 v42, s[32:33] offset:0
    global_load_lds_dwordx4 v42, s[32:33] offset:1024
    global_load_lds_dwordx4 v42, s[32:33] offset:2048
    s_add_u32 s32, s32, 3072
    s_addc_u32 s33, s33, 0
    s_add_u32 m0, s27, 21504
    s_nop 0
    global_load_lds_dwordx4 v42, s[32:33] offset:0
    global_load_lds_dwordx4 v42, s[32:33] offset:1024
    global_load_lds_dwordx4 v42, s[32:33] offset:2048
    s_add_u32 s32, s32, 3072
    s_addc_u32 s33, s33, 0
    s_add_u32 m0, s27, 24576
    s_nop 0
    global_load_lds_dwordx4 v42, s[32:33] offset:0
    global_load_lds_dwordx4 v42, s[32:33] offset:1024
    global_load_lds_dwordx4 v42, s[32:33] offset:2048
    s_add_u32 s32, s32, 3072
    s_addc_u32 s33, s33, 0
    s_add_u32 m0, s27, 27648
    s_nop 0
    global_load_lds_dwordx4 v42, s[32:33] offset:0
    global_load_lds_dwordx4 v42, s[32:33] offset:1024
    global_load_lds_dwordx4 v42, s[32:33] offset:2048
    s_add_u32 s32, s32, 3072
    s_addc_u32 s33, s33, 0
    s_add_u32 s32, s32, 92160
    s_addc_u32 s33, s33, 0
    s_waitcnt vmcnt(0)
    s_barrier
    ds_read_b64_tr_b16 a[0:1], v40 offset:0
    ds_read_b64_tr_b16 a[2:3], v40 offset:5120
    ds_read_b64_tr_b16 a[4:5], v40 offset:10240
    ds_read_b64_tr_b16 a[6:7], v41 offset:0
    ds_read_b64_tr_b16 a[8:9], v41 offset:5120
    ds_read_b64_tr_b16 a[10:11], v41 offset:10240
    s_waitcnt lgkmcnt(0)
    ds_read_b64_tr_b16 a[24:25], v40 offset:32
    ds_read_b64_tr_b16 a[26:27], v40 offset:5152
    ds_read_b64_tr_b16 a[28:29], v40 offset:10272
    ds_read_b64_tr_b16 a[30:31], v41 offset:32
    ds_read_b64_tr_b16 a[32:33], v41 offset:5152
    ds_read_b64_tr_b16 a[34:35], v41 offset:10272
    s_waitcnt lgkmcnt(0)
    ds_read_b64_tr_b16 a[48:49], v40 offset:64
    ds_read_b64_tr_b16 a[50:51], v40 offset:5184
    ds_read_b64_tr_b16 a[52:53], v40 offset:10304
    ds_read_b64_tr_b16 a[54:55], v41 offset:64
    ds_read_b64_tr_b16 a[56:57], v41 offset:5184
    ds_read_b64_tr_b16 a[58:59], v41 offset:10304
    s_waitcnt lgkmcnt(0)
    ds_read_b64_tr_b16 a[72:73], v40 offset:96
    ds_read_b64_tr_b16 a[74:75], v40 offset:5216
    ds_read_b64_tr_b16 a[76:77], v40 offset:10336
    ds_read_b64_tr_b16 a[78:79], v41 offset:96
    ds_read_b64_tr_b16 a[80:81], v41 offset:5216
    ds_read_b64_tr_b16 a[82:83], v41 offset:10336
    s_waitcnt lgkmcnt(0)
    ds_read_b64_tr_b16 a[96:97], v40 offset:128
    ds_read_b64_tr_b16 a[98:99], v40 offset:5248
    ds_read_b64_tr_b16 a[100:101], v40 offset:10368
    ds_read_b64_tr_b16 a[102:103], v41 offset:128
    ds_read_b64_tr_b16 a[104:105], v41 offset:5248
    ds_read_b64_tr_b16 a[106:107], v41 offset:10368
    s_waitcnt lgkmcnt(0)
    ds_read_b64_tr_b16 a[120:121], v40 offset:160
    ds_read_b64_tr_b16 a[122:123], v40 offset:5280
    ds_read_b64_tr_b16 a[124:125], v40 offset:10400
    ds_read_b64_tr_b16 a[126:127], v41 offset:160
    ds_read_b64_tr_b16 a[128:129], v41 offset:5280
    ds_read_b64_tr_b16 a[130:131], v41 offset:10400
    s_waitcnt lgkmcnt(0)
    ds_read_b64_tr_b16 a[144:145], v40 offset:192
    ds_read_b64_tr_b16 a[146:147], v40 offset:5312
    ds_read_b64_tr_b16 a[148:149], v40 offset:10432
    ds_read_b64_tr_b16 a[150:151], v41 offset:192
    ds_read_b64_tr_b16 a[152:153], v41 offset:5312
    ds_read_b64_tr_b16 a[154:155], v41 offset:10432
    s_waitcnt lgkmcnt(0)
    ds_read_b64_tr_b16 a[168:169], v40 offset:224
    ds_read_b64_tr_b16 a[170:171], v40 offset:5344
    ds_read_b64_tr_b16 a[172:173], v40 offset:10464
    ds_read_b64_tr_b16 a[174:175], v41 offset:224
    ds_read_b64_tr_b16 a[176:177], v41 offset:5344
    ds_read_b64_tr_b16 a[178:179], v41 offset:10464
    s_waitcnt lgkmcnt(0)
    ds_read_b64_tr_b16 a[192:193], v40 offset:256
    ds_read_b64_tr_b16 a[194:195], v40 offset:5376
    ds_read_b64_tr_b16 a[196:197], v40 offset:10496
    ds_read_b64_tr_b16 a[198:199], v41 offset:256
    ds_read_b64_tr_b16 a[200:201], v41 offset:5376
    ds_read_b64_tr_b16 a[202:203], v41 offset:10496
    s_waitcnt lgkmcnt(0)
    ds_read_b64_tr_b16 a[216:217], v40 offset:288
    ds_read_b64_tr_b16 a[218:219], v40 offset:5408
    ds_read_b64_tr_b16 a[220:221], v40 offset:10528
    ds_read_b64_tr_b16 a[222:223], v41 offset:288
    ds_read_b64_tr_b16 a[224:225], v41 offset:5408
    ds_read_b64_tr_b16 a[226:227], v41 offset:10528
    s_waitcnt lgkmcnt(0)
    s_barrier
    s_add_u32 m0, s27, 0
    s_nop 0
    global_load_lds_dwordx4 v42, s[32:33] offset:0
    global_load_lds_dwordx4 v42, s[32:33] offset:1024
    global_load_lds_dwordx4 v42, s[32:33] offset:2048
    s_add_u32 s32, s32, 3072
    s_addc_u32 s33, s33, 0
    s_add_u32 m0, s27, 3072
    s_nop 0
    global_load_lds_dwordx4 v42, s[32:33] offset:0
    global_load_lds_dwordx4 v42, s[32:33] offset:1024
    global_load_lds_dwordx4 v42, s[32:33] offset:2048
    s_add_u32 s32, s32, 3072
    s_addc_u32 s33, s33, 0
    s_add_u32 m0, s27, 6144
    s_nop 0
    global_load_lds_dwordx4 v42, s[32:33] offset:0
    global_load_lds_dwordx4 v42, s[32:33] offset:1024
    global_load_lds_dwordx4 v42, s[32:33] offset:2048
    s_add_u32 s32, s32, 3072
    s_addc_u32 s33, s33, 0
    s_add_u32 m0, s27, 9216
    s_nop 0
    global_load_lds_dwordx4 v42, s[32:33] offset:0
    global_load_lds_dwordx4 v42, s[32:33] offset:1024
    global_load_lds_dwordx4 v42, s[32:33] offset:2048
    s_add_u32 s32, s32, 3072
    s_addc_u32 s33, s33, 0
    s_add_u32 m0, s27, 12288
    s_nop 0
    global_load_lds_dwordx4 v42, s[32:33] offset:0
    global_load_lds_dwordx4 v42, s[32:33] offset:1024
    global_load_lds_dwordx4 v42, s[32:33] offset:2048
    s_add_u32 s32, s32, 3072
    s_addc_u32 s33, s33, 0
    s_add_u32 m0, s27, 15360
    s_nop 0
    global_load_lds_dwordx4 v42, s[32:33] offset:0
    global_load_lds_dwordx4 v42, s[32:33] offset:1024
    global_load_lds_dwordx4 v42, s[32:33] offset:2048
    s_add_u32 s32, s32, 3072
    s_addc_u32 s33, s33, 0
    s_add_u32 m0, s27, 18432
    s_nop 0
    global_load_lds_dwordx4 v42, s[32:33] offset:0
    global_load_lds_dwordx4 v42, s[32:33] offset:1024
    global_load_lds_dwordx4 v42, s[32:33] offset:2048
    s_add_u32 s32, s32, 3072
    s_addc_u32 s33, s33, 0
    s_add_u32 m0, s27, 21504
    s_nop 0
    global_load_lds_dwordx4 v42, s[32:33] offset:0
    global_load_lds_dwordx4 v42, s[32:33] offset:1024
    global_load_lds_dwordx4 v42, s[32:33] offset:2048
    s_add_u32 s32, s32, 3072
    s_addc_u32 s33, s33, 0
    s_add_u32 m0, s27, 24576
    s_nop 0
    global_load_lds_dwordx4 v42, s[32:33] offset:0
    global_load_lds_dwordx4 v42, s[32:33] offset:1024
    global_load_lds_dwordx4 v42, s[32:33] offset:2048
    s_add_u32 s32, s32, 3072
    s_addc_u32 s33, s33, 0
    s_add_u32 m0, s27, 27648
    s_nop 0
    global_load_lds_dwordx4 v42, s[32:33] offset:0
    global_load_lds_dwordx4 v42, s[32:33] offset:1024
    global_load_lds_dwordx4 v42, s[32:33] offset:2048
    s_add_u32 s32, s32, 3072
    s_addc_u32 s33, s33, 0
    s_add_u32 s32, s32, 92160
    s_addc_u32 s33, s33, 0
    s_waitcnt vmcnt(0)
    s_barrier
    ds_read_b64_tr_b16 a[12:13], v40 offset:0
    ds_read_b64_tr_b16 a[14:15], v40 offset:5120
    ds_read_b64_tr_b16 a[16:17], v40 offset:10240
    ds_read_b64_tr_b16 a[18:19], v41 offset:0
    ds_read_b64_tr_b16 a[20:21], v41 offset:5120
    ds_read_b64_tr_b16 a[22:23], v41 offset:10240
    s_waitcnt lgkmcnt(0)
    ds_read_b64_tr_b16 a[36:37], v40 offset:32
    ds_read_b64_tr_b16 a[38:39], v40 offset:5152
    ds_read_b64_tr_b16 a[40:41], v40 offset:10272
    ds_read_b64_tr_b16 a[42:43], v41 offset:32
    ds_read_b64_tr_b16 a[44:45], v41 offset:5152
    ds_read_b64_tr_b16 a[46:47], v41 offset:10272
    s_waitcnt lgkmcnt(0)
    ds_read_b64_tr_b16 a[60:61], v40 offset:64
    ds_read_b64_tr_b16 a[62:63], v40 offset:5184
    ds_read_b64_tr_b16 a[64:65], v40 offset:10304
    ds_read_b64_tr_b16 a[66:67], v41 offset:64
    ds_read_b64_tr_b16 a[68:69], v41 offset:5184
    ds_read_b64_tr_b16 a[70:71], v41 offset:10304
    s_waitcnt lgkmcnt(0)
    ds_read_b64_tr_b16 a[84:85], v40 offset:96
    ds_read_b64_tr_b16 a[86:87], v40 offset:5216
    ds_read_b64_tr_b16 a[88:89], v40 offset:10336
    ds_read_b64_tr_b16 a[90:91], v41 offset:96
    ds_read_b64_tr_b16 a[92:93], v41 offset:5216
    ds_read_b64_tr_b16 a[94:95], v41 offset:10336
    s_waitcnt lgkmcnt(0)
    ds_read_b64_tr_b16 a[108:109], v40 offset:128
    ds_read_b64_tr_b16 a[110:111], v40 offset:5248
    ds_read_b64_tr_b16 a[112:113], v40 offset:10368
    ds_read_b64_tr_b16 a[114:115], v41 offset:128
    ds_read_b64_tr_b16 a[116:117], v41 offset:5248
    ds_read_b64_tr_b16 a[118:119], v41 offset:10368
    s_waitcnt lgkmcnt(0)
    ds_read_b64_tr_b16 a[132:133], v40 offset:160
    ds_read_b64_tr_b16 a[134:135], v40 offset:5280
    ds_read_b64_tr_b16 a[136:137], v40 offset:10400
    ds_read_b64_tr_b16 a[138:139], v41 offset:160
    ds_read_b64_tr_b16 a[140:141], v41 offset:5280
    ds_read_b64_tr_b16 a[142:143], v41 offset:10400
    s_waitcnt lgkmcnt(0)
    ds_read_b64_tr_b16 a[156:157], v40 offset:192
    ds_read_b64_tr_b16 a[158:159], v40 offset:5312
    ds_read_b64_tr_b16 a[160:161], v40 offset:10432
    ds_read_b64_tr_b16 a[162:163], v41 offset:192
    ds_read_b64_tr_b16 a[164:165], v41 offset:5312
    ds_read_b64_tr_b16 a[166:167], v41 offset:10432
    s_waitcnt lgkmcnt(0)
    ds_read_b64_tr_b16 a[180:181], v40 offset:224
    ds_read_b64_tr_b16 a[182:183], v40 offset:5344
    ds_read_b64_tr_b16 a[184:185], v40 offset:10464
    ds_read_b64_tr_b16 a[186:187], v41 offset:224
    ds_read_b64_tr_b16 a[188:189], v41 offset:5344
    ds_read_b64_tr_b16 a[190:191], v41 offset:10464
    s_waitcnt lgkmcnt(0)
    ds_read_b64_tr_b16 a[204:205], v40 offset:256
    ds_read_b64_tr_b16 a[206:207], v40 offset:5376
    ds_read_b64_tr_b16 a[208:209], v40 offset:10496
    ds_read_b64_tr_b16 a[210:211], v41 offset:256
    ds_read_b64_tr_b16 a[212:213], v41 offset:5376
    ds_read_b64_tr_b16 a[214:215], v41 offset:10496
    s_waitcnt lgkmcnt(0)
    ds_read_b64_tr_b16 a[228:229], v40 offset:288
    ds_read_b64_tr_b16 a[230:231], v40 offset:5408
    ds_read_b64_tr_b16 a[232:233], v40 offset:10528
    ds_read_b64_tr_b16 a[234:235], v41 offset:288
    ds_read_b64_tr_b16 a[236:237], v41 offset:5408
    ds_read_b64_tr_b16 a[238:239], v41 offset:10528
    s_waitcnt lgkmcnt(0)
    v_mov_b32 v4, 32
    s_movk_i32 s24, 32
    s_mov_b64 exec, 1
Lwp_50119:
    buffer_load_dword v5, v4, s[64:67], 0 offen sc1
    s_waitcnt vmcnt(0)
    v_cmp_gt_u32 vcc, s24, v5
    s_nop 0
    s_cbranch_vccz Lwpd_50120
    s_sleep 6
    s_add_u32 s30, s30, 1
    s_cmp_lt_u32 s30, s31
    s_cbranch_scc1 Lwp_50119
Lwpd_50120:
    s_mov_b64 exec, -1
    v_lshlrev_b32 v1, 4, v0
    v_lshlrev_b32 v2, 3, v0
    s_mul_i32 s20, s26, 6144
    s_add_u32 s20, s20, 0x1c00000
    s_mul_i32 s21, s26, 40
    s_mul_i32 s22, s14, 10
    s_add_u32 s21, s21, s22
    s_lshl_b32 s21, s21, 10
    s_add_u32 s21, s21, 0x3400000
    s_lshl_b32 s40, s26, 7
    s_add_u32 s40, s40, 0xb201400
    v_mov_b32 v6, s40
    s_add_u32 s41, s17, 1
    s_nop 0
Lwp_50121:
    buffer_load_dword v7, v6, s[4:7], 0 offen sc1
    s_waitcnt vmcnt(0)
    v_cmp_gt_u32 vcc, s41, v7
    s_nop 0
    s_cbranch_vccz Lwpd_50122
    s_sleep 2
    s_add_u32 s30, s30, 1
    s_cmp_lt_u32 s30, s31
    s_cbranch_scc1 Lwp_50121
Lwpd_50122:
    s_mul_i32 s23, s17, 393216
    s_add_u32 s23, s23, s20
    s_add_u32 s24, s23, 4096
    s_add_u32 s25, s23, 196608
    s_add_u32 s28, s25, 4096
    buffer_load_dwordx2 v[8:9], v2, s[4:7], s23 offen offset:0 sc1
    buffer_load_dwordx2 v[10:11], v2, s[4:7], s23 offen offset:512 sc1
    buffer_load_dwordx2 v[12:13], v2, s[4:7], s23 offen offset:1024 sc1
    buffer_load_dwordx2 v[14:15], v2, s[4:7], s23 offen offset:1536 sc1
    buffer_load_dwordx2 v[16:17], v2, s[4:7], s23 offen offset:2048 sc1
    buffer_load_dwordx2 v[18:19], v2, s[4:7], s23 offen offset:2560 sc1
    buffer_load_dwordx2 v[20:21], v2, s[4:7], s23 offen offset:3072 sc1
    buffer_load_dwordx2 v[22:23], v2, s[4:7], s23 offen offset:3584 sc1
    buffer_load_dwordx2 v[24:25], v2, s[4:7], s24 offen offset:0 sc1
    buffer_load_dwordx2 v[26:27], v2, s[4:7], s24 offen offset:512 sc1
    buffer_load_dwordx2 v[28:29], v2, s[4:7], s24 offen offset:1024 sc1
    buffer_load_dwordx2 v[30:31], v2, s[4:7], s24 offen offset:1536 sc1
    buffer_load_dwordx2 v[32:33], v2, s[4:7], s25 offen offset:0 sc1
    buffer_load_dwordx2 v[34:35], v2, s[4:7], s25 offen offset:512 sc1
    buffer_load_dwordx2 v[36:37], v2, s[4:7], s25 offen offset:1024 sc1
    buffer_load_dwordx2 v[38:39], v2, s[4:7], s25 offen offset:1536 sc1
    buffer_load_dwordx2 v[40:41], v2, s[4:7], s25 offen offset:2048 sc1
    buffer_load_dwordx2 v[42:43], v2, s[4:7], s25 offen offset:2560 sc1
    buffer_load_dwordx2 v[44:45], v2, s[4:7], s25 offen offset:3072 sc1
    buffer_load_dwordx2 v[46:47], v2, s[4:7], s25 offen offset:3584 sc1
    buffer_load_dwordx2 v[48:49], v2, s[4:7], s28 offen offset:0 sc1
    buffer_load_dwordx2 v[50:51], v2, s[4:7], s28 offen offset:512 sc1
    buffer_load_dwordx2 v[52:53], v2, s[4:7], s28 offen offset:1024 sc1
    buffer_load_dwordx2 v[54:55], v2, s[4:7], s28 offen offset:1536 sc1
    s_waitcnt vmcnt(0)
    s_barrier
    s_add_u32 s41, s17, 2
    s_min_u32 s41, s41, 64
    v_cmp_gt_u32 vcc, s41, v7
    s_nop 0
    s_cbranch_vccz Lu_have_50125
    s_nop 2
Lwp_50126:
    buffer_load_dword v7, v6, s[4:7], 0 offen sc1
    s_waitcnt vmcnt(0)
    v_cmp_gt_u32 vcc, s41, v7
    s_nop 0
    s_cbranch_vccz Lwpd_50127
    s_sleep 2
    s_add_u32 s30, s30, 1
    s_cmp_lt_u32 s30, s31
    s_cbranch_scc1 Lwp_50126
Lwpd_50127:
Lu_have_50125:
    s_add_u32 s29, s17, 1
    s_mul_i32 s37, s17, 1310720
    s_add_u32 s37, s37, s21
    s_add_u32 s38, s37, 4096
    s_add_u32 s39, s37, 8192
    v_mfma_f32_16x16x32_bf16 v[104:107], v[8:11], a[0:3], 0
    s_mul_i32 s23, s29, 393216
    v_mfma_f32_16x16x32_bf16 v[108:111], v[32:35], a[0:3], 0
    s_add_u32 s23, s23, s20
    v_mfma_f32_16x16x32_bf16 v[104:107], v[12:15], a[4:7], v[104:107]
    s_add_u32 s24, s23, 4096
    v_mfma_f32_16x16x32_bf16 v[108:111], v[36:39], a[4:7], v[108:111]
    s_add_u32 s25, s23, 196608
    v_mfma_f32_16x16x32_bf16 v[104:107], v[16:19], a[8:11], v[104:107]
    s_add_u32 s28, s25, 4096
    v_mfma_f32_16x16x32_bf16 v[108:111], v[40:43], a[8:11], v[108:111]
    buffer_load_dwordx2 v[56:57], v2, s[4:7], s23 offen offset:0 sc1
    v_mfma_f32_16x16x32_bf16 v[104:107], v[20:23], a[12:15], v[104:107]
    buffer_load_dwordx2 v[58:59], v2, s[4:7], s23 offen offset:512 sc1
    v_mfma_f32_16x16x32_bf16 v[108:111], v[44:47], a[12:15], v[108:111]
    buffer_load_dwordx2 v[60:61], v2, s[4:7], s23 offen offset:1024 sc1
    v_mfma_f32_16x16x32_bf16 v[104:107], v[24:27], a[16:19], v[104:107]
    buffer_load_dwordx2 v[62:63], v2, s[4:7], s23 offen offset:1536 sc1
    v_mfma_f32_16x16x32_bf16 v[108:111], v[48:51], a[16:19], v[108:111]
    buffer_load_dwordx2 v[64:65], v2, s[4:7], s23 offen offset:2048 sc1
    v_mfma_f32_16x16x32_bf16 v[104:107], v[28:31], a[20:23], v[104:107]
    buffer_load_dwordx2 v[66:67], v2, s[4:7], s23 offen offset:2560 sc1
    v_mfma_f32_16x16x32_bf16 v[108:111], v[52:55], a[20:23], v[108:111]
    buffer_load_dwordx2 v[68:69], v2, s[4:7], s23 offen offset:3072 sc1
    v_mfma_f32_16x16x32_bf16 v[112:115], v[8:11], a[24:27], 0
    buffer_load_dwordx2 v[70:71], v2, s[4:7], s23 offen offset:3584 sc1
    v_mfma_f32_16x16x32_bf16 v[116:119], v[32:35], a[24:27], 0
    buffer_load_dwordx2 v[72:73], v2, s[4:7], s24 offen offset:0 sc1
    v_mfma_f32_16x16x32_bf16 v[112:115], v[12:15], a[28:31], v[112:115]
    buffer_load_dwordx2 v[74:75], v2, s[4:7], s24 offen offset:512 sc1
    v_mfma_f32_16x16x32_bf16 v[116:119], v[36:39], a[28:31], v[116:119]
    buffer_load_dwordx2 v[76:77], v2, s[4:7], s24 offen offset:1024 sc1
    v_mfma_f32_16x16x32_bf16 v[112:115], v[16:19], a[32:35], v[112:115]
    buffer_load_dwordx2 v[78:79], v2, s[4:7], s24 offen offset:1536 sc1
    v_mfma_f32_16x16x32_bf16 v[116:119], v[40:43], a[32:35], v[116:119]
    v_cvt_pk_bf16_f32 v128, v104, v105
    v_mfma_f32_16x16x32_bf16 v[112:115], v[20:23], a[36:39], v[112:115]
    v_cvt_pk_bf16_f32 v129, v106, v107
    v_mfma_f32_16x16x32_bf16 v[116:119], v[44:47], a[36:39], v[116:119]
    v_cvt_pk_bf16_f32 v130, v108, v109
    v_mfma_f32_16x16x32_bf16 v[112:115], v[24:27], a[40:43], v[112:115]
    v_cvt_pk_bf16_f32 v131, v110, v111
    v_mfma_f32_16x16x32_bf16 v[116:119], v[48:51], a[40:43], v[116:119]
    buffer_store_dwordx4 v[128:131], v1, s[4:7], s37 offen offset:0 sc1
    v_mfma_f32_16x16x32_bf16 v[112:115], v[28:31], a[44:47], v[112:115]
    buffer_load_dwordx2 v[80:81], v2, s[4:7], s25 offen offset:0 sc1
    v_mfma_f32_16x16x32_bf16 v[116:119], v[52:55], a[44:47], v[116:119]
    buffer_load_dwordx2 v[82:83], v2, s[4:7], s25 offen offset:512 sc1
    v_mfma_f32_16x16x32_bf16 v[120:123], v[8:11], a[48:51], 0
    buffer_load_dwordx2 v[84:85], v2, s[4:7], s25 offen offset:1024 sc1
    v_mfma_f32_16x16x32_bf16 v[124:127], v[32:35], a[48:51], 0
    buffer_load_dwordx2 v[86:87], v2, s[4:7], s25 offen offset:1536 sc1
    v_mfma_f32_16x16x32_bf16 v[120:123], v[12:15], a[52:55], v[120:123]
    buffer_load_dwordx2 v[88:89], v2, s[4:7], s25 offen offset:2048 sc1
    v_mfma_f32_16x16x32_bf16 v[124:127], v[36:39], a[52:55], v[124:127]
    buffer_load_dwordx2 v[90:91], v2, s[4:7], s25 offen offset:2560 sc1
    v_mfma_f32_16x16x32_bf16 v[120:123], v[16:19], a[56:59], v[120:123]
    buffer_load_dwordx2 v[92:93], v2, s[4:7], s25 offen offset:3072 sc1
    v_mfma_f32_16x16x32_bf16 v[124:127], v[40:43], a[56:59], v[124:127]
    v_cvt_pk_bf16_f32 v132, v112, v113
    v_mfma_f32_16x16x32_bf16 v[120:123], v[20:23], a[60:63], v[120:123]
    v_cvt_pk_bf16_f32 v133, v114, v115
    v_mfma_f32_16x16x32_bf16 v[124:127], v[44:47], a[60:63], v[124:127]
    v_cvt_pk_bf16_f32 v134, v116, v117
    v_mfma_f32_16x16x32_bf16 v[120:123], v[24:27], a[64:67], v[120:123]
    v_cvt_pk_bf16_f32 v135, v118, v119
    v_mfma_f32_16x16x32_bf16 v[124:127], v[48:51], a[64:67], v[124:127]
    buffer_store_dwordx4 v[132:135], v1, s[4:7], s37 offen offset:1024 sc1
    v_mfma_f32_16x16x32_bf16 v[120:123], v[28:31], a[68:71], v[120:123]
    buffer_load_dwordx2 v[94:95], v2, s[4:7], s25 offen offset:3584 sc1
    v_mfma_f32_16x16x32_bf16 v[124:127], v[52:55], a[68:71], v[124:127]
    buffer_load_dwordx2 v[96:97], v2, s[4:7], s28 offen offset:0 sc1
    v_mfma_f32_16x16x32_bf16 v[104:107], v[8:11], a[72:75], 0
    buffer_load_dwordx2 v[98:99], v2, s[4:7], s28 offen offset:512 sc1
    v_mfma_f32_16x16x32_bf16 v[108:111], v[32:35], a[72:75], 0
    buffer_load_dwordx2 v[100:101], v2, s[4:7], s28 offen offset:1024 sc1
    v_mfma_f32_16x16x32_bf16 v[104:107], v[12:15], a[76:79], v[104:107]
    buffer_load_dwordx2 v[102:103], v2, s[4:7], s28 offen offset:1536 sc1
    v_mfma_f32_16x16x32_bf16 v[108:111], v[36:39], a[76:79], v[108:111]
    buffer_load_dword v7, v6, s[4:7], 0 offen sc1
    v_mfma_f32_16x16x32_bf16 v[104:107], v[16:19], a[80:83], v[104:107]
    v_mfma_f32_16x16x32_bf16 v[108:111], v[40:43], a[80:83], v[108:111]
    v_cvt_pk_bf16_f32 v136, v120, v121
    v_mfma_f32_16x16x32_bf16 v[104:107], v[20:23], a[84:87], v[104:107]
    v_cvt_pk_bf16_f32 v137, v122, v123
    v_mfma_f32_16x16x32_bf16 v[108:111], v[44:47], a[84:87], v[108:111]
    v_cvt_pk_bf16_f32 v138, v124, v125
    v_mfma_f32_16x16x32_bf16 v[104:107], v[24:27], a[88:91], v[104:107]
    v_cvt_pk_bf16_f32 v139, v126, v127
    v_mfma_f32_16x16x32_bf16 v[108:111], v[48:51], a[88:91], v[108:111]
    buffer_store_dwordx4 v[136:139], v1, s[4:7], s37 offen offset:2048 sc1
    v_mfma_f32_16x16x32_bf16 v[104:107], v[28:31], a[92:95], v[104:107]
    v_mfma_f32_16x16x32_bf16 v[108:111], v[52:55], a[92:95], v[108:111]
    v_mfma_f32_16x16x32_bf16 v[112:115], v[8:11], a[96:99], 0
    v_mfma_f32_16x16x32_bf16 v[116:119], v[32:35], a[96:99], 0
    v_mfma_f32_16x16x32_bf16 v[112:115], v[12:15], a[100:103], v[112:115]
    v_mfma_f32_16x16x32_bf16 v[116:119], v[36:39], a[100:103], v[116:119]
    v_mfma_f32_16x16x32_bf16 v[112:115], v[16:19], a[104:107], v[112:115]
    v_mfma_f32_16x16x32_bf16 v[116:119], v[40:43], a[104:107], v[116:119]
    s_nop 0
    v_cvt_pk_bf16_f32 v128, v104, v105
    v_mfma_f32_16x16x32_bf16 v[112:115], v[20:23], a[108:111], v[112:115]
    v_cvt_pk_bf16_f32 v129, v106, v107
    v_mfma_f32_16x16x32_bf16 v[116:119], v[44:47], a[108:111], v[116:119]
    v_cvt_pk_bf16_f32 v130, v108, v109
    v_mfma_f32_16x16x32_bf16 v[112:115], v[24:27], a[112:115], v[112:115]
    v_cvt_pk_bf16_f32 v131, v110, v111
    v_mfma_f32_16x16x32_bf16 v[116:119], v[48:51], a[112:115], v[116:119]
    buffer_store_dwordx4 v[128:131], v1, s[4:7], s37 offen offset:3072 sc1
    v_mfma_f32_16x16x32_bf16 v[112:115], v[28:31], a[116:119], v[112:115]
    v_mfma_f32_16x16x32_bf16 v[116:119], v[52:55], a[116:119], v[116:119]
    v_mfma_f32_16x16x32_bf16 v[120:123], v[8:11], a[120:123], 0
    v_mfma_f32_16x16x32_bf16 v[124:127], v[32:35], a[120:123], 0
    v_mfma_f32_16x16x32_bf16 v[120:123], v[12:15], a[124:127], v[120:123]
    v_mfma_f32_16x16x32_bf16 v[124:127], v[36:39], a[124:127], v[124:127]
    v_mfma_f32_16x16x32_bf16 v[120:123], v[16:19], a[128:131], v[120:123]
    v_mfma_f32_16x16x32_bf16 v[124:127], v[40:43], a[128:131], v[124:127]
    s_nop 0
    v_cvt_pk_bf16_f32 v132, v112, v113
    v_mfma_f32_16x16x32_bf16 v[120:123], v[20:23], a[132:135], v[120:123]
    v_cvt_pk_bf16_f32 v133, v114, v115
    v_mfma_f32_16x16x32_bf16 v[124:127], v[44:47], a[132:135], v[124:127]
    v_cvt_pk_bf16_f32 v134, v116, v117
    v_mfma_f32_16x16x32_bf16 v[120:123], v[24:27], a[136:139], v[120:123]
    v_cvt_pk_bf16_f32 v135, v118, v119
    v_mfma_f32_16x16x32_bf16 v[124:127], v[48:51], a[136:139], v[124:127]
    buffer_store_dwordx4 v[132:135], v1, s[4:7], s38 offen offset:0 sc1
    v_mfma_f32_16x16x32_bf16 v[120:123], v[28:31], a[140:143], v[120:123]
    v_mfma_f32_16x16x32_bf16 v[124:127], v[52:55], a[140:143], v[124:127]
    v_mfma_f32_16x16x32_bf16 v[104:107], v[8:11], a[144:147], 0
    v_mfma_f32_16x16x32_bf16 v[108:111], v[32:35], a[144:147], 0
    v_mfma_f32_16x16x32_bf16 v[104:107], v[12:15], a[148:151], v[104:107]
    v_mfma_f32_16x16x32_bf16 v[108:111], v[36:39], a[148:151], v[108:111]
    v_mfma_f32_16x16x32_bf16 v[104:107], v[16:19], a[152:155], v[104:107]
    v_mfma_f32_16x16x32_bf16 v[108:111], v[40:43], a[152:155], v[108:111]
    s_nop 0
    v_cvt_pk_bf16_f32 v136, v120, v121
    v_mfma_f32_16x16x32_bf16 v[104:107], v[20:23], a[156:159], v[104:107]
    v_cvt_pk_bf16_f32 v137, v122, v123
    v_mfma_f32_16x16x32_bf16 v[108:111], v[44:47], a[156:159], v[108:111]
    v_cvt_pk_bf16_f32 v138, v124, v125
    v_mfma_f32_16x16x32_bf16 v[104:107], v[24:27], a[160:163], v[104:107]
    v_cvt_pk_bf16_f32 v139, v126, v127
    v_mfma_f32_16x16x32_bf16 v[108:111], v[48:51], a[160:163], v[108:111]
    buffer_store_dwordx4 v[136:139], v1, s[4:7], s38 offen offset:1024 sc1
    v_mfma_f32_16x16x32_bf16 v[104:107], v[28:31], a[164:167], v[104:107]
    v_mfma_f32_16x16x32_bf16 v[108:111], v[52:55], a[164:167], v[108:111]
    v_mfma_f32_16x16x32_bf16 v[112:115], v[8:11], a[168:171], 0
    v_mfma_f32_16x16x32_bf16 v[116:119], v[32:35], a[168:171], 0
    v_mfma_f32_16x16x32_bf16 v[112:115], v[12:15], a[172:175], v[112:115]
    v_mfma_f32_16x16x32_bf16 v[116:119], v[36:39], a[172:175], v[116:119]
    v_mfma_f32_16x16x32_bf16 v[112:115], v[16:19], a[176:179], v[112:115]
    v_mfma_f32_16x16x32_bf16 v[116:119], v[40:43], a[176:179], v[116:119]
    s_nop 0
    v_cvt_pk_bf16_f32 v128, v104, v105
    v_mfma_f32_16x16x32_bf16 v[112:115], v[20:23], a[180:183], v[112:115]
    v_cvt_pk_bf16_f32 v129, v106, v107
    v_mfma_f32_16x16x32_bf16 v[116:119], v[44:47], a[180:183], v[116:119]
    v_cvt_pk_bf16_f32 v130, v108, v109
    v_mfma_f32_16x16x32_bf16 v[112:115], v[24:27], a[184:187], v[112:115]
    v_cvt_pk_bf16_f32 v131, v110, v111
    v_mfma_f32_16x16x32_bf16 v[116:119], v[48:51], a[184:187], v[116:119]
    buffer_store_dwordx4 v[128:131], v1, s[4:7], s38 offen offset:2048 sc1
    v_mfma_f32_16x16x32_bf16 v[112:115], v[28:31], a[188:191], v[112:115]
    v_mfma_f32_16x16x32_bf16 v[116:119], v[52:55], a[188:191], v[116:119]
    v_mfma_f32_16x16x32_bf16 v[120:123], v[8:11], a[192:195], 0
    v_mfma_f32_16x16x32_bf16 v[124:127], v[32:35], a[192:195], 0
    v_mfma_f32_16x16x32_bf16 v[120:123], v[12:15], a[196:199], v[120:123]
    v_mfma_f32_16x16x32_bf16 v[124:127], v[36:39], a[196:199], v[124:127]
    v_mfma_f32_16x16x32_bf16 v[120:123], v[16:19], a[200:203], v[120:123]
    v_mfma_f32_16x16x32_bf16 v[124:127], v[40:43], a[200:203], v[124:127]
    s_nop 0
    v_cvt_pk_bf16_f32 v132, v112, v113
    v_mfma_f32_16x16x32_bf16 v[120:123], v[20:23], a[204:207], v[120:123]
    v_cvt_pk_bf16_f32 v133, v114, v115
    v_mfma_f32_16x16x32_bf16 v[124:127], v[44:47], a[204:207], v[124:127]
    v_cvt_pk_bf16_f32 v134, v116, v117
    v_mfma_f32_16x16x32_bf16 v[120:123], v[24:27], a[208:211], v[120:123]
    v_cvt_pk_bf16_f32 v135, v118, v119
    v_mfma_f32_16x16x32_bf16 v[124:127], v[48:51], a[208:211], v[124:127]
    buffer_store_dwordx4 v[132:135], v1, s[4:7], s38 offen offset:3072 sc1
    v_mfma_f32_16x16x32_bf16 v[120:123], v[28:31], a[212:215], v[120:123]
    v_mfma_f32_16x16x32_bf16 v[124:127], v[52:55], a[212:215], v[124:127]
    v_mfma_f32_16x16x32_bf16 v[104:107], v[8:11], a[216:219], 0
    v_mfma_f32_16x16x32_bf16 v[108:111], v[32:35], a[216:219], 0
    v_mfma_f32_16x16x32_bf16 v[104:107], v[12:15], a[220:223], v[104:107]
    v_mfma_f32_16x16x32_bf16 v[108:111], v[36:39], a[220:223], v[108:111]
    v_mfma_f32_16x16x32_bf16 v[104:107], v[16:19], a[224:227], v[104:107]
    v_mfma_f32_16x16x32_bf16 v[108:111], v[40:43], a[224:227], v[108:111]
    s_nop 0
    v_cvt_pk_bf16_f32 v136, v120, v121
    v_mfma_f32_16x16x32_bf16 v[104:107], v[20:23], a[228:231], v[104:107]
    v_cvt_pk_bf16_f32 v137, v122, v123
    v_mfma_f32_16x16x32_bf16 v[108:111], v[44:47], a[228:231], v[108:111]
    v_cvt_pk_bf16_f32 v138, v124, v125
    v_mfma_f32_16x16x32_bf16 v[104:107], v[24:27], a[232:235], v[104:107]
    v_cvt_pk_bf16_f32 v139, v126, v127
    v_mfma_f32_16x16x32_bf16 v[108:111], v[48:51], a[232:235], v[108:111]
    buffer_store_dwordx4 v[136:139], v1, s[4:7], s39 offen offset:0 sc1
    v_mfma_f32_16x16x32_bf16 v[104:107], v[28:31], a[236:239], v[104:107]
    v_mfma_f32_16x16x32_bf16 v[108:111], v[52:55], a[236:239], v[108:111]
    s_nop 6
    v_cvt_pk_bf16_f32 v128, v104, v105
    v_cvt_pk_bf16_f32 v129, v106, v107
    v_cvt_pk_bf16_f32 v130, v108, v109
    v_cvt_pk_bf16_f32 v131, v110, v111
    buffer_store_dwordx4 v[128:131], v1, s[4:7], s39 offen offset:1024 sc1
    s_add_u32 s17, s17, 1
    s_cmp_ge_u32 s17, s18
    s_cbranch_scc1 Lu_end_50124
Lu_loop_50123:
    s_waitcnt vmcnt(8)
    s_barrier
    s_cmp_lg_u32 s14, 0
    s_cbranch_scc1 Lsig_50128
    s_sub_u32 s46, s17, 1
    v_mov_b32 v4, s46
    v_mov_b32 v5, s47
    s_mov_b64 exec, 1
    buffer_store_dword v4, v5, s[4:7], 0 offen sc1
    s_mov_b64 exec, -1
Lsig_50128:
    s_add_u32 s41, s17, 2
    s_min_u32 s41, s41, 64
    v_cmp_gt_u32 vcc, s41, v7
    s_nop 0
    s_cbranch_vccz Lu_have_50129
    s_nop 2
Lwp_50130:
    buffer_load_dword v7, v6, s[4:7], 0 offen sc1
    s_waitcnt vmcnt(0)
    v_cmp_gt_u32 vcc, s41, v7
    s_nop 0
    s_cbranch_vccz Lwpd_50131
    s_sleep 2
    s_add_u32 s30, s30, 1
    s_cmp_lt_u32 s30, s31
    s_cbranch_scc1 Lwp_50130
Lwpd_50131:
Lu_have_50129:
    s_add_u32 s29, s17, 1
    s_mul_i32 s37, s17, 1310720
    s_add_u32 s37, s37, s21
    s_add_u32 s38, s37, 4096
    s_add_u32 s39, s37, 8192
    v_mfma_f32_16x16x32_bf16 v[104:107], v[56:59], a[0:3], 0
    s_mul_i32 s23, s29, 393216
    v_mfma_f32_16x16x32_bf16 v[108:111], v[80:83], a[0:3], 0
    s_add_u32 s23, s23, s20
    v_mfma_f32_16x16x32_bf16 v[104:107], v[60:63], a[4:7], v[104:107]
    s_add_u32 s24, s23, 4096
    v_mfma_f32_16x16x32_bf16 v[108:111], v[84:87], a[4:7], v[108:111]
    s_add_u32 s25, s23, 196608
    v_mfma_f32_16x16x32_bf16 v[104:107], v[64:67], a[8:11], v[104:107]
    s_add_u32 s28, s25, 4096
    v_mfma_f32_16x16x32_bf16 v[108:111], v[88:91], a[8:11], v[108:111]
    buffer_load_dwordx2 v[8:9], v2, s[4:7], s23 offen offset:0 sc1
    v_mfma_f32_16x16x32_bf16 v[104:107], v[68:71], a[12:15], v[104:107]
    buffer_load_dwordx2 v[10:11], v2, s[4:7], s23 offen offset:512 sc1
    v_mfma_f32_16x16x32_bf16 v[108:111], v[92:95], a[12:15], v[108:111]
    buffer_load_dwordx2 v[12:13], v2, s[4:7], s23 offen offset:1024 sc1
    v_mfma_f32_16x16x32_bf16 v[104:107], v[72:75], a[16:19], v[104:107]
    buffer_load_dwordx2 v[14:15], v2, s[4:7], s23 offen offset:1536 sc1
    v_mfma_f32_16x16x32_bf16 v[108:111], v[96:99], a[16:19], v[108:111]
    buffer_load_dwordx2 v[16:17], v2, s[4:7], s23 offen offset:2048 sc1
    v_mfma_f32_16x16x32_bf16 v[104:107], v[76:79], a[20:23], v[104:107]
    buffer_load_dwordx2 v[18:19], v2, s[4:7], s23 offen offset:2560 sc1
    v_mfma_f32_16x16x32_bf16 v[108:111], v[100:103], a[20:23], v[108:111]
    buffer_load_dwordx2 v[20:21], v2, s[4:7], s23 offen offset:3072 sc1
    v_mfma_f32_16x16x32_bf16 v[112:115], v[56:59], a[24:27], 0
    buffer_load_dwordx2 v[22:23], v2, s[4:7], s23 offen offset:3584 sc1
    v_mfma_f32_16x16x32_bf16 v[116:119], v[80:83], a[24:27], 0
    buffer_load_dwordx2 v[24:25], v2, s[4:7], s24 offen offset:0 sc1
    v_mfma_f32_16x16x32_bf16 v[112:115], v[60:63], a[28:31], v[112:115]
    buffer_load_dwordx2 v[26:27], v2, s[4:7], s24 offen offset:512 sc1
    v_mfma_f32_16x16x32_bf16 v[116:119], v[84:87], a[28:31], v[116:119]
    buffer_load_dwordx2 v[28:29], v2, s[4:7], s24 offen offset:1024 sc1
    v_mfma_f32_16x16x32_bf16 v[112:115], v[64:67], a[32:35], v[112:115]
    buffer_load_dwordx2 v[30:31], v2, s[4:7], s24 offen offset:1536 sc1
    v_mfma_f32_16x16x32_bf16 v[116:119], v[88:91], a[32:35], v[116:119]
    v_cvt_pk_bf16_f32 v128, v104, v105
    v_mfma_f32_16x16x32_bf16 v[112:115], v[68:71], a[36:39], v[112:115]
    v_cvt_pk_bf16_f32 v129, v106, v107
    v_mfma_f32_16x16x32_bf16 v[116:119], v[92:95], a[36:39], v[116:119]
    v_cvt_pk_bf16_f32 v130, v108, v109
    v_mfma_f32_16x16x32_bf16 v[112:115], v[72:75], a[40:43], v[112:115]
    v_cvt_pk_bf16_f32 v131, v110, v111
    v_mfma_f32_16x16x32_bf16 v[116:119], v[96:99], a[40:43], v[116:119]
    buffer_store_dwordx4 v[128:131], v1, s[4:7], s37 offen offset:0 sc1
    v_mfma_f32_16x16x32_bf16 v[112:115], v[76:79], a[44:47], v[112:115]
    buffer_load_dwordx2 v[32:33], v2, s[4:7], s25 offen offset:0 sc1
    v_mfma_f32_16x16x32_bf16 v[116:119], v[100:103], a[44:47], v[116:119]
    buffer_load_dwordx2 v[34:35], v2, s[4:7], s25 offen offset:512 sc1
    v_mfma_f32_16x16x32_bf16 v[120:123], v[56:59], a[48:51], 0
    buffer_load_dwordx2 v[36:37], v2, s[4:7], s25 offen offset:1024 sc1
    v_mfma_f32_16x16x32_bf16 v[124:127], v[80:83], a[48:51], 0
    buffer_load_dwordx2 v[38:39], v2, s[4:7], s25 offen offset:1536 sc1
    v_mfma_f32_16x16x32_bf16 v[120:123], v[60:63], a[52:55], v[120:123]
    buffer_load_dwordx2 v[40:41], v2, s[4:7], s25 offen offset:2048 sc1
    v_mfma_f32_16x16x32_bf16 v[124:127], v[84:87], a[52:55], v[124:127]
    buffer_load_dwordx2 v[42:43], v2, s[4:7], s25 offen offset:2560 sc1
    v_mfma_f32_16x16x32_bf16 v[120:123], v[64:67], a[56:59], v[120:123]
    buffer_load_dwordx2 v[44:45], v2, s[4:7], s25 offen offset:3072 sc1
    v_mfma_f32_16x16x32_bf16 v[124:127], v[88:91], a[56:59], v[124:127]
    v_cvt_pk_bf16_f32 v132, v112, v113
    v_mfma_f32_16x16x32_bf16 v[120:123], v[68:71], a[60:63], v[120:123]
    v_cvt_pk_bf16_f32 v133, v114, v115
    v_mfma_f32_16x16x32_bf16 v[124:127], v[92:95], a[60:63], v[124:127]
    v_cvt_pk_bf16_f32 v134, v116, v117
    v_mfma_f32_16x16x32_bf16 v[120:123], v[72:75], a[64:67], v[120:123]
    v_cvt_pk_bf16_f32 v135, v118, v119
    v_mfma_f32_16x16x32_bf16 v[124:127], v[96:99], a[64:67], v[124:127]
    buffer_store_dwordx4 v[132:135], v1, s[4:7], s37 offen offset:1024 sc1
    v_mfma_f32_16x16x32_bf16 v[120:123], v[76:79], a[68:71], v[120:123]
    buffer_load_dwordx2 v[46:47], v2, s[4:7], s25 offen offset:3584 sc1
    v_mfma_f32_16x16x32_bf16 v[124:127], v[100:103], a[68:71], v[124:127]
    buffer_load_dwordx2 v[48:49], v2, s[4:7], s28 offen offset:0 sc1
    v_mfma_f32_16x16x32_bf16 v[104:107], v[56:59], a[72:75], 0
    buffer_load_dwordx2 v[50:51], v2, s[4:7], s28 offen offset:512 sc1
    v_mfma_f32_16x16x32_bf16 v[108:111], v[80:83], a[72:75], 0
    buffer_load_dwordx2 v[52:53], v2, s[4:7], s28 offen offset:1024 sc1
    v_mfma_f32_16x16x32_bf16 v[104:107], v[60:63], a[76:79], v[104:107]
    buffer_load_dwordx2 v[54:55], v2, s[4:7], s28 offen offset:1536 sc1
    v_mfma_f32_16x16x32_bf16 v[108:111], v[84:87], a[76:79], v[108:111]
    buffer_load_dword v7, v6, s[4:7], 0 offen sc1
    v_mfma_f32_16x16x32_bf16 v[104:107], v[64:67], a[80:83], v[104:107]
    v_mfma_f32_16x16x32_bf16 v[108:111], v[88:91], a[80:83], v[108:111]
    v_cvt_pk_bf16_f32 v136, v120, v121
    v_mfma_f32_16x16x32_bf16 v[104:107], v[68:71], a[84:87], v[104:107]
    v_cvt_pk_bf16_f32 v137, v122, v123
    v_mfma_f32_16x16x32_bf16 v[108:111], v[92:95], a[84:87], v[108:111]
    v_cvt_pk_bf16_f32 v138, v124, v125
    v_mfma_f32_16x16x32_bf16 v[104:107], v[72:75], a[88:91], v[104:107]
    v_cvt_pk_bf16_f32 v139, v126, v127
    v_mfma_f32_16x16x32_bf16 v[108:111], v[96:99], a[88:91], v[108:111]
    buffer_store_dwordx4 v[136:139], v1, s[4:7], s37 offen offset:2048 sc1
    v_mfma_f32_16x16x32_bf16 v[104:107], v[76:79], a[92:95], v[104:107]
    v_mfma_f32_16x16x32_bf16 v[108:111], v[100:103], a[92:95], v[108:111]
    v_mfma_f32_16x16x32_bf16 v[112:115], v[56:59], a[96:99], 0
    v_mfma_f32_16x16x32_bf16 v[116:119], v[80:83], a[96:99], 0
    v_mfma_f32_16x16x32_bf16 v[112:115], v[60:63], a[100:103], v[112:115]
    v_mfma_f32_16x16x32_bf16 v[116:119], v[84:87], a[100:103], v[116:119]
    v_mfma_f32_16x16x32_bf16 v[112:115], v[64:67], a[104:107], v[112:115]
    v_mfma_f32_16x16x32_bf16 v[116:119], v[88:91], a[104:107], v[116:119]
    s_nop 0
    v_cvt_pk_bf16_f32 v128, v104, v105
    v_mfma_f32_16x16x32_bf16 v[112:115], v[68:71], a[108:111], v[112:115]
    v_cvt_pk_bf16_f32 v129, v106, v107
    v_mfma_f32_16x16x32_bf16 v[116:119], v[92:95], a[108:111], v[116:119]
    v_cvt_pk_bf16_f32 v130, v108, v109
    v_mfma_f32_16x16x32_bf16 v[112:115], v[72:75], a[112:115], v[112:115]
    v_cvt_pk_bf16_f32 v131, v110, v111
    v_mfma_f32_16x16x32_bf16 v[116:119], v[96:99], a[112:115], v[116:119]
    buffer_store_dwordx4 v[128:131], v1, s[4:7], s37 offen offset:3072 sc1
    v_mfma_f32_16x16x32_bf16 v[112:115], v[76:79], a[116:119], v[112:115]
    v_mfma_f32_16x16x32_bf16 v[116:119], v[100:103], a[116:119], v[116:119]
    v_mfma_f32_16x16x32_bf16 v[120:123], v[56:59], a[120:123], 0
    v_mfma_f32_16x16x32_bf16 v[124:127], v[80:83], a[120:123], 0
    v_mfma_f32_16x16x32_bf16 v[120:123], v[60:63], a[124:127], v[120:123]
    v_mfma_f32_16x16x32_bf16 v[124:127], v[84:87], a[124:127], v[124:127]
    v_mfma_f32_16x16x32_bf16 v[120:123], v[64:67], a[128:131], v[120:123]
    v_mfma_f32_16x16x32_bf16 v[124:127], v[88:91], a[128:131], v[124:127]
    s_nop 0
    v_cvt_pk_bf16_f32 v132, v112, v113
    v_mfma_f32_16x16x32_bf16 v[120:123], v[68:71], a[132:135], v[120:123]
    v_cvt_pk_bf16_f32 v133, v114, v115
    v_mfma_f32_16x16x32_bf16 v[124:127], v[92:95], a[132:135], v[124:127]
    v_cvt_pk_bf16_f32 v134, v116, v117
    v_mfma_f32_16x16x32_bf16 v[120:123], v[72:75], a[136:139], v[120:123]
    v_cvt_pk_bf16_f32 v135, v118, v119
    v_mfma_f32_16x16x32_bf16 v[124:127], v[96:99], a[136:139], v[124:127]
    buffer_store_dwordx4 v[132:135], v1, s[4:7], s38 offen offset:0 sc1
    v_mfma_f32_16x16x32_bf16 v[120:123], v[76:79], a[140:143], v[120:123]
    v_mfma_f32_16x16x32_bf16 v[124:127], v[100:103], a[140:143], v[124:127]
    v_mfma_f32_16x16x32_bf16 v[104:107], v[56:59], a[144:147], 0
    v_mfma_f32_16x16x32_bf16 v[108:111], v[80:83], a[144:147], 0
    v_mfma_f32_16x16x32_bf16 v[104:107], v[60:63], a[148:151], v[104:107]
    v_mfma_f32_16x16x32_bf16 v[108:111], v[84:87], a[148:151], v[108:111]
    v_mfma_f32_16x16x32_bf16 v[104:107], v[64:67], a[152:155], v[104:107]
    v_mfma_f32_16x16x32_bf16 v[108:111], v[88:91], a[152:155], v[108:111]
    s_nop 0
    v_cvt_pk_bf16_f32 v136, v120, v121
    v_mfma_f32_16x16x32_bf16 v[104:107], v[68:71], a[156:159], v[104:107]
    v_cvt_pk_bf16_f32 v137, v122, v123
    v_mfma_f32_16x16x32_bf16 v[108:111], v[92:95], a[156:159], v[108:111]
    v_cvt_pk_bf16_f32 v138, v124, v125
    v_mfma_f32_16x16x32_bf16 v[104:107], v[72:75], a[160:163], v[104:107]
    v_cvt_pk_bf16_f32 v139, v126, v127
    v_mfma_f32_16x16x32_bf16 v[108:111], v[96:99], a[160:163], v[108:111]
    buffer_store_dwordx4 v[136:139], v1, s[4:7], s38 offen offset:1024 sc1
    v_mfma_f32_16x16x32_bf16 v[104:107], v[76:79], a[164:167], v[104:107]
    v_mfma_f32_16x16x32_bf16 v[108:111], v[100:103], a[164:167], v[108:111]
    v_mfma_f32_16x16x32_bf16 v[112:115], v[56:59], a[168:171], 0
    v_mfma_f32_16x16x32_bf16 v[116:119], v[80:83], a[168:171], 0
    v_mfma_f32_16x16x32_bf16 v[112:115], v[60:63], a[172:175], v[112:115]
    v_mfma_f32_16x16x32_bf16 v[116:119], v[84:87], a[172:175], v[116:119]
    v_mfma_f32_16x16x32_bf16 v[112:115], v[64:67], a[176:179], v[112:115]
    v_mfma_f32_16x16x32_bf16 v[116:119], v[88:91], a[176:179], v[116:119]
    s_nop 0
    v_cvt_pk_bf16_f32 v128, v104, v105
    v_mfma_f32_16x16x32_bf16 v[112:115], v[68:71], a[180:183], v[112:115]
    v_cvt_pk_bf16_f32 v129, v106, v107
    v_mfma_f32_16x16x32_bf16 v[116:119], v[92:95], a[180:183], v[116:119]
    v_cvt_pk_bf16_f32 v130, v108, v109
    v_mfma_f32_16x16x32_bf16 v[112:115], v[72:75], a[184:187], v[112:115]
    v_cvt_pk_bf16_f32 v131, v110, v111
    v_mfma_f32_16x16x32_bf16 v[116:119], v[96:99], a[184:187], v[116:119]
    buffer_store_dwordx4 v[128:131], v1, s[4:7], s38 offen offset:2048 sc1
    v_mfma_f32_16x16x32_bf16 v[112:115], v[76:79], a[188:191], v[112:115]
    v_mfma_f32_16x16x32_bf16 v[116:119], v[100:103], a[188:191], v[116:119]
    v_mfma_f32_16x16x32_bf16 v[120:123], v[56:59], a[192:195], 0
    v_mfma_f32_16x16x32_bf16 v[124:127], v[80:83], a[192:195], 0
    v_mfma_f32_16x16x32_bf16 v[120:123], v[60:63], a[196:199], v[120:123]
    v_mfma_f32_16x16x32_bf16 v[124:127], v[84:87], a[196:199], v[124:127]
    v_mfma_f32_16x16x32_bf16 v[120:123], v[64:67], a[200:203], v[120:123]
    v_mfma_f32_16x16x32_bf16 v[124:127], v[88:91], a[200:203], v[124:127]
    s_nop 0
    v_cvt_pk_bf16_f32 v132, v112, v113
    v_mfma_f32_16x16x32_bf16 v[120:123], v[68:71], a[204:207], v[120:123]
    v_cvt_pk_bf16_f32 v133, v114, v115
    v_mfma_f32_16x16x32_bf16 v[124:127], v[92:95], a[204:207], v[124:127]
    v_cvt_pk_bf16_f32 v134, v116, v117
    v_mfma_f32_16x16x32_bf16 v[120:123], v[72:75], a[208:211], v[120:123]
    v_cvt_pk_bf16_f32 v135, v118, v119
    v_mfma_f32_16x16x32_bf16 v[124:127], v[96:99], a[208:211], v[124:127]
    buffer_store_dwordx4 v[132:135], v1, s[4:7], s38 offen offset:3072 sc1
    v_mfma_f32_16x16x32_bf16 v[120:123], v[76:79], a[212:215], v[120:123]
    v_mfma_f32_16x16x32_bf16 v[124:127], v[100:103], a[212:215], v[124:127]
    v_mfma_f32_16x16x32_bf16 v[104:107], v[56:59], a[216:219], 0
    v_mfma_f32_16x16x32_bf16 v[108:111], v[80:83], a[216:219], 0
    v_mfma_f32_16x16x32_bf16 v[104:107], v[60:63], a[220:223], v[104:107]
    v_mfma_f32_16x16x32_bf16 v[108:111], v[84:87], a[220:223], v[108:111]
    v_mfma_f32_16x16x32_bf16 v[104:107], v[64:67], a[224:227], v[104:107]
    v_mfma_f32_16x16x32_bf16 v[108:111], v[88:91], a[224:227], v[108:111]
    s_nop 0
    v_cvt_pk_bf16_f32 v136, v120, v121
    v_mfma_f32_16x16x32_bf16 v[104:107], v[68:71], a[228:231], v[104:107]
    v_cvt_pk_bf16_f32 v137, v122, v123
    v_mfma_f32_16x16x32_bf16 v[108:111], v[92:95], a[228:231], v[108:111]
    v_cvt_pk_bf16_f32 v138, v124, v125
    v_mfma_f32_16x16x32_bf16 v[104:107], v[72:75], a[232:235], v[104:107]
    v_cvt_pk_bf16_f32 v139, v126, v127
    v_mfma_f32_16x16x32_bf16 v[108:111], v[96:99], a[232:235], v[108:111]
    buffer_store_dwordx4 v[136:139], v1, s[4:7], s39 offen offset:0 sc1
    v_mfma_f32_16x16x32_bf16 v[104:107], v[76:79], a[236:239], v[104:107]
    v_mfma_f32_16x16x32_bf16 v[108:111], v[100:103], a[236:239], v[108:111]
    s_nop 6
    v_cvt_pk_bf16_f32 v128, v104, v105
    v_cvt_pk_bf16_f32 v129, v106, v107
    v_cvt_pk_bf16_f32 v130, v108, v109
    v_cvt_pk_bf16_f32 v131, v110, v111
    buffer_store_dwordx4 v[128:131], v1, s[4:7], s39 offen offset:1024 sc1
    s_add_u32 s17, s17, 1
    s_cmp_ge_u32 s17, s18
    s_cbranch_scc1 Lu_end_50124
    s_waitcnt vmcnt(8)
    s_barrier
    s_cmp_lg_u32 s14, 0
    s_cbranch_scc1 Lsig_50132
    s_sub_u32 s46, s17, 1
    v_mov_b32 v4, s46
    v_mov_b32 v5, s47
    s_mov_b64 exec, 1
    buffer_store_dword v4, v5, s[4:7], 0 offen sc1
    s_mov_b64 exec, -1
Lsig_50132:
    s_add_u32 s41, s17, 2
    s_min_u32 s41, s41, 64
    v_cmp_gt_u32 vcc, s41, v7
    s_nop 0
    s_cbranch_vccz Lu_have_50133
    s_nop 2
Lwp_50134:
    buffer_load_dword v7, v6, s[4:7], 0 offen sc1
    s_waitcnt vmcnt(0)
    v_cmp_gt_u32 vcc, s41, v7
    s_nop 0
    s_cbranch_vccz Lwpd_50135
    s_sleep 2
    s_add_u32 s30, s30, 1
    s_cmp_lt_u32 s30, s31
    s_cbranch_scc1 Lwp_50134
Lwpd_50135:
Lu_have_50133:
    s_add_u32 s29, s17, 1
    s_mul_i32 s37, s17, 1310720
    s_add_u32 s37, s37, s21
    s_add_u32 s38, s37, 4096
    s_add_u32 s39, s37, 8192
    v_mfma_f32_16x16x32_bf16 v[104:107], v[8:11], a[0:3], 0
    s_mul_i32 s23, s29, 393216
    v_mfma_f32_16x16x32_bf16 v[108:111], v[32:35], a[0:3], 0
    s_add_u32 s23, s23, s20
    v_mfma_f32_16x16x32_bf16 v[104:107], v[12:15], a[4:7], v[104:107]
    s_add_u32 s24, s23, 4096
    v_mfma_f32_16x16x32_bf16 v[108:111], v[36:39], a[4:7], v[108:111]
    s_add_u32 s25, s23, 196608
    v_mfma_f32_16x16x32_bf16 v[104:107], v[16:19], a[8:11], v[104:107]
    s_add_u32 s28, s25, 4096
    v_mfma_f32_16x16x32_bf16 v[108:111], v[40:43], a[8:11], v[108:111]
    buffer_load_dwordx2 v[56:57], v2, s[4:7], s23 offen offset:0 sc1
    v_mfma_f32_16x16x32_bf16 v[104:107], v[20:23], a[12:15], v[104:107]
    buffer_load_dwordx2 v[58:59], v2, s[4:7], s23 offen offset:512 sc1
    v_mfma_f32_16x16x32_bf16 v[108:111], v[44:47], a[12:15], v[108:111]
    buffer_load_dwordx2 v[60:61], v2, s[4:7], s23 offen offset:1024 sc1
    v_mfma_f32_16x16x32_bf16 v[104:107], v[24:27], a[16:19], v[104:107]
    buffer_load_dwordx2 v[62:63], v2, s[4:7], s23 offen offset:1536 sc1
    v_mfma_f32_16x16x32_bf16 v[108:111], v[48:51], a[16:19], v[108:111]
    buffer_load_dwordx2 v[64:65], v2, s[4:7], s23 offen offset:2048 sc1
    v_mfma_f32_16x16x32_bf16 v[104:107], v[28:31], a[20:23], v[104:107]
    buffer_load_dwordx2 v[66:67], v2, s[4:7], s23 offen offset:2560 sc1
    v_mfma_f32_16x16x32_bf16 v[108:111], v[52:55], a[20:23], v[108:111]
    buffer_load_dwordx2 v[68:69], v2, s[4:7], s23 offen offset:3072 sc1
    v_mfma_f32_16x16x32_bf16 v[112:115], v[8:11], a[24:27], 0
    buffer_load_dwordx2 v[70:71], v2, s[4:7], s23 offen offset:3584 sc1
    v_mfma_f32_16x16x32_bf16 v[116:119], v[32:35], a[24:27], 0
    buffer_load_dwordx2 v[72:73], v2, s[4:7], s24 offen offset:0 sc1
    v_mfma_f32_16x16x32_bf16 v[112:115], v[12:15], a[28:31], v[112:115]
    buffer_load_dwordx2 v[74:75], v2, s[4:7], s24 offen offset:512 sc1
    v_mfma_f32_16x16x32_bf16 v[116:119], v[36:39], a[28:31], v[116:119]
    buffer_load_dwordx2 v[76:77], v2, s[4:7], s24 offen offset:1024 sc1
    v_mfma_f32_16x16x32_bf16 v[112:115], v[16:19], a[32:35], v[112:115]
    buffer_load_dwordx2 v[78:79], v2, s[4:7], s24 offen offset:1536 sc1
    v_mfma_f32_16x16x32_bf16 v[116:119], v[40:43], a[32:35], v[116:119]
    v_cvt_pk_bf16_f32 v128, v104, v105
    v_mfma_f32_16x16x32_bf16 v[112:115], v[20:23], a[36:39], v[112:115]
    v_cvt_pk_bf16_f32 v129, v106, v107
    v_mfma_f32_16x16x32_bf16 v[116:119], v[44:47], a[36:39], v[116:119]
    v_cvt_pk_bf16_f32 v130, v108, v109
    v_mfma_f32_16x16x32_bf16 v[112:115], v[24:27], a[40:43], v[112:115]
    v_cvt_pk_bf16_f32 v131, v110, v111
    v_mfma_f32_16x16x32_bf16 v[116:119], v[48:51], a[40:43], v[116:119]
    buffer_store_dwordx4 v[128:131], v1, s[4:7], s37 offen offset:0 sc1
    v_mfma_f32_16x16x32_bf16 v[112:115], v[28:31], a[44:47], v[112:115]
    buffer_load_dwordx2 v[80:81], v2, s[4:7], s25 offen offset:0 sc1
    v_mfma_f32_16x16x32_bf16 v[116:119], v[52:55], a[44:47], v[116:119]
    buffer_load_dwordx2 v[82:83], v2, s[4:7], s25 offen offset:512 sc1
    v_mfma_f32_16x16x32_bf16 v[120:123], v[8:11], a[48:51], 0
    buffer_load_dwordx2 v[84:85], v2, s[4:7], s25 offen offset:1024 sc1
    v_mfma_f32_16x16x32_bf16 v[124:127], v[32:35], a[48:51], 0
    buffer_load_dwordx2 v[86:87], v2, s[4:7], s25 offen offset:1536 sc1
    v_mfma_f32_16x16x32_bf16 v[120:123], v[12:15], a[52:55], v[120:123]
    buffer_load_dwordx2 v[88:89], v2, s[4:7], s25 offen offset:2048 sc1
    v_mfma_f32_16x16x32_bf16 v[124:127], v[36:39], a[52:55], v[124:127]
    buffer_load_dwordx2 v[90:91], v2, s[4:7], s25 offen offset:2560 sc1
    v_mfma_f32_16x16x32_bf16 v[120:123], v[16:19], a[56:59], v[120:123]
    buffer_load_dwordx2 v[92:93], v2, s[4:7], s25 offen offset:3072 sc1
    v_mfma_f32_16x16x32_bf16 v[124:127], v[40:43], a[56:59], v[124:127]
    v_cvt_pk_bf16_f32 v132, v112, v113
    v_mfma_f32_16x16x32_bf16 v[120:123], v[20:23], a[60:63], v[120:123]
    v_cvt_pk_bf16_f32 v133, v114, v115
    v_mfma_f32_16x16x32_bf16 v[124:127], v[44:47], a[60:63], v[124:127]
    v_cvt_pk_bf16_f32 v134, v116, v117
    v_mfma_f32_16x16x32_bf16 v[120:123], v[24:27], a[64:67], v[120:123]
    v_cvt_pk_bf16_f32 v135, v118, v119
    v_mfma_f32_16x16x32_bf16 v[124:127], v[48:51], a[64:67], v[124:127]
    buffer_store_dwordx4 v[132:135], v1, s[4:7], s37 offen offset:1024 sc1
    v_mfma_f32_16x16x32_bf16 v[120:123], v[28:31], a[68:71], v[120:123]
    buffer_load_dwordx2 v[94:95], v2, s[4:7], s25 offen offset:3584 sc1
    v_mfma_f32_16x16x32_bf16 v[124:127], v[52:55], a[68:71], v[124:127]
    buffer_load_dwordx2 v[96:97], v2, s[4:7], s28 offen offset:0 sc1
    v_mfma_f32_16x16x32_bf16 v[104:107], v[8:11], a[72:75], 0
    buffer_load_dwordx2 v[98:99], v2, s[4:7], s28 offen offset:512 sc1
    v_mfma_f32_16x16x32_bf16 v[108:111], v[32:35], a[72:75], 0
    buffer_load_dwordx2 v[100:101], v2, s[4:7], s28 offen offset:1024 sc1
    v_mfma_f32_16x16x32_bf16 v[104:107], v[12:15], a[76:79], v[104:107]
    buffer_load_dwordx2 v[102:103], v2, s[4:7], s28 offen offset:1536 sc1
    v_mfma_f32_16x16x32_bf16 v[108:111], v[36:39], a[76:79], v[108:111]
    buffer_load_dword v7, v6, s[4:7], 0 offen sc1
    v_mfma_f32_16x16x32_bf16 v[104:107], v[16:19], a[80:83], v[104:107]
    v_mfma_f32_16x16x32_bf16 v[108:111], v[40:43], a[80:83], v[108:111]
    v_cvt_pk_bf16_f32 v136, v120, v121
    v_mfma_f32_16x16x32_bf16 v[104:107], v[20:23], a[84:87], v[104:107]
    v_cvt_pk_bf16_f32 v137, v122, v123
    v_mfma_f32_16x16x32_bf16 v[108:111], v[44:47], a[84:87], v[108:111]
    v_cvt_pk_bf16_f32 v138, v124, v125
    v_mfma_f32_16x16x32_bf16 v[104:107], v[24:27], a[88:91], v[104:107]
    v_cvt_pk_bf16_f32 v139, v126, v127
    v_mfma_f32_16x16x32_bf16 v[108:111], v[48:51], a[88:91], v[108:111]
    buffer_store_dwordx4 v[136:139], v1, s[4:7], s37 offen offset:2048 sc1
    v_mfma_f32_16x16x32_bf16 v[104:107], v[28:31], a[92:95], v[104:107]
    v_mfma_f32_16x16x32_bf16 v[108:111], v[52:55], a[92:95], v[108:111]
    v_mfma_f32_16x16x32_bf16 v[112:115], v[8:11], a[96:99], 0
    v_mfma_f32_16x16x32_bf16 v[116:119], v[32:35], a[96:99], 0
    v_mfma_f32_16x16x32_bf16 v[112:115], v[12:15], a[100:103], v[112:115]
    v_mfma_f32_16x16x32_bf16 v[116:119], v[36:39], a[100:103], v[116:119]
    v_mfma_f32_16x16x32_bf16 v[112:115], v[16:19], a[104:107], v[112:115]
    v_mfma_f32_16x16x32_bf16 v[116:119], v[40:43], a[104:107], v[116:119]
    s_nop 0
    v_cvt_pk_bf16_f32 v128, v104, v105
    v_mfma_f32_16x16x32_bf16 v[112:115], v[20:23], a[108:111], v[112:115]
    v_cvt_pk_bf16_f32 v129, v106, v107
    v_mfma_f32_16x16x32_bf16 v[116:119], v[44:47], a[108:111], v[116:119]
    v_cvt_pk_bf16_f32 v130, v108, v109
    v_mfma_f32_16x16x32_bf16 v[112:115], v[24:27], a[112:115], v[112:115]
    v_cvt_pk_bf16_f32 v131, v110, v111
    v_mfma_f32_16x16x32_bf16 v[116:119], v[48:51], a[112:115], v[116:119]
    buffer_store_dwordx4 v[128:131], v1, s[4:7], s37 offen offset:3072 sc1
    v_mfma_f32_16x16x32_bf16 v[112:115], v[28:31], a[116:119], v[112:115]
    v_mfma_f32_16x16x32_bf16 v[116:119], v[52:55], a[116:119], v[116:119]
    v_mfma_f32_16x16x32_bf16 v[120:123], v[8:11], a[120:123], 0
    v_mfma_f32_16x16x32_bf16 v[124:127], v[32:35], a[120:123], 0
    v_mfma_f32_16x16x32_bf16 v[120:123], v[12:15], a[124:127], v[120:123]
    v_mfma_f32_16x16x32_bf16 v[124:127], v[36:39], a[124:127], v[124:127]
    v_mfma_f32_16x16x32_bf16 v[120:123], v[16:19], a[128:131], v[120:123]
    v_mfma_f32_16x16x32_bf16 v[124:127], v[40:43], a[128:131], v[124:127]
    s_nop 0
    v_cvt_pk_bf16_f32 v132, v112, v113
    v_mfma_f32_16x16x32_bf16 v[120:123], v[20:23], a[132:135], v[120:123]
    v_cvt_pk_bf16_f32 v133, v114, v115
    v_mfma_f32_16x16x32_bf16 v[124:127], v[44:47], a[132:135], v[124:127]
    v_cvt_pk_bf16_f32 v134, v116, v117
    v_mfma_f32_16x16x32_bf16 v[120:123], v[24:27], a[136:139], v[120:123]
    v_cvt_pk_bf16_f32 v135, v118, v119
    v_mfma_f32_16x16x32_bf16 v[124:127], v[48:51], a[136:139], v[124:127]
    buffer_store_dwordx4 v[132:135], v1, s[4:7], s38 offen offset:0 sc1
    v_mfma_f32_16x16x32_bf16 v[120:123], v[28:31], a[140:143], v[120:123]
    v_mfma_f32_16x16x32_bf16 v[124:127], v[52:55], a[140:143], v[124:127]
    v_mfma_f32_16x16x32_bf16 v[104:107], v[8:11], a[144:147], 0
    v_mfma_f32_16x16x32_bf16 v[108:111], v[32:35], a[144:147], 0
    v_mfma_f32_16x16x32_bf16 v[104:107], v[12:15], a[148:151], v[104:107]
    v_mfma_f32_16x16x32_bf16 v[108:111], v[36:39], a[148:151], v[108:111]
    v_mfma_f32_16x16x32_bf16 v[104:107], v[16:19], a[152:155], v[104:107]
    v_mfma_f32_16x16x32_bf16 v[108:111], v[40:43], a[152:155], v[108:111]
    s_nop 0
    v_cvt_pk_bf16_f32 v136, v120, v121
    v_mfma_f32_16x16x32_bf16 v[104:107], v[20:23], a[156:159], v[104:107]
    v_cvt_pk_bf16_f32 v137, v122, v123
    v_mfma_f32_16x16x32_bf16 v[108:111], v[44:47], a[156:159], v[108:111]
    v_cvt_pk_bf16_f32 v138, v124, v125
    v_mfma_f32_16x16x32_bf16 v[104:107], v[24:27], a[160:163], v[104:107]
    v_cvt_pk_bf16_f32 v139, v126, v127
    v_mfma_f32_16x16x32_bf16 v[108:111], v[48:51], a[160:163], v[108:111]
    buffer_store_dwordx4 v[136:139], v1, s[4:7], s38 offen offset:1024 sc1
    v_mfma_f32_16x16x32_bf16 v[104:107], v[28:31], a[164:167], v[104:107]
    v_mfma_f32_16x16x32_bf16 v[108:111], v[52:55], a[164:167], v[108:111]
    v_mfma_f32_16x16x32_bf16 v[112:115], v[8:11], a[168:171], 0
    v_mfma_f32_16x16x32_bf16 v[116:119], v[32:35], a[168:171], 0
    v_mfma_f32_16x16x32_bf16 v[112:115], v[12:15], a[172:175], v[112:115]
    v_mfma_f32_16x16x32_bf16 v[116:119], v[36:39], a[172:175], v[116:119]
    v_mfma_f32_16x16x32_bf16 v[112:115], v[16:19], a[176:179], v[112:115]
    v_mfma_f32_16x16x32_bf16 v[116:119], v[40:43], a[176:179], v[116:119]
    s_nop 0
    v_cvt_pk_bf16_f32 v128, v104, v105
    v_mfma_f32_16x16x32_bf16 v[112:115], v[20:23], a[180:183], v[112:115]
    v_cvt_pk_bf16_f32 v129, v106, v107
    v_mfma_f32_16x16x32_bf16 v[116:119], v[44:47], a[180:183], v[116:119]
    v_cvt_pk_bf16_f32 v130, v108, v109
    v_mfma_f32_16x16x32_bf16 v[112:115], v[24:27], a[184:187], v[112:115]
    v_cvt_pk_bf16_f32 v131, v110, v111
    v_mfma_f32_16x16x32_bf16 v[116:119], v[48:51], a[184:187], v[116:119]
    buffer_store_dwordx4 v[128:131], v1, s[4:7], s38 offen offset:2048 sc1
    v_mfma_f32_16x16x32_bf16 v[112:115], v[28:31], a[188:191], v[112:115]
    v_mfma_f32_16x16x32_bf16 v[116:119], v[52:55], a[188:191], v[116:119]
    v_mfma_f32_16x16x32_bf16 v[120:123], v[8:11], a[192:195], 0
    v_mfma_f32_16x16x32_bf16 v[124:127], v[32:35], a[192:195], 0
    v_mfma_f32_16x16x32_bf16 v[120:123], v[12:15], a[196:199], v[120:123]
    v_mfma_f32_16x16x32_bf16 v[124:127], v[36:39], a[196:199], v[124:127]
    v_mfma_f32_16x16x32_bf16 v[120:123], v[16:19], a[200:203], v[120:123]
    v_mfma_f32_16x16x32_bf16 v[124:127], v[40:43], a[200:203], v[124:127]
    s_nop 0
    v_cvt_pk_bf16_f32 v132, v112, v113
    v_mfma_f32_16x16x32_bf16 v[120:123], v[20:23], a[204:207], v[120:123]
    v_cvt_pk_bf16_f32 v133, v114, v115
    v_mfma_f32_16x16x32_bf16 v[124:127], v[44:47], a[204:207], v[124:127]
    v_cvt_pk_bf16_f32 v134, v116, v117
    v_mfma_f32_16x16x32_bf16 v[120:123], v[24:27], a[208:211], v[120:123]
    v_cvt_pk_bf16_f32 v135, v118, v119
    v_mfma_f32_16x16x32_bf16 v[124:127], v[48:51], a[208:211], v[124:127]
    buffer_store_dwordx4 v[132:135], v1, s[4:7], s38 offen offset:3072 sc1
    v_mfma_f32_16x16x32_bf16 v[120:123], v[28:31], a[212:215], v[120:123]
    v_mfma_f32_16x16x32_bf16 v[124:127], v[52:55], a[212:215], v[124:127]
    v_mfma_f32_16x16x32_bf16 v[104:107], v[8:11], a[216:219], 0
    v_mfma_f32_16x16x32_bf16 v[108:111], v[32:35], a[216:219], 0
    v_mfma_f32_16x16x32_bf16 v[104:107], v[12:15], a[220:223], v[104:107]
    v_mfma_f32_16x16x32_bf16 v[108:111], v[36:39], a[220:223], v[108:111]
    v_mfma_f32_16x16x32_bf16 v[104:107], v[16:19], a[224:227], v[104:107]
    v_mfma_f32_16x16x32_bf16 v[108:111], v[40:43], a[224:227], v[108:111]
    s_nop 0
    v_cvt_pk_bf16_f32 v136, v120, v121
    v_mfma_f32_16x16x32_bf16 v[104:107], v[20:23], a[228:231], v[104:107]
    v_cvt_pk_bf16_f32 v137, v122, v123
    v_mfma_f32_16x16x32_bf16 v[108:111], v[44:47], a[228:231], v[108:111]
    v_cvt_pk_bf16_f32 v138, v124, v125
    v_mfma_f32_16x16x32_bf16 v[104:107], v[24:27], a[232:235], v[104:107]
    v_cvt_pk_bf16_f32 v139, v126, v127
    v_mfma_f32_16x16x32_bf16 v[108:111], v[48:51], a[232:235], v[108:111]
    buffer_store_dwordx4 v[136:139], v1, s[4:7], s39 offen offset:0 sc1
    v_mfma_f32_16x16x32_bf16 v[104:107], v[28:31], a[236:239], v[104:107]
    v_mfma_f32_16x16x32_bf16 v[108:111], v[52:55], a[236:239], v[108:111]
    s_nop 6
    v_cvt_pk_bf16_f32 v128, v104, v105
    v_cvt_pk_bf16_f32 v129, v106, v107
    v_cvt_pk_bf16_f32 v130, v108, v109
    v_cvt_pk_bf16_f32 v131, v110, v111
    buffer_store_dwordx4 v[128:131], v1, s[4:7], s39 offen offset:1024 sc1
    s_add_u32 s17, s17, 1
    s_cmp_lt_u32 s17, s18
    s_cbranch_scc1 Lu_loop_50123
Lu_end_50124:
    s_waitcnt vmcnt(0)
    s_barrier
    s_cmp_lg_u32 s14, 0
    s_cbranch_scc1 Lsig_50136
    s_add_u32 s46, s17, 0
    v_mov_b32 v4, s46
    v_mov_b32 v5, s47
    s_mov_b64 exec, 1
    buffer_store_dword v4, v5, s[4:7], 0 offen sc1
    s_mov_b64 exec, -1
Lsig_50136:
    s_branch Lmain_tasks
Lmain_q:
    s_mov_b32 s68, s26
    s_mov_b32 s61, s30
    s_mov_b32 s69, s16
    s_load_dwordx4 s[8:11], s[0:1], 0
    s_load_dwordx8 s[16:23], s[0:1], 64
    v_mov_b32 v2, v0
    s_lshl_b32 s24, s14, 6
    v_add_u32 v0, s24, v0
    s_waitcnt lgkmcnt(0)
    s_mov_b32 s60, s68
    s_add_u32 s2, s60, 335
    s_cmp_ge_u32 s2, 336
    s_cbranch_scc1 Lpt_50137
    s_call_b64 s[62:63], Lprep_sub
Lpt_50137:
    s_barrier
    s_add_u32 s2, s60, 128
    s_cmp_ge_u32 s2, 298
    s_cbranch_scc1 Lpt_50138
    s_call_b64 s[62:63], Lprep_sub
Lpt_50138:
    s_add_u32 s2, s60, 160
    s_cmp_ge_u32 s2, 298
    s_cbranch_scc1 Lpt_50139
    s_call_b64 s[62:63], Lprep_sub
Lpt_50139:
    s_add_u32 s2, s60, 192
    s_cmp_ge_u32 s2, 298
    s_cbranch_scc1 Lpt_50140
    s_call_b64 s[62:63], Lprep_sub
Lpt_50140:
    s_add_u32 s2, s60, 224
    s_cmp_ge_u32 s2, 298
    s_cbranch_scc1 Lpt_50141
    s_call_b64 s[62:63], Lprep_sub
Lpt_50141:
    s_add_u32 s2, s60, 256
    s_cmp_ge_u32 s2, 298
    s_cbranch_scc1 Lpt_50142
    s_call_b64 s[62:63], Lprep_sub
Lpt_50142:
    s_add_u32 s2, s60, 288
    s_cmp_ge_u32 s2, 298
    s_cbranch_scc1 Lpt_50143
    s_call_b64 s[62:63], Lprep_sub
Lpt_50143:
    s_waitcnt vmcnt(0)
    s_barrier
    v_mov_b32 v0, v2
    s_mov_b32 s26, s68
    s_mov_b32 s30, s61
    s_mov_b32 s31, 0x100000
    s_mov_b32 s16, s69
    s_mov_b32 s17, 0
    s_mov_b32 s18, 64
    v_mov_b32 v4, 36
    s_movk_i32 s24, 128
    s_mov_b64 exec, 1
Lwp_50144:
    buffer_load_dword v5, v4, s[64:67], 0 offen sc1
    s_waitcnt vmcnt(0)
    v_cmp_gt_u32 vcc, s24, v5
    s_nop 0
    s_cbranch_vccz Lwpd_50145
    s_sleep 6
    s_add_u32 s30, s30, 1
    s_cmp_lt_u32 s30, s31
    s_cbranch_scc1 Lwp_50144
Lwpd_50145:
    s_mov_b64 exec, -1
    s_branch Lmain_q2
Lprep_sub:
    s_cmp_lt_u32 s2, 128
    s_cbranch_scc1 Lprep_ln
    s_cmp_lt_u32 s2, 298
    s_cbranch_scc1 Lprep_pk
    s_cmp_lt_u32 s2, 334
    s_cbranch_scc1 Lprep_init
    s_cmp_eq_u32 s2, 334
    s_cbranch_scc1 Lprep_mem
    s_mov_b64 exec, 1
    s_lshl_b32 s26, s14, 10
    s_add_u32 s27, s26, 0xb900000
    v_mov_b32 v3, s27
    v_add_u32 v4, 0x2000, v3
    s_mov_b32 s24, -1
    s_mov_b32 s25, -1
    s_mov_b32 s26, 0
Lprep_cal:
    buffer_store_dword v2, v3, s[4:7], 0 offen sc1
    s_waitcnt vmcnt(0)
    s_memtime s[28:29]
    s_waitcnt lgkmcnt(0)
    buffer_load_dword v5, v3, s[4:7], 0 offen sc1
    s_waitcnt vmcnt(0)
    s_memtime s[30:31]
    s_waitcnt lgkmcnt(0)
    s_sub_u32 s27, s30, s28
    s_min_u32 s24, s24, s27
    buffer_store_dword v2, v4, s[4:7], 0 offen sc1
    s_waitcnt vmcnt(0)
    s_memtime s[28:29]
    s_waitcnt lgkmcnt(0)
    buffer_load_dword v5, v4, s[4:7], 0 offen sc1
    s_waitcnt vmcnt(0)
    s_memtime s[30:31]
    s_waitcnt lgkmcnt(0)
    s_sub_u32 s27, s30, s28
    s_min_u32 s25, s25, s27
    s_add_u32 s26, s26, 1
    s_cmp_lt_u32 s26, 5
    s_cbranch_scc1 Lprep_cal
    v_mov_b32 v6, s24
    v_mov_b32 v7, s25
    s_lshl_b32 s26, s14, 3
    v_mov_b32 v5, s26
    ds_write_b64 v5, v[6:7]
    s_waitcnt lgkmcnt(0)
    s_barrier
    s_cmp_lg_u32 s14, 0
    s_cbranch_scc1 Lprep_end
    v_mov_b32 v5, 0
    ds_read_b128 v[8:11], v5
    ds_read_b128 v[12:15], v5 offset:16
    s_waitcnt lgkmcnt(0)
    v_min_u32 v8, v8, v10
    v_min3_u32 v8, v8, v12, v14
    v_min_u32 v9, v9, v11
    v_min3_u32 v9, v9, v13, v15
    v_readfirstlane_b32 s24, v8
    v_readfirstlane_b32 s25, v9
    s_cmp_lt_u32 s25, s24
    s_cselect_b32 s26, 8192, 0
    s_getreg_b32 s27, hwreg(HW_REG_XCC_ID)
    s_and_b32 s27, s27, 4
    s_lshl_b32 s27, s27, 11
    s_xor_b32 s26, s26, s27
    s_or_b32 s26, s26, 1
    v_mov_b32 v5, s26
    v_mov_b32 v3, 40
    buffer_store_dword v5, v3, s[64:67], 0 offen sc1
    s_branch Lprep_end
Lprep_mem:
    s_mov_b32 s24, s10
    s_and_b32 s25, s11, 0xffff
    s_mov_b32 s26, 0x2800
    s_mov_b32 s27, 0x20000
    v_add_u32 v3, 0, v0
    v_mul_u32_u24 v4, 0x199a, v3
    v_lshrrev_b32 v4, 20, v4
    v_mul_u32_u24 v5, 160, v4
    v_sub_u32 v5, v3, v5
    v_lshlrev_b32 v6, 3, v3
    buffer_load_dwordx2 v[8:9], v6, s[24:27], 0 offen
    v_lshrrev_b32 v6, 3, v5
    v_mul_u32_u24 v7, 0x3334, v6
    v_lshrrev_b32 v7, 16, v7
    v_mul_u32_u24 v10, 5, v7
    v_sub_u32 v6, v6, v10
    v_lshlrev_b32 v7, 14, v7
    v_lshl_add_u32 v7, v6, 10, v7
    v_and_b32 v6, 7, v5
    v_lshl_add_u32 v7, v6, 7, v7
    v_lshl_add_u32 v7, v4, 4, v7
    s_waitcnt vmcnt(0)
    s_movk_i32 s29, 0x4080
    v_lshl_or_b32 v12, v8, 16, s29
    v_and_b32 v13, 0xffff0000, v8
    v_or_b32 v13, s29, v13
    v_lshl_or_b32 v14, v9, 16, s29
    v_and_b32 v15, 0xffff0000, v9
    v_or_b32 v15, s29, v15
    s_mov_b32 s28, 0xb800000
    buffer_store_dwordx4 v[12:15], v7, s[4:7], s28 offen sc1
    s_mov_b32 s28, 0xb802000
    buffer_store_dwordx4 v[12:15], v7, s[4:7], s28 offen sc1
    v_add_u32 v3, 256, v0
    v_mul_u32_u24 v4, 0x199a, v3
    v_lshrrev_b32 v4, 20, v4
    v_mul_u32_u24 v5, 160, v4
    v_sub_u32 v5, v3, v5
    v_lshlrev_b32 v6, 3, v3
    buffer_load_dwordx2 v[8:9], v6, s[24:27], 0 offen
    v_lshrrev_b32 v6, 3, v5
    v_mul_u32_u24 v7, 0x3334, v6
    v_lshrrev_b32 v7, 16, v7
    v_mul_u32_u24 v10, 5, v7
    v_sub_u32 v6, v6, v10
    v_lshlrev_b32 v7, 14, v7
    v_lshl_add_u32 v7, v6, 10, v7
    v_and_b32 v6, 7, v5
    v_lshl_add_u32 v7, v6, 7, v7
    v_lshl_add_u32 v7, v4, 4, v7
    s_waitcnt vmcnt(0)
    s_movk_i32 s29, 0x4080
    v_lshl_or_b32 v12, v8, 16, s29
    v_and_b32 v13, 0xffff0000, v8
    v_or_b32 v13, s29, v13
    v_lshl_or_b32 v14, v9, 16, s29
    v_and_b32 v15, 0xffff0000, v9
    v_or_b32 v15, s29, v15
    s_mov_b32 s28, 0xb800000
    buffer_store_dwordx4 v[12:15], v7, s[4:7], s28 offen sc1
    s_mov_b32 s28, 0xb802000
    buffer_store_dwordx4 v[12:15], v7, s[4:7], s28 offen sc1
    v_add_u32 v3, 512, v0
    v_mul_u32_u24 v4, 0x199a, v3
    v_lshrrev_b32 v4, 20, v4
    v_mul_u32_u24 v5, 160, v4
    v_sub_u32 v5, v3, v5
    v_lshlrev_b32 v6, 3, v3
    buffer_load_dwordx2 v[8:9], v6, s[24:27], 0 offen
    v_lshrrev_b32 v6, 3, v5
    v_mul_u32_u24 v7, 0x3334, v6
    v_lshrrev_b32 v7, 16, v7
    v_mul_u32_u24 v10, 5, v7
    v_sub_u32 v6, v6, v10
    v_lshlrev_b32 v7, 14, v7
    v_lshl_add_u32 v7, v6, 10, v7
    v_and_b32 v6, 7, v5
    v_lshl_add_u32 v7, v6, 7, v7
    v_lshl_add_u32 v7, v4, 4, v7
    s_waitcnt vmcnt(0)
    s_movk_i32 s29, 0x4080
    v_lshl_or_b32 v12, v8, 16, s29
    v_and_b32 v13, 0xffff0000, v8
    v_or_b32 v13, s29, v13
    v_lshl_or_b32 v14, v9, 16, s29
    v_and_b32 v15, 0xffff0000, v9
    v_or_b32 v15, s29, v15
    s_mov_b32 s28, 0xb800000
    buffer_store_dwordx4 v[12:15], v7, s[4:7], s28 offen sc1
    s_mov_b32 s28, 0xb802000
    buffer_store_dwordx4 v[12:15], v7, s[4:7], s28 offen sc1
    v_add_u32 v3, 768, v0
    v_mul_u32_u24 v4, 0x199a, v3
    v_lshrrev_b32 v4, 20, v4
    v_mul_u32_u24 v5, 160, v4
    v_sub_u32 v5, v3, v5
    v_lshlrev_b32 v6, 3, v3
    buffer_load_dwordx2 v[8:9], v6, s[24:27], 0 offen
    v_lshrrev_b32 v6, 3, v5
    v_mul_u32_u24 v7, 0x3334, v6
    v_lshrrev_b32 v7, 16, v7
    v_mul_u32_u24 v10, 5, v7
    v_sub_u32 v6, v6, v10
    v_lshlrev_b32 v7, 14, v7
    v_lshl_add_u32 v7, v6, 10, v7
    v_and_b32 v6, 7, v5
    v_lshl_add_u32 v7, v6, 7, v7
    v_lshl_add_u32 v7, v4, 4, v7
    s_waitcnt vmcnt(0)
    s_movk_i32 s29, 0x4080
    v_lshl_or_b32 v12, v8, 16, s29
    v_and_b32 v13, 0xffff0000, v8
    v_or_b32 v13, s29, v13
    v_lshl_or_b32 v14, v9, 16, s29
    v_and_b32 v15, 0xffff0000, v9
    v_or_b32 v15, s29, v15
    s_mov_b32 s28, 0xb800000
    buffer_store_dwordx4 v[12:15], v7, s[4:7], s28 offen sc1
    s_mov_b32 s28, 0xb802000
    buffer_store_dwordx4 v[12:15], v7, s[4:7], s28 offen sc1
    v_add_u32 v3, 1024, v0
    v_mul_u32_u24 v4, 0x199a, v3
    v_lshrrev_b32 v4, 20, v4
    v_mul_u32_u24 v5, 160, v4
    v_sub_u32 v5, v3, v5
    v_lshlrev_b32 v6, 3, v3
    buffer_load_dwordx2 v[8:9], v6, s[24:27], 0 offen
    v_lshrrev_b32 v6, 3, v5
    v_mul_u32_u24 v7, 0x3334, v6
    v_lshrrev_b32 v7, 16, v7
    v_mul_u32_u24 v10, 5, v7
    v_sub_u32 v6, v6, v10
    v_lshlrev_b32 v7, 14, v7
    v_lshl_add_u32 v7, v6, 10, v7
    v_and_b32 v6, 7, v5
    v_lshl_add_u32 v7, v6, 7, v7
    v_lshl_add_u32 v7, v4, 4, v7
    s_waitcnt vmcnt(0)
    s_movk_i32 s29, 0x4080
    v_lshl_or_b32 v12, v8, 16, s29
    v_and_b32 v13, 0xffff0000, v8
    v_or_b32 v13, s29, v13
    v_lshl_or_b32 v14, v9, 16, s29
    v_and_b32 v15, 0xffff0000, v9
    v_or_b32 v15, s29, v15
    s_mov_b32 s28, 0xb800000
    buffer_store_dwordx4 v[12:15], v7, s[4:7], s28 offen sc1
    s_mov_b32 s28, 0xb802000
    buffer_store_dwordx4 v[12:15], v7, s[4:7], s28 offen sc1
    s_nop 0
    s_branch Lprep_end
Lprep_init:
    s_sub_u32 s24, s2, 298
    s_lshl_b32 s25, s24, 14
    s_add_u32 s26, s25, 0xb700000
    s_mov_b32 s28, -1
    s_cmp_lt_u32 s24, 20
    s_cbranch_scc1 Lprep_ig
    s_mov_b32 s28, 0
    s_sub_u32 s27, s24, 16
    s_lshr_b32 s26, s27, 2
    s_lshl_b32 s26, s26, 18
    s_and_b32 s27, s27, 3
    s_lshl_b32 s27, s27, 14
    s_add_u32 s26, s26, s27
    s_add_u32 s26, s26, 0xb800000
    s_cmp_lt_u32 s24, 32
    s_cbranch_scc1 Lprep_ig
    s_add_u32 s26, s25, 0xb181000
    s_cmp_lt_u32 s24, 36
    s_cbranch_scc1 Lprep_ig
    s_add_u32 s26, s25, 0xb570000
    s_mov_b32 s28, -1
Lprep_ig:
    v_mov_b32 v4, s28
    v_mov_b32 v5, s28
    v_mov_b32 v6, s28
    v_mov_b32 v7, s28
    v_lshlrev_b32 v3, 4, v0
    buffer_store_dwordx4 v[4:7], v3, s[4:7], s26 offen sc1
    s_add_u32 s26, s26, 4096
    buffer_store_dwordx4 v[4:7], v3, s[4:7], s26 offen sc1
    s_add_u32 s26, s26, 4096
    buffer_store_dwordx4 v[4:7], v3, s[4:7], s26 offen sc1
    s_add_u32 s26, s26, 4096
    buffer_store_dwordx4 v[4:7], v3, s[4:7], s26 offen sc1
    s_nop 0
    s_branch Lprep_end
Lprep_pk:
    s_sub_u32 s24, s2, 128
    s_lshl_b32 s24, s24, 2
    s_add_u32 s24, s24, s14
    s_mov_b32 s26, s16
    s_mov_b32 s27, s17
    s_mov_b32 s28, 5
    s_mov_b32 s29, 1280
    s_mov_b32 s30, 20
    s_mov_b32 s31, 0xba00000
    s_cmp_lt_u32 s24, 100
    s_cbranch_scc1 Lprep_pk_go
    s_mov_b32 s26, s18
    s_mov_b32 s27, s19
    s_mov_b32 s28, 5
    s_mov_b32 s29, 1280
    s_mov_b32 s30, 20
    s_mov_b32 s31, 0xbb00000
    s_mov_b32 s25, 100
    s_cmp_lt_u32 s24, 200
    s_cbranch_scc1 Lprep_pk_go
    s_mov_b32 s26, s20
    s_mov_b32 s27, s21
    s_mov_b32 s28, 12
    s_mov_b32 s29, 3072
    s_mov_b32 s30, 20
    s_mov_b32 s31, 0xbc00000
    s_mov_b32 s25, 200
    s_cmp_lt_u32 s24, 440
    s_cbranch_scc1 Lprep_pk_go
    s_mov_b32 s26, s22
    s_mov_b32 s27, s23
    s_mov_b32 s28, 5
    s_mov_b32 s29, 1280
    s_mov_b32 s30, 48
    s_mov_b32 s31, 0xbe00000
    s_mov_b32 s25, 440
Lprep_pk_go:
    s_cmp_lt_u32 s24, 100
    s_cselect_b32 s25, 0, s25
    s_sub_u32 s24, s24, s25
    s_movk_i32 s32, 0x1556
    s_cmp_eq_u32 s28, 5
    s_cselect_b32 s32, 0x3334, s32
    s_mul_i32 s33, s24, s32
    s_lshr_b32 s33, s33, 16
    s_mul_i32 s34, s33, s28
    s_sub_u32 s34, s24, s34
    s_mul_i32 s35, s33, s29
    s_lshl_b32 s35, s35, 5
    s_lshl_b32 s36, s34, 8
    s_add_u32 s35, s35, s36
    s_add_u32 s26, s26, s35
    s_addc_u32 s27, s27, 0
    v_lshrrev_b32 v3, 4, v2
    v_mul_lo_u32 v3, v3, s29
    v_and_b32 v4, 15, v2
    v_lshl_add_u32 v3, v4, 4, v3
    s_lshl_b32 s37, s14, 13
    s_lshl_b32 s38, s29, 2
    s_add_u32 m0, s37, 0
    s_nop 0
    global_load_lds_dwordx4 v3, s[26:27]
    v_add_u32 v3, s38, v3
    s_add_u32 m0, s37, 1024
    s_nop 0
    global_load_lds_dwordx4 v3, s[26:27]
    v_add_u32 v3, s38, v3
    s_add_u32 m0, s37, 2048
    s_nop 0
    global_load_lds_dwordx4 v3, s[26:27]
    v_add_u32 v3, s38, v3
    s_add_u32 m0, s37, 3072
    s_nop 0
    global_load_lds_dwordx4 v3, s[26:27]
    v_add_u32 v3, s38, v3
    s_add_u32 m0, s37, 4096
    s_nop 0
    global_load_lds_dwordx4 v3, s[26:27]
    v_add_u32 v3, s38, v3
    s_add_u32 m0, s37, 5120
    s_nop 0
    global_load_lds_dwordx4 v3, s[26:27]
    v_add_u32 v3, s38, v3
    s_add_u32 m0, s37, 6144
    s_nop 0
    global_load_lds_dwordx4 v3, s[26:27]
    v_add_u32 v3, s38, v3
    s_add_u32 m0, s37, 7168
    s_nop 0
    global_load_lds_dwordx4 v3, s[26:27]
    v_lshrrev_b32 v5, 4, v2
    v_bfe_u32 v6, v2, 2, 2
    v_lshl_add_u32 v5, v5, 2, v6
    v_lshlrev_b32 v5, 8, v5
    v_and_b32 v6, 3, v2
    v_lshl_add_u32 v5, v6, 3, v5
    v_add_u32 v5, s37, v5
    s_lshl_b32 s35, s34, 3
    s_mul_i32 s35, s35, s30
    s_add_u32 s35, s35, s33
    s_lshl_b32 s35, s35, 10
    s_add_u32 s35, s35, s31
    s_lshl_b32 s36, s30, 10
    v_lshlrev_b32 v7, 4, v2
    s_waitcnt vmcnt(0)
    ds_read_b64_tr_b16 v[8:9], v5 offset:0
    ds_read_b64_tr_b16 v[10:11], v5 offset:4096
    ds_read_b64_tr_b16 v[12:13], v5 offset:32
    ds_read_b64_tr_b16 v[14:15], v5 offset:4128
    ds_read_b64_tr_b16 v[16:17], v5 offset:64
    ds_read_b64_tr_b16 v[18:19], v5 offset:4160
    ds_read_b64_tr_b16 v[20:21], v5 offset:96
    ds_read_b64_tr_b16 v[22:23], v5 offset:4192
    ds_read_b64_tr_b16 v[24:25], v5 offset:128
    ds_read_b64_tr_b16 v[26:27], v5 offset:4224
    ds_read_b64_tr_b16 v[28:29], v5 offset:160
    ds_read_b64_tr_b16 v[30:31], v5 offset:4256
    ds_read_b64_tr_b16 v[32:33], v5 offset:192
    ds_read_b64_tr_b16 v[34:35], v5 offset:4288
    ds_read_b64_tr_b16 v[36:37], v5 offset:224
    ds_read_b64_tr_b16 v[38:39], v5 offset:4320
    s_waitcnt lgkmcnt(14)
    buffer_store_dwordx4 v[8:11], v7, s[4:7], s35 offen sc1
    s_add_u32 s35, s35, s36
    s_waitcnt lgkmcnt(12)
    buffer_store_dwordx4 v[12:15], v7, s[4:7], s35 offen sc1
    s_add_u32 s35, s35, s36
    s_waitcnt lgkmcnt(10)
    buffer_store_dwordx4 v[16:19], v7, s[4:7], s35 offen sc1
    s_add_u32 s35, s35, s36
    s_waitcnt lgkmcnt(8)
    buffer_store_dwordx4 v[20:23], v7, s[4:7], s35 offen sc1
    s_add_u32 s35, s35, s36
    s_waitcnt lgkmcnt(6)
    buffer_store_dwordx4 v[24:27], v7, s[4:7], s35 offen sc1
    s_add_u32 s35, s35, s36
    s_waitcnt lgkmcnt(4)
    buffer_store_dwordx4 v[28:31], v7, s[4:7], s35 offen sc1
    s_add_u32 s35, s35, s36
    s_waitcnt lgkmcnt(2)
    buffer_store_dwordx4 v[32:35], v7, s[4:7], s35 offen sc1
    s_add_u32 s35, s35, s36
    s_waitcnt lgkmcnt(0)
    buffer_store_dwordx4 v[36:39], v7, s[4:7], s35 offen sc1
    s_nop 0
    s_branch Lprep_end
Lprep_ln:
    s_mov_b32 s24, s8
    s_and_b32 s25, s9, 0xffff
    s_mov_b32 s26, 0x280000
    s_mov_b32 s27, 0x20000
    v_lshrrev_b32 v3, 4, v0
    v_and_b32 v4, 15, v0
    v_mul_u32_u24 v5, 1280, v3
    v_lshl_add_u32 v5, v4, 4, v5
    s_mul_i32 s28, s2, 20480
    buffer_load_dwordx4 v[8:11], v5, s[24:27], s28 offen offset:0
    buffer_load_dwordx4 v[12:15], v5, s[24:27], s28 offen offset:256
    buffer_load_dwordx4 v[16:19], v5, s[24:27], s28 offen offset:512
    buffer_load_dwordx4 v[20:23], v5, s[24:27], s28 offen offset:768
    buffer_load_dwordx4 v[24:27], v5, s[24:27], s28 offen offset:1024
    v_lshrrev_b32 v6, 2, v4
    v_lshlrev_b32 v6, 10, v6
    v_and_b32 v7, 1, v4
    v_lshl_add_u32 v6, v7, 9, v6
    v_lshl_add_u32 v6, v3, 4, v6
    v_bfe_u32 v7, v4, 1, 1
    v_lshl_add_u32 v6, v7, 3, v6
    s_mul_i32 s29, s2, 20480
    s_add_u32 s29, s29, 0x0
    s_waitcnt vmcnt(0)
    v_lshlrev_b32 v28, 16, v8
    v_and_b32 v29, 0xffff0000, v8
    v_lshlrev_b32 v30, 16, v9
    v_and_b32 v31, 0xffff0000, v9
    v_lshlrev_b32 v32, 16, v10
    v_and_b32 v33, 0xffff0000, v10
    v_lshlrev_b32 v34, 16, v11
    v_and_b32 v35, 0xffff0000, v11
    v_lshlrev_b32 v36, 16, v12
    v_and_b32 v37, 0xffff0000, v12
    v_lshlrev_b32 v38, 16, v13
    v_and_b32 v39, 0xffff0000, v13
    v_lshlrev_b32 v40, 16, v14
    v_and_b32 v41, 0xffff0000, v14
    v_lshlrev_b32 v42, 16, v15
    v_and_b32 v43, 0xffff0000, v15
    v_lshlrev_b32 v44, 16, v16
    v_and_b32 v45, 0xffff0000, v16
    v_lshlrev_b32 v46, 16, v17
    v_and_b32 v47, 0xffff0000, v17
    v_lshlrev_b32 v48, 16, v18
    v_and_b32 v49, 0xffff0000, v18
    v_lshlrev_b32 v50, 16, v19
    v_and_b32 v51, 0xffff0000, v19
    v_lshlrev_b32 v52, 16, v20
    v_and_b32 v53, 0xffff0000, v20
    v_lshlrev_b32 v54, 16, v21
    v_and_b32 v55, 0xffff0000, v21
    v_lshlrev_b32 v56, 16, v22
    v_and_b32 v57, 0xffff0000, v22
    v_lshlrev_b32 v58, 16, v23
    v_and_b32 v59, 0xffff0000, v23
    v_lshlrev_b32 v60, 16, v24
    v_and_b32 v61, 0xffff0000, v24
    v_lshlrev_b32 v62, 16, v25
    v_and_b32 v63, 0xffff0000, v25
    v_lshlrev_b32 v64, 16, v26
    v_and_b32 v65, 0xffff0000, v26
    v_lshlrev_b32 v66, 16, v27
    v_and_b32 v67, 0xffff0000, v27
    v_pk_add_f32 v[68:69], v[28:29], v[30:31]
    v_pk_add_f32 v[68:69], v[68:69], v[32:33]
    v_pk_add_f32 v[68:69], v[68:69], v[34:35]
    v_pk_add_f32 v[68:69], v[68:69], v[36:37]
    v_pk_add_f32 v[68:69], v[68:69], v[38:39]
    v_pk_add_f32 v[68:69], v[68:69], v[40:41]
    v_pk_add_f32 v[68:69], v[68:69], v[42:43]
    v_pk_add_f32 v[68:69], v[68:69], v[44:45]
    v_pk_add_f32 v[68:69], v[68:69], v[46:47]
    v_pk_add_f32 v[68:69], v[68:69], v[48:49]
    v_pk_add_f32 v[68:69], v[68:69], v[50:51]
    v_pk_add_f32 v[68:69], v[68:69], v[52:53]
    v_pk_add_f32 v[68:69], v[68:69], v[54:55]
    v_pk_add_f32 v[68:69], v[68:69], v[56:57]
    v_pk_add_f32 v[68:69], v[68:69], v[58:59]
    v_pk_add_f32 v[68:69], v[68:69], v[60:61]
    v_pk_add_f32 v[68:69], v[68:69], v[62:63]
    v_pk_add_f32 v[68:69], v[68:69], v[64:65]
    v_pk_add_f32 v[68:69], v[68:69], v[66:67]
    v_add_f32 v68, v68, v69
    s_nop 1
    v_add_f32_dpp v68, v68, v68 row_ror:8 row_mask:0xf bank_mask:0xf
    s_nop 1
    v_add_f32_dpp v68, v68, v68 row_ror:4 row_mask:0xf bank_mask:0xf
    s_nop 1
    v_add_f32_dpp v68, v68, v68 row_ror:2 row_mask:0xf bank_mask:0xf
    s_nop 1
    v_add_f32_dpp v68, v68, v68 row_ror:1 row_mask:0xf bank_mask:0xf
    v_mul_f32 v68, 0x3acccccd, v68
    v_mov_b32 v70, 0
    v_sub_f32 v71, v28, v68
    v_fmac_f32 v70, v71, v71
    v_sub_f32 v71, v29, v68
    v_fmac_f32 v70, v71, v71
    v_sub_f32 v71, v30, v68
    v_fmac_f32 v70, v71, v71
    v_sub_f32 v71, v31, v68
    v_fmac_f32 v70, v71, v71
    v_sub_f32 v71, v32, v68
    v_fmac_f32 v70, v71, v71
    v_sub_f32 v71, v33, v68
    v_fmac_f32 v70, v71, v71
    v_sub_f32 v71, v34, v68
    v_fmac_f32 v70, v71, v71
    v_sub_f32 v71, v35, v68
    v_fmac_f32 v70, v71, v71
    v_sub_f32 v71, v36, v68
    v_fmac_f32 v70, v71, v71
    v_sub_f32 v71, v37, v68
    v_fmac_f32 v70, v71, v71
    v_sub_f32 v71, v38, v68
    v_fmac_f32 v70, v71, v71
    v_sub_f32 v71, v39, v68
    v_fmac_f32 v70, v71, v71
    v_sub_f32 v71, v40, v68
    v_fmac_f32 v70, v71, v71
    v_sub_f32 v71, v41, v68
    v_fmac_f32 v70, v71, v71
    v_sub_f32 v71, v42, v68
    v_fmac_f32 v70, v71, v71
    v_sub_f32 v71, v43, v68
    v_fmac_f32 v70, v71, v71
    v_sub_f32 v71, v44, v68
    v_fmac_f32 v70, v71, v71
    v_sub_f32 v71, v45, v68
    v_fmac_f32 v70, v71, v71
    v_sub_f32 v71, v46, v68
    v_fmac_f32 v70, v71, v71
    v_sub_f32 v71, v47, v68
    v_fmac_f32 v70, v71, v71
    v_sub_f32 v71, v48, v68
    v_fmac_f32 v70, v71, v71
    v_sub_f32 v71, v49, v68
    v_fmac_f32 v70, v71, v71
    v_sub_f32 v71, v50, v68
    v_fmac_f32 v70, v71, v71
    v_sub_f32 v71, v51, v68
    v_fmac_f32 v70, v71, v71
    v_sub_f32 v71, v52, v68
    v_fmac_f32 v70, v71, v71
    v_sub_f32 v71, v53, v68
    v_fmac_f32 v70, v71, v71
    v_sub_f32 v71, v54, v68
    v_fmac_f32 v70, v71, v71
    v_sub_f32 v71, v55, v68
    v_fmac_f32 v70, v71, v71
    v_sub_f32 v71, v56, v68
    v_fmac_f32 v70, v71, v71
    v_sub_f32 v71, v57, v68
    v_fmac_f32 v70, v71, v71
    v_sub_f32 v71, v58, v68
    v_fmac_f32 v70, v71, v71
    v_sub_f32 v71, v59, v68
    v_fmac_f32 v70, v71, v71
    v_sub_f32 v71, v60, v68
    v_fmac_f32 v70, v71, v71
    v_sub_f32 v71, v61, v68
    v_fmac_f32 v70, v71, v71
    v_sub_f32 v71, v62, v68
    v_fmac_f32 v70, v71, v71
    v_sub_f32 v71, v63, v68
    v_fmac_f32 v70, v71, v71
    v_sub_f32 v71, v64, v68
    v_fmac_f32 v70, v71, v71
    v_sub_f32 v71, v65, v68
    v_fmac_f32 v70, v71, v71
    v_sub_f32 v71, v66, v68
    v_fmac_f32 v70, v71, v71
    v_sub_f32 v71, v67, v68
    v_fmac_f32 v70, v71, v71
    s_nop 1
    v_add_f32_dpp v70, v70, v70 row_ror:8 row_mask:0xf bank_mask:0xf
    s_nop 1
    v_add_f32_dpp v70, v70, v70 row_ror:4 row_mask:0xf bank_mask:0xf
    s_nop 1
    v_add_f32_dpp v70, v70, v70 row_ror:2 row_mask:0xf bank_mask:0xf
    s_nop 1
    v_add_f32_dpp v70, v70, v70 row_ror:1 row_mask:0xf bank_mask:0xf
    v_mul_f32 v70, 0x3acccccd, v70
    v_cvt_pk_bf16_f32 v68, v68, v68
    v_lshlrev_b32 v68, 16, v68
    v_cvt_pk_bf16_f32 v70, v70, v70
    v_lshlrev_b32 v70, 16, v70
    v_add_f32 v70, 0x3727c5ac, v70
    v_cvt_pk_bf16_f32 v70, v70, v70
    v_lshlrev_b32 v70, 16, v70
    v_sqrt_f32 v70, v70
    s_nop 0
    v_cvt_pk_bf16_f32 v70, v70, v70
    v_lshlrev_b32 v70, 16, v70
    v_rcp_f32 v70, v70
    v_sub_f32 v28, v28, v68
    v_sub_f32 v29, v29, v68
    v_cvt_pk_bf16_f32 v72, v28, v29
    v_lshlrev_b32 v73, 16, v72
    v_and_b32 v74, 0xffff0000, v72
    v_mul_f32 v73, v73, v70
    v_mul_f32 v74, v74, v70
    v_cvt_pk_bf16_f32 v8, v73, v74
    v_sub_f32 v30, v30, v68
    v_sub_f32 v31, v31, v68
    v_cvt_pk_bf16_f32 v72, v30, v31
    v_lshlrev_b32 v73, 16, v72
    v_and_b32 v74, 0xffff0000, v72
    v_mul_f32 v73, v73, v70
    v_mul_f32 v74, v74, v70
    v_cvt_pk_bf16_f32 v9, v73, v74
    v_sub_f32 v32, v32, v68
    v_sub_f32 v33, v33, v68
    v_cvt_pk_bf16_f32 v72, v32, v33
    v_lshlrev_b32 v73, 16, v72
    v_and_b32 v74, 0xffff0000, v72
    v_mul_f32 v73, v73, v70
    v_mul_f32 v74, v74, v70
    v_cvt_pk_bf16_f32 v10, v73, v74
    v_sub_f32 v34, v34, v68
    v_sub_f32 v35, v35, v68
    v_cvt_pk_bf16_f32 v72, v34, v35
    v_lshlrev_b32 v73, 16, v72
    v_and_b32 v74, 0xffff0000, v72
    v_mul_f32 v73, v73, v70
    v_mul_f32 v74, v74, v70
    v_cvt_pk_bf16_f32 v11, v73, v74
    v_sub_f32 v36, v36, v68
    v_sub_f32 v37, v37, v68
    v_cvt_pk_bf16_f32 v72, v36, v37
    v_lshlrev_b32 v73, 16, v72
    v_and_b32 v74, 0xffff0000, v72
    v_mul_f32 v73, v73, v70
    v_mul_f32 v74, v74, v70
    v_cvt_pk_bf16_f32 v12, v73, v74
    v_sub_f32 v38, v38, v68
    v_sub_f32 v39, v39, v68
    v_cvt_pk_bf16_f32 v72, v38, v39
    v_lshlrev_b32 v73, 16, v72
    v_and_b32 v74, 0xffff0000, v72
    v_mul_f32 v73, v73, v70
    v_mul_f32 v74, v74, v70
    v_cvt_pk_bf16_f32 v13, v73, v74
    v_sub_f32 v40, v40, v68
    v_sub_f32 v41, v41, v68
    v_cvt_pk_bf16_f32 v72, v40, v41
    v_lshlrev_b32 v73, 16, v72
    v_and_b32 v74, 0xffff0000, v72
    v_mul_f32 v73, v73, v70
    v_mul_f32 v74, v74, v70
    v_cvt_pk_bf16_f32 v14, v73, v74
    v_sub_f32 v42, v42, v68
    v_sub_f32 v43, v43, v68
    v_cvt_pk_bf16_f32 v72, v42, v43
    v_lshlrev_b32 v73, 16, v72
    v_and_b32 v74, 0xffff0000, v72
    v_mul_f32 v73, v73, v70
    v_mul_f32 v74, v74, v70
    v_cvt_pk_bf16_f32 v15, v73, v74
    v_sub_f32 v44, v44, v68
    v_sub_f32 v45, v45, v68
    v_cvt_pk_bf16_f32 v72, v44, v45
    v_lshlrev_b32 v73, 16, v72
    v_and_b32 v74, 0xffff0000, v72
    v_mul_f32 v73, v73, v70
    v_mul_f32 v74, v74, v70
    v_cvt_pk_bf16_f32 v16, v73, v74
    v_sub_f32 v46, v46, v68
    v_sub_f32 v47, v47, v68
    v_cvt_pk_bf16_f32 v72, v46, v47
    v_lshlrev_b32 v73, 16, v72
    v_and_b32 v74, 0xffff0000, v72
    v_mul_f32 v73, v73, v70
    v_mul_f32 v74, v74, v70
    v_cvt_pk_bf16_f32 v17, v73, v74
    v_sub_f32 v48, v48, v68
    v_sub_f32 v49, v49, v68
    v_cvt_pk_bf16_f32 v72, v48, v49
    v_lshlrev_b32 v73, 16, v72
    v_and_b32 v74, 0xffff0000, v72
    v_mul_f32 v73, v73, v70
    v_mul_f32 v74, v74, v70
    v_cvt_pk_bf16_f32 v18, v73, v74
    v_sub_f32 v50, v50, v68
    v_sub_f32 v51, v51, v68
    v_cvt_pk_bf16_f32 v72, v50, v51
    v_lshlrev_b32 v73, 16, v72
    v_and_b32 v74, 0xffff0000, v72
    v_mul_f32 v73, v73, v70
    v_mul_f32 v74, v74, v70
    v_cvt_pk_bf16_f32 v19, v73, v74
    v_sub_f32 v52, v52, v68
    v_sub_f32 v53, v53, v68
    v_cvt_pk_bf16_f32 v72, v52, v53
    v_lshlrev_b32 v73, 16, v72
    v_and_b32 v74, 0xffff0000, v72
    v_mul_f32 v73, v73, v70
    v_mul_f32 v74, v74, v70
    v_cvt_pk_bf16_f32 v20, v73, v74
    v_sub_f32 v54, v54, v68
    v_sub_f32 v55, v55, v68
    v_cvt_pk_bf16_f32 v72, v54, v55
    v_lshlrev_b32 v73, 16, v72
    v_and_b32 v74, 0xffff0000, v72
    v_mul_f32 v73, v73, v70
    v_mul_f32 v74, v74, v70
    v_cvt_pk_bf16_f32 v21, v73, v74
    v_sub_f32 v56, v56, v68
    v_sub_f32 v57, v57, v68
    v_cvt_pk_bf16_f32 v72, v56, v57
    v_lshlrev_b32 v73, 16, v72
    v_and_b32 v74, 0xffff0000, v72
    v_mul_f32 v73, v73, v70
    v_mul_f32 v74, v74, v70
    v_cvt_pk_bf16_f32 v22, v73, v74
    v_sub_f32 v58, v58, v68
    v_sub_f32 v59, v59, v68
    v_cvt_pk_bf16_f32 v72, v58, v59
    v_lshlrev_b32 v73, 16, v72
    v_and_b32 v74, 0xffff0000, v72
    v_mul_f32 v73, v73, v70
    v_mul_f32 v74, v74, v70
    v_cvt_pk_bf16_f32 v23, v73, v74
    v_sub_f32 v60, v60, v68
    v_sub_f32 v61, v61, v68
    v_cvt_pk_bf16_f32 v72, v60, v61
    v_lshlrev_b32 v73, 16, v72
    v_and_b32 v74, 0xffff0000, v72
    v_mul_f32 v73, v73, v70
    v_mul_f32 v74, v74, v70
    v_cvt_pk_bf16_f32 v24, v73, v74
    v_sub_f32 v62, v62, v68
    v_sub_f32 v63, v63, v68
    v_cvt_pk_bf16_f32 v72, v62, v63
    v_lshlrev_b32 v73, 16, v72
    v_and_b32 v74, 0xffff0000, v72
    v_mul_f32 v73, v73, v70
    v_mul_f32 v74, v74, v70
    v_cvt_pk_bf16_f32 v25, v73, v74
    v_sub_f32 v64, v64, v68
    v_sub_f32 v65, v65, v68
    v_cvt_pk_bf16_f32 v72, v64, v65
    v_lshlrev_b32 v73, 16, v72
    v_and_b32 v74, 0xffff0000, v72
    v_mul_f32 v73, v73, v70
    v_mul_f32 v74, v74, v70
    v_cvt_pk_bf16_f32 v26, v73, v74
    v_sub_f32 v66, v66, v68
    v_sub_f32 v67, v67, v68
    v_cvt_pk_bf16_f32 v72, v66, v67
    v_lshlrev_b32 v73, 16, v72
    v_and_b32 v74, 0xffff0000, v72
    v_mul_f32 v73, v73, v70
    v_mul_f32 v74, v74, v70
    v_cvt_pk_bf16_f32 v27, v73, v74
    s_barrier
    ds_write_b64 v6, v[8:9] offset:0
    ds_write_b64 v6, v[10:11] offset:256
    ds_write_b64 v6, v[12:13] offset:4096
    ds_write_b64 v6, v[14:15] offset:4352
    ds_write_b64 v6, v[16:17] offset:8192
    ds_write_b64 v6, v[18:19] offset:8448
    ds_write_b64 v6, v[20:21] offset:12288
    ds_write_b64 v6, v[22:23] offset:12544
    ds_write_b64 v6, v[24:25] offset:16384
    ds_write_b64 v6, v[26:27] offset:16640
    v_lshlrev_b32 v7, 4, v0
    s_waitcnt lgkmcnt(0)
    s_barrier
    ds_read_b128 v[28:31], v7 offset:0
    ds_read_b128 v[32:35], v7 offset:4096
    ds_read_b128 v[36:39], v7 offset:8192
    ds_read_b128 v[40:43], v7 offset:12288
    ds_read_b128 v[44:47], v7 offset:16384
    s_waitcnt lgkmcnt(4)
    buffer_store_dwordx4 v[28:31], v7, s[4:7], s29 offen sc1
    s_add_u32 s29, s29, 4096
    s_waitcnt lgkmcnt(3)
    buffer_store_dwordx4 v[32:35], v7, s[4:7], s29 offen sc1
    s_add_u32 s29, s29, 4096
    s_waitcnt lgkmcnt(2)
    buffer_store_dwordx4 v[36:39], v7, s[4:7], s29 offen sc1
    s_add_u32 s29, s29, 4096
    s_waitcnt lgkmcnt(1)
    buffer_store_dwordx4 v[40:43], v7, s[4:7], s29 offen sc1
    s_add_u32 s29, s29, 4096
    s_waitcnt lgkmcnt(0)
    buffer_store_dwordx4 v[44:47], v7, s[4:7], s29 offen sc1
    s_nop 1
Lprep_end:
    s_mov_b64 exec, -1
    s_setpc_b64 s[62:63]
Lmain_q2:
    s_mov_b32 s8, s48
    s_mov_b32 s9, s49
    s_add_u32 s47, s47, 0xa000
    s_lshr_b32 s20, s26, 3
    s_lshl_b32 s20, s20, 7
    s_and_b32 s21, s26, 7
    s_lshl_b32 s21, s21, 2
    s_add_u32 s20, s20, s21
    s_add_u32 s20, s20, 0xb201020
    v_mov_b32 v165, s20
    s_mov_b64 exec, 1
    s_nop 0
Lwp_50149:
    buffer_load_dword v162, v165, s[4:7], 0 offen sc1
    s_waitcnt vmcnt(0)
    v_cmp_gt_u32 vcc, 1, v162
    s_nop 0
    s_cbranch_vccz Lwpd_50150
    s_sleep 16
    s_add_u32 s30, s30, 1
    s_cmp_lt_u32 s30, s31
    s_cbranch_scc1 Lwp_50149
Lwpd_50150:
    s_mov_b64 exec, -1
    s_lshl_b32 s27, s14, 10
    s_lshl_b32 s29, s14, 6
    v_add_u32 v40, s29, v0
    v_add_u32 v40, 0, v40
    v_mul_u32_u24 v41, 0xaab, v40
    v_lshrrev_b32 v41, 16, v41
    v_mul_u32_u24 v42, 24, v41
    v_sub_u32 v42, v40, v42
    v_mul_u32_u24 v41, 12288, v41
    v_lshl_add_u32 v43, v42, 4, v41
    v_add_u32 v40, s29, v0
    v_add_u32 v40, 256, v40
    v_mul_u32_u24 v41, 0xaab, v40
    v_lshrrev_b32 v41, 16, v41
    v_mul_u32_u24 v42, 24, v41
    v_sub_u32 v42, v40, v42
    v_mul_u32_u24 v41, 12288, v41
    v_lshl_add_u32 v44, v42, 4, v41
    v_add_u32 v40, s29, v0
    v_add_u32 v40, 512, v40
    v_mul_u32_u24 v41, 0xaab, v40
    v_lshrrev_b32 v41, 16, v41
    v_mul_u32_u24 v42, 24, v41
    v_sub_u32 v42, v40, v42
    v_mul_u32_u24 v41, 12288, v41
    v_lshl_add_u32 v45, v42, 4, v41
    s_mul_i32 s28, s26, 384
    s_add_u32 s32, s8, s28
    s_addc_u32 s33, s9, 0
    v_lshrrev_b32 v40, 4, v0
    v_bfe_u32 v41, v0, 2, 2
    v_lshl_add_u32 v40, v40, 2, v41
    v_mul_u32_u24 v40, 384, v40
    v_and_b32 v41, 3, v0
    v_mul_u32_u24 v41, 24, v41
    s_mul_i32 s29, s14, 96
    v_add3_u32 v40, v40, v41, s29
    v_add_u32 v41, 61440, v40
    s_add_u32 m0, s27, 0
    s_nop 0
    global_load_lds_dwordx4 v43, s[32:33]
    s_add_u32 m0, s27, 4096
    s_nop 0
    global_load_lds_dwordx4 v44, s[32:33]
    s_add_u32 m0, s27, 8192
    s_nop 0
    global_load_lds_dwordx4 v45, s[32:33]
    s_add_u32 s32, s32, 393216
    s_addc_u32 s33, s33, 0
    s_add_u32 m0, s27, 12288
    s_nop 0
    global_load_lds_dwordx4 v43, s[32:33]
    s_add_u32 m0, s27, 16384
    s_nop 0
    global_load_lds_dwordx4 v44, s[32:33]
    s_add_u32 m0, s27, 20480
    s_nop 0
    global_load_lds_dwordx4 v45, s[32:33]
    s_add_u32 s32, s32, 393216
    s_addc_u32 s33, s33, 0
    s_add_u32 m0, s27, 24576
    s_nop 0
    global_load_lds_dwordx4 v43, s[32:33]
    s_add_u32 m0, s27, 28672
    s_nop 0
    global_load_lds_dwordx4 v44, s[32:33]
    s_add_u32 m0, s27, 32768
    s_nop 0
    global_load_lds_dwordx4 v45, s[32:33]
    s_add_u32 s32, s32, 393216
    s_addc_u32 s33, s33, 0
    s_add_u32 m0, s27, 36864
    s_nop 0
    global_load_lds_dwordx4 v43, s[32:33]
    s_add_u32 m0, s27, 40960
    s_nop 0
    global_load_lds_dwordx4 v44, s[32:33]
    s_add_u32 m0, s27, 45056
    s_nop 0
    global_load_lds_dwordx4 v45, s[32:33]
    s_add_u32 s32, s32, 393216
    s_addc_u32 s33, s33, 0
    s_add_u32 m0, s27, 49152
    s_nop 0
    global_load_lds_dwordx4 v43, s[32:33]
    s_add_u32 m0, s27, 53248
    s_nop 0
    global_load_lds_dwordx4 v44, s[32:33]
    s_add_u32 m0, s27, 57344
    s_nop 0
    global_load_lds_dwordx4 v45, s[32:33]
    s_add_u32 s32, s32, 393216
    s_addc_u32 s33, s33, 0
    s_add_u32 m0, s27, 61440
    s_nop 0
    global_load_lds_dwordx4 v43, s[32:33]
    s_add_u32 m0, s27, 65536
    s_nop 0
    global_load_lds_dwordx4 v44, s[32:33]
    s_add_u32 m0, s27, 69632
    s_nop 0
    global_load_lds_dwordx4 v45, s[32:33]
    s_add_u32 s32, s32, 393216
    s_addc_u32 s33, s33, 0
    s_add_u32 m0, s27, 73728
    s_nop 0
    global_load_lds_dwordx4 v43, s[32:33]
    s_add_u32 m0, s27, 77824
    s_nop 0
    global_load_lds_dwordx4 v44, s[32:33]
    s_add_u32 m0, s27, 81920
    s_nop 0
    global_load_lds_dwordx4 v45, s[32:33]
    s_add_u32 s32, s32, 393216
    s_addc_u32 s33, s33, 0
    s_add_u32 m0, s27, 86016
    s_nop 0
    global_load_lds_dwordx4 v43, s[32:33]
    s_add_u32 m0, s27, 90112
    s_nop 0
    global_load_lds_dwordx4 v44, s[32:33]
    s_add_u32 m0, s27, 94208
    s_nop 0
    global_load_lds_dwordx4 v45, s[32:33]
    s_add_u32 s32, s32, 393216
    s_addc_u32 s33, s33, 0
    s_add_u32 m0, s27, 98304
    s_nop 0
    global_load_lds_dwordx4 v43, s[32:33]
    s_add_u32 m0, s27, 102400
    s_nop 0
    global_load_lds_dwordx4 v44, s[32:33]
    s_add_u32 m0, s27, 106496
    s_nop 0
    global_load_lds_dwordx4 v45, s[32:33]
    s_add_u32 s32, s32, 393216
    s_addc_u32 s33, s33, 0
    s_add_u32 m0, s27, 110592
    s_nop 0
    global_load_lds_dwordx4 v43, s[32:33]
    s_add_u32 m0, s27, 114688
    s_nop 0
    global_load_lds_dwordx4 v44, s[32:33]
    s_add_u32 m0, s27, 118784
    s_nop 0
    global_load_lds_dwordx4 v45, s[32:33]
    s_add_u32 s32, s32, 393216
    s_addc_u32 s33, s33, 0
    s_waitcnt vmcnt(0)
    s_barrier
    ds_read_b64_tr_b16 a[0:1], v40 offset:0
    ds_read_b64_tr_b16 a[2:3], v40 offset:6144
    ds_read_b64_tr_b16 a[4:5], v40 offset:12288
    ds_read_b64_tr_b16 a[6:7], v40 offset:18432
    ds_read_b64_tr_b16 a[8:9], v40 offset:24576
    ds_read_b64_tr_b16 a[10:11], v40 offset:30720
    ds_read_b64_tr_b16 a[12:13], v40 offset:36864
    ds_read_b64_tr_b16 a[14:15], v40 offset:43008
    ds_read_b64_tr_b16 a[16:17], v40 offset:49152
    ds_read_b64_tr_b16 a[18:19], v40 offset:55296
    s_waitcnt lgkmcnt(0)
    ds_read_b64_tr_b16 a[20:21], v41 offset:0
    ds_read_b64_tr_b16 a[22:23], v41 offset:6144
    ds_read_b64_tr_b16 a[24:25], v41 offset:12288
    ds_read_b64_tr_b16 a[26:27], v41 offset:18432
    ds_read_b64_tr_b16 a[28:29], v41 offset:24576
    ds_read_b64_tr_b16 a[30:31], v41 offset:30720
    ds_read_b64_tr_b16 a[32:33], v41 offset:36864
    ds_read_b64_tr_b16 a[34:35], v41 offset:43008
    ds_read_b64_tr_b16 a[36:37], v41 offset:49152
    ds_read_b64_tr_b16 a[38:39], v41 offset:55296
    s_waitcnt lgkmcnt(0)
    ds_read_b64_tr_b16 a[80:81], v40 offset:8
    ds_read_b64_tr_b16 a[82:83], v40 offset:6152
    ds_read_b64_tr_b16 a[84:85], v40 offset:12296
    ds_read_b64_tr_b16 a[86:87], v40 offset:18440
    ds_read_b64_tr_b16 a[88:89], v40 offset:24584
    ds_read_b64_tr_b16 a[90:91], v40 offset:30728
    ds_read_b64_tr_b16 a[92:93], v40 offset:36872
    ds_read_b64_tr_b16 a[94:95], v40 offset:43016
    ds_read_b64_tr_b16 a[96:97], v40 offset:49160
    ds_read_b64_tr_b16 a[98:99], v40 offset:55304
    s_waitcnt lgkmcnt(0)
    ds_read_b64_tr_b16 a[100:101], v41 offset:8
    ds_read_b64_tr_b16 a[102:103], v41 offset:6152
    ds_read_b64_tr_b16 a[104:105], v41 offset:12296
    ds_read_b64_tr_b16 a[106:107], v41 offset:18440
    ds_read_b64_tr_b16 a[108:109], v41 offset:24584
    ds_read_b64_tr_b16 a[110:111], v41 offset:30728
    ds_read_b64_tr_b16 a[112:113], v41 offset:36872
    ds_read_b64_tr_b16 a[114:115], v41 offset:43016
    ds_read_b64_tr_b16 a[116:117], v41 offset:49160
    ds_read_b64_tr_b16 a[118:119], v41 offset:55304
    s_waitcnt lgkmcnt(0)
    ds_read_b64_tr_b16 a[160:161], v40 offset:16
    ds_read_b64_tr_b16 a[162:163], v40 offset:6160
    ds_read_b64_tr_b16 a[164:165], v40 offset:12304
    ds_read_b64_tr_b16 a[166:167], v40 offset:18448
    ds_read_b64_tr_b16 a[168:169], v40 offset:24592
    ds_read_b64_tr_b16 a[170:171], v40 offset:30736
    ds_read_b64_tr_b16 a[172:173], v40 offset:36880
    ds_read_b64_tr_b16 a[174:175], v40 offset:43024
    ds_read_b64_tr_b16 a[176:177], v40 offset:49168
    ds_read_b64_tr_b16 a[178:179], v40 offset:55312
    s_waitcnt lgkmcnt(0)
    ds_read_b64_tr_b16 a[180:181], v41 offset:16
    ds_read_b64_tr_b16 a[182:183], v41 offset:6160
    ds_read_b64_tr_b16 a[184:185], v41 offset:12304
    ds_read_b64_tr_b16 a[186:187], v41 offset:18448
    ds_read_b64_tr_b16 a[188:189], v41 offset:24592
    ds_read_b64_tr_b16 a[190:191], v41 offset:30736
    ds_read_b64_tr_b16 a[192:193], v41 offset:36880
    ds_read_b64_tr_b16 a[194:195], v41 offset:43024
    ds_read_b64_tr_b16 a[196:197], v41 offset:49168
    ds_read_b64_tr_b16 a[198:199], v41 offset:55312
    s_waitcnt lgkmcnt(0)
    s_barrier
    s_add_u32 m0, s27, 0
    s_nop 0
    global_load_lds_dwordx4 v43, s[32:33]
    s_add_u32 m0, s27, 4096
    s_nop 0
    global_load_lds_dwordx4 v44, s[32:33]
    s_add_u32 m0, s27, 8192
    s_nop 0
    global_load_lds_dwordx4 v45, s[32:33]
    s_add_u32 s32, s32, 393216
    s_addc_u32 s33, s33, 0
    s_add_u32 m0, s27, 12288
    s_nop 0
    global_load_lds_dwordx4 v43, s[32:33]
    s_add_u32 m0, s27, 16384
    s_nop 0
    global_load_lds_dwordx4 v44, s[32:33]
    s_add_u32 m0, s27, 20480
    s_nop 0
    global_load_lds_dwordx4 v45, s[32:33]
    s_add_u32 s32, s32, 393216
    s_addc_u32 s33, s33, 0
    s_add_u32 m0, s27, 24576
    s_nop 0
    global_load_lds_dwordx4 v43, s[32:33]
    s_add_u32 m0, s27, 28672
    s_nop 0
    global_load_lds_dwordx4 v44, s[32:33]
    s_add_u32 m0, s27, 32768
    s_nop 0
    global_load_lds_dwordx4 v45, s[32:33]
    s_add_u32 s32, s32, 393216
    s_addc_u32 s33, s33, 0
    s_add_u32 m0, s27, 36864
    s_nop 0
    global_load_lds_dwordx4 v43, s[32:33]
    s_add_u32 m0, s27, 40960
    s_nop 0
    global_load_lds_dwordx4 v44, s[32:33]
    s_add_u32 m0, s27, 45056
    s_nop 0
    global_load_lds_dwordx4 v45, s[32:33]
    s_add_u32 s32, s32, 393216
    s_addc_u32 s33, s33, 0
    s_add_u32 m0, s27, 49152
    s_nop 0
    global_load_lds_dwordx4 v43, s[32:33]
    s_add_u32 m0, s27, 53248
    s_nop 0
    global_load_lds_dwordx4 v44, s[32:33]
    s_add_u32 m0, s27, 57344
    s_nop 0
    global_load_lds_dwordx4 v45, s[32:33]
    s_add_u32 s32, s32, 393216
    s_addc_u32 s33, s33, 0
    s_add_u32 m0, s27, 61440
    s_nop 0
    global_load_lds_dwordx4 v43, s[32:33]
    s_add_u32 m0, s27, 65536
    s_nop 0
    global_load_lds_dwordx4 v44, s[32:33]
    s_add_u32 m0, s27, 69632
    s_nop 0
    global_load_lds_dwordx4 v45, s[32:33]
    s_add_u32 s32, s32, 393216
    s_addc_u32 s33, s33, 0
    s_add_u32 m0, s27, 73728
    s_nop 0
    global_load_lds_dwordx4 v43, s[32:33]
    s_add_u32 m0, s27, 77824
    s_nop 0
    global_load_lds_dwordx4 v44, s[32:33]
    s_add_u32 m0, s27, 81920
    s_nop 0
    global_load_lds_dwordx4 v45, s[32:33]
    s_add_u32 s32, s32, 393216
    s_addc_u32 s33, s33, 0
    s_add_u32 m0, s27, 86016
    s_nop 0
    global_load_lds_dwordx4 v43, s[32:33]
    s_add_u32 m0, s27, 90112
    s_nop 0
    global_load_lds_dwordx4 v44, s[32:33]
    s_add_u32 m0, s27, 94208
    s_nop 0
    global_load_lds_dwordx4 v45, s[32:33]
    s_add_u32 s32, s32, 393216
    s_addc_u32 s33, s33, 0
    s_add_u32 m0, s27, 98304
    s_nop 0
    global_load_lds_dwordx4 v43, s[32:33]
    s_add_u32 m0, s27, 102400
    s_nop 0
    global_load_lds_dwordx4 v44, s[32:33]
    s_add_u32 m0, s27, 106496
    s_nop 0
    global_load_lds_dwordx4 v45, s[32:33]
    s_add_u32 s32, s32, 393216
    s_addc_u32 s33, s33, 0
    s_add_u32 m0, s27, 110592
    s_nop 0
    global_load_lds_dwordx4 v43, s[32:33]
    s_add_u32 m0, s27, 114688
    s_nop 0
    global_load_lds_dwordx4 v44, s[32:33]
    s_add_u32 m0, s27, 118784
    s_nop 0
    global_load_lds_dwordx4 v45, s[32:33]
    s_add_u32 s32, s32, 393216
    s_addc_u32 s33, s33, 0
    s_waitcnt vmcnt(0)
    s_barrier
    ds_read_b64_tr_b16 a[40:41], v40 offset:0
    ds_read_b64_tr_b16 a[42:43], v40 offset:6144
    ds_read_b64_tr_b16 a[44:45], v40 offset:12288
    ds_read_b64_tr_b16 a[46:47], v40 offset:18432
    ds_read_b64_tr_b16 a[48:49], v40 offset:24576
    ds_read_b64_tr_b16 a[50:51], v40 offset:30720
    ds_read_b64_tr_b16 a[52:53], v40 offset:36864
    ds_read_b64_tr_b16 a[54:55], v40 offset:43008
    ds_read_b64_tr_b16 a[56:57], v40 offset:49152
    ds_read_b64_tr_b16 a[58:59], v40 offset:55296
    s_waitcnt lgkmcnt(0)
    ds_read_b64_tr_b16 a[60:61], v41 offset:0
    ds_read_b64_tr_b16 a[62:63], v41 offset:6144
    ds_read_b64_tr_b16 a[64:65], v41 offset:12288
    ds_read_b64_tr_b16 a[66:67], v41 offset:18432
    ds_read_b64_tr_b16 a[68:69], v41 offset:24576
    ds_read_b64_tr_b16 a[70:71], v41 offset:30720
    ds_read_b64_tr_b16 a[72:73], v41 offset:36864
    ds_read_b64_tr_b16 a[74:75], v41 offset:43008
    ds_read_b64_tr_b16 a[76:77], v41 offset:49152
    ds_read_b64_tr_b16 a[78:79], v41 offset:55296
    s_waitcnt lgkmcnt(0)
    ds_read_b64_tr_b16 a[120:121], v40 offset:8
    ds_read_b64_tr_b16 a[122:123], v40 offset:6152
    ds_read_b64_tr_b16 a[124:125], v40 offset:12296
    ds_read_b64_tr_b16 a[126:127], v40 offset:18440
    ds_read_b64_tr_b16 a[128:129], v40 offset:24584
    ds_read_b64_tr_b16 a[130:131], v40 offset:30728
    ds_read_b64_tr_b16 a[132:133], v40 offset:36872
    ds_read_b64_tr_b16 a[134:135], v40 offset:43016
    ds_read_b64_tr_b16 a[136:137], v40 offset:49160
    ds_read_b64_tr_b16 a[138:139], v40 offset:55304
    s_waitcnt lgkmcnt(0)
    ds_read_b64_tr_b16 a[140:141], v41 offset:8
    ds_read_b64_tr_b16 a[142:143], v41 offset:6152
    ds_read_b64_tr_b16 a[144:145], v41 offset:12296
    ds_read_b64_tr_b16 a[146:147], v41 offset:18440
    ds_read_b64_tr_b16 a[148:149], v41 offset:24584
    ds_read_b64_tr_b16 a[150:151], v41 offset:30728
    ds_read_b64_tr_b16 a[152:153], v41 offset:36872
    ds_read_b64_tr_b16 a[154:155], v41 offset:43016
    ds_read_b64_tr_b16 a[156:157], v41 offset:49160
    ds_read_b64_tr_b16 a[158:159], v41 offset:55304
    s_waitcnt lgkmcnt(0)
    ds_read_b64_tr_b16 a[200:201], v40 offset:16
    ds_read_b64_tr_b16 a[202:203], v40 offset:6160
    ds_read_b64_tr_b16 a[204:205], v40 offset:12304
    ds_read_b64_tr_b16 a[206:207], v40 offset:18448
    ds_read_b64_tr_b16 a[208:209], v40 offset:24592
    ds_read_b64_tr_b16 a[210:211], v40 offset:30736
    ds_read_b64_tr_b16 a[212:213], v40 offset:36880
    ds_read_b64_tr_b16 a[214:215], v40 offset:43024
    ds_read_b64_tr_b16 a[216:217], v40 offset:49168
    ds_read_b64_tr_b16 a[218:219], v40 offset:55312
    s_waitcnt lgkmcnt(0)
    ds_read_b64_tr_b16 a[220:221], v41 offset:16
    ds_read_b64_tr_b16 a[222:223], v41 offset:6160
    ds_read_b64_tr_b16 a[224:225], v41 offset:12304
    ds_read_b64_tr_b16 a[226:227], v41 offset:18448
    ds_read_b64_tr_b16 a[228:229], v41 offset:24592
    ds_read_b64_tr_b16 a[230:231], v41 offset:30736
    ds_read_b64_tr_b16 a[232:233], v41 offset:36880
    ds_read_b64_tr_b16 a[234:235], v41 offset:43024
    ds_read_b64_tr_b16 a[236:237], v41 offset:49168
    ds_read_b64_tr_b16 a[238:239], v41 offset:55312
    s_waitcnt lgkmcnt(0)
    s_barrier
    v_lshlrev_b32 v1, 4, v0
    v_and_b32 v40, 15, v0
    v_lshrrev_b32 v41, 4, v0
    s_mul_i32 s20, s26, 12
    s_mul_i32 s21, s14, 3
    s_add_u32 s20, s20, s21
    s_lshl_b32 s20, s20, 9
    v_lshlrev_b32 v2, 3, v0
    v_add_u32 v2, s20, v2
    s_lshl_b32 s20, s26, 2
    s_add_u32 s20, s20, s14
    s_lshl_b32 s20, s20, 12
    s_add_u32 s20, s20, 3072
    v_and_b32 v42, 7, v40
    v_lshlrev_b32 v163, 3, v42
    v_lshl_add_u32 v163, v41, 6, v163
    v_add_u32 v163, s20, v163
    s_lshr_b32 s20, s26, 2
    s_lshl_b32 s20, s20, 1
    s_add_u32 s20, s20, s14
    s_lshl_b32 s20, s20, 10
    s_and_b32 s21, s26, 3
    s_lshl_b32 s21, s21, 8
    s_add_u32 s20, s20, s21
    v_lshlrev_b32 v164, 4, v40
    v_lshl_add_u32 v164, v41, 3, v164
    v_add_u32 v164, s20, v164
    v_mov_b32 v43, 0xf149f2ca
    s_cmp_eq_u32 s14, 0
    s_cselect_b64 s[40:41], -1, 0
    v_lshl_add_u32 v42, v41, 2, 0
    v_cmp_gt_u32 vcc, v42, v40
    s_nop 1
    v_cndmask_b32 v44, 0, v43, vcc
    v_cndmask_b32 v152, 0, v44, s[40:41]
    v_cndmask_b32 v156, v44, v43, s[40:41]
    v_lshl_add_u32 v42, v41, 2, 1
    v_cmp_gt_u32 vcc, v42, v40
    s_nop 1
    v_cndmask_b32 v44, 0, v43, vcc
    v_cndmask_b32 v153, 0, v44, s[40:41]
    v_cndmask_b32 v157, v44, v43, s[40:41]
    v_lshl_add_u32 v42, v41, 2, 2
    v_cmp_gt_u32 vcc, v42, v40
    s_nop 1
    v_cndmask_b32 v44, 0, v43, vcc
    v_cndmask_b32 v154, 0, v44, s[40:41]
    v_cndmask_b32 v158, v44, v43, s[40:41]
    v_lshl_add_u32 v42, v41, 2, 3
    v_cmp_gt_u32 vcc, v42, v40
    s_nop 1
    v_cndmask_b32 v44, 0, v43, vcc
    v_cndmask_b32 v155, 0, v44, s[40:41]
    v_cndmask_b32 v159, v44, v43, s[40:41]
    v_cmp_lt_u32 vcc, 1, v41
    s_nop 1
    v_cndmask_b32 v160, 0, v43, vcc
    s_mul_i32 s22, s14, 10240
    s_mul_i32 s42, s14, 6144
    s_add_u32 s42, s42, 122880
    s_mul_i32 s43, s14, 3072
    s_add_u32 s43, s43, 122880
    s_lshl_b32 s44, s26, 1
    s_add_u32 s44, s44, s14
    s_lshl_b32 s44, s44, 10
    s_add_u32 s44, s44, 0x9d00000
    s_mov_b32 s45, 0x3d93cd3a
    s_mov_b32 s50, 0x3fb8aa3b
    s_mov_b32 s48, -1
    s_mov_b32 s49, 0
    s_lshl_b32 s20, s26, 5
    s_add_u32 s20, s20, s14
    s_lshl_b32 s20, s20, 2
    s_add_u32 s20, s20, 0xb20a000
    v_mov_b32 v161, s20
    s_mov_b32 s34, 0
    s_mov_b32 s35, 40960
    s_mov_b32 s36, 81920
    s_mul_i32 s23, s17, 40960
    s_add_u32 s23, s23, s22
    s_add_u32 s24, s34, s22
    s_mov_b32 m0, s24
    s_nop 0
    buffer_load_dwordx4 v1, s[4:7], s23 offen offset:0 sc1 lds
    buffer_load_dwordx4 v1, s[4:7], s23 offen offset:1024 sc1 lds
    buffer_load_dwordx4 v1, s[4:7], s23 offen offset:2048 sc1 lds
    buffer_load_dwordx4 v1, s[4:7], s23 offen offset:3072 sc1 lds
    s_add_u32 s23, s23, 4096
    s_add_u32 s24, s24, 4096
    s_mov_b32 m0, s24
    s_nop 0
    buffer_load_dwordx4 v1, s[4:7], s23 offen offset:0 sc1 lds
    buffer_load_dwordx4 v1, s[4:7], s23 offen offset:1024 sc1 lds
    buffer_load_dwordx4 v1, s[4:7], s23 offen offset:2048 sc1 lds
    buffer_load_dwordx4 v1, s[4:7], s23 offen offset:3072 sc1 lds
    s_add_u32 s23, s23, 4096
    s_add_u32 s24, s24, 4096
    s_mov_b32 m0, s24
    s_nop 0
    buffer_load_dwordx4 v1, s[4:7], s23 offen offset:0 sc1 lds
    buffer_load_dwordx4 v1, s[4:7], s23 offen offset:1024 sc1 lds
    s_add_u32 s25, s17, 1
    s_mul_i32 s23, s25, 40960
    s_add_u32 s23, s23, s22
    s_add_u32 s24, s35, s22
    s_mov_b32 m0, s24
    s_nop 0
    buffer_load_dwordx4 v1, s[4:7], s23 offen offset:0 sc1 lds
    buffer_load_dwordx4 v1, s[4:7], s23 offen offset:1024 sc1 lds
    buffer_load_dwordx4 v1, s[4:7], s23 offen offset:2048 sc1 lds
    buffer_load_dwordx4 v1, s[4:7], s23 offen offset:3072 sc1 lds
    s_add_u32 s23, s23, 4096
    s_add_u32 s24, s24, 4096
    s_mov_b32 m0, s24
    s_nop 0
    buffer_load_dwordx4 v1, s[4:7], s23 offen offset:0 sc1 lds
    buffer_load_dwordx4 v1, s[4:7], s23 offen offset:1024 sc1 lds
    buffer_load_dwordx4 v1, s[4:7], s23 offen offset:2048 sc1 lds
    buffer_load_dwordx4 v1, s[4:7], s23 offen offset:3072 sc1 lds
    s_add_u32 s23, s23, 4096
    s_add_u32 s24, s24, 4096
    s_mov_b32 m0, s24
    s_nop 0
    buffer_load_dwordx4 v1, s[4:7], s23 offen offset:0 sc1 lds
    buffer_load_dwordx4 v1, s[4:7], s23 offen offset:1024 sc1 lds
    s_waitcnt vmcnt(10)
    s_barrier
    buffer_load_dword v162, v161, s[4:7], 0 offen sc1
    s_mul_i32 s37, s17, 393216
    s_add_u32 s37, s37, 0x400000
    s_add_u32 s38, s37, 196608
    buffer_load_dwordx2 v[60:61], v2, s[4:7], s37 offen offset:0 sc1
    buffer_load_dwordx2 v[62:63], v2, s[4:7], s37 offen offset:512 sc1
    buffer_load_dwordx2 v[64:65], v2, s[4:7], s37 offen offset:1024 sc1
    buffer_load_dwordx2 v[66:67], v2, s[4:7], s38 offen offset:0 sc1
    buffer_load_dwordx2 v[68:69], v2, s[4:7], s38 offen offset:512 sc1
    buffer_load_dwordx2 v[70:71], v2, s[4:7], s38 offen offset:1024 sc1
    s_mov_b32 s54, 0
    s_add_u32 s41, s17, 1
    s_add_u32 s25, s17, 2
    s_mul_i32 s23, s25, 40960
    s_add_u32 s23, s23, s22
    s_add_u32 s24, s36, s22
    v_add_u32 v3, s34, v1
    ds_read_b128 v[8:11], v3 offset:0
    ds_read_b128 v[12:15], v3 offset:20480
    ds_read_b128 v[16:19], v3 offset:1024
    ds_read_b128 v[20:23], v3 offset:21504
    s_waitcnt lgkmcnt(3)
    v_mfma_f32_16x16x32_bf16 v[24:27], a[0:3], v[8:11], 0
    v_mfma_f32_16x16x32_bf16 v[28:31], a[80:83], v[8:11], 0
    v_mfma_f32_16x16x32_bf16 v[32:35], a[160:163], v[8:11], 0
    s_mov_b32 m0, s24
    s_nop 0
    buffer_load_dwordx4 v1, s[4:7], s23 offen offset:0 sc1 lds
    ds_read_b128 v[8:11], v3 offset:2048
    s_waitcnt lgkmcnt(3)
    v_mfma_f32_16x16x32_bf16 v[36:39], a[0:3], v[12:15], 0
    v_mfma_f32_16x16x32_bf16 v[40:43], a[80:83], v[12:15], 0
    v_mfma_f32_16x16x32_bf16 v[44:47], a[160:163], v[12:15], 0
    buffer_load_dwordx4 v1, s[4:7], s23 offen offset:1024 sc1 lds
    ds_read_b128 v[12:15], v3 offset:22528
    s_waitcnt lgkmcnt(3)
    v_mfma_f32_16x16x32_bf16 v[24:27], a[4:7], v[16:19], v[24:27]
    v_mfma_f32_16x16x32_bf16 v[28:31], a[84:87], v[16:19], v[28:31]
    v_mfma_f32_16x16x32_bf16 v[32:35], a[164:167], v[16:19], v[32:35]
    buffer_load_dwordx4 v1, s[4:7], s23 offen offset:2048 sc1 lds
    ds_read_b128 v[16:19], v3 offset:3072
    s_waitcnt lgkmcnt(3)
    v_mfma_f32_16x16x32_bf16 v[36:39], a[4:7], v[20:23], v[36:39]
    v_mfma_f32_16x16x32_bf16 v[40:43], a[84:87], v[20:23], v[40:43]
    v_mfma_f32_16x16x32_bf16 v[44:47], a[164:167], v[20:23], v[44:47]
    buffer_load_dwordx4 v1, s[4:7], s23 offen offset:3072 sc1 lds
    ds_read_b128 v[20:23], v3 offset:23552
    s_waitcnt lgkmcnt(3)
    v_mfma_f32_16x16x32_bf16 v[24:27], a[8:11], v[8:11], v[24:27]
    v_mfma_f32_16x16x32_bf16 v[28:31], a[88:91], v[8:11], v[28:31]
    v_mfma_f32_16x16x32_bf16 v[32:35], a[168:171], v[8:11], v[32:35]
    s_add_u32 s23, s23, 4096
    s_add_u32 s24, s24, 4096
    s_mov_b32 m0, s24
    s_nop 0
    buffer_load_dwordx4 v1, s[4:7], s23 offen offset:0 sc1 lds
    ds_read_b128 v[8:11], v3 offset:4096
    s_waitcnt lgkmcnt(3)
    v_mfma_f32_16x16x32_bf16 v[36:39], a[8:11], v[12:15], v[36:39]
    v_mfma_f32_16x16x32_bf16 v[40:43], a[88:91], v[12:15], v[40:43]
    v_mfma_f32_16x16x32_bf16 v[44:47], a[168:171], v[12:15], v[44:47]
    buffer_load_dwordx4 v1, s[4:7], s23 offen offset:1024 sc1 lds
    ds_read_b128 v[12:15], v3 offset:24576
    s_waitcnt lgkmcnt(3)
    v_mfma_f32_16x16x32_bf16 v[24:27], a[12:15], v[16:19], v[24:27]
    v_mfma_f32_16x16x32_bf16 v[28:31], a[92:95], v[16:19], v[28:31]
    v_mfma_f32_16x16x32_bf16 v[32:35], a[172:175], v[16:19], v[32:35]
    buffer_load_dwordx4 v1, s[4:7], s23 offen offset:2048 sc1 lds
    ds_read_b128 v[16:19], v3 offset:5120
    s_waitcnt lgkmcnt(3)
    v_mfma_f32_16x16x32_bf16 v[36:39], a[12:15], v[20:23], v[36:39]
    v_mfma_f32_16x16x32_bf16 v[40:43], a[92:95], v[20:23], v[40:43]
    v_mfma_f32_16x16x32_bf16 v[44:47], a[172:175], v[20:23], v[44:47]
    buffer_load_dwordx4 v1, s[4:7], s23 offen offset:3072 sc1 lds
    ds_read_b128 v[20:23], v3 offset:25600
    s_waitcnt lgkmcnt(3)
    v_mfma_f32_16x16x32_bf16 v[24:27], a[16:19], v[8:11], v[24:27]
    v_mfma_f32_16x16x32_bf16 v[28:31], a[96:99], v[8:11], v[28:31]
    v_mfma_f32_16x16x32_bf16 v[32:35], a[176:179], v[8:11], v[32:35]
    s_add_u32 s23, s23, 4096
    s_add_u32 s24, s24, 4096
    s_mov_b32 m0, s24
    s_nop 0
    buffer_load_dwordx4 v1, s[4:7], s23 offen offset:0 sc1 lds
    ds_read_b128 v[8:11], v3 offset:6144
    s_waitcnt lgkmcnt(3)
    v_mfma_f32_16x16x32_bf16 v[36:39], a[16:19], v[12:15], v[36:39]
    v_mfma_f32_16x16x32_bf16 v[40:43], a[96:99], v[12:15], v[40:43]
    v_mfma_f32_16x16x32_bf16 v[44:47], a[176:179], v[12:15], v[44:47]
    buffer_load_dwordx4 v1, s[4:7], s23 offen offset:1024 sc1 lds
    ds_read_b128 v[12:15], v3 offset:26624
    s_waitcnt lgkmcnt(3)
    v_mfma_f32_16x16x32_bf16 v[24:27], a[20:23], v[16:19], v[24:27]
    v_mfma_f32_16x16x32_bf16 v[28:31], a[100:103], v[16:19], v[28:31]
    v_mfma_f32_16x16x32_bf16 v[32:35], a[180:183], v[16:19], v[32:35]
    ds_read_b128 v[16:19], v3 offset:7168
    s_waitcnt lgkmcnt(3)
    v_mfma_f32_16x16x32_bf16 v[36:39], a[20:23], v[20:23], v[36:39]
    v_mfma_f32_16x16x32_bf16 v[40:43], a[100:103], v[20:23], v[40:43]
    v_mfma_f32_16x16x32_bf16 v[44:47], a[180:183], v[20:23], v[44:47]
    ds_read_b128 v[20:23], v3 offset:27648
    s_waitcnt lgkmcnt(3)
    v_mfma_f32_16x16x32_bf16 v[24:27], a[24:27], v[8:11], v[24:27]
    v_mfma_f32_16x16x32_bf16 v[28:31], a[104:107], v[8:11], v[28:31]
    v_mfma_f32_16x16x32_bf16 v[32:35], a[184:187], v[8:11], v[32:35]
    ds_read_b128 v[8:11], v3 offset:8192
    s_waitcnt lgkmcnt(3)
    v_mfma_f32_16x16x32_bf16 v[36:39], a[24:27], v[12:15], v[36:39]
    v_mfma_f32_16x16x32_bf16 v[40:43], a[104:107], v[12:15], v[40:43]
    v_mfma_f32_16x16x32_bf16 v[44:47], a[184:187], v[12:15], v[44:47]
    ds_read_b128 v[12:15], v3 offset:28672
    s_waitcnt lgkmcnt(3)
    v_mfma_f32_16x16x32_bf16 v[24:27], a[28:31], v[16:19], v[24:27]
    v_mfma_f32_16x16x32_bf16 v[28:31], a[108:111], v[16:19], v[28:31]
    v_mfma_f32_16x16x32_bf16 v[32:35], a[188:191], v[16:19], v[32:35]
    ds_read_b128 v[16:19], v3 offset:9216
    s_waitcnt lgkmcnt(3)
    v_mfma_f32_16x16x32_bf16 v[36:39], a[28:31], v[20:23], v[36:39]
    v_mfma_f32_16x16x32_bf16 v[40:43], a[108:111], v[20:23], v[40:43]
    v_mfma_f32_16x16x32_bf16 v[44:47], a[188:191], v[20:23], v[44:47]
    ds_read_b128 v[20:23], v3 offset:29696
    s_waitcnt lgkmcnt(3)
    v_mfma_f32_16x16x32_bf16 v[24:27], a[32:35], v[8:11], v[24:27]
    v_mfma_f32_16x16x32_bf16 v[28:31], a[112:115], v[8:11], v[28:31]
    v_mfma_f32_16x16x32_bf16 v[32:35], a[192:195], v[8:11], v[32:35]
    s_cmp_eq_u32 s54, 1
    s_nop 5
    s_cbranch_scc1 Lqe_50155
    s_waitcnt vmcnt(16)
    v_cmp_gt_u32 vcc, s41, v162
    s_nop 0
    s_cbranch_vccnz Lqn_50156
    s_lshl_b32 s39, s17, 19
    s_add_u32 s39, s39, 0xc000000
    buffer_load_dwordx2 v[72:73], v163, s[4:7], s39 offen offset:0 sc1
    buffer_load_dwordx2 v[74:75], v163, s[4:7], s39 offen offset:256 sc1
    buffer_load_dwordx2 v[76:77], v163, s[4:7], s39 offen offset:512 sc1
    s_mov_b32 s54, 1
Lqn_50156:
Lqe_50155:
    ds_read_b128 v[8:11], v3 offset:10240
    s_waitcnt lgkmcnt(3)
    v_mfma_f32_16x16x32_bf16 v[36:39], a[32:35], v[12:15], v[36:39]
    v_mfma_f32_16x16x32_bf16 v[40:43], a[112:115], v[12:15], v[40:43]
    v_mfma_f32_16x16x32_bf16 v[44:47], a[192:195], v[12:15], v[44:47]
    ds_read_b128 v[12:15], v3 offset:30720
    s_waitcnt lgkmcnt(3)
    v_mfma_f32_16x16x32_bf16 v[24:27], a[36:39], v[16:19], v[24:27]
    v_mfma_f32_16x16x32_bf16 v[28:31], a[116:119], v[16:19], v[28:31]
    v_mfma_f32_16x16x32_bf16 v[32:35], a[196:199], v[16:19], v[32:35]
    ds_read_b128 v[16:19], v3 offset:11264
    s_waitcnt lgkmcnt(3)
    v_mfma_f32_16x16x32_bf16 v[36:39], a[36:39], v[20:23], v[36:39]
    v_mfma_f32_16x16x32_bf16 v[40:43], a[116:119], v[20:23], v[40:43]
    v_mfma_f32_16x16x32_bf16 v[44:47], a[196:199], v[20:23], v[44:47]
    ds_read_b128 v[20:23], v3 offset:31744
    s_waitcnt lgkmcnt(3)
    v_mfma_f32_16x16x32_bf16 v[24:27], a[40:43], v[8:11], v[24:27]
    v_mfma_f32_16x16x32_bf16 v[28:31], a[120:123], v[8:11], v[28:31]
    v_mfma_f32_16x16x32_bf16 v[32:35], a[200:203], v[8:11], v[32:35]
    ds_read_b128 v[8:11], v3 offset:12288
    s_waitcnt lgkmcnt(3)
    v_mfma_f32_16x16x32_bf16 v[36:39], a[40:43], v[12:15], v[36:39]
    v_mfma_f32_16x16x32_bf16 v[40:43], a[120:123], v[12:15], v[40:43]
    v_mfma_f32_16x16x32_bf16 v[44:47], a[200:203], v[12:15], v[44:47]
    buffer_load_dword v162, v161, s[4:7], 0 offen sc1
    ds_read_b128 v[12:15], v3 offset:32768
    s_waitcnt lgkmcnt(3)
    v_mfma_f32_16x16x32_bf16 v[24:27], a[44:47], v[16:19], v[24:27]
    v_mfma_f32_16x16x32_bf16 v[28:31], a[124:127], v[16:19], v[28:31]
    v_mfma_f32_16x16x32_bf16 v[32:35], a[204:207], v[16:19], v[32:35]
    ds_read_b128 v[16:19], v3 offset:13312
    s_waitcnt lgkmcnt(3)
    v_mfma_f32_16x16x32_bf16 v[36:39], a[44:47], v[20:23], v[36:39]
    v_mfma_f32_16x16x32_bf16 v[40:43], a[124:127], v[20:23], v[40:43]
    v_mfma_f32_16x16x32_bf16 v[44:47], a[204:207], v[20:23], v[44:47]
    ds_read_b128 v[20:23], v3 offset:33792
    s_waitcnt lgkmcnt(3)
    v_mfma_f32_16x16x32_bf16 v[24:27], a[48:51], v[8:11], v[24:27]
    v_mfma_f32_16x16x32_bf16 v[28:31], a[128:131], v[8:11], v[28:31]
    v_mfma_f32_16x16x32_bf16 v[32:35], a[208:211], v[8:11], v[32:35]
    ds_read_b128 v[8:11], v3 offset:14336
    s_waitcnt lgkmcnt(3)
    v_mfma_f32_16x16x32_bf16 v[36:39], a[48:51], v[12:15], v[36:39]
    v_mfma_f32_16x16x32_bf16 v[40:43], a[128:131], v[12:15], v[40:43]
    v_mfma_f32_16x16x32_bf16 v[44:47], a[208:211], v[12:15], v[44:47]
    ds_read_b128 v[12:15], v3 offset:34816
    s_waitcnt lgkmcnt(3)
    v_mfma_f32_16x16x32_bf16 v[24:27], a[52:55], v[16:19], v[24:27]
    v_mfma_f32_16x16x32_bf16 v[28:31], a[132:135], v[16:19], v[28:31]
    v_mfma_f32_16x16x32_bf16 v[32:35], a[212:215], v[16:19], v[32:35]
    ds_read_b128 v[16:19], v3 offset:15360
    s_waitcnt lgkmcnt(3)
    v_mfma_f32_16x16x32_bf16 v[36:39], a[52:55], v[20:23], v[36:39]
    v_mfma_f32_16x16x32_bf16 v[40:43], a[132:135], v[20:23], v[40:43]
    v_mfma_f32_16x16x32_bf16 v[44:47], a[212:215], v[20:23], v[44:47]
    ds_read_b128 v[20:23], v3 offset:35840
    s_waitcnt lgkmcnt(3)
    v_mfma_f32_16x16x32_bf16 v[24:27], a[56:59], v[8:11], v[24:27]
    v_mfma_f32_16x16x32_bf16 v[28:31], a[136:139], v[8:11], v[28:31]
    v_mfma_f32_16x16x32_bf16 v[32:35], a[216:219], v[8:11], v[32:35]
    ds_read_b128 v[8:11], v3 offset:16384
    s_waitcnt lgkmcnt(3)
    v_mfma_f32_16x16x32_bf16 v[36:39], a[56:59], v[12:15], v[36:39]
    v_mfma_f32_16x16x32_bf16 v[40:43], a[136:139], v[12:15], v[40:43]
    v_mfma_f32_16x16x32_bf16 v[44:47], a[216:219], v[12:15], v[44:47]
    ds_read_b128 v[12:15], v3 offset:36864
    s_waitcnt lgkmcnt(3)
    v_mfma_f32_16x16x32_bf16 v[24:27], a[60:63], v[16:19], v[24:27]
    v_mfma_f32_16x16x32_bf16 v[28:31], a[140:143], v[16:19], v[28:31]
    v_mfma_f32_16x16x32_bf16 v[32:35], a[220:223], v[16:19], v[32:35]
    ds_read_b128 v[16:19], v3 offset:17408
    s_waitcnt lgkmcnt(3)
    v_mfma_f32_16x16x32_bf16 v[36:39], a[60:63], v[20:23], v[36:39]
    v_mfma_f32_16x16x32_bf16 v[40:43], a[140:143], v[20:23], v[40:43]
    v_mfma_f32_16x16x32_bf16 v[44:47], a[220:223], v[20:23], v[44:47]
    ds_read_b128 v[20:23], v3 offset:37888
    s_waitcnt lgkmcnt(3)
    v_mfma_f32_16x16x32_bf16 v[24:27], a[64:67], v[8:11], v[24:27]
    v_mfma_f32_16x16x32_bf16 v[28:31], a[144:147], v[8:11], v[28:31]
    v_mfma_f32_16x16x32_bf16 v[32:35], a[224:227], v[8:11], v[32:35]
    ds_read_b128 v[8:11], v3 offset:18432
    s_waitcnt lgkmcnt(3)
    v_mfma_f32_16x16x32_bf16 v[36:39], a[64:67], v[12:15], v[36:39]
    v_mfma_f32_16x16x32_bf16 v[40:43], a[144:147], v[12:15], v[40:43]
    v_mfma_f32_16x16x32_bf16 v[44:47], a[224:227], v[12:15], v[44:47]
    s_cmp_eq_u32 s54, 1
    s_nop 5
    s_cbranch_scc1 Lqe_50157
    s_waitcnt vmcnt(0)
    v_cmp_gt_u32 vcc, s41, v162
    s_nop 0
    s_cbranch_vccnz Lqn_50158
    s_lshl_b32 s39, s17, 19
    s_add_u32 s39, s39, 0xc000000
    buffer_load_dwordx2 v[72:73], v163, s[4:7], s39 offen offset:0 sc1
    buffer_load_dwordx2 v[74:75], v163, s[4:7], s39 offen offset:256 sc1
    buffer_load_dwordx2 v[76:77], v163, s[4:7], s39 offen offset:512 sc1
    s_mov_b32 s54, 1
Lqn_50158:
Lqe_50157:
    ds_read_b128 v[12:15], v3 offset:38912
    s_waitcnt lgkmcnt(3)
    v_mfma_f32_16x16x32_bf16 v[24:27], a[68:71], v[16:19], v[24:27]
    v_mfma_f32_16x16x32_bf16 v[28:31], a[148:151], v[16:19], v[28:31]
    v_mfma_f32_16x16x32_bf16 v[32:35], a[228:231], v[16:19], v[32:35]
    ds_read_b128 v[16:19], v3 offset:19456
    s_waitcnt lgkmcnt(3)
    v_mfma_f32_16x16x32_bf16 v[36:39], a[68:71], v[20:23], v[36:39]
    v_mfma_f32_16x16x32_bf16 v[40:43], a[148:151], v[20:23], v[40:43]
    v_mfma_f32_16x16x32_bf16 v[44:47], a[228:231], v[20:23], v[44:47]
    ds_read_b128 v[20:23], v3 offset:39936
    s_waitcnt lgkmcnt(3)
    v_mfma_f32_16x16x32_bf16 v[24:27], a[72:75], v[8:11], v[24:27]
    v_mfma_f32_16x16x32_bf16 v[28:31], a[152:155], v[8:11], v[28:31]
    v_mfma_f32_16x16x32_bf16 v[32:35], a[232:235], v[8:11], v[32:35]
    s_waitcnt lgkmcnt(2)
    v_mfma_f32_16x16x32_bf16 v[36:39], a[72:75], v[12:15], v[36:39]
    v_mfma_f32_16x16x32_bf16 v[40:43], a[152:155], v[12:15], v[40:43]
    v_mfma_f32_16x16x32_bf16 v[44:47], a[232:235], v[12:15], v[44:47]
    s_waitcnt lgkmcnt(1)
    v_mfma_f32_16x16x32_bf16 v[24:27], a[76:79], v[16:19], v[24:27]
    v_mfma_f32_16x16x32_bf16 v[28:31], a[156:159], v[16:19], v[28:31]
    v_mfma_f32_16x16x32_bf16 v[32:35], a[236:239], v[16:19], v[32:35]
    s_waitcnt lgkmcnt(0)
    v_mfma_f32_16x16x32_bf16 v[36:39], a[76:79], v[20:23], v[36:39]
    v_mfma_f32_16x16x32_bf16 v[40:43], a[156:159], v[20:23], v[40:43]
    v_mfma_f32_16x16x32_bf16 v[44:47], a[236:239], v[20:23], v[44:47]
    s_mov_b32 s25, s34
    s_mov_b32 s34, s35
    s_mov_b32 s35, s36
    s_mov_b32 s36, s25
    s_mul_i32 s22, s14, 6144
    s_sub_u32 s20, s14, 2
    s_mul_i32 s20, s20, 14336
    s_add_u32 s20, s20, 12288
    s_cmp_ge_u32 s14, 2
    s_cselect_b32 s22, s20, s22
Lq_loop_50151:
    v_cvt_pk_bf16_f32 v48, v24, v25
    v_cvt_pk_bf16_f32 v49, v26, v27
    v_cvt_pk_bf16_f32 v50, v28, v29
    v_cvt_pk_bf16_f32 v51, v30, v31
    v_cvt_pk_bf16_f32 v52, v32, v33
    v_cvt_pk_bf16_f32 v53, v34, v35
    v_cvt_pk_bf16_f32 v54, v36, v37
    v_cvt_pk_bf16_f32 v55, v38, v39
    v_cvt_pk_bf16_f32 v56, v40, v41
    v_cvt_pk_bf16_f32 v57, v42, v43
    v_cvt_pk_bf16_f32 v58, v44, v45
    v_cvt_pk_bf16_f32 v59, v46, v47
    s_waitcnt vmcnt(0)
    s_barrier
    s_cmp_lg_u32 s14, 0
    s_cbranch_scc1 Lsig_50159
    s_add_u32 s46, s17, 0
    v_mov_b32 v4, s46
    v_mov_b32 v5, s47
    s_mov_b64 exec, 1
    buffer_store_dword v4, v5, s[4:7], 0 offen sc1
    s_mov_b64 exec, -1
Lsig_50159:
    v_mfma_f32_16x16x16_bf16 v[80:83], v[60:61], v[48:49], 0
    v_mfma_f32_16x16x16_bf16 v[92:95], v[60:61], v[54:55], 0
    v_mfma_f32_16x16x16_bf16 v[96:99], v[66:67], v[54:55], 0
    v_mfma_f32_16x16x16_bf16 v[80:83], v[62:63], v[50:51], v[80:83]
    v_mfma_f32_16x16x16_bf16 v[92:95], v[62:63], v[56:57], v[92:95]
    v_mfma_f32_16x16x16_bf16 v[96:99], v[68:69], v[56:57], v[96:99]
    v_mfma_f32_16x16x16_bf16 v[80:83], v[64:65], v[52:53], v[80:83]
    v_mfma_f32_16x16x16_bf16 v[92:95], v[64:65], v[58:59], v[92:95]
    v_mfma_f32_16x16x16_bf16 v[96:99], v[70:71], v[58:59], v[96:99]
    v_add_u32 v3, s42, v1
    s_nop 4
    ds_write_b128 v3, v[80:83] offset:0
    ds_write_b128 v3, v[92:95] offset:3072
    ds_write_b128 v3, v[96:99] offset:4096
    s_cmp_eq_u32 s54, 1
    s_cbranch_scc1 Lqh_50160
    s_mov_b64 exec, 1
Lwp_50161:
    buffer_load_dword v162, v161, s[4:7], 0 offen sc1
    s_waitcnt vmcnt(0)
    v_cmp_gt_u32 vcc, s41, v162
    s_nop 0
    s_cbranch_vccz Lwpd_50162
    s_sleep 3
    s_add_u32 s30, s30, 1
    s_cmp_lt_u32 s30, s31
    s_cbranch_scc1 Lwp_50161
Lwpd_50162:
    s_mov_b64 exec, -1
    s_lshl_b32 s39, s17, 19
    s_add_u32 s39, s39, 0xc000000
    buffer_load_dwordx2 v[72:73], v163, s[4:7], s39 offen offset:0 sc1
    buffer_load_dwordx2 v[74:75], v163, s[4:7], s39 offen offset:256 sc1
    buffer_load_dwordx2 v[76:77], v163, s[4:7], s39 offen offset:512 sc1
    s_waitcnt vmcnt(0)
Lqh_50160:
    v_mfma_f32_16x16x16_bf16 v[88:91], v[72:73], v[48:49], 0
    v_mfma_f32_16x16x16_bf16 v[100:103], v[72:73], v[54:55], 0
    v_mfma_f32_16x16x16_bf16 v[88:91], v[74:75], v[50:51], v[88:91]
    v_mfma_f32_16x16x16_bf16 v[100:103], v[74:75], v[56:57], v[100:103]
    v_mfma_f32_16x16x16_bf16 v[88:91], v[76:77], v[52:53], v[88:91]
    v_mfma_f32_16x16x16_bf16 v[100:103], v[76:77], v[58:59], v[100:103]
    s_nop 6
    ds_write_b128 v3, v[88:91] offset:2048
    ds_write_b128 v3, v[100:103] offset:5120
    s_waitcnt lgkmcnt(0)
    s_barrier
    s_add_u32 s25, s17, 1
    s_cmp_ge_u32 s25, s18
    s_cbranch_scc1 Lq_last_50152
    s_cmp_ge_u32 s14, 2
    s_cbranch_scc1 Lq_23_50153
    v_add_u32 v3, s43, v1
    s_lshl_b32 s52, s14, 10
    v_add_u32 v166, s52, v3
    ds_read_b128 v[104:107], v3 offset:0
    ds_read_b128 v[108:111], v3 offset:6144
    ds_read_b128 v[112:115], v3 offset:12288
    ds_read_b128 v[116:119], v3 offset:18432
    ds_read_b128 v[120:123], v166 offset:0
    ds_read_b128 v[124:127], v166 offset:6144
    ds_read_b128 v[128:131], v166 offset:12288
    ds_read_b128 v[132:135], v166 offset:18432
    ds_read_b128 v[136:139], v3 offset:2048
    ds_read_b128 v[140:143], v3 offset:8192
    ds_read_b128 v[144:147], v3 offset:14336
    ds_read_b128 v[148:151], v3 offset:20480
    s_lshl_b32 s52, s17, 16
    s_add_u32 s52, s52, s44
    s_lshl_b32 s53, s17, 14
    s_add_u32 s53, s53, 0xa100000
    s_waitcnt lgkmcnt(0)
    s_add_u32 s17, s17, 1
    buffer_load_dword v162, v161, s[4:7], 0 offen sc1
    s_mul_i32 s37, s17, 393216
    s_add_u32 s37, s37, 0x400000
    s_add_u32 s38, s37, 196608
    buffer_load_dwordx2 v[60:61], v2, s[4:7], s37 offen offset:0 sc1
    buffer_load_dwordx2 v[62:63], v2, s[4:7], s37 offen offset:512 sc1
    buffer_load_dwordx2 v[64:65], v2, s[4:7], s37 offen offset:1024 sc1
    buffer_load_dwordx2 v[66:67], v2, s[4:7], s38 offen offset:0 sc1
    buffer_load_dwordx2 v[68:69], v2, s[4:7], s38 offen offset:512 sc1
    buffer_load_dwordx2 v[70:71], v2, s[4:7], s38 offen offset:1024 sc1
    s_mov_b32 s54, 0
    s_add_u32 s41, s17, 1
    s_add_u32 s25, s17, 2
    s_mul_i32 s23, s25, 40960
    s_add_u32 s23, s23, s22
    s_add_u32 s24, s36, s22
    v_add_u32 v3, s34, v1
    ds_read_b128 v[8:11], v3 offset:0
    ds_read_b128 v[12:15], v3 offset:20480
    ds_read_b128 v[16:19], v3 offset:1024
    ds_read_b128 v[20:23], v3 offset:21504
    s_waitcnt lgkmcnt(3)
    v_mfma_f32_16x16x32_bf16 v[24:27], a[0:3], v[8:11], 0
    v_add_f32 v104, v104, v108
    v_add_f32 v112, v112, v116
    v_mfma_f32_16x16x32_bf16 v[28:31], a[80:83], v[8:11], 0
    v_add_f32 v105, v105, v109
    v_add_f32 v113, v113, v117
    v_mfma_f32_16x16x32_bf16 v[32:35], a[160:163], v[8:11], 0
    v_add_f32 v106, v106, v110
    v_add_f32 v114, v114, v118
    s_mov_b32 m0, s24
    s_nop 0
    buffer_load_dwordx4 v1, s[4:7], s23 offen offset:0 sc1 lds
    ds_read_b128 v[8:11], v3 offset:2048
    s_waitcnt lgkmcnt(3)
    v_mfma_f32_16x16x32_bf16 v[36:39], a[0:3], v[12:15], 0
    v_add_f32 v107, v107, v111
    v_add_f32 v115, v115, v119
    v_mfma_f32_16x16x32_bf16 v[40:43], a[80:83], v[12:15], 0
    v_add_f32 v104, v104, v112
    v_add_f32 v105, v105, v113
    v_mfma_f32_16x16x32_bf16 v[44:47], a[160:163], v[12:15], 0
    v_add_f32 v106, v106, v114
    v_add_f32 v107, v107, v115
    buffer_load_dwordx4 v1, s[4:7], s23 offen offset:1024 sc1 lds
    ds_read_b128 v[12:15], v3 offset:22528
    s_waitcnt lgkmcnt(3)
    v_mfma_f32_16x16x32_bf16 v[24:27], a[4:7], v[16:19], v[24:27]
    v_cvt_pk_bf16_f32 v6, v104, v105
    v_lshlrev_b32 v7, 16, v6
    v_mfma_f32_16x16x32_bf16 v[28:31], a[84:87], v[16:19], v[28:31]
    v_and_b32 v6, 0xffff0000, v6
    v_mul_f32 v7, s45, v7
    v_mfma_f32_16x16x32_bf16 v[32:35], a[164:167], v[16:19], v[32:35]
    v_mul_f32 v6, s45, v6
    v_cvt_pk_bf16_f32 v6, v7, v6
    buffer_load_dwordx4 v1, s[4:7], s23 offen offset:2048 sc1 lds
    ds_read_b128 v[16:19], v3 offset:3072
    s_waitcnt lgkmcnt(3)
    v_mfma_f32_16x16x32_bf16 v[36:39], a[4:7], v[20:23], v[36:39]
    v_lshlrev_b32 v7, 16, v6
    v_and_b32 v6, 0xffff0000, v6
    v_mfma_f32_16x16x32_bf16 v[40:43], a[84:87], v[20:23], v[40:43]
    v_add_f32 v80, v7, v152
    v_add_f32 v81, v6, v153
    v_mfma_f32_16x16x32_bf16 v[44:47], a[164:167], v[20:23], v[44:47]
    v_cvt_pk_bf16_f32 v6, v106, v107
    v_lshlrev_b32 v7, 16, v6
    buffer_load_dwordx4 v1, s[4:7], s23 offen offset:3072 sc1 lds
    ds_read_b128 v[20:23], v3 offset:23552
    s_waitcnt lgkmcnt(3)
    v_mfma_f32_16x16x32_bf16 v[24:27], a[8:11], v[8:11], v[24:27]
    v_and_b32 v6, 0xffff0000, v6
    v_mul_f32 v7, s45, v7
    v_mfma_f32_16x16x32_bf16 v[28:31], a[88:91], v[8:11], v[28:31]
    v_mul_f32 v6, s45, v6
    v_cvt_pk_bf16_f32 v6, v7, v6
    v_mfma_f32_16x16x32_bf16 v[32:35], a[168:171], v[8:11], v[32:35]
    v_lshlrev_b32 v7, 16, v6
    v_and_b32 v6, 0xffff0000, v6
    s_add_u32 s23, s23, 4096
    s_add_u32 s24, s24, 4096
    s_mov_b32 m0, s24
    s_nop 0
    buffer_load_dwordx4 v1, s[4:7], s23 offen offset:0 sc1 lds
    ds_read_b128 v[8:11], v3 offset:4096
    s_waitcnt lgkmcnt(3)
    v_mfma_f32_16x16x32_bf16 v[36:39], a[8:11], v[12:15], v[36:39]
    v_add_f32 v82, v7, v154
    v_add_f32 v83, v6, v155
    v_mfma_f32_16x16x32_bf16 v[40:43], a[88:91], v[12:15], v[40:43]
    v_add_f32 v120, v120, v124
    v_add_f32 v128, v128, v132
    v_mfma_f32_16x16x32_bf16 v[44:47], a[168:171], v[12:15], v[44:47]
    v_add_f32 v121, v121, v125
    v_add_f32 v129, v129, v133
    buffer_load_dwordx4 v1, s[4:7], s23 offen offset:1024 sc1 lds
    ds_read_b128 v[12:15], v3 offset:24576
    s_waitcnt lgkmcnt(3)
    v_mfma_f32_16x16x32_bf16 v[24:27], a[12:15], v[16:19], v[24:27]
    v_add_f32 v122, v122, v126
    v_add_f32 v130, v130, v134
    v_mfma_f32_16x16x32_bf16 v[28:31], a[92:95], v[16:19], v[28:31]
    v_add_f32 v123, v123, v127
    v_add_f32 v131, v131, v135
    v_mfma_f32_16x16x32_bf16 v[32:35], a[172:175], v[16:19], v[32:35]
    v_add_f32 v120, v120, v128
    v_add_f32 v121, v121, v129
    ds_read_b128 v[16:19], v3 offset:5120
    s_waitcnt lgkmcnt(3)
    v_mfma_f32_16x16x32_bf16 v[36:39], a[12:15], v[20:23], v[36:39]
    v_add_f32 v122, v122, v130
    v_add_f32 v123, v123, v131
    v_mfma_f32_16x16x32_bf16 v[40:43], a[92:95], v[20:23], v[40:43]
    v_cvt_pk_bf16_f32 v6, v120, v121
    v_lshlrev_b32 v7, 16, v6
    v_mfma_f32_16x16x32_bf16 v[44:47], a[172:175], v[20:23], v[44:47]
    v_and_b32 v6, 0xffff0000, v6
    v_mul_f32 v7, s45, v7
    ds_read_b128 v[20:23], v3 offset:25600
    s_waitcnt lgkmcnt(3)
    v_mfma_f32_16x16x32_bf16 v[24:27], a[16:19], v[8:11], v[24:27]
    v_mul_f32 v6, s45, v6
    v_cvt_pk_bf16_f32 v6, v7, v6
    v_mfma_f32_16x16x32_bf16 v[28:31], a[96:99], v[8:11], v[28:31]
    v_lshlrev_b32 v7, 16, v6
    v_and_b32 v6, 0xffff0000, v6
    v_mfma_f32_16x16x32_bf16 v[32:35], a[176:179], v[8:11], v[32:35]
    v_add_f32 v84, v7, v156
    v_add_f32 v85, v6, v157
    ds_read_b128 v[8:11], v3 offset:6144
    s_waitcnt lgkmcnt(3)
    v_mfma_f32_16x16x32_bf16 v[36:39], a[16:19], v[12:15], v[36:39]
    v_cvt_pk_bf16_f32 v6, v122, v123
    v_lshlrev_b32 v7, 16, v6
    v_mfma_f32_16x16x32_bf16 v[40:43], a[96:99], v[12:15], v[40:43]
    v_and_b32 v6, 0xffff0000, v6
    v_mul_f32 v7, s45, v7
    v_mfma_f32_16x16x32_bf16 v[44:47], a[176:179], v[12:15], v[44:47]
    v_mul_f32 v6, s45, v6
    v_cvt_pk_bf16_f32 v6, v7, v6
    ds_read_b128 v[12:15], v3 offset:26624
    s_waitcnt lgkmcnt(3)
    v_mfma_f32_16x16x32_bf16 v[24:27], a[20:23], v[16:19], v[24:27]
    v_lshlrev_b32 v7, 16, v6
    v_and_b32 v6, 0xffff0000, v6
    v_mfma_f32_16x16x32_bf16 v[28:31], a[100:103], v[16:19], v[28:31]
    v_add_f32 v86, v7, v158
    v_add_f32 v87, v6, v159
    v_mfma_f32_16x16x32_bf16 v[32:35], a[180:183], v[16:19], v[32:35]
    v_add_f32 v136, v136, v140
    v_add_f32 v144, v144, v148
    ds_read_b128 v[16:19], v3 offset:7168
    s_waitcnt lgkmcnt(3)
    v_mfma_f32_16x16x32_bf16 v[36:39], a[20:23], v[20:23], v[36:39]
    v_add_f32 v137, v137, v141
    v_add_f32 v145, v145, v149
    v_mfma_f32_16x16x32_bf16 v[40:43], a[100:103], v[20:23], v[40:43]
    v_add_f32 v138, v138, v142
    v_add_f32 v146, v146, v150
    v_mfma_f32_16x16x32_bf16 v[44:47], a[180:183], v[20:23], v[44:47]
    v_add_f32 v139, v139, v143
    v_add_f32 v147, v147, v151
    ds_read_b128 v[20:23], v3 offset:27648
    s_waitcnt lgkmcnt(3)
    v_mfma_f32_16x16x32_bf16 v[24:27], a[24:27], v[8:11], v[24:27]
    v_add_f32 v136, v136, v144
    v_add_f32 v137, v137, v145
    v_mfma_f32_16x16x32_bf16 v[28:31], a[104:107], v[8:11], v[28:31]
    v_add_f32 v138, v138, v146
    v_add_f32 v139, v139, v147
    v_mfma_f32_16x16x32_bf16 v[32:35], a[184:187], v[8:11], v[32:35]
    v_cvt_pk_bf16_f32 v6, v136, v137
    v_lshlrev_b32 v7, 16, v6
    ds_read_b128 v[8:11], v3 offset:8192
    s_waitcnt lgkmcnt(3)
    v_mfma_f32_16x16x32_bf16 v[36:39], a[24:27], v[12:15], v[36:39]
    v_and_b32 v6, 0xffff0000, v6
    v_mul_f32 v7, s45, v7
    v_mfma_f32_16x16x32_bf16 v[40:43], a[104:107], v[12:15], v[40:43]
    v_mul_f32 v6, s45, v6
    v_cvt_pk_bf16_f32 v6, v7, v6
    v_mfma_f32_16x16x32_bf16 v[44:47], a[184:187], v[12:15], v[44:47]
    v_lshlrev_b32 v7, 16, v6
    v_and_b32 v6, 0xffff0000, v6
    ds_read_b128 v[12:15], v3 offset:28672
    s_waitcnt lgkmcnt(3)
    v_mfma_f32_16x16x32_bf16 v[24:27], a[28:31], v[16:19], v[24:27]
    v_add_f32 v88, v7, v160
    v_add_f32 v89, v6, v160
    v_mfma_f32_16x16x32_bf16 v[28:31], a[108:111], v[16:19], v[28:31]
    v_cvt_pk_bf16_f32 v6, v138, v139
    v_lshlrev_b32 v7, 16, v6
    v_mfma_f32_16x16x32_bf16 v[32:35], a[188:191], v[16:19], v[32:35]
    v_and_b32 v6, 0xffff0000, v6
    v_mul_f32 v7, s45, v7
    ds_read_b128 v[16:19], v3 offset:9216
    s_waitcnt lgkmcnt(3)
    v_mfma_f32_16x16x32_bf16 v[36:39], a[28:31], v[20:23], v[36:39]
    v_mul_f32 v6, s45, v6
    v_cvt_pk_bf16_f32 v6, v7, v6
    v_mfma_f32_16x16x32_bf16 v[40:43], a[108:111], v[20:23], v[40:43]
    v_lshlrev_b32 v7, 16, v6
    v_and_b32 v6, 0xffff0000, v6
    v_mfma_f32_16x16x32_bf16 v[44:47], a[188:191], v[20:23], v[44:47]
    v_add_f32 v90, v7, v160
    v_add_f32 v91, v6, v160
    ds_read_b128 v[20:23], v3 offset:29696
    s_waitcnt lgkmcnt(3)
    v_mfma_f32_16x16x32_bf16 v[24:27], a[32:35], v[8:11], v[24:27]
    v_max3_f32 v6, v80, v81, v82
    v_max3_f32 v6, v6, v83, v84
    v_mfma_f32_16x16x32_bf16 v[28:31], a[112:115], v[8:11], v[28:31]
    v_max3_f32 v6, v6, v85, v86
    v_max3_f32 v6, v6, v87, v88
    v_mfma_f32_16x16x32_bf16 v[32:35], a[192:195], v[8:11], v[32:35]
    v_max3_f32 v6, v6, v89, v90
    v_max_f32 v6, v6, v91
    s_cmp_eq_u32 s54, 1
    s_nop 3
    s_cbranch_scc1 Lqe_50163
    s_waitcnt vmcnt(12)
    v_cmp_gt_u32 vcc, s41, v162
    s_nop 0
    s_cbranch_vccnz Lqn_50164
    s_lshl_b32 s39, s17, 19
    s_add_u32 s39, s39, 0xc000000
    buffer_load_dwordx2 v[72:73], v163, s[4:7], s39 offen offset:0 sc1
    buffer_load_dwordx2 v[74:75], v163, s[4:7], s39 offen offset:256 sc1
    buffer_load_dwordx2 v[76:77], v163, s[4:7], s39 offen offset:512 sc1
    s_mov_b32 s54, 1
Lqn_50164:
Lqe_50163:
    ds_read_b128 v[8:11], v3 offset:10240
    s_waitcnt lgkmcnt(3)
    v_mfma_f32_16x16x32_bf16 v[36:39], a[32:35], v[12:15], v[36:39]
    v_mov_b32 v7, v6
    s_nop 1
    v_permlane16_swap_b32 v6, v7
    v_mfma_f32_16x16x32_bf16 v[40:43], a[112:115], v[12:15], v[40:43]
    v_max_f32 v6, v6, v7
    v_mov_b32 v7, v6
    v_mfma_f32_16x16x32_bf16 v[44:47], a[192:195], v[12:15], v[44:47]
    s_nop 0
    v_permlane32_swap_b32 v6, v7
    v_max_f32 v6, v6, v7
    ds_read_b128 v[12:15], v3 offset:30720
    s_waitcnt lgkmcnt(3)
    v_mfma_f32_16x16x32_bf16 v[24:27], a[36:39], v[16:19], v[24:27]
    v_sub_f32 v80, v80, v6
    v_mul_f32 v80, s50, v80
    v_mfma_f32_16x16x32_bf16 v[28:31], a[116:119], v[16:19], v[28:31]
    v_exp_f32 v80, v80
    v_sub_f32 v81, v81, v6
    v_mfma_f32_16x16x32_bf16 v[32:35], a[196:199], v[16:19], v[32:35]
    v_mul_f32 v81, s50, v81
    v_exp_f32 v81, v81
    ds_read_b128 v[16:19], v3 offset:11264
    s_waitcnt lgkmcnt(3)
    v_mfma_f32_16x16x32_bf16 v[36:39], a[36:39], v[20:23], v[36:39]
    v_sub_f32 v82, v82, v6
    v_mul_f32 v82, s50, v82
    v_mfma_f32_16x16x32_bf16 v[40:43], a[116:119], v[20:23], v[40:43]
    v_exp_f32 v82, v82
    v_sub_f32 v83, v83, v6
    v_mfma_f32_16x16x32_bf16 v[44:47], a[196:199], v[20:23], v[44:47]
    v_mul_f32 v83, s50, v83
    v_exp_f32 v83, v83
    ds_read_b128 v[20:23], v3 offset:31744
    s_waitcnt lgkmcnt(3)
    v_mfma_f32_16x16x32_bf16 v[24:27], a[40:43], v[8:11], v[24:27]
    v_sub_f32 v84, v84, v6
    v_mul_f32 v84, s50, v84
    v_mfma_f32_16x16x32_bf16 v[28:31], a[120:123], v[8:11], v[28:31]
    v_exp_f32 v84, v84
    v_sub_f32 v85, v85, v6
    v_mfma_f32_16x16x32_bf16 v[32:35], a[200:203], v[8:11], v[32:35]
    v_mul_f32 v85, s50, v85
    v_exp_f32 v85, v85
    ds_read_b128 v[8:11], v3 offset:12288
    s_waitcnt lgkmcnt(3)
    v_mfma_f32_16x16x32_bf16 v[36:39], a[40:43], v[12:15], v[36:39]
    v_sub_f32 v86, v86, v6
    v_mul_f32 v86, s50, v86
    v_mfma_f32_16x16x32_bf16 v[40:43], a[120:123], v[12:15], v[40:43]
    v_exp_f32 v86, v86
    v_sub_f32 v87, v87, v6
    v_mfma_f32_16x16x32_bf16 v[44:47], a[200:203], v[12:15], v[44:47]
    v_mul_f32 v87, s50, v87
    v_exp_f32 v87, v87
    buffer_load_dword v162, v161, s[4:7], 0 offen sc1
    ds_read_b128 v[12:15], v3 offset:32768
    s_waitcnt lgkmcnt(3)
    v_mfma_f32_16x16x32_bf16 v[24:27], a[44:47], v[16:19], v[24:27]
    v_sub_f32 v88, v88, v6
    v_mul_f32 v88, s50, v88
    v_mfma_f32_16x16x32_bf16 v[28:31], a[124:127], v[16:19], v[28:31]
    v_exp_f32 v88, v88
    v_sub_f32 v89, v89, v6
    v_mfma_f32_16x16x32_bf16 v[32:35], a[204:207], v[16:19], v[32:35]
    v_mul_f32 v89, s50, v89
    v_exp_f32 v89, v89
    ds_read_b128 v[16:19], v3 offset:13312
    s_waitcnt lgkmcnt(3)
    v_mfma_f32_16x16x32_bf16 v[36:39], a[44:47], v[20:23], v[36:39]
    v_sub_f32 v90, v90, v6
    v_mul_f32 v90, s50, v90
    v_mfma_f32_16x16x32_bf16 v[40:43], a[124:127], v[20:23], v[40:43]
    v_exp_f32 v90, v90
    v_sub_f32 v91, v91, v6
    v_mfma_f32_16x16x32_bf16 v[44:47], a[204:207], v[20:23], v[44:47]
    v_mul_f32 v91, s50, v91
    v_exp_f32 v91, v91
    ds_read_b128 v[20:23], v3 offset:33792
    s_waitcnt lgkmcnt(3)
    v_mfma_f32_16x16x32_bf16 v[24:27], a[48:51], v[8:11], v[24:27]
    v_add_f32 v6, v80, v81
    v_add_f32 v6, v6, v82
    v_mfma_f32_16x16x32_bf16 v[28:31], a[128:131], v[8:11], v[28:31]
    v_add_f32 v6, v6, v83
    v_add_f32 v6, v6, v84
    v_mfma_f32_16x16x32_bf16 v[32:35], a[208:211], v[8:11], v[32:35]
    v_add_f32 v6, v6, v85
    v_add_f32 v6, v6, v86
    ds_read_b128 v[8:11], v3 offset:14336
    s_waitcnt lgkmcnt(3)
    v_mfma_f32_16x16x32_bf16 v[36:39], a[48:51], v[12:15], v[36:39]
    v_add_f32 v6, v6, v87
    v_add_f32 v6, v6, v88
    v_mfma_f32_16x16x32_bf16 v[40:43], a[128:131], v[12:15], v[40:43]
    v_add_f32 v6, v6, v89
    v_add_f32 v6, v6, v90
    v_mfma_f32_16x16x32_bf16 v[44:47], a[208:211], v[12:15], v[44:47]
    v_add_f32 v6, v6, v91
    v_mov_b32 v7, v6
    ds_read_b128 v[12:15], v3 offset:34816
    s_waitcnt lgkmcnt(3)
    v_mfma_f32_16x16x32_bf16 v[24:27], a[52:55], v[16:19], v[24:27]
    v_permlane16_swap_b32 v6, v7
    v_add_f32 v6, v6, v7
    v_mfma_f32_16x16x32_bf16 v[28:31], a[132:135], v[16:19], v[28:31]
    v_mov_b32 v7, v6
    s_nop 1
    v_permlane32_swap_b32 v6, v7
    v_mfma_f32_16x16x32_bf16 v[32:35], a[212:215], v[16:19], v[32:35]
    v_add_f32 v6, v6, v7
    v_rcp_f32 v6, v6
    ds_read_b128 v[16:19], v3 offset:15360
    s_waitcnt lgkmcnt(3)
    v_mfma_f32_16x16x32_bf16 v[36:39], a[52:55], v[20:23], v[36:39]
    v_mul_f32 v80, v80, v6
    v_mul_f32 v81, v81, v6
    v_mfma_f32_16x16x32_bf16 v[40:43], a[132:135], v[20:23], v[40:43]
    v_mul_f32 v82, v82, v6
    v_mul_f32 v83, v83, v6
    v_mfma_f32_16x16x32_bf16 v[44:47], a[212:215], v[20:23], v[44:47]
    v_mul_f32 v84, v84, v6
    v_mul_f32 v85, v85, v6
    ds_read_b128 v[20:23], v3 offset:35840
    s_waitcnt lgkmcnt(3)
    v_mfma_f32_16x16x32_bf16 v[24:27], a[56:59], v[8:11], v[24:27]
    v_mul_f32 v86, v86, v6
    v_mul_f32 v87, v87, v6
    v_mfma_f32_16x16x32_bf16 v[28:31], a[136:139], v[8:11], v[28:31]
    v_mul_f32 v88, v88, v6
    v_mul_f32 v89, v89, v6
    v_mfma_f32_16x16x32_bf16 v[32:35], a[216:219], v[8:11], v[32:35]
    v_mul_f32 v90, v90, v6
    v_mul_f32 v91, v91, v6
    ds_read_b128 v[8:11], v3 offset:16384
    s_waitcnt lgkmcnt(3)
    v_mfma_f32_16x16x32_bf16 v[36:39], a[56:59], v[12:15], v[36:39]
    v_cvt_pk_bf16_f32 v104, v80, v81
    v_cvt_pk_bf16_f32 v105, v82, v83
    v_mfma_f32_16x16x32_bf16 v[40:43], a[136:139], v[12:15], v[40:43]
    v_cvt_pk_bf16_f32 v106, v84, v85
    v_cvt_pk_bf16_f32 v107, v86, v87
    v_mfma_f32_16x16x32_bf16 v[44:47], a[216:219], v[12:15], v[44:47]
    v_cvt_pk_bf16_f32 v108, v88, v89
    v_cvt_pk_bf16_f32 v109, v90, v91
    ds_read_b128 v[12:15], v3 offset:36864
    s_waitcnt lgkmcnt(3)
    v_mfma_f32_16x16x32_bf16 v[24:27], a[60:63], v[16:19], v[24:27]
    buffer_store_dwordx4 v[104:107], v1, s[4:7], s52 offen sc1
    s_mov_b64 exec, s[48:49]
    buffer_store_dwordx2 v[108:109], v164, s[4:7], s53 offen sc1
    s_mov_b64 exec, -1
    v_mfma_f32_16x16x32_bf16 v[28:31], a[140:143], v[16:19], v[28:31]
    v_mfma_f32_16x16x32_bf16 v[32:35], a[220:223], v[16:19], v[32:35]
    ds_read_b128 v[16:19], v3 offset:17408
    s_waitcnt lgkmcnt(3)
    v_mfma_f32_16x16x32_bf16 v[36:39], a[60:63], v[20:23], v[36:39]
    v_mfma_f32_16x16x32_bf16 v[40:43], a[140:143], v[20:23], v[40:43]
    v_mfma_f32_16x16x32_bf16 v[44:47], a[220:223], v[20:23], v[44:47]
    ds_read_b128 v[20:23], v3 offset:37888
    s_waitcnt lgkmcnt(3)
    v_mfma_f32_16x16x32_bf16 v[24:27], a[64:67], v[8:11], v[24:27]
    v_mfma_f32_16x16x32_bf16 v[28:31], a[144:147], v[8:11], v[28:31]
    v_mfma_f32_16x16x32_bf16 v[32:35], a[224:227], v[8:11], v[32:35]
    ds_read_b128 v[8:11], v3 offset:18432
    s_waitcnt lgkmcnt(3)
    v_mfma_f32_16x16x32_bf16 v[36:39], a[64:67], v[12:15], v[36:39]
    v_mfma_f32_16x16x32_bf16 v[40:43], a[144:147], v[12:15], v[40:43]
    v_mfma_f32_16x16x32_bf16 v[44:47], a[224:227], v[12:15], v[44:47]
    s_cmp_eq_u32 s54, 1
    s_nop 5
    s_cbranch_scc1 Lqe_50165
    s_waitcnt vmcnt(0)
    v_cmp_gt_u32 vcc, s41, v162
    s_nop 0
    s_cbranch_vccnz Lqn_50166
    s_lshl_b32 s39, s17, 19
    s_add_u32 s39, s39, 0xc000000
    buffer_load_dwordx2 v[72:73], v163, s[4:7], s39 offen offset:0 sc1
    buffer_load_dwordx2 v[74:75], v163, s[4:7], s39 offen offset:256 sc1
    buffer_load_dwordx2 v[76:77], v163, s[4:7], s39 offen offset:512 sc1
    s_mov_b32 s54, 1
Lqn_50166:
Lqe_50165:
    ds_read_b128 v[12:15], v3 offset:38912
    s_waitcnt lgkmcnt(3)
    v_mfma_f32_16x16x32_bf16 v[24:27], a[68:71], v[16:19], v[24:27]
    v_mfma_f32_16x16x32_bf16 v[28:31], a[148:151], v[16:19], v[28:31]
    v_mfma_f32_16x16x32_bf16 v[32:35], a[228:231], v[16:19], v[32:35]
    ds_read_b128 v[16:19], v3 offset:19456
    s_waitcnt lgkmcnt(3)
    v_mfma_f32_16x16x32_bf16 v[36:39], a[68:71], v[20:23], v[36:39]
    v_mfma_f32_16x16x32_bf16 v[40:43], a[148:151], v[20:23], v[40:43]
    v_mfma_f32_16x16x32_bf16 v[44:47], a[228:231], v[20:23], v[44:47]
    ds_read_b128 v[20:23], v3 offset:39936
    s_waitcnt lgkmcnt(3)
    v_mfma_f32_16x16x32_bf16 v[24:27], a[72:75], v[8:11], v[24:27]
    v_mfma_f32_16x16x32_bf16 v[28:31], a[152:155], v[8:11], v[28:31]
    v_mfma_f32_16x16x32_bf16 v[32:35], a[232:235], v[8:11], v[32:35]
    s_waitcnt lgkmcnt(2)
    v_mfma_f32_16x16x32_bf16 v[36:39], a[72:75], v[12:15], v[36:39]
    v_mfma_f32_16x16x32_bf16 v[40:43], a[152:155], v[12:15], v[40:43]
    v_mfma_f32_16x16x32_bf16 v[44:47], a[232:235], v[12:15], v[44:47]
    s_waitcnt lgkmcnt(1)
    v_mfma_f32_16x16x32_bf16 v[24:27], a[76:79], v[16:19], v[24:27]
    v_mfma_f32_16x16x32_bf16 v[28:31], a[156:159], v[16:19], v[28:31]
    v_mfma_f32_16x16x32_bf16 v[32:35], a[236:239], v[16:19], v[32:35]
    s_waitcnt lgkmcnt(0)
    v_mfma_f32_16x16x32_bf16 v[36:39], a[76:79], v[20:23], v[36:39]
    v_mfma_f32_16x16x32_bf16 v[40:43], a[156:159], v[20:23], v[40:43]
    v_mfma_f32_16x16x32_bf16 v[44:47], a[236:239], v[20:23], v[44:47]
    s_mov_b32 s25, s34
    s_mov_b32 s34, s35
    s_mov_b32 s35, s36
    s_mov_b32 s36, s25
    s_nop 2
    s_branch Lq_loop_50151
Lq_23_50153:
    s_add_u32 s17, s17, 1
    buffer_load_dword v162, v161, s[4:7], 0 offen sc1
    s_mul_i32 s37, s17, 393216
    s_add_u32 s37, s37, 0x400000
    s_add_u32 s38, s37, 196608
    buffer_load_dwordx2 v[60:61], v2, s[4:7], s37 offen offset:0 sc1
    buffer_load_dwordx2 v[62:63], v2, s[4:7], s37 offen offset:512 sc1
    buffer_load_dwordx2 v[64:65], v2, s[4:7], s37 offen offset:1024 sc1
    buffer_load_dwordx2 v[66:67], v2, s[4:7], s38 offen offset:0 sc1
    buffer_load_dwordx2 v[68:69], v2, s[4:7], s38 offen offset:512 sc1
    buffer_load_dwordx2 v[70:71], v2, s[4:7], s38 offen offset:1024 sc1
    s_mov_b32 s54, 0
    s_add_u32 s41, s17, 1
    s_add_u32 s25, s17, 2
    s_mul_i32 s23, s25, 40960
    s_add_u32 s23, s23, s22
    s_add_u32 s24, s36, s22
    v_add_u32 v3, s34, v1
    ds_read_b128 v[8:11], v3 offset:0
    ds_read_b128 v[12:15], v3 offset:20480
    ds_read_b128 v[16:19], v3 offset:1024
    ds_read_b128 v[20:23], v3 offset:21504
    s_waitcnt lgkmcnt(3)
    v_mfma_f32_16x16x32_bf16 v[24:27], a[0:3], v[8:11], 0
    v_mfma_f32_16x16x32_bf16 v[28:31], a[80:83], v[8:11], 0
    v_mfma_f32_16x16x32_bf16 v[32:35], a[160:163], v[8:11], 0
    s_mov_b32 m0, s24
    s_nop 0
    buffer_load_dwordx4 v1, s[4:7], s23 offen offset:0 sc1 lds
    ds_read_b128 v[8:11], v3 offset:2048
    s_waitcnt lgkmcnt(3)
    v_mfma_f32_16x16x32_bf16 v[36:39], a[0:3], v[12:15], 0
    v_mfma_f32_16x16x32_bf16 v[40:43], a[80:83], v[12:15], 0
    v_mfma_f32_16x16x32_bf16 v[44:47], a[160:163], v[12:15], 0
    buffer_load_dwordx4 v1, s[4:7], s23 offen offset:1024 sc1 lds
    ds_read_b128 v[12:15], v3 offset:22528
    s_waitcnt lgkmcnt(3)
    v_mfma_f32_16x16x32_bf16 v[24:27], a[4:7], v[16:19], v[24:27]
    v_mfma_f32_16x16x32_bf16 v[28:31], a[84:87], v[16:19], v[28:31]
    v_mfma_f32_16x16x32_bf16 v[32:35], a[164:167], v[16:19], v[32:35]
    buffer_load_dwordx4 v1, s[4:7], s23 offen offset:2048 sc1 lds
    ds_read_b128 v[16:19], v3 offset:3072
    s_waitcnt lgkmcnt(3)
    v_mfma_f32_16x16x32_bf16 v[36:39], a[4:7], v[20:23], v[36:39]
    v_mfma_f32_16x16x32_bf16 v[40:43], a[84:87], v[20:23], v[40:43]
    v_mfma_f32_16x16x32_bf16 v[44:47], a[164:167], v[20:23], v[44:47]
    buffer_load_dwordx4 v1, s[4:7], s23 offen offset:3072 sc1 lds
    ds_read_b128 v[20:23], v3 offset:23552
    s_waitcnt lgkmcnt(3)
    v_mfma_f32_16x16x32_bf16 v[24:27], a[8:11], v[8:11], v[24:27]
    v_mfma_f32_16x16x32_bf16 v[28:31], a[88:91], v[8:11], v[28:31]
    v_mfma_f32_16x16x32_bf16 v[32:35], a[168:171], v[8:11], v[32:35]
    s_add_u32 s23, s23, 4096
    s_add_u32 s24, s24, 4096
    s_mov_b32 m0, s24
    s_nop 0
    buffer_load_dwordx4 v1, s[4:7], s23 offen offset:0 sc1 lds
    ds_read_b128 v[8:11], v3 offset:4096
    s_waitcnt lgkmcnt(3)
    v_mfma_f32_16x16x32_bf16 v[36:39], a[8:11], v[12:15], v[36:39]
    v_mfma_f32_16x16x32_bf16 v[40:43], a[88:91], v[12:15], v[40:43]
    v_mfma_f32_16x16x32_bf16 v[44:47], a[168:171], v[12:15], v[44:47]
    buffer_load_dwordx4 v1, s[4:7], s23 offen offset:1024 sc1 lds
    ds_read_b128 v[12:15], v3 offset:24576
    s_waitcnt lgkmcnt(3)
    v_mfma_f32_16x16x32_bf16 v[24:27], a[12:15], v[16:19], v[24:27]
    v_mfma_f32_16x16x32_bf16 v[28:31], a[92:95], v[16:19], v[28:31]
    v_mfma_f32_16x16x32_bf16 v[32:35], a[172:175], v[16:19], v[32:35]
    buffer_load_dwordx4 v1, s[4:7], s23 offen offset:2048 sc1 lds
    ds_read_b128 v[16:19], v3 offset:5120
    s_waitcnt lgkmcnt(3)
    v_mfma_f32_16x16x32_bf16 v[36:39], a[12:15], v[20:23], v[36:39]
    v_mfma_f32_16x16x32_bf16 v[40:43], a[92:95], v[20:23], v[40:43]
    v_mfma_f32_16x16x32_bf16 v[44:47], a[172:175], v[20:23], v[44:47]
    buffer_load_dwordx4 v1, s[4:7], s23 offen offset:3072 sc1 lds
    ds_read_b128 v[20:23], v3 offset:25600
    s_waitcnt lgkmcnt(3)
    v_mfma_f32_16x16x32_bf16 v[24:27], a[16:19], v[8:11], v[24:27]
    v_mfma_f32_16x16x32_bf16 v[28:31], a[96:99], v[8:11], v[28:31]
    v_mfma_f32_16x16x32_bf16 v[32:35], a[176:179], v[8:11], v[32:35]
    s_add_u32 s23, s23, 4096
    s_add_u32 s24, s24, 4096
    s_mov_b32 m0, s24
    s_nop 0
    buffer_load_dwordx4 v1, s[4:7], s23 offen offset:0 sc1 lds
    ds_read_b128 v[8:11], v3 offset:6144
    s_waitcnt lgkmcnt(3)
    v_mfma_f32_16x16x32_bf16 v[36:39], a[16:19], v[12:15], v[36:39]
    v_mfma_f32_16x16x32_bf16 v[40:43], a[96:99], v[12:15], v[40:43]
    v_mfma_f32_16x16x32_bf16 v[44:47], a[176:179], v[12:15], v[44:47]
    buffer_load_dwordx4 v1, s[4:7], s23 offen offset:1024 sc1 lds
    ds_read_b128 v[12:15], v3 offset:26624
    s_waitcnt lgkmcnt(3)
    v_mfma_f32_16x16x32_bf16 v[24:27], a[20:23], v[16:19], v[24:27]
    v_mfma_f32_16x16x32_bf16 v[28:31], a[100:103], v[16:19], v[28:31]
    v_mfma_f32_16x16x32_bf16 v[32:35], a[180:183], v[16:19], v[32:35]
    buffer_load_dwordx4 v1, s[4:7], s23 offen offset:2048 sc1 lds
    ds_read_b128 v[16:19], v3 offset:7168
    s_waitcnt lgkmcnt(3)
    v_mfma_f32_16x16x32_bf16 v[36:39], a[20:23], v[20:23], v[36:39]
    v_mfma_f32_16x16x32_bf16 v[40:43], a[100:103], v[20:23], v[40:43]
    v_mfma_f32_16x16x32_bf16 v[44:47], a[180:183], v[20:23], v[44:47]
    buffer_load_dwordx4 v1, s[4:7], s23 offen offset:3072 sc1 lds
    ds_read_b128 v[20:23], v3 offset:27648
    s_waitcnt lgkmcnt(3)
    v_mfma_f32_16x16x32_bf16 v[24:27], a[24:27], v[8:11], v[24:27]
    v_mfma_f32_16x16x32_bf16 v[28:31], a[104:107], v[8:11], v[28:31]
    v_mfma_f32_16x16x32_bf16 v[32:35], a[184:187], v[8:11], v[32:35]
    s_add_u32 s23, s23, 4096
    s_add_u32 s24, s24, 4096
    s_mov_b32 m0, s24
    s_nop 0
    buffer_load_dwordx4 v1, s[4:7], s23 offen offset:0 sc1 lds
    ds_read_b128 v[8:11], v3 offset:8192
    s_waitcnt lgkmcnt(3)
    v_mfma_f32_16x16x32_bf16 v[36:39], a[24:27], v[12:15], v[36:39]
    v_mfma_f32_16x16x32_bf16 v[40:43], a[104:107], v[12:15], v[40:43]
    v_mfma_f32_16x16x32_bf16 v[44:47], a[184:187], v[12:15], v[44:47]
    buffer_load_dwordx4 v1, s[4:7], s23 offen offset:1024 sc1 lds
    ds_read_b128 v[12:15], v3 offset:28672
    s_waitcnt lgkmcnt(3)
    v_mfma_f32_16x16x32_bf16 v[24:27], a[28:31], v[16:19], v[24:27]
    v_mfma_f32_16x16x32_bf16 v[28:31], a[108:111], v[16:19], v[28:31]
    v_mfma_f32_16x16x32_bf16 v[32:35], a[188:191], v[16:19], v[32:35]
    ds_read_b128 v[16:19], v3 offset:9216
    s_waitcnt lgkmcnt(3)
    v_mfma_f32_16x16x32_bf16 v[36:39], a[28:31], v[20:23], v[36:39]
    v_mfma_f32_16x16x32_bf16 v[40:43], a[108:111], v[20:23], v[40:43]
    v_mfma_f32_16x16x32_bf16 v[44:47], a[188:191], v[20:23], v[44:47]
    ds_read_b128 v[20:23], v3 offset:29696
    s_waitcnt lgkmcnt(3)
    v_mfma_f32_16x16x32_bf16 v[24:27], a[32:35], v[8:11], v[24:27]
    v_mfma_f32_16x16x32_bf16 v[28:31], a[112:115], v[8:11], v[28:31]
    v_mfma_f32_16x16x32_bf16 v[32:35], a[192:195], v[8:11], v[32:35]
    s_cmp_eq_u32 s54, 1
    s_nop 5
    s_cbranch_scc1 Lqe_50167
    s_waitcnt vmcnt(20)
    v_cmp_gt_u32 vcc, s41, v162
    s_nop 0
    s_cbranch_vccnz Lqn_50168
    s_lshl_b32 s39, s17, 19
    s_add_u32 s39, s39, 0xc000000
    buffer_load_dwordx2 v[72:73], v163, s[4:7], s39 offen offset:0 sc1
    buffer_load_dwordx2 v[74:75], v163, s[4:7], s39 offen offset:256 sc1
    buffer_load_dwordx2 v[76:77], v163, s[4:7], s39 offen offset:512 sc1
    s_mov_b32 s54, 1
Lqn_50168:
Lqe_50167:
    ds_read_b128 v[8:11], v3 offset:10240
    s_waitcnt lgkmcnt(3)
    v_mfma_f32_16x16x32_bf16 v[36:39], a[32:35], v[12:15], v[36:39]
    v_mfma_f32_16x16x32_bf16 v[40:43], a[112:115], v[12:15], v[40:43]
    v_mfma_f32_16x16x32_bf16 v[44:47], a[192:195], v[12:15], v[44:47]
    ds_read_b128 v[12:15], v3 offset:30720
    s_waitcnt lgkmcnt(3)
    v_mfma_f32_16x16x32_bf16 v[24:27], a[36:39], v[16:19], v[24:27]
    v_mfma_f32_16x16x32_bf16 v[28:31], a[116:119], v[16:19], v[28:31]
    v_mfma_f32_16x16x32_bf16 v[32:35], a[196:199], v[16:19], v[32:35]
    ds_read_b128 v[16:19], v3 offset:11264
    s_waitcnt lgkmcnt(3)
    v_mfma_f32_16x16x32_bf16 v[36:39], a[36:39], v[20:23], v[36:39]
    v_mfma_f32_16x16x32_bf16 v[40:43], a[116:119], v[20:23], v[40:43]
    v_mfma_f32_16x16x32_bf16 v[44:47], a[196:199], v[20:23], v[44:47]
    ds_read_b128 v[20:23], v3 offset:31744
    s_waitcnt lgkmcnt(3)
    v_mfma_f32_16x16x32_bf16 v[24:27], a[40:43], v[8:11], v[24:27]
    v_mfma_f32_16x16x32_bf16 v[28:31], a[120:123], v[8:11], v[28:31]
    v_mfma_f32_16x16x32_bf16 v[32:35], a[200:203], v[8:11], v[32:35]
    ds_read_b128 v[8:11], v3 offset:12288
    s_waitcnt lgkmcnt(3)
    v_mfma_f32_16x16x32_bf16 v[36:39], a[40:43], v[12:15], v[36:39]
    v_mfma_f32_16x16x32_bf16 v[40:43], a[120:123], v[12:15], v[40:43]
    v_mfma_f32_16x16x32_bf16 v[44:47], a[200:203], v[12:15], v[44:47]
    buffer_load_dword v162, v161, s[4:7], 0 offen sc1
    ds_read_b128 v[12:15], v3 offset:32768
    s_waitcnt lgkmcnt(3)
    v_mfma_f32_16x16x32_bf16 v[24:27], a[44:47], v[16:19], v[24:27]
    v_mfma_f32_16x16x32_bf16 v[28:31], a[124:127], v[16:19], v[28:31]
    v_mfma_f32_16x16x32_bf16 v[32:35], a[204:207], v[16:19], v[32:35]
    ds_read_b128 v[16:19], v3 offset:13312
    s_waitcnt lgkmcnt(3)
    v_mfma_f32_16x16x32_bf16 v[36:39], a[44:47], v[20:23], v[36:39]
    v_mfma_f32_16x16x32_bf16 v[40:43], a[124:127], v[20:23], v[40:43]
    v_mfma_f32_16x16x32_bf16 v[44:47], a[204:207], v[20:23], v[44:47]
    ds_read_b128 v[20:23], v3 offset:33792
    s_waitcnt lgkmcnt(3)
    v_mfma_f32_16x16x32_bf16 v[24:27], a[48:51], v[8:11], v[24:27]
    v_mfma_f32_16x16x32_bf16 v[28:31], a[128:131], v[8:11], v[28:31]
    v_mfma_f32_16x16x32_bf16 v[32:35], a[208:211], v[8:11], v[32:35]
    ds_read_b128 v[8:11], v3 offset:14336
    s_waitcnt lgkmcnt(3)
    v_mfma_f32_16x16x32_bf16 v[36:39], a[48:51], v[12:15], v[36:39]
    v_mfma_f32_16x16x32_bf16 v[40:43], a[128:131], v[12:15], v[40:43]
    v_mfma_f32_16x16x32_bf16 v[44:47], a[208:211], v[12:15], v[44:47]
    ds_read_b128 v[12:15], v3 offset:34816
    s_waitcnt lgkmcnt(3)
    v_mfma_f32_16x16x32_bf16 v[24:27], a[52:55], v[16:19], v[24:27]
    v_mfma_f32_16x16x32_bf16 v[28:31], a[132:135], v[16:19], v[28:31]
    v_mfma_f32_16x16x32_bf16 v[32:35], a[212:215], v[16:19], v[32:35]
    ds_read_b128 v[16:19], v3 offset:15360
    s_waitcnt lgkmcnt(3)
    v_mfma_f32_16x16x32_bf16 v[36:39], a[52:55], v[20:23], v[36:39]
    v_mfma_f32_16x16x32_bf16 v[40:43], a[132:135], v[20:23], v[40:43]
    v_mfma_f32_16x16x32_bf16 v[44:47], a[212:215], v[20:23], v[44:47]
    ds_read_b128 v[20:23], v3 offset:35840
    s_waitcnt lgkmcnt(3)
    v_mfma_f32_16x16x32_bf16 v[24:27], a[56:59], v[8:11], v[24:27]
    v_mfma_f32_16x16x32_bf16 v[28:31], a[136:139], v[8:11], v[28:31]
    v_mfma_f32_16x16x32_bf16 v[32:35], a[216:219], v[8:11], v[32:35]
    ds_read_b128 v[8:11], v3 offset:16384
    s_waitcnt lgkmcnt(3)
    v_mfma_f32_16x16x32_bf16 v[36:39], a[56:59], v[12:15], v[36:39]
    v_mfma_f32_16x16x32_bf16 v[40:43], a[136:139], v[12:15], v[40:43]
    v_mfma_f32_16x16x32_bf16 v[44:47], a[216:219], v[12:15], v[44:47]
    ds_read_b128 v[12:15], v3 offset:36864
    s_waitcnt lgkmcnt(3)
    v_mfma_f32_16x16x32_bf16 v[24:27], a[60:63], v[16:19], v[24:27]
    v_mfma_f32_16x16x32_bf16 v[28:31], a[140:143], v[16:19], v[28:31]
    v_mfma_f32_16x16x32_bf16 v[32:35], a[220:223], v[16:19], v[32:35]
    ds_read_b128 v[16:19], v3 offset:17408
    s_waitcnt lgkmcnt(3)
    v_mfma_f32_16x16x32_bf16 v[36:39], a[60:63], v[20:23], v[36:39]
    v_mfma_f32_16x16x32_bf16 v[40:43], a[140:143], v[20:23], v[40:43]
    v_mfma_f32_16x16x32_bf16 v[44:47], a[220:223], v[20:23], v[44:47]
    ds_read_b128 v[20:23], v3 offset:37888
    s_waitcnt lgkmcnt(3)
    v_mfma_f32_16x16x32_bf16 v[24:27], a[64:67], v[8:11], v[24:27]
    v_mfma_f32_16x16x32_bf16 v[28:31], a[144:147], v[8:11], v[28:31]
    v_mfma_f32_16x16x32_bf16 v[32:35], a[224:227], v[8:11], v[32:35]
    ds_read_b128 v[8:11], v3 offset:18432
    s_waitcnt lgkmcnt(3)
    v_mfma_f32_16x16x32_bf16 v[36:39], a[64:67], v[12:15], v[36:39]
    v_mfma_f32_16x16x32_bf16 v[40:43], a[144:147], v[12:15], v[40:43]
    v_mfma_f32_16x16x32_bf16 v[44:47], a[224:227], v[12:15], v[44:47]
    s_cmp_eq_u32 s54, 1
    s_nop 5
    s_cbranch_scc1 Lqe_50169
    s_waitcnt vmcnt(0)
    v_cmp_gt_u32 vcc, s41, v162
    s_nop 0
    s_cbranch_vccnz Lqn_50170
    s_lshl_b32 s39, s17, 19
    s_add_u32 s39, s39, 0xc000000
    buffer_load_dwordx2 v[72:73], v163, s[4:7], s39 offen offset:0 sc1
    buffer_load_dwordx2 v[74:75], v163, s[4:7], s39 offen offset:256 sc1
    buffer_load_dwordx2 v[76:77], v163, s[4:7], s39 offen offset:512 sc1
    s_mov_b32 s54, 1
Lqn_50170:
Lqe_50169:
    ds_read_b128 v[12:15], v3 offset:38912
    s_waitcnt lgkmcnt(3)
    v_mfma_f32_16x16x32_bf16 v[24:27], a[68:71], v[16:19], v[24:27]
    v_mfma_f32_16x16x32_bf16 v[28:31], a[148:151], v[16:19], v[28:31]
    v_mfma_f32_16x16x32_bf16 v[32:35], a[228:231], v[16:19], v[32:35]
    ds_read_b128 v[16:19], v3 offset:19456
    s_waitcnt lgkmcnt(3)
    v_mfma_f32_16x16x32_bf16 v[36:39], a[68:71], v[20:23], v[36:39]
    v_mfma_f32_16x16x32_bf16 v[40:43], a[148:151], v[20:23], v[40:43]
    v_mfma_f32_16x16x32_bf16 v[44:47], a[228:231], v[20:23], v[44:47]
    ds_read_b128 v[20:23], v3 offset:39936
    s_waitcnt lgkmcnt(3)
    v_mfma_f32_16x16x32_bf16 v[24:27], a[72:75], v[8:11], v[24:27]
    v_mfma_f32_16x16x32_bf16 v[28:31], a[152:155], v[8:11], v[28:31]
    v_mfma_f32_16x16x32_bf16 v[32:35], a[232:235], v[8:11], v[32:35]
    s_waitcnt lgkmcnt(2)
    v_mfma_f32_16x16x32_bf16 v[36:39], a[72:75], v[12:15], v[36:39]
    v_mfma_f32_16x16x32_bf16 v[40:43], a[152:155], v[12:15], v[40:43]
    v_mfma_f32_16x16x32_bf16 v[44:47], a[232:235], v[12:15], v[44:47]
    s_waitcnt lgkmcnt(1)
    v_mfma_f32_16x16x32_bf16 v[24:27], a[76:79], v[16:19], v[24:27]
    v_mfma_f32_16x16x32_bf16 v[28:31], a[156:159], v[16:19], v[28:31]
    v_mfma_f32_16x16x32_bf16 v[32:35], a[236:239], v[16:19], v[32:35]
    s_waitcnt lgkmcnt(0)
    v_mfma_f32_16x16x32_bf16 v[36:39], a[76:79], v[20:23], v[36:39]
    v_mfma_f32_16x16x32_bf16 v[40:43], a[156:159], v[20:23], v[40:43]
    v_mfma_f32_16x16x32_bf16 v[44:47], a[236:239], v[20:23], v[44:47]
    s_mov_b32 s25, s34
    s_mov_b32 s34, s35
    s_mov_b32 s35, s36
    s_mov_b32 s36, s25
    s_nop 2
    s_branch Lq_loop_50151
Lq_last_50152:
    s_cmp_ge_u32 s14, 2
    s_cbranch_scc1 Lq_fin_50154
    v_add_u32 v3, s43, v1
    s_lshl_b32 s52, s14, 10
    v_add_u32 v166, s52, v3
    ds_read_b128 v[104:107], v3 offset:0
    ds_read_b128 v[108:111], v3 offset:6144
    ds_read_b128 v[112:115], v3 offset:12288
    ds_read_b128 v[116:119], v3 offset:18432
    ds_read_b128 v[120:123], v166 offset:0
    ds_read_b128 v[124:127], v166 offset:6144
    ds_read_b128 v[128:131], v166 offset:12288
    ds_read_b128 v[132:135], v166 offset:18432
    ds_read_b128 v[136:139], v3 offset:2048
    ds_read_b128 v[140:143], v3 offset:8192
    ds_read_b128 v[144:147], v3 offset:14336
    ds_read_b128 v[148:151], v3 offset:20480
    s_lshl_b32 s52, s17, 16
    s_add_u32 s52, s52, s44
    s_lshl_b32 s53, s17, 14
    s_add_u32 s53, s53, 0xa100000
    s_waitcnt lgkmcnt(0)
    v_add_f32 v104, v104, v108
    v_add_f32 v112, v112, v116
    v_add_f32 v105, v105, v109
    v_add_f32 v113, v113, v117
    v_add_f32 v106, v106, v110
    v_add_f32 v114, v114, v118
    v_add_f32 v107, v107, v111
    v_add_f32 v115, v115, v119
    v_add_f32 v104, v104, v112
    v_add_f32 v105, v105, v113
    v_add_f32 v106, v106, v114
    v_add_f32 v107, v107, v115
    v_cvt_pk_bf16_f32 v6, v104, v105
    v_lshlrev_b32 v7, 16, v6
    v_and_b32 v6, 0xffff0000, v6
    v_mul_f32 v7, s45, v7
    v_mul_f32 v6, s45, v6
    v_cvt_pk_bf16_f32 v6, v7, v6
    v_lshlrev_b32 v7, 16, v6
    v_and_b32 v6, 0xffff0000, v6
    v_add_f32 v80, v7, v152
    v_add_f32 v81, v6, v153
    v_cvt_pk_bf16_f32 v6, v106, v107
    v_lshlrev_b32 v7, 16, v6
    v_and_b32 v6, 0xffff0000, v6
    v_mul_f32 v7, s45, v7
    v_mul_f32 v6, s45, v6
    v_cvt_pk_bf16_f32 v6, v7, v6
    v_lshlrev_b32 v7, 16, v6
    v_and_b32 v6, 0xffff0000, v6
    v_add_f32 v82, v7, v154
    v_add_f32 v83, v6, v155
    v_add_f32 v120, v120, v124
    v_add_f32 v128, v128, v132
    v_add_f32 v121, v121, v125
    v_add_f32 v129, v129, v133
    v_add_f32 v122, v122, v126
    v_add_f32 v130, v130, v134
    v_add_f32 v123, v123, v127
    v_add_f32 v131, v131, v135
    v_add_f32 v120, v120, v128
    v_add_f32 v121, v121, v129
    v_add_f32 v122, v122, v130
    v_add_f32 v123, v123, v131
    v_cvt_pk_bf16_f32 v6, v120, v121
    v_lshlrev_b32 v7, 16, v6
    v_and_b32 v6, 0xffff0000, v6
    v_mul_f32 v7, s45, v7
    v_mul_f32 v6, s45, v6
    v_cvt_pk_bf16_f32 v6, v7, v6
    v_lshlrev_b32 v7, 16, v6
    v_and_b32 v6, 0xffff0000, v6
    v_add_f32 v84, v7, v156
    v_add_f32 v85, v6, v157
    v_cvt_pk_bf16_f32 v6, v122, v123
    v_lshlrev_b32 v7, 16, v6
    v_and_b32 v6, 0xffff0000, v6
    v_mul_f32 v7, s45, v7
    v_mul_f32 v6, s45, v6
    v_cvt_pk_bf16_f32 v6, v7, v6
    v_lshlrev_b32 v7, 16, v6
    v_and_b32 v6, 0xffff0000, v6
    v_add_f32 v86, v7, v158
    v_add_f32 v87, v6, v159
    v_add_f32 v136, v136, v140
    v_add_f32 v144, v144, v148
    v_add_f32 v137, v137, v141
    v_add_f32 v145, v145, v149
    v_add_f32 v138, v138, v142
    v_add_f32 v146, v146, v150
    v_add_f32 v139, v139, v143
    v_add_f32 v147, v147, v151
    v_add_f32 v136, v136, v144
    v_add_f32 v137, v137, v145
    v_add_f32 v138, v138, v146
    v_add_f32 v139, v139, v147
    v_cvt_pk_bf16_f32 v6, v136, v137
    v_lshlrev_b32 v7, 16, v6
    v_and_b32 v6, 0xffff0000, v6
    v_mul_f32 v7, s45, v7
    v_mul_f32 v6, s45, v6
    v_cvt_pk_bf16_f32 v6, v7, v6
    v_lshlrev_b32 v7, 16, v6
    v_and_b32 v6, 0xffff0000, v6
    v_add_f32 v88, v7, v160
    v_add_f32 v89, v6, v160
    v_cvt_pk_bf16_f32 v6, v138, v139
    v_lshlrev_b32 v7, 16, v6
    v_and_b32 v6, 0xffff0000, v6
    v_mul_f32 v7, s45, v7
    v_mul_f32 v6, s45, v6
    v_cvt_pk_bf16_f32 v6, v7, v6
    v_lshlrev_b32 v7, 16, v6
    v_and_b32 v6, 0xffff0000, v6
    v_add_f32 v90, v7, v160
    v_add_f32 v91, v6, v160
    v_max3_f32 v6, v80, v81, v82
    v_max3_f32 v6, v6, v83, v84
    v_max3_f32 v6, v6, v85, v86
    v_max3_f32 v6, v6, v87, v88
    v_max3_f32 v6, v6, v89, v90
    v_max_f32 v6, v6, v91
    v_mov_b32 v7, v6
    s_nop 1
    v_permlane16_swap_b32 v6, v7
    v_max_f32 v6, v6, v7
    v_mov_b32 v7, v6
    s_nop 1
    v_permlane32_swap_b32 v6, v7
    v_max_f32 v6, v6, v7
    v_sub_f32 v80, v80, v6
    v_mul_f32 v80, s50, v80
    v_exp_f32 v80, v80
    v_sub_f32 v81, v81, v6
    v_mul_f32 v81, s50, v81
    v_exp_f32 v81, v81
    v_sub_f32 v82, v82, v6
    v_mul_f32 v82, s50, v82
    v_exp_f32 v82, v82
    v_sub_f32 v83, v83, v6
    v_mul_f32 v83, s50, v83
    v_exp_f32 v83, v83
    v_sub_f32 v84, v84, v6
    v_mul_f32 v84, s50, v84
    v_exp_f32 v84, v84
    v_sub_f32 v85, v85, v6
    v_mul_f32 v85, s50, v85
    v_exp_f32 v85, v85
    v_sub_f32 v86, v86, v6
    v_mul_f32 v86, s50, v86
    v_exp_f32 v86, v86
    v_sub_f32 v87, v87, v6
    v_mul_f32 v87, s50, v87
    v_exp_f32 v87, v87
    v_sub_f32 v88, v88, v6
    v_mul_f32 v88, s50, v88
    v_exp_f32 v88, v88
    v_sub_f32 v89, v89, v6
    v_mul_f32 v89, s50, v89
    v_exp_f32 v89, v89
    v_sub_f32 v90, v90, v6
    v_mul_f32 v90, s50, v90
    v_exp_f32 v90, v90
    v_sub_f32 v91, v91, v6
    v_mul_f32 v91, s50, v91
    v_exp_f32 v91, v91
    v_add_f32 v6, v80, v81
    v_add_f32 v6, v6, v82
    v_add_f32 v6, v6, v83
    v_add_f32 v6, v6, v84
    v_add_f32 v6, v6, v85
    v_add_f32 v6, v6, v86
    v_add_f32 v6, v6, v87
    v_add_f32 v6, v6, v88
    v_add_f32 v6, v6, v89
    v_add_f32 v6, v6, v90
    v_add_f32 v6, v6, v91
    v_mov_b32 v7, v6
    s_nop 1
    v_permlane16_swap_b32 v6, v7
    v_add_f32 v6, v6, v7
    v_mov_b32 v7, v6
    s_nop 1
    v_permlane32_swap_b32 v6, v7
    v_add_f32 v6, v6, v7
    v_rcp_f32 v6, v6
    s_nop 0
    v_mul_f32 v80, v80, v6
    v_mul_f32 v81, v81, v6
    v_mul_f32 v82, v82, v6
    v_mul_f32 v83, v83, v6
    v_mul_f32 v84, v84, v6
    v_mul_f32 v85, v85, v6
    v_mul_f32 v86, v86, v6
    v_mul_f32 v87, v87, v6
    v_mul_f32 v88, v88, v6
    v_mul_f32 v89, v89, v6
    v_mul_f32 v90, v90, v6
    v_mul_f32 v91, v91, v6
    v_cvt_pk_bf16_f32 v104, v80, v81
    v_cvt_pk_bf16_f32 v105, v82, v83
    v_cvt_pk_bf16_f32 v106, v84, v85
    v_cvt_pk_bf16_f32 v107, v86, v87
    v_cvt_pk_bf16_f32 v108, v88, v89
    v_cvt_pk_bf16_f32 v109, v90, v91
    buffer_store_dwordx4 v[104:107], v1, s[4:7], s52 offen sc1
    s_mov_b64 exec, s[48:49]
    buffer_store_dwordx2 v[108:109], v164, s[4:7], s53 offen sc1
    s_mov_b64 exec, -1
Lq_fin_50154:
    s_waitcnt vmcnt(0)
    s_add_u32 s17, s17, 1
    s_barrier
    s_cmp_lg_u32 s14, 0
    s_cbranch_scc1 Lsig_50171
    s_add_u32 s46, s17, 0
    v_mov_b32 v4, s46
    v_mov_b32 v5, s47
    s_mov_b64 exec, 1
    buffer_store_dword v4, v5, s[4:7], 0 offen sc1
    s_mov_b64 exec, -1
Lsig_50171:
    s_branch Lmain_end
Lmain_tasks:
    s_load_dwordx2 s[58:59], s[0:1], 0
    s_load_dwordx2 s[60:61], s[0:1], 96
    s_load_dwordx2 s[56:57], s[0:1], 112
    s_waitcnt vmcnt(0) lgkmcnt(0)
    v_and_b32 v4, 7, v0
    v_bfe_u32 v5, v0, 3, 2
    v_lshlrev_b32 v4, 2, v4
    v_lshl_add_u32 v4, v5, 7, v4
    v_add_u32 v4, 0xb20b000, v4
    s_nop 1
Lwp_50172:
    buffer_load_dword v5, v4, s[4:7], 0 offen sc1
    s_waitcnt vmcnt(0)
    v_cmp_gt_u32 vcc, 1, v5
    s_nop 0
    s_cbranch_vccz Lwpd_50173
    s_sleep 8
    s_add_u32 s30, s30, 1
    s_cmp_lt_u32 s30, s31
    s_cbranch_scc1 Lwp_50172
Lwpd_50173:
    s_barrier
    s_cmp_eq_u32 s16, 4
    s_cbranch_scc1 Lph_late
    s_lshl_b32 s20, s16, 5
    s_add_u32 s26, s26, s20
    s_mov_b32 s19, 2
    s_mov_b32 s50, 54
    s_cmp_ge_u32 s26, 94
    s_cbranch_scc1 Lmain_end
    s_cmp_ge_u32 s26, 70
    s_cbranch_scc1 Lph_d3
    s_cmp_ge_u32 s26, 55
    s_cbranch_scc1 Lph_d4
    s_cmp_ge_u32 s26, 45
    s_cbranch_scc1 Lph_d2
    s_cmp_ge_u32 s26, 35
    s_cbranch_scc1 Lph_d1
    s_sub_u32 s20, s26, 0
    s_mul_i32 s17, s20, 0x3334
    s_lshr_b32 s17, s17, 16
    s_mul_i32 s18, s17, 5
    s_sub_u32 s18, s20, s18
    s_mov_b32 s19, 7
    s_mov_b32 s8, s58
    s_and_b32 s9, s59, 0xffff
    s_mov_b32 s10, 0x280000
    s_mov_b32 s11, 0x20000
    v_lshlrev_b32 v1, 4, v0
    v_and_b32 v10, 15, v0
    v_lshrrev_b32 v11, 4, v0
    s_lshl_b32 s29, s18, 4
    s_add_u32 s29, s29, 0
    v_lshrrev_b32 v220, 3, v10
    v_add_u32 v220, s29, v220
    v_mul_u32_u24 v221, 0x3334, v220
    v_lshrrev_b32 v221, 16, v221
    v_mul_u32_u24 v222, 5, v221
    v_sub_u32 v222, v220, v222
    v_cmp_lt_u32 vcc, 2, v222
    s_nop 1
    v_cndmask_b32 v223, 0, 1, vcc
    v_lshl_add_u32 v221, v221, 1, v223
    v_mul_u32_u24 v223, 3, v223
    v_sub_u32 v222, v222, v223
    v_lshlrev_b32 v2, 12, v221
    v_lshl_add_u32 v2, v222, 7, v2
    v_and_b32 v223, 7, v10
    v_lshl_add_u32 v2, v223, 4, v2
    v_mul_u32_u24 v223, 384, v11
    v_add_u32 v2, v2, v223
    s_lshl_b32 s29, s18, 4
    s_add_u32 s29, s29, 2
    v_lshrrev_b32 v220, 3, v10
    v_add_u32 v220, s29, v220
    v_mul_u32_u24 v221, 0x3334, v220
    v_lshrrev_b32 v221, 16, v221
    v_mul_u32_u24 v222, 5, v221
    v_sub_u32 v222, v220, v222
    v_cmp_lt_u32 vcc, 2, v222
    s_nop 1
    v_cndmask_b32 v223, 0, 1, vcc
    v_lshl_add_u32 v221, v221, 1, v223
    v_mul_u32_u24 v223, 3, v223
    v_sub_u32 v222, v222, v223
    v_lshlrev_b32 v3, 12, v221
    v_lshl_add_u32 v3, v222, 7, v3
    v_and_b32 v223, 7, v10
    v_lshl_add_u32 v3, v223, 4, v3
    v_mul_u32_u24 v223, 384, v11
    v_add_u32 v3, v3, v223
    s_lshl_b32 s29, s18, 4
    s_add_u32 s29, s29, 4
    v_lshrrev_b32 v220, 3, v10
    v_add_u32 v220, s29, v220
    v_mul_u32_u24 v221, 0x3334, v220
    v_lshrrev_b32 v221, 16, v221
    v_mul_u32_u24 v222, 5, v221
    v_sub_u32 v222, v220, v222
    v_cmp_lt_u32 vcc, 2, v222
    s_nop 1
    v_cndmask_b32 v223, 0, 1, vcc
    v_lshl_add_u32 v221, v221, 1, v223
    v_mul_u32_u24 v223, 3, v223
    v_sub_u32 v222, v222, v223
    v_lshlrev_b32 v4, 12, v221
    v_lshl_add_u32 v4, v222, 7, v4
    v_and_b32 v223, 7, v10
    v_lshl_add_u32 v4, v223, 4, v4
    v_mul_u32_u24 v223, 384, v11
    v_add_u32 v4, v4, v223
    s_lshl_b32 s29, s18, 4
    s_add_u32 s29, s29, 6
    v_lshrrev_b32 v220, 3, v10
    v_add_u32 v220, s29, v220
    v_mul_u32_u24 v221, 0x3334, v220
    v_lshrrev_b32 v221, 16, v221
    v_mul_u32_u24 v222, 5, v221
    v_sub_u32 v222, v220, v222
    v_cmp_lt_u32 vcc, 2, v222
    s_nop 1
    v_cndmask_b32 v223, 0, 1, vcc
    v_lshl_add_u32 v221, v221, 1, v223
    v_mul_u32_u24 v223, 3, v223
    v_sub_u32 v222, v222, v223
    v_lshlrev_b32 v5, 12, v221
    v_lshl_add_u32 v5, v222, 7, v5
    v_and_b32 v223, 7, v10
    v_lshl_add_u32 v5, v223, 4, v5
    v_mul_u32_u24 v223, 384, v11
    v_add_u32 v5, v5, v223
    s_lshl_b32 s29, s18, 4
    s_add_u32 s29, s29, 8
    v_lshrrev_b32 v220, 3, v10
    v_add_u32 v220, s29, v220
    v_mul_u32_u24 v221, 0x3334, v220
    v_lshrrev_b32 v221, 16, v221
    v_mul_u32_u24 v222, 5, v221
    v_sub_u32 v222, v220, v222
    v_cmp_lt_u32 vcc, 2, v222
    s_nop 1
    v_cndmask_b32 v223, 0, 1, vcc
    v_lshl_add_u32 v221, v221, 1, v223
    v_mul_u32_u24 v223, 3, v223
    v_sub_u32 v222, v222, v223
    v_lshlrev_b32 v6, 12, v221
    v_lshl_add_u32 v6, v222, 7, v6
    v_and_b32 v223, 7, v10
    v_lshl_add_u32 v6, v223, 4, v6
    v_mul_u32_u24 v223, 384, v11
    v_add_u32 v6, v6, v223
    s_lshl_b32 s29, s18, 4
    s_add_u32 s29, s29, 10
    v_lshrrev_b32 v220, 3, v10
    v_add_u32 v220, s29, v220
    v_mul_u32_u24 v221, 0x3334, v220
    v_lshrrev_b32 v221, 16, v221
    v_mul_u32_u24 v222, 5, v221
    v_sub_u32 v222, v220, v222
    v_cmp_lt_u32 vcc, 2, v222
    s_nop 1
    v_cndmask_b32 v223, 0, 1, vcc
    v_lshl_add_u32 v221, v221, 1, v223
    v_mul_u32_u24 v223, 3, v223
    v_sub_u32 v222, v222, v223
    v_lshlrev_b32 v7, 12, v221
    v_lshl_add_u32 v7, v222, 7, v7
    v_and_b32 v223, 7, v10
    v_lshl_add_u32 v7, v223, 4, v7
    v_mul_u32_u24 v223, 384, v11
    v_add_u32 v7, v7, v223
    s_lshl_b32 s29, s18, 4
    s_add_u32 s29, s29, 12
    v_lshrrev_b32 v220, 3, v10
    v_add_u32 v220, s29, v220
    v_mul_u32_u24 v221, 0x3334, v220
    v_lshrrev_b32 v221, 16, v221
    v_mul_u32_u24 v222, 5, v221
    v_sub_u32 v222, v220, v222
    v_cmp_lt_u32 vcc, 2, v222
    s_nop 1
    v_cndmask_b32 v223, 0, 1, vcc
    v_lshl_add_u32 v221, v221, 1, v223
    v_mul_u32_u24 v223, 3, v223
    v_sub_u32 v222, v222, v223
    v_lshlrev_b32 v8, 12, v221
    v_lshl_add_u32 v8, v222, 7, v8
    v_and_b32 v223, 7, v10
    v_lshl_add_u32 v8, v223, 4, v8
    v_mul_u32_u24 v223, 384, v11
    v_add_u32 v8, v8, v223
    s_lshl_b32 s29, s18, 4
    s_add_u32 s29, s29, 14
    v_lshrrev_b32 v220, 3, v10
    v_add_u32 v220, s29, v220
    v_mul_u32_u24 v221, 0x3334, v220
    v_lshrrev_b32 v221, 16, v221
    v_mul_u32_u24 v222, 5, v221
    v_sub_u32 v222, v220, v222
    v_cmp_lt_u32 vcc, 2, v222
    s_nop 1
    v_cndmask_b32 v223, 0, 1, vcc
    v_lshl_add_u32 v221, v221, 1, v223
    v_mul_u32_u24 v223, 3, v223
    v_sub_u32 v222, v222, v223
    v_lshlrev_b32 v9, 12, v221
    v_lshl_add_u32 v9, v222, 7, v9
    v_and_b32 v223, 7, v10
    v_lshl_add_u32 v9, v223, 4, v9
    v_mul_u32_u24 v223, 384, v11
    v_add_u32 v9, v9, v223
    s_lshl_b32 s29, s18, 2
    s_add_u32 s29, s29, s14
    v_mul_u32_u24 v232, 1280, v10
    v_lshl_add_u32 v232, v11, 3, v232
    v_lshlrev_b32 v233, 3, v10
    s_lshl_b32 s20, s14, 7
    s_add_u32 s20, s20, 0xb20b000
    v_and_b32 v234, 7, v0
    v_lshlrev_b32 v234, 2, v234
    v_add_u32 v234, s20, v234
    s_lshl_b32 s20, s14, 7
    s_add_u32 s20, s20, 0xb201000
    v_and_b32 v236, 7, v0
    v_lshlrev_b32 v236, 2, v236
    v_add_u32 v236, s20, v236
    s_mov_b32 s48, -1
    s_mov_b32 s49, 0xff
    s_add_u32 s41, s17, 1
    s_mov_b64 exec, 0xff
Lwp_50176:
    buffer_load_dword v235, v236, s[4:7], 0 offen sc1
    s_waitcnt vmcnt(0)
    v_cmp_gt_u32 vcc, s41, v235
    s_nop 0
    s_cbranch_vccz Lwpd_50177
    s_sleep 8
    s_add_u32 s30, s30, 1
    s_cmp_lt_u32 s30, s31
    s_cbranch_scc1 Lwp_50176
Lwpd_50177:
    s_mov_b64 exec, -1
    s_lshl_b32 s22, s17, 5
    s_lshl_b32 s21, s14, 3
    s_add_u32 s22, s22, s21
    s_mul_i32 s22, s22, 40
    s_lshl_b32 s23, s18, 3
    s_add_u32 s22, s22, s23
    s_lshl_b32 s22, s22, 10
    s_add_u32 s22, s22, 0x3400000
    s_add_u32 s23, s22, 4096
    buffer_load_dwordx4 a[0:3], v1, s[4:7], s22 offen offset:0 sc1
    buffer_load_dwordx4 a[4:7], v1, s[4:7], s22 offen offset:1024 sc1
    buffer_load_dwordx4 a[8:11], v1, s[4:7], s22 offen offset:2048 sc1
    buffer_load_dwordx4 a[12:15], v1, s[4:7], s22 offen offset:3072 sc1
    buffer_load_dwordx4 a[16:19], v1, s[4:7], s23 offen offset:0 sc1
    buffer_load_dwordx4 a[20:23], v1, s[4:7], s23 offen offset:1024 sc1
    buffer_load_dwordx4 a[24:27], v1, s[4:7], s23 offen offset:2048 sc1
    buffer_load_dwordx4 a[28:31], v1, s[4:7], s23 offen offset:3072 sc1
    s_add_u32 s22, s22, 40960
    s_add_u32 s23, s22, 4096
    buffer_load_dwordx4 a[32:35], v1, s[4:7], s22 offen offset:0 sc1
    buffer_load_dwordx4 a[36:39], v1, s[4:7], s22 offen offset:1024 sc1
    buffer_load_dwordx4 a[40:43], v1, s[4:7], s22 offen offset:2048 sc1
    buffer_load_dwordx4 a[44:47], v1, s[4:7], s22 offen offset:3072 sc1
    buffer_load_dwordx4 a[48:51], v1, s[4:7], s23 offen offset:0 sc1
    buffer_load_dwordx4 a[52:55], v1, s[4:7], s23 offen offset:1024 sc1
    buffer_load_dwordx4 a[56:59], v1, s[4:7], s23 offen offset:2048 sc1
    buffer_load_dwordx4 a[60:63], v1, s[4:7], s23 offen offset:3072 sc1
    s_add_u32 s22, s22, 40960
    s_add_u32 s23, s22, 4096
    buffer_load_dwordx4 a[64:67], v1, s[4:7], s22 offen offset:0 sc1
    buffer_load_dwordx4 a[68:71], v1, s[4:7], s22 offen offset:1024 sc1
    buffer_load_dwordx4 a[72:75], v1, s[4:7], s22 offen offset:2048 sc1
    buffer_load_dwordx4 a[76:79], v1, s[4:7], s22 offen offset:3072 sc1
    buffer_load_dwordx4 a[80:83], v1, s[4:7], s23 offen offset:0 sc1
    buffer_load_dwordx4 a[84:87], v1, s[4:7], s23 offen offset:1024 sc1
    buffer_load_dwordx4 a[88:91], v1, s[4:7], s23 offen offset:2048 sc1
    buffer_load_dwordx4 a[92:95], v1, s[4:7], s23 offen offset:3072 sc1
    s_add_u32 s22, s22, 40960
    s_add_u32 s23, s22, 4096
    buffer_load_dwordx4 a[96:99], v1, s[4:7], s22 offen offset:0 sc1
    buffer_load_dwordx4 a[100:103], v1, s[4:7], s22 offen offset:1024 sc1
    buffer_load_dwordx4 a[104:107], v1, s[4:7], s22 offen offset:2048 sc1
    buffer_load_dwordx4 a[108:111], v1, s[4:7], s22 offen offset:3072 sc1
    buffer_load_dwordx4 a[112:115], v1, s[4:7], s23 offen offset:0 sc1
    buffer_load_dwordx4 a[116:119], v1, s[4:7], s23 offen offset:1024 sc1
    buffer_load_dwordx4 a[120:123], v1, s[4:7], s23 offen offset:2048 sc1
    buffer_load_dwordx4 a[124:127], v1, s[4:7], s23 offen offset:3072 sc1
    s_add_u32 s22, s22, 40960
    s_add_u32 s23, s22, 4096
    buffer_load_dwordx4 a[128:131], v1, s[4:7], s22 offen offset:0 sc1
    buffer_load_dwordx4 a[132:135], v1, s[4:7], s22 offen offset:1024 sc1
    buffer_load_dwordx4 a[136:139], v1, s[4:7], s22 offen offset:2048 sc1
    buffer_load_dwordx4 a[140:143], v1, s[4:7], s22 offen offset:3072 sc1
    buffer_load_dwordx4 a[144:147], v1, s[4:7], s23 offen offset:0 sc1
    buffer_load_dwordx4 a[148:151], v1, s[4:7], s23 offen offset:1024 sc1
    buffer_load_dwordx4 a[152:155], v1, s[4:7], s23 offen offset:2048 sc1
    buffer_load_dwordx4 a[156:159], v1, s[4:7], s23 offen offset:3072 sc1
    s_add_u32 s22, s22, 40960
    s_add_u32 s23, s22, 4096
    buffer_load_dwordx4 a[160:163], v1, s[4:7], s22 offen offset:0 sc1
    buffer_load_dwordx4 a[164:167], v1, s[4:7], s22 offen offset:1024 sc1
    buffer_load_dwordx4 a[168:171], v1, s[4:7], s22 offen offset:2048 sc1
    buffer_load_dwordx4 a[172:175], v1, s[4:7], s22 offen offset:3072 sc1
    buffer_load_dwordx4 a[176:179], v1, s[4:7], s23 offen offset:0 sc1
    buffer_load_dwordx4 a[180:183], v1, s[4:7], s23 offen offset:1024 sc1
    buffer_load_dwordx4 a[184:187], v1, s[4:7], s23 offen offset:2048 sc1
    buffer_load_dwordx4 a[188:191], v1, s[4:7], s23 offen offset:3072 sc1
    s_add_u32 s22, s22, 40960
    s_add_u32 s23, s22, 4096
    buffer_load_dwordx4 a[192:195], v1, s[4:7], s22 offen offset:0 sc1
    buffer_load_dwordx4 a[196:199], v1, s[4:7], s22 offen offset:1024 sc1
    buffer_load_dwordx4 a[200:203], v1, s[4:7], s22 offen offset:2048 sc1
    buffer_load_dwordx4 a[204:207], v1, s[4:7], s22 offen offset:3072 sc1
    buffer_load_dwordx4 a[208:211], v1, s[4:7], s23 offen offset:0 sc1
    buffer_load_dwordx4 a[212:215], v1, s[4:7], s23 offen offset:1024 sc1
    buffer_load_dwordx4 a[216:219], v1, s[4:7], s23 offen offset:2048 sc1
    buffer_load_dwordx4 a[220:223], v1, s[4:7], s23 offen offset:3072 sc1
    s_add_u32 s22, s22, 40960
    s_add_u32 s23, s22, 4096
    buffer_load_dwordx4 a[224:227], v1, s[4:7], s22 offen offset:0 sc1
    buffer_load_dwordx4 a[228:231], v1, s[4:7], s22 offen offset:1024 sc1
    buffer_load_dwordx4 a[232:235], v1, s[4:7], s22 offen offset:2048 sc1
    buffer_load_dwordx4 a[236:239], v1, s[4:7], s22 offen offset:3072 sc1
    buffer_load_dwordx4 a[240:243], v1, s[4:7], s23 offen offset:0 sc1
    buffer_load_dwordx4 a[244:247], v1, s[4:7], s23 offen offset:1024 sc1
    buffer_load_dwordx4 a[248:251], v1, s[4:7], s23 offen offset:2048 sc1
    buffer_load_dwordx4 a[252:255], v1, s[4:7], s23 offen offset:3072 sc1
    s_add_u32 s22, s22, 40960
Lc_loop_50174:
    s_add_u32 s41, s17, 1
    s_add_u32 s40, s17, s19
    s_lshl_b32 s20, s17, 5
    s_lshl_b32 s21, s14, 3
    s_add_u32 s20, s20, s21
    s_lshl_b32 s24, s20, 11
    s_add_u32 s24, s24, 0x9d00000
    s_lshl_b32 s25, s20, 9
    s_add_u32 s25, s25, 0xa100000
    s_lshl_b32 s27, s17, 19
    s_lshl_b32 s28, s14, 17
    s_add_u32 s27, s27, s28
    s_add_u32 s27, s27, 0xc000000
    s_mul_i32 s34, s17, 40960
    s_lshl_b32 s35, s29, 6
    s_add_u32 s34, s34, s35
    s_add_u32 s35, s34, 20480
    buffer_load_dwordx2 v[224:225], v232, s[8:11], s34 offen offset:0
    buffer_load_dwordx2 v[226:227], v232, s[8:11], s34 offen offset:32
    buffer_load_dwordx2 v[228:229], v232, s[8:11], s35 offen offset:0
    buffer_load_dwordx2 v[230:231], v232, s[8:11], s35 offen offset:32
    s_add_u32 s42, s40, 1
    s_min_u32 s42, s42, 64
    s_mov_b64 exec, 0xff
Lwp_50178:
    buffer_load_dword v235, v236, s[4:7], 0 offen sc1
    s_waitcnt vmcnt(0)
    v_cmp_gt_u32 vcc, s42, v235
    s_nop 0
    s_cbranch_vccz Lwpd_50179
    s_sleep 8
    s_add_u32 s30, s30, 1
    s_cmp_lt_u32 s30, s31
    s_cbranch_scc1 Lwp_50178
Lwpd_50179:
    s_mov_b64 exec, -1
    s_mov_b64 exec, 0xff
Lwp_50180:
    buffer_load_dword v235, v234, s[4:7], 0 offen sc1
    s_waitcnt vmcnt(0)
    v_cmp_gt_u32 vcc, s41, v235
    s_nop 0
    s_cbranch_vccz Lwpd_50181
    s_sleep 4
    v_cmp_gt_u32 vcc, s17, v235
    s_nop 0
    s_cbranch_vccz Lwf_50182
    s_sleep 24
    s_nop 1
Lwf_50182:
    s_add_u32 s30, s30, 1
    s_cmp_lt_u32 s30, s31
    s_cbranch_scc1 Lwp_50180
Lwpd_50181:
    s_mov_b64 exec, -1
    buffer_load_dwordx4 v[204:207], v1, s[4:7], s25 offen offset:0 sc1
    buffer_load_dwordx4 v[208:211], v1, s[4:7], s25 offen offset:1024 sc1
    buffer_load_dwordx4 v[140:143], v2, s[4:7], s27 offen offset:0 sc1
    buffer_load_dwordx4 v[144:147], v3, s[4:7], s27 offen offset:0 sc1
    buffer_load_dwordx4 v[148:151], v4, s[4:7], s27 offen offset:0 sc1
    buffer_load_dwordx4 v[152:155], v5, s[4:7], s27 offen offset:0 sc1
    buffer_load_dwordx4 v[156:159], v6, s[4:7], s27 offen offset:0 sc1
    buffer_load_dwordx4 v[160:163], v7, s[4:7], s27 offen offset:0 sc1
    buffer_load_dwordx4 v[164:167], v8, s[4:7], s27 offen offset:0 sc1
    buffer_load_dwordx4 v[168:171], v9, s[4:7], s27 offen offset:0 sc1
    buffer_load_dwordx4 v[212:215], v1, s[4:7], s25 offen offset:2048 sc1
    buffer_load_dwordx4 v[216:219], v1, s[4:7], s25 offen offset:3072 sc1
    buffer_load_dwordx4 v[172:175], v2, s[4:7], s27 offen offset:1536 sc1
    buffer_load_dwordx4 v[176:179], v3, s[4:7], s27 offen offset:1536 sc1
    buffer_load_dwordx4 v[180:183], v4, s[4:7], s27 offen offset:1536 sc1
    buffer_load_dwordx4 v[184:187], v5, s[4:7], s27 offen offset:1536 sc1
    buffer_load_dwordx4 v[188:191], v6, s[4:7], s27 offen offset:1536 sc1
    buffer_load_dwordx4 v[192:195], v7, s[4:7], s27 offen offset:1536 sc1
    buffer_load_dwordx4 v[196:199], v8, s[4:7], s27 offen offset:1536 sc1
    buffer_load_dwordx4 v[200:203], v9, s[4:7], s27 offen offset:1536 sc1
    buffer_load_dwordx4 v[76:79], v1, s[4:7], s24 offen offset:0 sc1
    buffer_load_dwordx4 v[80:83], v1, s[4:7], s24 offen offset:1024 sc1
    buffer_load_dwordx4 v[84:87], v1, s[4:7], s24 offen offset:2048 sc1
    buffer_load_dwordx4 v[88:91], v1, s[4:7], s24 offen offset:3072 sc1
    s_add_u32 s24, s24, 4096
    buffer_load_dwordx4 v[92:95], v1, s[4:7], s24 offen offset:0 sc1
    buffer_load_dwordx4 v[96:99], v1, s[4:7], s24 offen offset:1024 sc1
    buffer_load_dwordx4 v[100:103], v1, s[4:7], s24 offen offset:2048 sc1
    buffer_load_dwordx4 v[104:107], v1, s[4:7], s24 offen offset:3072 sc1
    s_add_u32 s24, s24, 4096
    buffer_load_dwordx4 v[108:111], v1, s[4:7], s24 offen offset:0 sc1
    buffer_load_dwordx4 v[112:115], v1, s[4:7], s24 offen offset:1024 sc1
    buffer_load_dwordx4 v[116:119], v1, s[4:7], s24 offen offset:2048 sc1
    buffer_load_dwordx4 v[120:123], v1, s[4:7], s24 offen offset:3072 sc1
    s_add_u32 s24, s24, 4096
    buffer_load_dwordx4 v[124:127], v1, s[4:7], s24 offen offset:0 sc1
    buffer_load_dwordx4 v[128:131], v1, s[4:7], s24 offen offset:1024 sc1
    buffer_load_dwordx4 v[132:135], v1, s[4:7], s24 offen offset:2048 sc1
    buffer_load_dwordx4 v[136:139], v1, s[4:7], s24 offen offset:3072 sc1
    s_add_u32 s24, s24, 4096
    s_waitcnt vmcnt(26)
    v_mfma_f32_16x16x32_bf16 v[12:15], v[140:143], v[204:207], 0
    v_mfma_f32_16x16x32_bf16 v[16:19], v[140:143], v[208:211], 0
    v_mfma_f32_16x16x32_bf16 v[20:23], v[144:147], v[204:207], 0
    v_mfma_f32_16x16x32_bf16 v[24:27], v[144:147], v[208:211], 0
    v_mfma_f32_16x16x32_bf16 v[28:31], v[148:151], v[204:207], 0
    v_mfma_f32_16x16x32_bf16 v[32:35], v[148:151], v[208:211], 0
    v_mfma_f32_16x16x32_bf16 v[36:39], v[152:155], v[204:207], 0
    v_mfma_f32_16x16x32_bf16 v[40:43], v[152:155], v[208:211], 0
    v_mfma_f32_16x16x32_bf16 v[44:47], v[156:159], v[204:207], 0
    v_mfma_f32_16x16x32_bf16 v[48:51], v[156:159], v[208:211], 0
    v_mfma_f32_16x16x32_bf16 v[52:55], v[160:163], v[204:207], 0
    v_mfma_f32_16x16x32_bf16 v[56:59], v[160:163], v[208:211], 0
    v_mfma_f32_16x16x32_bf16 v[60:63], v[164:167], v[204:207], 0
    v_mfma_f32_16x16x32_bf16 v[64:67], v[164:167], v[208:211], 0
    v_mfma_f32_16x16x32_bf16 v[68:71], v[168:171], v[204:207], 0
    v_mfma_f32_16x16x32_bf16 v[72:75], v[168:171], v[208:211], 0
    s_waitcnt vmcnt(16)
    v_mfma_f32_16x16x32_bf16 v[12:15], v[172:175], v[212:215], v[12:15]
    v_mfma_f32_16x16x32_bf16 v[16:19], v[172:175], v[216:219], v[16:19]
    v_mfma_f32_16x16x32_bf16 v[20:23], v[176:179], v[212:215], v[20:23]
    v_mfma_f32_16x16x32_bf16 v[24:27], v[176:179], v[216:219], v[24:27]
    v_mfma_f32_16x16x32_bf16 v[28:31], v[180:183], v[212:215], v[28:31]
    v_mfma_f32_16x16x32_bf16 v[32:35], v[180:183], v[216:219], v[32:35]
    v_mfma_f32_16x16x32_bf16 v[36:39], v[184:187], v[212:215], v[36:39]
    v_mfma_f32_16x16x32_bf16 v[40:43], v[184:187], v[216:219], v[40:43]
    v_mfma_f32_16x16x32_bf16 v[44:47], v[188:191], v[212:215], v[44:47]
    v_mfma_f32_16x16x32_bf16 v[48:51], v[188:191], v[216:219], v[48:51]
    v_mfma_f32_16x16x32_bf16 v[52:55], v[192:195], v[212:215], v[52:55]
    v_mfma_f32_16x16x32_bf16 v[56:59], v[192:195], v[216:219], v[56:59]
    v_mfma_f32_16x16x32_bf16 v[60:63], v[196:199], v[212:215], v[60:63]
    v_mfma_f32_16x16x32_bf16 v[64:67], v[196:199], v[216:219], v[64:67]
    v_mfma_f32_16x16x32_bf16 v[68:71], v[200:203], v[212:215], v[68:71]
    v_mfma_f32_16x16x32_bf16 v[72:75], v[200:203], v[216:219], v[72:75]
    s_waitcnt vmcnt(0)
    s_cmp_ge_u32 s40, 64
    s_nop 4
    s_cbranch_scc1 Lc_np_50183
    s_lshl_b32 s22, s40, 5
    s_lshl_b32 s21, s14, 3
    s_add_u32 s22, s22, s21
    s_mul_i32 s22, s22, 40
    s_lshl_b32 s23, s18, 3
    s_add_u32 s22, s22, s23
    s_lshl_b32 s22, s22, 10
    s_add_u32 s22, s22, 0x3400000
    v_mfma_f32_16x16x32_bf16 v[12:15], a[0:3], v[76:79], v[12:15]
    v_mfma_f32_16x16x32_bf16 v[16:19], a[0:3], v[80:83], v[16:19]
    v_mfma_f32_16x16x32_bf16 v[20:23], a[4:7], v[76:79], v[20:23]
    v_mfma_f32_16x16x32_bf16 v[24:27], a[4:7], v[80:83], v[24:27]
    v_mfma_f32_16x16x32_bf16 v[28:31], a[8:11], v[76:79], v[28:31]
    v_mfma_f32_16x16x32_bf16 v[32:35], a[8:11], v[80:83], v[32:35]
    v_mfma_f32_16x16x32_bf16 v[36:39], a[12:15], v[76:79], v[36:39]
    v_mfma_f32_16x16x32_bf16 v[40:43], a[12:15], v[80:83], v[40:43]
    v_mfma_f32_16x16x32_bf16 v[44:47], a[16:19], v[76:79], v[44:47]
    v_mfma_f32_16x16x32_bf16 v[48:51], a[16:19], v[80:83], v[48:51]
    v_mfma_f32_16x16x32_bf16 v[52:55], a[20:23], v[76:79], v[52:55]
    v_mfma_f32_16x16x32_bf16 v[56:59], a[20:23], v[80:83], v[56:59]
    v_mfma_f32_16x16x32_bf16 v[60:63], a[24:27], v[76:79], v[60:63]
    v_mfma_f32_16x16x32_bf16 v[64:67], a[24:27], v[80:83], v[64:67]
    v_mfma_f32_16x16x32_bf16 v[68:71], a[28:31], v[76:79], v[68:71]
    v_mfma_f32_16x16x32_bf16 v[72:75], a[28:31], v[80:83], v[72:75]
    v_mfma_f32_16x16x32_bf16 v[12:15], a[32:35], v[84:87], v[12:15]
    s_add_u32 s23, s22, 4096
    v_mfma_f32_16x16x32_bf16 v[16:19], a[32:35], v[88:91], v[16:19]
    buffer_load_dwordx4 a[0:3], v1, s[4:7], s22 offen offset:0 sc1
    v_mfma_f32_16x16x32_bf16 v[20:23], a[36:39], v[84:87], v[20:23]
    buffer_load_dwordx4 a[4:7], v1, s[4:7], s22 offen offset:1024 sc1
    v_mfma_f32_16x16x32_bf16 v[24:27], a[36:39], v[88:91], v[24:27]
    buffer_load_dwordx4 a[8:11], v1, s[4:7], s22 offen offset:2048 sc1
    v_mfma_f32_16x16x32_bf16 v[28:31], a[40:43], v[84:87], v[28:31]
    buffer_load_dwordx4 a[12:15], v1, s[4:7], s22 offen offset:3072 sc1
    v_mfma_f32_16x16x32_bf16 v[32:35], a[40:43], v[88:91], v[32:35]
    buffer_load_dwordx4 a[16:19], v1, s[4:7], s23 offen offset:0 sc1
    v_mfma_f32_16x16x32_bf16 v[36:39], a[44:47], v[84:87], v[36:39]
    buffer_load_dwordx4 a[20:23], v1, s[4:7], s23 offen offset:1024 sc1
    v_mfma_f32_16x16x32_bf16 v[40:43], a[44:47], v[88:91], v[40:43]
    buffer_load_dwordx4 a[24:27], v1, s[4:7], s23 offen offset:2048 sc1
    v_mfma_f32_16x16x32_bf16 v[44:47], a[48:51], v[84:87], v[44:47]
    buffer_load_dwordx4 a[28:31], v1, s[4:7], s23 offen offset:3072 sc1
    v_mfma_f32_16x16x32_bf16 v[48:51], a[48:51], v[88:91], v[48:51]
    s_add_u32 s22, s22, 40960
    v_mfma_f32_16x16x32_bf16 v[52:55], a[52:55], v[84:87], v[52:55]
    v_mfma_f32_16x16x32_bf16 v[56:59], a[52:55], v[88:91], v[56:59]
    v_mfma_f32_16x16x32_bf16 v[60:63], a[56:59], v[84:87], v[60:63]
    v_mfma_f32_16x16x32_bf16 v[64:67], a[56:59], v[88:91], v[64:67]
    v_mfma_f32_16x16x32_bf16 v[68:71], a[60:63], v[84:87], v[68:71]
    v_mfma_f32_16x16x32_bf16 v[72:75], a[60:63], v[88:91], v[72:75]
    v_mfma_f32_16x16x32_bf16 v[12:15], a[64:67], v[92:95], v[12:15]
    s_add_u32 s23, s22, 4096
    v_mfma_f32_16x16x32_bf16 v[16:19], a[64:67], v[96:99], v[16:19]
    buffer_load_dwordx4 a[32:35], v1, s[4:7], s22 offen offset:0 sc1
    v_mfma_f32_16x16x32_bf16 v[20:23], a[68:71], v[92:95], v[20:23]
    buffer_load_dwordx4 a[36:39], v1, s[4:7], s22 offen offset:1024 sc1
    v_mfma_f32_16x16x32_bf16 v[24:27], a[68:71], v[96:99], v[24:27]
    buffer_load_dwordx4 a[40:43], v1, s[4:7], s22 offen offset:2048 sc1
    v_mfma_f32_16x16x32_bf16 v[28:31], a[72:75], v[92:95], v[28:31]
    buffer_load_dwordx4 a[44:47], v1, s[4:7], s22 offen offset:3072 sc1
    v_mfma_f32_16x16x32_bf16 v[32:35], a[72:75], v[96:99], v[32:35]
    buffer_load_dwordx4 a[48:51], v1, s[4:7], s23 offen offset:0 sc1
    v_mfma_f32_16x16x32_bf16 v[36:39], a[76:79], v[92:95], v[36:39]
    buffer_load_dwordx4 a[52:55], v1, s[4:7], s23 offen offset:1024 sc1
    v_mfma_f32_16x16x32_bf16 v[40:43], a[76:79], v[96:99], v[40:43]
    buffer_load_dwordx4 a[56:59], v1, s[4:7], s23 offen offset:2048 sc1
    v_mfma_f32_16x16x32_bf16 v[44:47], a[80:83], v[92:95], v[44:47]
    buffer_load_dwordx4 a[60:63], v1, s[4:7], s23 offen offset:3072 sc1
    v_mfma_f32_16x16x32_bf16 v[48:51], a[80:83], v[96:99], v[48:51]
    s_add_u32 s22, s22, 40960
    v_mfma_f32_16x16x32_bf16 v[52:55], a[84:87], v[92:95], v[52:55]
    v_mfma_f32_16x16x32_bf16 v[56:59], a[84:87], v[96:99], v[56:59]
    v_mfma_f32_16x16x32_bf16 v[60:63], a[88:91], v[92:95], v[60:63]
    v_mfma_f32_16x16x32_bf16 v[64:67], a[88:91], v[96:99], v[64:67]
    v_mfma_f32_16x16x32_bf16 v[68:71], a[92:95], v[92:95], v[68:71]
    v_mfma_f32_16x16x32_bf16 v[72:75], a[92:95], v[96:99], v[72:75]
    v_mfma_f32_16x16x32_bf16 v[12:15], a[96:99], v[100:103], v[12:15]
    s_add_u32 s23, s22, 4096
    v_mfma_f32_16x16x32_bf16 v[16:19], a[96:99], v[104:107], v[16:19]
    buffer_load_dwordx4 a[64:67], v1, s[4:7], s22 offen offset:0 sc1
    v_mfma_f32_16x16x32_bf16 v[20:23], a[100:103], v[100:103], v[20:23]
    buffer_load_dwordx4 a[68:71], v1, s[4:7], s22 offen offset:1024 sc1
    v_mfma_f32_16x16x32_bf16 v[24:27], a[100:103], v[104:107], v[24:27]
    buffer_load_dwordx4 a[72:75], v1, s[4:7], s22 offen offset:2048 sc1
    v_mfma_f32_16x16x32_bf16 v[28:31], a[104:107], v[100:103], v[28:31]
    buffer_load_dwordx4 a[76:79], v1, s[4:7], s22 offen offset:3072 sc1
    v_mfma_f32_16x16x32_bf16 v[32:35], a[104:107], v[104:107], v[32:35]
    buffer_load_dwordx4 a[80:83], v1, s[4:7], s23 offen offset:0 sc1
    v_mfma_f32_16x16x32_bf16 v[36:39], a[108:111], v[100:103], v[36:39]
    buffer_load_dwordx4 a[84:87], v1, s[4:7], s23 offen offset:1024 sc1
    v_mfma_f32_16x16x32_bf16 v[40:43], a[108:111], v[104:107], v[40:43]
    buffer_load_dwordx4 a[88:91], v1, s[4:7], s23 offen offset:2048 sc1
    v_mfma_f32_16x16x32_bf16 v[44:47], a[112:115], v[100:103], v[44:47]
    buffer_load_dwordx4 a[92:95], v1, s[4:7], s23 offen offset:3072 sc1
    v_mfma_f32_16x16x32_bf16 v[48:51], a[112:115], v[104:107], v[48:51]
    s_add_u32 s22, s22, 40960
    v_mfma_f32_16x16x32_bf16 v[52:55], a[116:119], v[100:103], v[52:55]
    v_mfma_f32_16x16x32_bf16 v[56:59], a[116:119], v[104:107], v[56:59]
    v_mfma_f32_16x16x32_bf16 v[60:63], a[120:123], v[100:103], v[60:63]
    v_mfma_f32_16x16x32_bf16 v[64:67], a[120:123], v[104:107], v[64:67]
    v_mfma_f32_16x16x32_bf16 v[68:71], a[124:127], v[100:103], v[68:71]
    v_mfma_f32_16x16x32_bf16 v[72:75], a[124:127], v[104:107], v[72:75]
    v_mfma_f32_16x16x32_bf16 v[12:15], a[128:131], v[108:111], v[12:15]
    s_add_u32 s23, s22, 4096
    v_mfma_f32_16x16x32_bf16 v[16:19], a[128:131], v[112:115], v[16:19]
    buffer_load_dwordx4 a[96:99], v1, s[4:7], s22 offen offset:0 sc1
    v_mfma_f32_16x16x32_bf16 v[20:23], a[132:135], v[108:111], v[20:23]
    buffer_load_dwordx4 a[100:103], v1, s[4:7], s22 offen offset:1024 sc1
    v_mfma_f32_16x16x32_bf16 v[24:27], a[132:135], v[112:115], v[24:27]
    buffer_load_dwordx4 a[104:107], v1, s[4:7], s22 offen offset:2048 sc1
    v_mfma_f32_16x16x32_bf16 v[28:31], a[136:139], v[108:111], v[28:31]
    buffer_load_dwordx4 a[108:111], v1, s[4:7], s22 offen offset:3072 sc1
    v_mfma_f32_16x16x32_bf16 v[32:35], a[136:139], v[112:115], v[32:35]
    buffer_load_dwordx4 a[112:115], v1, s[4:7], s23 offen offset:0 sc1
    v_mfma_f32_16x16x32_bf16 v[36:39], a[140:143], v[108:111], v[36:39]
    buffer_load_dwordx4 a[116:119], v1, s[4:7], s23 offen offset:1024 sc1
    v_mfma_f32_16x16x32_bf16 v[40:43], a[140:143], v[112:115], v[40:43]
    buffer_load_dwordx4 a[120:123], v1, s[4:7], s23 offen offset:2048 sc1
    v_mfma_f32_16x16x32_bf16 v[44:47], a[144:147], v[108:111], v[44:47]
    buffer_load_dwordx4 a[124:127], v1, s[4:7], s23 offen offset:3072 sc1
    v_mfma_f32_16x16x32_bf16 v[48:51], a[144:147], v[112:115], v[48:51]
    s_add_u32 s22, s22, 40960
    v_mfma_f32_16x16x32_bf16 v[52:55], a[148:151], v[108:111], v[52:55]
    v_mfma_f32_16x16x32_bf16 v[56:59], a[148:151], v[112:115], v[56:59]
    v_mfma_f32_16x16x32_bf16 v[60:63], a[152:155], v[108:111], v[60:63]
    v_mfma_f32_16x16x32_bf16 v[64:67], a[152:155], v[112:115], v[64:67]
    v_mfma_f32_16x16x32_bf16 v[68:71], a[156:159], v[108:111], v[68:71]
    v_mfma_f32_16x16x32_bf16 v[72:75], a[156:159], v[112:115], v[72:75]
    v_mfma_f32_16x16x32_bf16 v[12:15], a[160:163], v[116:119], v[12:15]
    s_add_u32 s23, s22, 4096
    v_mfma_f32_16x16x32_bf16 v[16:19], a[160:163], v[120:123], v[16:19]
    buffer_load_dwordx4 a[128:131], v1, s[4:7], s22 offen offset:0 sc1
    v_mfma_f32_16x16x32_bf16 v[20:23], a[164:167], v[116:119], v[20:23]
    buffer_load_dwordx4 a[132:135], v1, s[4:7], s22 offen offset:1024 sc1
    v_mfma_f32_16x16x32_bf16 v[24:27], a[164:167], v[120:123], v[24:27]
    buffer_load_dwordx4 a[136:139], v1, s[4:7], s22 offen offset:2048 sc1
    v_mfma_f32_16x16x32_bf16 v[28:31], a[168:171], v[116:119], v[28:31]
    buffer_load_dwordx4 a[140:143], v1, s[4:7], s22 offen offset:3072 sc1
    v_mfma_f32_16x16x32_bf16 v[32:35], a[168:171], v[120:123], v[32:35]
    buffer_load_dwordx4 a[144:147], v1, s[4:7], s23 offen offset:0 sc1
    v_mfma_f32_16x16x32_bf16 v[36:39], a[172:175], v[116:119], v[36:39]
    buffer_load_dwordx4 a[148:151], v1, s[4:7], s23 offen offset:1024 sc1
    v_mfma_f32_16x16x32_bf16 v[40:43], a[172:175], v[120:123], v[40:43]
    buffer_load_dwordx4 a[152:155], v1, s[4:7], s23 offen offset:2048 sc1
    v_mfma_f32_16x16x32_bf16 v[44:47], a[176:179], v[116:119], v[44:47]
    buffer_load_dwordx4 a[156:159], v1, s[4:7], s23 offen offset:3072 sc1
    v_mfma_f32_16x16x32_bf16 v[48:51], a[176:179], v[120:123], v[48:51]
    s_add_u32 s22, s22, 40960
    v_mfma_f32_16x16x32_bf16 v[52:55], a[180:183], v[116:119], v[52:55]
    v_mfma_f32_16x16x32_bf16 v[56:59], a[180:183], v[120:123], v[56:59]
    v_mfma_f32_16x16x32_bf16 v[60:63], a[184:187], v[116:119], v[60:63]
    v_mfma_f32_16x16x32_bf16 v[64:67], a[184:187], v[120:123], v[64:67]
    v_mfma_f32_16x16x32_bf16 v[68:71], a[188:191], v[116:119], v[68:71]
    v_mfma_f32_16x16x32_bf16 v[72:75], a[188:191], v[120:123], v[72:75]
    v_mfma_f32_16x16x32_bf16 v[12:15], a[192:195], v[124:127], v[12:15]
    s_add_u32 s23, s22, 4096
    v_mfma_f32_16x16x32_bf16 v[16:19], a[192:195], v[128:131], v[16:19]
    buffer_load_dwordx4 a[160:163], v1, s[4:7], s22 offen offset:0 sc1
    v_mfma_f32_16x16x32_bf16 v[20:23], a[196:199], v[124:127], v[20:23]
    buffer_load_dwordx4 a[164:167], v1, s[4:7], s22 offen offset:1024 sc1
    v_mfma_f32_16x16x32_bf16 v[24:27], a[196:199], v[128:131], v[24:27]
    buffer_load_dwordx4 a[168:171], v1, s[4:7], s22 offen offset:2048 sc1
    v_mfma_f32_16x16x32_bf16 v[28:31], a[200:203], v[124:127], v[28:31]
    buffer_load_dwordx4 a[172:175], v1, s[4:7], s22 offen offset:3072 sc1
    v_mfma_f32_16x16x32_bf16 v[32:35], a[200:203], v[128:131], v[32:35]
    buffer_load_dwordx4 a[176:179], v1, s[4:7], s23 offen offset:0 sc1
    v_mfma_f32_16x16x32_bf16 v[36:39], a[204:207], v[124:127], v[36:39]
    buffer_load_dwordx4 a[180:183], v1, s[4:7], s23 offen offset:1024 sc1
    v_mfma_f32_16x16x32_bf16 v[40:43], a[204:207], v[128:131], v[40:43]
    buffer_load_dwordx4 a[184:187], v1, s[4:7], s23 offen offset:2048 sc1
    v_mfma_f32_16x16x32_bf16 v[44:47], a[208:211], v[124:127], v[44:47]
    buffer_load_dwordx4 a[188:191], v1, s[4:7], s23 offen offset:3072 sc1
    v_mfma_f32_16x16x32_bf16 v[48:51], a[208:211], v[128:131], v[48:51]
    s_add_u32 s22, s22, 40960
    v_mfma_f32_16x16x32_bf16 v[52:55], a[212:215], v[124:127], v[52:55]
    v_mfma_f32_16x16x32_bf16 v[56:59], a[212:215], v[128:131], v[56:59]
    v_mfma_f32_16x16x32_bf16 v[60:63], a[216:219], v[124:127], v[60:63]
    v_mfma_f32_16x16x32_bf16 v[64:67], a[216:219], v[128:131], v[64:67]
    v_mfma_f32_16x16x32_bf16 v[68:71], a[220:223], v[124:127], v[68:71]
    v_mfma_f32_16x16x32_bf16 v[72:75], a[220:223], v[128:131], v[72:75]
    v_mfma_f32_16x16x32_bf16 v[12:15], a[224:227], v[132:135], v[12:15]
    s_add_u32 s23, s22, 4096
    v_mfma_f32_16x16x32_bf16 v[16:19], a[224:227], v[136:139], v[16:19]
    buffer_load_dwordx4 a[192:195], v1, s[4:7], s22 offen offset:0 sc1
    v_mfma_f32_16x16x32_bf16 v[20:23], a[228:231], v[132:135], v[20:23]
    buffer_load_dwordx4 a[196:199], v1, s[4:7], s22 offen offset:1024 sc1
    v_mfma_f32_16x16x32_bf16 v[24:27], a[228:231], v[136:139], v[24:27]
    buffer_load_dwordx4 a[200:203], v1, s[4:7], s22 offen offset:2048 sc1
    v_mfma_f32_16x16x32_bf16 v[28:31], a[232:235], v[132:135], v[28:31]
    buffer_load_dwordx4 a[204:207], v1, s[4:7], s22 offen offset:3072 sc1
    v_mfma_f32_16x16x32_bf16 v[32:35], a[232:235], v[136:139], v[32:35]
    buffer_load_dwordx4 a[208:211], v1, s[4:7], s23 offen offset:0 sc1
    v_mfma_f32_16x16x32_bf16 v[36:39], a[236:239], v[132:135], v[36:39]
    buffer_load_dwordx4 a[212:215], v1, s[4:7], s23 offen offset:1024 sc1
    v_mfma_f32_16x16x32_bf16 v[40:43], a[236:239], v[136:139], v[40:43]
    buffer_load_dwordx4 a[216:219], v1, s[4:7], s23 offen offset:2048 sc1
    v_mfma_f32_16x16x32_bf16 v[44:47], a[240:243], v[132:135], v[44:47]
    buffer_load_dwordx4 a[220:223], v1, s[4:7], s23 offen offset:3072 sc1
    v_mfma_f32_16x16x32_bf16 v[48:51], a[240:243], v[136:139], v[48:51]
    s_add_u32 s22, s22, 40960
    v_mfma_f32_16x16x32_bf16 v[52:55], a[244:247], v[132:135], v[52:55]
    v_mfma_f32_16x16x32_bf16 v[56:59], a[244:247], v[136:139], v[56:59]
    v_mfma_f32_16x16x32_bf16 v[60:63], a[248:251], v[132:135], v[60:63]
    v_mfma_f32_16x16x32_bf16 v[64:67], a[248:251], v[136:139], v[64:67]
    v_mfma_f32_16x16x32_bf16 v[68:71], a[252:255], v[132:135], v[68:71]
    v_mfma_f32_16x16x32_bf16 v[72:75], a[252:255], v[136:139], v[72:75]
    s_add_u32 s23, s22, 4096
    buffer_load_dwordx4 a[224:227], v1, s[4:7], s22 offen offset:0 sc1
    buffer_load_dwordx4 a[228:231], v1, s[4:7], s22 offen offset:1024 sc1
    buffer_load_dwordx4 a[232:235], v1, s[4:7], s22 offen offset:2048 sc1
    buffer_load_dwordx4 a[236:239], v1, s[4:7], s22 offen offset:3072 sc1
    buffer_load_dwordx4 a[240:243], v1, s[4:7], s23 offen offset:0 sc1
    buffer_load_dwordx4 a[244:247], v1, s[4:7], s23 offen offset:1024 sc1
    buffer_load_dwordx4 a[248:251], v1, s[4:7], s23 offen offset:2048 sc1
    buffer_load_dwordx4 a[252:255], v1, s[4:7], s23 offen offset:3072 sc1
    s_add_u32 s22, s22, 40960
    s_branch Lc_j_50184
Lc_np_50183:
    v_mfma_f32_16x16x32_bf16 v[12:15], a[0:3], v[76:79], v[12:15]
    v_mfma_f32_16x16x32_bf16 v[16:19], a[0:3], v[80:83], v[16:19]
    v_mfma_f32_16x16x32_bf16 v[20:23], a[4:7], v[76:79], v[20:23]
    v_mfma_f32_16x16x32_bf16 v[24:27], a[4:7], v[80:83], v[24:27]
    v_mfma_f32_16x16x32_bf16 v[28:31], a[8:11], v[76:79], v[28:31]
    v_mfma_f32_16x16x32_bf16 v[32:35], a[8:11], v[80:83], v[32:35]
    v_mfma_f32_16x16x32_bf16 v[36:39], a[12:15], v[76:79], v[36:39]
    v_mfma_f32_16x16x32_bf16 v[40:43], a[12:15], v[80:83], v[40:43]
    v_mfma_f32_16x16x32_bf16 v[44:47], a[16:19], v[76:79], v[44:47]
    v_mfma_f32_16x16x32_bf16 v[48:51], a[16:19], v[80:83], v[48:51]
    v_mfma_f32_16x16x32_bf16 v[52:55], a[20:23], v[76:79], v[52:55]
    v_mfma_f32_16x16x32_bf16 v[56:59], a[20:23], v[80:83], v[56:59]
    v_mfma_f32_16x16x32_bf16 v[60:63], a[24:27], v[76:79], v[60:63]
    v_mfma_f32_16x16x32_bf16 v[64:67], a[24:27], v[80:83], v[64:67]
    v_mfma_f32_16x16x32_bf16 v[68:71], a[28:31], v[76:79], v[68:71]
    v_mfma_f32_16x16x32_bf16 v[72:75], a[28:31], v[80:83], v[72:75]
    v_mfma_f32_16x16x32_bf16 v[12:15], a[32:35], v[84:87], v[12:15]
    v_mfma_f32_16x16x32_bf16 v[16:19], a[32:35], v[88:91], v[16:19]
    v_mfma_f32_16x16x32_bf16 v[20:23], a[36:39], v[84:87], v[20:23]
    v_mfma_f32_16x16x32_bf16 v[24:27], a[36:39], v[88:91], v[24:27]
    v_mfma_f32_16x16x32_bf16 v[28:31], a[40:43], v[84:87], v[28:31]
    v_mfma_f32_16x16x32_bf16 v[32:35], a[40:43], v[88:91], v[32:35]
    v_mfma_f32_16x16x32_bf16 v[36:39], a[44:47], v[84:87], v[36:39]
    v_mfma_f32_16x16x32_bf16 v[40:43], a[44:47], v[88:91], v[40:43]
    v_mfma_f32_16x16x32_bf16 v[44:47], a[48:51], v[84:87], v[44:47]
    v_mfma_f32_16x16x32_bf16 v[48:51], a[48:51], v[88:91], v[48:51]
    v_mfma_f32_16x16x32_bf16 v[52:55], a[52:55], v[84:87], v[52:55]
    v_mfma_f32_16x16x32_bf16 v[56:59], a[52:55], v[88:91], v[56:59]
    v_mfma_f32_16x16x32_bf16 v[60:63], a[56:59], v[84:87], v[60:63]
    v_mfma_f32_16x16x32_bf16 v[64:67], a[56:59], v[88:91], v[64:67]
    v_mfma_f32_16x16x32_bf16 v[68:71], a[60:63], v[84:87], v[68:71]
    v_mfma_f32_16x16x32_bf16 v[72:75], a[60:63], v[88:91], v[72:75]
    v_mfma_f32_16x16x32_bf16 v[12:15], a[64:67], v[92:95], v[12:15]
    v_mfma_f32_16x16x32_bf16 v[16:19], a[64:67], v[96:99], v[16:19]
    v_mfma_f32_16x16x32_bf16 v[20:23], a[68:71], v[92:95], v[20:23]
    v_mfma_f32_16x16x32_bf16 v[24:27], a[68:71], v[96:99], v[24:27]
    v_mfma_f32_16x16x32_bf16 v[28:31], a[72:75], v[92:95], v[28:31]
    v_mfma_f32_16x16x32_bf16 v[32:35], a[72:75], v[96:99], v[32:35]
    v_mfma_f32_16x16x32_bf16 v[36:39], a[76:79], v[92:95], v[36:39]
    v_mfma_f32_16x16x32_bf16 v[40:43], a[76:79], v[96:99], v[40:43]
    v_mfma_f32_16x16x32_bf16 v[44:47], a[80:83], v[92:95], v[44:47]
    v_mfma_f32_16x16x32_bf16 v[48:51], a[80:83], v[96:99], v[48:51]
    v_mfma_f32_16x16x32_bf16 v[52:55], a[84:87], v[92:95], v[52:55]
    v_mfma_f32_16x16x32_bf16 v[56:59], a[84:87], v[96:99], v[56:59]
    v_mfma_f32_16x16x32_bf16 v[60:63], a[88:91], v[92:95], v[60:63]
    v_mfma_f32_16x16x32_bf16 v[64:67], a[88:91], v[96:99], v[64:67]
    v_mfma_f32_16x16x32_bf16 v[68:71], a[92:95], v[92:95], v[68:71]
    v_mfma_f32_16x16x32_bf16 v[72:75], a[92:95], v[96:99], v[72:75]
    v_mfma_f32_16x16x32_bf16 v[12:15], a[96:99], v[100:103], v[12:15]
    v_mfma_f32_16x16x32_bf16 v[16:19], a[96:99], v[104:107], v[16:19]
    v_mfma_f32_16x16x32_bf16 v[20:23], a[100:103], v[100:103], v[20:23]
    v_mfma_f32_16x16x32_bf16 v[24:27], a[100:103], v[104:107], v[24:27]
    v_mfma_f32_16x16x32_bf16 v[28:31], a[104:107], v[100:103], v[28:31]
    v_mfma_f32_16x16x32_bf16 v[32:35], a[104:107], v[104:107], v[32:35]
    v_mfma_f32_16x16x32_bf16 v[36:39], a[108:111], v[100:103], v[36:39]
    v_mfma_f32_16x16x32_bf16 v[40:43], a[108:111], v[104:107], v[40:43]
    v_mfma_f32_16x16x32_bf16 v[44:47], a[112:115], v[100:103], v[44:47]
    v_mfma_f32_16x16x32_bf16 v[48:51], a[112:115], v[104:107], v[48:51]
    v_mfma_f32_16x16x32_bf16 v[52:55], a[116:119], v[100:103], v[52:55]
    v_mfma_f32_16x16x32_bf16 v[56:59], a[116:119], v[104:107], v[56:59]
    v_mfma_f32_16x16x32_bf16 v[60:63], a[120:123], v[100:103], v[60:63]
    v_mfma_f32_16x16x32_bf16 v[64:67], a[120:123], v[104:107], v[64:67]
    v_mfma_f32_16x16x32_bf16 v[68:71], a[124:127], v[100:103], v[68:71]
    v_mfma_f32_16x16x32_bf16 v[72:75], a[124:127], v[104:107], v[72:75]
    v_mfma_f32_16x16x32_bf16 v[12:15], a[128:131], v[108:111], v[12:15]
    v_mfma_f32_16x16x32_bf16 v[16:19], a[128:131], v[112:115], v[16:19]
    v_mfma_f32_16x16x32_bf16 v[20:23], a[132:135], v[108:111], v[20:23]
    v_mfma_f32_16x16x32_bf16 v[24:27], a[132:135], v[112:115], v[24:27]
    v_mfma_f32_16x16x32_bf16 v[28:31], a[136:139], v[108:111], v[28:31]
    v_mfma_f32_16x16x32_bf16 v[32:35], a[136:139], v[112:115], v[32:35]
    v_mfma_f32_16x16x32_bf16 v[36:39], a[140:143], v[108:111], v[36:39]
    v_mfma_f32_16x16x32_bf16 v[40:43], a[140:143], v[112:115], v[40:43]
    v_mfma_f32_16x16x32_bf16 v[44:47], a[144:147], v[108:111], v[44:47]
    v_mfma_f32_16x16x32_bf16 v[48:51], a[144:147], v[112:115], v[48:51]
    v_mfma_f32_16x16x32_bf16 v[52:55], a[148:151], v[108:111], v[52:55]
    v_mfma_f32_16x16x32_bf16 v[56:59], a[148:151], v[112:115], v[56:59]
    v_mfma_f32_16x16x32_bf16 v[60:63], a[152:155], v[108:111], v[60:63]
    v_mfma_f32_16x16x32_bf16 v[64:67], a[152:155], v[112:115], v[64:67]
    v_mfma_f32_16x16x32_bf16 v[68:71], a[156:159], v[108:111], v[68:71]
    v_mfma_f32_16x16x32_bf16 v[72:75], a[156:159], v[112:115], v[72:75]
    v_mfma_f32_16x16x32_bf16 v[12:15], a[160:163], v[116:119], v[12:15]
    v_mfma_f32_16x16x32_bf16 v[16:19], a[160:163], v[120:123], v[16:19]
    v_mfma_f32_16x16x32_bf16 v[20:23], a[164:167], v[116:119], v[20:23]
    v_mfma_f32_16x16x32_bf16 v[24:27], a[164:167], v[120:123], v[24:27]
    v_mfma_f32_16x16x32_bf16 v[28:31], a[168:171], v[116:119], v[28:31]
    v_mfma_f32_16x16x32_bf16 v[32:35], a[168:171], v[120:123], v[32:35]
    v_mfma_f32_16x16x32_bf16 v[36:39], a[172:175], v[116:119], v[36:39]
    v_mfma_f32_16x16x32_bf16 v[40:43], a[172:175], v[120:123], v[40:43]
    v_mfma_f32_16x16x32_bf16 v[44:47], a[176:179], v[116:119], v[44:47]
    v_mfma_f32_16x16x32_bf16 v[48:51], a[176:179], v[120:123], v[48:51]
    v_mfma_f32_16x16x32_bf16 v[52:55], a[180:183], v[116:119], v[52:55]
    v_mfma_f32_16x16x32_bf16 v[56:59], a[180:183], v[120:123], v[56:59]
    v_mfma_f32_16x16x32_bf16 v[60:63], a[184:187], v[116:119], v[60:63]
    v_mfma_f32_16x16x32_bf16 v[64:67], a[184:187], v[120:123], v[64:67]
    v_mfma_f32_16x16x32_bf16 v[68:71], a[188:191], v[116:119], v[68:71]
    v_mfma_f32_16x16x32_bf16 v[72:75], a[188:191], v[120:123], v[72:75]
    v_mfma_f32_16x16x32_bf16 v[12:15], a[192:195], v[124:127], v[12:15]
    v_mfma_f32_16x16x32_bf16 v[16:19], a[192:195], v[128:131], v[16:19]
    v_mfma_f32_16x16x32_bf16 v[20:23], a[196:199], v[124:127], v[20:23]
    v_mfma_f32_16x16x32_bf16 v[24:27], a[196:199], v[128:131], v[24:27]
    v_mfma_f32_16x16x32_bf16 v[28:31], a[200:203], v[124:127], v[28:31]
    v_mfma_f32_16x16x32_bf16 v[32:35], a[200:203], v[128:131], v[32:35]
    v_mfma_f32_16x16x32_bf16 v[36:39], a[204:207], v[124:127], v[36:39]
    v_mfma_f32_16x16x32_bf16 v[40:43], a[204:207], v[128:131], v[40:43]
    v_mfma_f32_16x16x32_bf16 v[44:47], a[208:211], v[124:127], v[44:47]
    v_mfma_f32_16x16x32_bf16 v[48:51], a[208:211], v[128:131], v[48:51]
    v_mfma_f32_16x16x32_bf16 v[52:55], a[212:215], v[124:127], v[52:55]
    v_mfma_f32_16x16x32_bf16 v[56:59], a[212:215], v[128:131], v[56:59]
    v_mfma_f32_16x16x32_bf16 v[60:63], a[216:219], v[124:127], v[60:63]
    v_mfma_f32_16x16x32_bf16 v[64:67], a[216:219], v[128:131], v[64:67]
    v_mfma_f32_16x16x32_bf16 v[68:71], a[220:223], v[124:127], v[68:71]
    v_mfma_f32_16x16x32_bf16 v[72:75], a[220:223], v[128:131], v[72:75]
    v_mfma_f32_16x16x32_bf16 v[12:15], a[224:227], v[132:135], v[12:15]
    v_mfma_f32_16x16x32_bf16 v[16:19], a[224:227], v[136:139], v[16:19]
    v_mfma_f32_16x16x32_bf16 v[20:23], a[228:231], v[132:135], v[20:23]
    v_mfma_f32_16x16x32_bf16 v[24:27], a[228:231], v[136:139], v[24:27]
    v_mfma_f32_16x16x32_bf16 v[28:31], a[232:235], v[132:135], v[28:31]
    v_mfma_f32_16x16x32_bf16 v[32:35], a[232:235], v[136:139], v[32:35]
    v_mfma_f32_16x16x32_bf16 v[36:39], a[236:239], v[132:135], v[36:39]
    v_mfma_f32_16x16x32_bf16 v[40:43], a[236:239], v[136:139], v[40:43]
    v_mfma_f32_16x16x32_bf16 v[44:47], a[240:243], v[132:135], v[44:47]
    v_mfma_f32_16x16x32_bf16 v[48:51], a[240:243], v[136:139], v[48:51]
    v_mfma_f32_16x16x32_bf16 v[52:55], a[244:247], v[132:135], v[52:55]
    v_mfma_f32_16x16x32_bf16 v[56:59], a[244:247], v[136:139], v[56:59]
    v_mfma_f32_16x16x32_bf16 v[60:63], a[248:251], v[132:135], v[60:63]
    v_mfma_f32_16x16x32_bf16 v[64:67], a[248:251], v[136:139], v[64:67]
    v_mfma_f32_16x16x32_bf16 v[68:71], a[252:255], v[132:135], v[68:71]
    v_mfma_f32_16x16x32_bf16 v[72:75], a[252:255], v[136:139], v[72:75]
    s_nop 7
Lc_j_50184:
    s_lshl_b32 s36, s14, 14
    v_add_u32 v221, s36, v1
    ds_write_b128 v221, v[12:15] offset:0
    ds_write_b128 v221, v[16:19] offset:1024
    ds_write_b128 v221, v[20:23] offset:2048
    ds_write_b128 v221, v[24:27] offset:3072
    ds_write_b128 v221, v[28:31] offset:4096
    ds_write_b128 v221, v[32:35] offset:5120
    ds_write_b128 v221, v[36:39] offset:6144
    ds_write_b128 v221, v[40:43] offset:7168
    ds_write_b128 v221, v[44:47] offset:8192
    ds_write_b128 v221, v[48:51] offset:9216
    ds_write_b128 v221, v[52:55] offset:10240
    ds_write_b128 v221, v[56:59] offset:11264
    ds_write_b128 v221, v[60:63] offset:12288
    ds_write_b128 v221, v[64:67] offset:13312
    ds_write_b128 v221, v[68:71] offset:14336
    ds_write_b128 v221, v[72:75] offset:15360
    s_waitcnt lgkmcnt(0)
    s_barrier
    s_lshl_b32 s36, s14, 12
    v_add_u32 v221, s36, v1
    ds_read_b128 v[76:79], v221 offset:0
    ds_read_b128 v[80:83], v221 offset:16384
    ds_read_b128 v[84:87], v221 offset:32768
    ds_read_b128 v[88:91], v221 offset:49152
    ds_read_b128 v[92:95], v221 offset:1024
    ds_read_b128 v[96:99], v221 offset:17408
    ds_read_b128 v[100:103], v221 offset:33792
    ds_read_b128 v[104:107], v221 offset:50176
    ds_read_b128 v[108:111], v221 offset:2048
    ds_read_b128 v[112:115], v221 offset:18432
    ds_read_b128 v[116:119], v221 offset:34816
    ds_read_b128 v[120:123], v221 offset:51200
    ds_read_b128 v[124:127], v221 offset:3072
    ds_read_b128 v[128:131], v221 offset:19456
    ds_read_b128 v[132:135], v221 offset:35840
    ds_read_b128 v[136:139], v221 offset:52224
    s_waitcnt lgkmcnt(12)
    v_pk_add_f32 v[76:77], v[76:77], v[80:81]
    v_pk_add_f32 v[84:85], v[84:85], v[88:89]
    v_pk_add_f32 v[78:79], v[78:79], v[82:83]
    v_pk_add_f32 v[86:87], v[86:87], v[90:91]
    v_pk_add_f32 v[76:77], v[76:77], v[84:85]
    v_pk_add_f32 v[78:79], v[78:79], v[86:87]
    s_waitcnt lgkmcnt(8)
    v_pk_add_f32 v[92:93], v[92:93], v[96:97]
    v_pk_add_f32 v[100:101], v[100:101], v[104:105]
    v_pk_add_f32 v[94:95], v[94:95], v[98:99]
    v_pk_add_f32 v[102:103], v[102:103], v[106:107]
    v_pk_add_f32 v[92:93], v[92:93], v[100:101]
    v_pk_add_f32 v[94:95], v[94:95], v[102:103]
    s_waitcnt lgkmcnt(4)
    v_pk_add_f32 v[108:109], v[108:109], v[112:113]
    v_pk_add_f32 v[116:117], v[116:117], v[120:121]
    v_pk_add_f32 v[110:111], v[110:111], v[114:115]
    v_pk_add_f32 v[118:119], v[118:119], v[122:123]
    v_pk_add_f32 v[108:109], v[108:109], v[116:117]
    v_pk_add_f32 v[110:111], v[110:111], v[118:119]
    s_waitcnt lgkmcnt(0)
    v_pk_add_f32 v[124:125], v[124:125], v[128:129]
    v_pk_add_f32 v[132:133], v[132:133], v[136:137]
    v_pk_add_f32 v[126:127], v[126:127], v[130:131]
    v_pk_add_f32 v[134:135], v[134:135], v[138:139]
    v_pk_add_f32 v[124:125], v[124:125], v[132:133]
    v_pk_add_f32 v[126:127], v[126:127], v[134:135]
    v_cvt_pk_bf16_f32 v28, v76, v77
    v_lshlrev_b32 v29, 16, v28
    v_and_b32 v28, 0xffff0000, v28
    v_lshlrev_b32 v30, 16, v224
    v_and_b32 v31, 0xffff0000, v224
    v_add_f32 v29, v29, v30
    v_add_f32 v28, v28, v31
    v_cvt_pk_bf16_f32 v12, v29, v28
    v_lshlrev_b32 v20, 16, v12
    v_and_b32 v21, 0xffff0000, v12
    v_cvt_pk_bf16_f32 v28, v78, v79
    v_lshlrev_b32 v29, 16, v28
    v_and_b32 v28, 0xffff0000, v28
    v_lshlrev_b32 v30, 16, v225
    v_and_b32 v31, 0xffff0000, v225
    v_add_f32 v29, v29, v30
    v_add_f32 v28, v28, v31
    v_cvt_pk_bf16_f32 v13, v29, v28
    v_lshlrev_b32 v22, 16, v13
    v_and_b32 v23, 0xffff0000, v13
    v_cvt_pk_bf16_f32 v28, v108, v109
    v_lshlrev_b32 v29, 16, v28
    v_and_b32 v28, 0xffff0000, v28
    v_lshlrev_b32 v30, 16, v226
    v_and_b32 v31, 0xffff0000, v226
    v_add_f32 v29, v29, v30
    v_add_f32 v28, v28, v31
    v_cvt_pk_bf16_f32 v14, v29, v28
    v_lshlrev_b32 v24, 16, v14
    v_and_b32 v25, 0xffff0000, v14
    v_cvt_pk_bf16_f32 v28, v110, v111
    v_lshlrev_b32 v29, 16, v28
    v_and_b32 v28, 0xffff0000, v28
    v_lshlrev_b32 v30, 16, v227
    v_and_b32 v31, 0xffff0000, v227
    v_add_f32 v29, v29, v30
    v_add_f32 v28, v28, v31
    v_cvt_pk_bf16_f32 v15, v29, v28
    v_lshlrev_b32 v26, 16, v15
    v_and_b32 v27, 0xffff0000, v15
    s_lshl_b32 s34, s17, 1
    s_add_u32 s34, s34, 0
    s_mul_i32 s35, s34, 20
    s_add_u32 s35, s35, s29
    s_lshl_b32 s35, s35, 10
    s_add_u32 s35, s35, 0xa200000
    buffer_store_dwordx4 v[12:15], v1, s[4:7], s35 offen sc1
    s_mul_i32 s34, s34, 2560
    s_lshl_b32 s35, s29, 7
    s_add_u32 s34, s34, s35
    s_add_u32 s34, s34, 0xb100000
    v_add_f32 v32, v20, v21
    v_mul_f32 v33, v20, v20
    v_fmac_f32 v33, v21, v21
    v_add_f32 v32, v32, v22
    v_fmac_f32 v33, v22, v22
    v_add_f32 v32, v32, v23
    v_fmac_f32 v33, v23, v23
    v_add_f32 v32, v32, v24
    v_fmac_f32 v33, v24, v24
    v_add_f32 v32, v32, v25
    v_fmac_f32 v33, v25, v25
    v_add_f32 v32, v32, v26
    v_fmac_f32 v33, v26, v26
    v_add_f32 v32, v32, v27
    v_fmac_f32 v33, v27, v27
    v_mov_b32 v28, v32
    s_nop 1
    v_permlane16_swap_b32 v32, v28
    v_add_f32 v32, v32, v28
    v_mov_b32 v28, v32
    s_nop 1
    v_permlane32_swap_b32 v32, v28
    v_add_f32 v32, v32, v28
    v_mov_b32 v28, v33
    s_nop 1
    v_permlane16_swap_b32 v33, v28
    v_add_f32 v33, v33, v28
    v_mov_b32 v28, v33
    s_nop 1
    v_permlane32_swap_b32 v33, v28
    v_add_f32 v33, v33, v28
    s_mov_b64 exec, 0xffff
    buffer_store_dwordx2 v[32:33], v233, s[4:7], s34 offen sc1
    s_mov_b64 exec, -1
    v_cvt_pk_bf16_f32 v28, v92, v93
    v_lshlrev_b32 v29, 16, v28
    v_and_b32 v28, 0xffff0000, v28
    v_lshlrev_b32 v30, 16, v228
    v_and_b32 v31, 0xffff0000, v228
    v_add_f32 v29, v29, v30
    v_add_f32 v28, v28, v31
    v_cvt_pk_bf16_f32 v16, v29, v28
    v_lshlrev_b32 v20, 16, v16
    v_and_b32 v21, 0xffff0000, v16
    v_cvt_pk_bf16_f32 v28, v94, v95
    v_lshlrev_b32 v29, 16, v28
    v_and_b32 v28, 0xffff0000, v28
    v_lshlrev_b32 v30, 16, v229
    v_and_b32 v31, 0xffff0000, v229
    v_add_f32 v29, v29, v30
    v_add_f32 v28, v28, v31
    v_cvt_pk_bf16_f32 v17, v29, v28
    v_lshlrev_b32 v22, 16, v17
    v_and_b32 v23, 0xffff0000, v17
    v_cvt_pk_bf16_f32 v28, v124, v125
    v_lshlrev_b32 v29, 16, v28
    v_and_b32 v28, 0xffff0000, v28
    v_lshlrev_b32 v30, 16, v230
    v_and_b32 v31, 0xffff0000, v230
    v_add_f32 v29, v29, v30
    v_add_f32 v28, v28, v31
    v_cvt_pk_bf16_f32 v18, v29, v28
    v_lshlrev_b32 v24, 16, v18
    v_and_b32 v25, 0xffff0000, v18
    v_cvt_pk_bf16_f32 v28, v126, v127
    v_lshlrev_b32 v29, 16, v28
    v_and_b32 v28, 0xffff0000, v28
    v_lshlrev_b32 v30, 16, v231
    v_and_b32 v31, 0xffff0000, v231
    v_add_f32 v29, v29, v30
    v_add_f32 v28, v28, v31
    v_cvt_pk_bf16_f32 v19, v29, v28
    v_lshlrev_b32 v26, 16, v19
    v_and_b32 v27, 0xffff0000, v19
    s_lshl_b32 s34, s17, 1
    s_add_u32 s34, s34, 1
    s_mul_i32 s35, s34, 20
    s_add_u32 s35, s35, s29
    s_lshl_b32 s35, s35, 10
    s_add_u32 s35, s35, 0xa200000
    buffer_store_dwordx4 v[16:19], v1, s[4:7], s35 offen sc1
    s_mul_i32 s34, s34, 2560
    s_lshl_b32 s35, s29, 7
    s_add_u32 s34, s34, s35
    s_add_u32 s34, s34, 0xb100000
    v_add_f32 v34, v20, v21
    v_mul_f32 v35, v20, v20
    v_fmac_f32 v35, v21, v21
    v_add_f32 v34, v34, v22
    v_fmac_f32 v35, v22, v22
    v_add_f32 v34, v34, v23
    v_fmac_f32 v35, v23, v23
    v_add_f32 v34, v34, v24
    v_fmac_f32 v35, v24, v24
    v_add_f32 v34, v34, v25
    v_fmac_f32 v35, v25, v25
    v_add_f32 v34, v34, v26
    v_fmac_f32 v35, v26, v26
    v_add_f32 v34, v34, v27
    v_fmac_f32 v35, v27, v27
    v_mov_b32 v28, v34
    s_nop 1
    v_permlane16_swap_b32 v34, v28
    v_add_f32 v34, v34, v28
    v_mov_b32 v28, v34
    s_nop 1
    v_permlane32_swap_b32 v34, v28
    v_add_f32 v34, v34, v28
    v_mov_b32 v28, v35
    s_nop 1
    v_permlane16_swap_b32 v35, v28
    v_add_f32 v35, v35, v28
    v_mov_b32 v28, v35
    s_nop 1
    v_permlane32_swap_b32 v35, v28
    v_add_f32 v35, v35, v28
    s_mov_b64 exec, 0xffff
    buffer_store_dwordx2 v[34:35], v233, s[4:7], s34 offen sc1
    s_mov_b64 exec, -1
    s_waitcnt vmcnt(0)
    s_barrier
    v_mov_b32 v40, v4
    v_mov_b32 v41, v5
    s_cmp_lg_u32 s14, 0
    s_cbranch_scc1 Lcs_50185
    s_lshl_b32 s46, s17, 6
    s_add_u32 s46, s46, 0xb203040
    v_mov_b32 v4, s46
    v_mov_b32 v5, 1
    s_mov_b64 exec, 1
    buffer_atomic_add v5, v4, s[4:7], 0 offen
    s_mov_b64 exec, -1
Lcs_50185:
    v_mov_b32 v4, v40
    v_mov_b32 v5, v41
    s_add_u32 s17, s17, s19
    s_cmp_lt_u32 s17, 64
    s_cbranch_scc1 Lc_loop_50174
    s_branch Lmain_end
Lph_d1:
    s_sub_u32 s20, s26, 35
    s_mul_i32 s17, s20, 0x3334
    s_lshr_b32 s17, s17, 16
    s_mul_i32 s18, s17, 5
    s_sub_u32 s18, s20, s18
    s_mov_b32 s50, 64
Lph_d1b:
    v_lshlrev_b32 v1, 4, v0
    v_and_b32 v2, 15, v0
    v_lshrrev_b32 v3, 4, v0
    s_lshl_b32 s29, s18, 2
    s_add_u32 s29, s29, s14
    s_mul_i32 s23, s29, 40960
    s_add_u32 s23, s23, 0xba00000
    buffer_load_dwordx4 a[0:3], v1, s[4:7], s23 offen offset:0 sc1
    buffer_load_dwordx4 a[4:7], v1, s[4:7], s23 offen offset:1024 sc1
    buffer_load_dwordx4 a[8:11], v1, s[4:7], s23 offen offset:2048 sc1
    buffer_load_dwordx4 a[12:15], v1, s[4:7], s23 offen offset:3072 sc1
    s_add_u32 s23, s23, 4096
    buffer_load_dwordx4 a[16:19], v1, s[4:7], s23 offen offset:0 sc1
    buffer_load_dwordx4 a[20:23], v1, s[4:7], s23 offen offset:1024 sc1
    buffer_load_dwordx4 a[24:27], v1, s[4:7], s23 offen offset:2048 sc1
    buffer_load_dwordx4 a[28:31], v1, s[4:7], s23 offen offset:3072 sc1
    s_add_u32 s23, s23, 4096
    buffer_load_dwordx4 a[32:35], v1, s[4:7], s23 offen offset:0 sc1
    buffer_load_dwordx4 a[36:39], v1, s[4:7], s23 offen offset:1024 sc1
    buffer_load_dwordx4 a[40:43], v1, s[4:7], s23 offen offset:2048 sc1
    buffer_load_dwordx4 a[44:47], v1, s[4:7], s23 offen offset:3072 sc1
    s_add_u32 s23, s23, 4096
    buffer_load_dwordx4 a[48:51], v1, s[4:7], s23 offen offset:0 sc1
    buffer_load_dwordx4 a[52:55], v1, s[4:7], s23 offen offset:1024 sc1
    buffer_load_dwordx4 a[56:59], v1, s[4:7], s23 offen offset:2048 sc1
    buffer_load_dwordx4 a[60:63], v1, s[4:7], s23 offen offset:3072 sc1
    s_add_u32 s23, s23, 4096
    buffer_load_dwordx4 a[64:67], v1, s[4:7], s23 offen offset:0 sc1
    buffer_load_dwordx4 a[68:71], v1, s[4:7], s23 offen offset:1024 sc1
    buffer_load_dwordx4 a[72:75], v1, s[4:7], s23 offen offset:2048 sc1
    buffer_load_dwordx4 a[76:79], v1, s[4:7], s23 offen offset:3072 sc1
    s_add_u32 s23, s23, 4096
    buffer_load_dwordx4 a[80:83], v1, s[4:7], s23 offen offset:0 sc1
    buffer_load_dwordx4 a[84:87], v1, s[4:7], s23 offen offset:1024 sc1
    buffer_load_dwordx4 a[88:91], v1, s[4:7], s23 offen offset:2048 sc1
    buffer_load_dwordx4 a[92:95], v1, s[4:7], s23 offen offset:3072 sc1
    s_add_u32 s23, s23, 4096
    buffer_load_dwordx4 a[96:99], v1, s[4:7], s23 offen offset:0 sc1
    buffer_load_dwordx4 a[100:103], v1, s[4:7], s23 offen offset:1024 sc1
    buffer_load_dwordx4 a[104:107], v1, s[4:7], s23 offen offset:2048 sc1
    buffer_load_dwordx4 a[108:111], v1, s[4:7], s23 offen offset:3072 sc1
    s_add_u32 s23, s23, 4096
    buffer_load_dwordx4 a[112:115], v1, s[4:7], s23 offen offset:0 sc1
    buffer_load_dwordx4 a[116:119], v1, s[4:7], s23 offen offset:1024 sc1
    buffer_load_dwordx4 a[120:123], v1, s[4:7], s23 offen offset:2048 sc1
    buffer_load_dwordx4 a[124:127], v1, s[4:7], s23 offen offset:3072 sc1
    s_add_u32 s23, s23, 4096
    buffer_load_dwordx4 a[128:131], v1, s[4:7], s23 offen offset:0 sc1
    buffer_load_dwordx4 a[132:135], v1, s[4:7], s23 offen offset:1024 sc1
    buffer_load_dwordx4 a[136:139], v1, s[4:7], s23 offen offset:2048 sc1
    buffer_load_dwordx4 a[140:143], v1, s[4:7], s23 offen offset:3072 sc1
    s_add_u32 s23, s23, 4096
    buffer_load_dwordx4 a[144:147], v1, s[4:7], s23 offen offset:0 sc1
    buffer_load_dwordx4 a[148:151], v1, s[4:7], s23 offen offset:1024 sc1
    buffer_load_dwordx4 a[152:155], v1, s[4:7], s23 offen offset:2048 sc1
    buffer_load_dwordx4 a[156:159], v1, s[4:7], s23 offen offset:3072 sc1
    s_add_u32 s23, s23, 4096
    v_mov_b32 v7, 0xc0135761
    s_mov_b32 s51, 0xbdd2d3e8
    s_waitcnt vmcnt(0)
    v_mov_b32 v36, 0x3f803f80
    v_mov_b32 v37, 0x3f803f80
    v_mov_b32 v38, 0x3f803f80
    v_mov_b32 v39, 0x3f803f80
    s_nop 1
    v_mfma_f32_16x16x32_bf16 v[28:31], a[0:3], v[36:39], 0
    v_mfma_f32_16x16x32_bf16 v[32:35], a[80:83], v[36:39], 0
    v_mfma_f32_16x16x32_bf16 v[28:31], a[4:7], v[36:39], v[28:31]
    v_mfma_f32_16x16x32_bf16 v[32:35], a[84:87], v[36:39], v[32:35]
    v_mfma_f32_16x16x32_bf16 v[28:31], a[8:11], v[36:39], v[28:31]
    v_mfma_f32_16x16x32_bf16 v[32:35], a[88:91], v[36:39], v[32:35]
    v_mfma_f32_16x16x32_bf16 v[28:31], a[12:15], v[36:39], v[28:31]
    v_mfma_f32_16x16x32_bf16 v[32:35], a[92:95], v[36:39], v[32:35]
    v_mfma_f32_16x16x32_bf16 v[28:31], a[16:19], v[36:39], v[28:31]
    v_mfma_f32_16x16x32_bf16 v[32:35], a[96:99], v[36:39], v[32:35]
    v_mfma_f32_16x16x32_bf16 v[28:31], a[20:23], v[36:39], v[28:31]
    v_mfma_f32_16x16x32_bf16 v[32:35], a[100:103], v[36:39], v[32:35]
    v_mfma_f32_16x16x32_bf16 v[28:31], a[24:27], v[36:39], v[28:31]
    v_mfma_f32_16x16x32_bf16 v[32:35], a[104:107], v[36:39], v[32:35]
    v_mfma_f32_16x16x32_bf16 v[28:31], a[28:31], v[36:39], v[28:31]
    v_mfma_f32_16x16x32_bf16 v[32:35], a[108:111], v[36:39], v[32:35]
    v_mfma_f32_16x16x32_bf16 v[28:31], a[32:35], v[36:39], v[28:31]
    v_mfma_f32_16x16x32_bf16 v[32:35], a[112:115], v[36:39], v[32:35]
    v_mfma_f32_16x16x32_bf16 v[28:31], a[36:39], v[36:39], v[28:31]
    v_mfma_f32_16x16x32_bf16 v[32:35], a[116:119], v[36:39], v[32:35]
    v_mfma_f32_16x16x32_bf16 v[28:31], a[40:43], v[36:39], v[28:31]
    v_mfma_f32_16x16x32_bf16 v[32:35], a[120:123], v[36:39], v[32:35]
    v_mfma_f32_16x16x32_bf16 v[28:31], a[44:47], v[36:39], v[28:31]
    v_mfma_f32_16x16x32_bf16 v[32:35], a[124:127], v[36:39], v[32:35]
    v_mfma_f32_16x16x32_bf16 v[28:31], a[48:51], v[36:39], v[28:31]
    v_mfma_f32_16x16x32_bf16 v[32:35], a[128:131], v[36:39], v[32:35]
    v_mfma_f32_16x16x32_bf16 v[28:31], a[52:55], v[36:39], v[28:31]
    v_mfma_f32_16x16x32_bf16 v[32:35], a[132:135], v[36:39], v[32:35]
    v_mfma_f32_16x16x32_bf16 v[28:31], a[56:59], v[36:39], v[28:31]
    v_mfma_f32_16x16x32_bf16 v[32:35], a[136:139], v[36:39], v[32:35]
    v_mfma_f32_16x16x32_bf16 v[28:31], a[60:63], v[36:39], v[28:31]
    v_mfma_f32_16x16x32_bf16 v[32:35], a[140:143], v[36:39], v[32:35]
    v_mfma_f32_16x16x32_bf16 v[28:31], a[64:67], v[36:39], v[28:31]
    v_mfma_f32_16x16x32_bf16 v[32:35], a[144:147], v[36:39], v[32:35]
    v_mfma_f32_16x16x32_bf16 v[28:31], a[68:71], v[36:39], v[28:31]
    v_mfma_f32_16x16x32_bf16 v[32:35], a[148:151], v[36:39], v[32:35]
    v_mfma_f32_16x16x32_bf16 v[28:31], a[72:75], v[36:39], v[28:31]
    v_mfma_f32_16x16x32_bf16 v[32:35], a[152:155], v[36:39], v[32:35]
    v_mfma_f32_16x16x32_bf16 v[28:31], a[76:79], v[36:39], v[28:31]
    v_mfma_f32_16x16x32_bf16 v[32:35], a[156:159], v[36:39], v[32:35]
    s_mov_b32 s55, 64
    v_add_u32 v8, s17, v0
    v_cmp_gt_u32 vcc, 64, v8
    s_and_b64 s[48:49], vcc, 1
    v_lshlrev_b32 v8, 6, v8
    v_add_u32 v8, 0xb203040, v8
    s_mov_b64 exec, s[48:49]
    s_nop 0
Lwp_50188:
    buffer_load_dword v9, v8, s[4:7], 0 offen sc1
    s_waitcnt vmcnt(0)
    v_cmp_gt_u32 vcc, 5, v9
    s_nop 0
    s_cbranch_vccz Lwpd_50189
    s_sleep 5
    s_add_u32 s30, s30, 1
    s_cmp_lt_u32 s30, s31
    s_cbranch_scc1 Lwp_50188
Lwpd_50189:
    s_mov_b64 exec, -1
    s_mul_i32 s20, s17, 40960
    s_add_u32 s20, s20, 0xa200000
    s_mul_i32 s21, s14, 10240
    s_add_u32 s20, s20, s21
    s_add_u32 s21, s21, 0
    s_mov_b32 m0, s21
    s_nop 0
    buffer_load_dwordx4 v1, s[4:7], s20 offen offset:0 sc1 lds
    buffer_load_dwordx4 v1, s[4:7], s20 offen offset:1024 sc1 lds
    buffer_load_dwordx4 v1, s[4:7], s20 offen offset:2048 sc1 lds
    buffer_load_dwordx4 v1, s[4:7], s20 offen offset:3072 sc1 lds
    s_add_u32 s20, s20, 4096
    s_add_u32 s21, s21, 4096
    s_mov_b32 m0, s21
    s_nop 0
    buffer_load_dwordx4 v1, s[4:7], s20 offen offset:0 sc1 lds
    buffer_load_dwordx4 v1, s[4:7], s20 offen offset:1024 sc1 lds
    buffer_load_dwordx4 v1, s[4:7], s20 offen offset:2048 sc1 lds
    buffer_load_dwordx4 v1, s[4:7], s20 offen offset:3072 sc1 lds
    s_add_u32 s20, s20, 4096
    s_add_u32 s21, s21, 4096
    s_mov_b32 m0, s21
    s_nop 0
    buffer_load_dwordx4 v1, s[4:7], s20 offen offset:0 sc1 lds
    buffer_load_dwordx4 v1, s[4:7], s20 offen offset:1024 sc1 lds
    v_mul_u32_u24 v124, 640, v3
    v_lshl_add_u32 v124, v2, 3, v124
    s_mul_i32 s25, s17, 5120
    s_add_u32 s25, s25, 0xb100000
    buffer_load_dwordx2 v[64:65], v124, s[4:7], s25 offen offset:0 sc1
    buffer_load_dwordx2 v[66:67], v124, s[4:7], s25 offen offset:128 sc1
    buffer_load_dwordx2 v[68:69], v124, s[4:7], s25 offen offset:256 sc1
    buffer_load_dwordx2 v[70:71], v124, s[4:7], s25 offen offset:384 sc1
    buffer_load_dwordx2 v[72:73], v124, s[4:7], s25 offen offset:512 sc1
    buffer_load_dwordx2 v[74:75], v124, s[4:7], s25 offen offset:2560 sc1
    buffer_load_dwordx2 v[76:77], v124, s[4:7], s25 offen offset:2688 sc1
    buffer_load_dwordx2 v[78:79], v124, s[4:7], s25 offen offset:2816 sc1
    buffer_load_dwordx2 v[80:81], v124, s[4:7], s25 offen offset:2944 sc1
    buffer_load_dwordx2 v[82:83], v124, s[4:7], s25 offen offset:3072 sc1
    s_add_u32 s33, s17, s19
    v_add_u32 v8, s33, v0
    v_cmp_gt_u32 vcc, 64, v8
    s_and_b64 s[48:49], vcc, 1
    v_lshlrev_b32 v8, 6, v8
    v_add_u32 v8, 0xb203040, v8
    buffer_load_dword v9, v8, s[4:7], 0 offen sc1
    s_waitcnt vmcnt(0)
Ls_loop_50187:
    s_waitcnt vmcnt(2)
    s_barrier
    s_add_u32 s27, s17, s19
    s_mov_b32 s28, 1
    v_add_u32 v92, 0, v1
    v_add_u32 v93, 65536, v1
    s_cmp_ge_u32 s27, s50
    s_cbranch_scc1 Lsp_50190
    v_cmp_gt_u32 vcc, 5, v9
    s_and_b64 vcc, vcc, s[48:49]
    s_cbranch_scc1 Lsp_50190
    s_mov_b32 s28, 0
    ds_read_b128 v[36:39], v92 offset:0
    ds_read_b128 v[40:43], v92 offset:20480
    ds_read_b128 v[44:47], v92 offset:1024
    ds_read_b128 v[48:51], v92 offset:21504
    ds_read_b128 v[52:55], v92 offset:2048
    s_waitcnt lgkmcnt(4)
    v_mfma_f32_16x16x32_bf16 v[12:15], a[0:3], v[36:39], 0
    s_mul_i32 s20, s27, 40960
    s_add_u32 s20, s20, 0xa200000
    s_mul_i32 s21, s14, 10240
    s_add_u32 s20, s20, s21
    s_add_u32 s21, s21, 40960
    s_mov_b32 m0, s21
    s_nop 0
    buffer_load_dwordx4 v1, s[4:7], s20 offen offset:0 sc1 lds
    v_mfma_f32_16x16x32_bf16 v[16:19], a[80:83], v[36:39], 0
    v_add_f32 v64, v64, v66
    v_add_f32 v65, v65, v67
    v_add_f32 v64, v64, v68
    ds_read_b128 v[56:59], v92 offset:22528
    s_waitcnt lgkmcnt(4)
    v_mfma_f32_16x16x32_bf16 v[20:23], a[0:3], v[40:43], 0
    buffer_load_dwordx4 v1, s[4:7], s20 offen offset:1024 sc1 lds
    v_mfma_f32_16x16x32_bf16 v[24:27], a[80:83], v[40:43], 0
    v_add_f32 v65, v65, v69
    v_add_f32 v64, v64, v70
    v_add_f32 v65, v65, v71
    ds_read_b128 v[36:39], v92 offset:3072
    s_waitcnt lgkmcnt(4)
    v_mfma_f32_16x16x32_bf16 v[12:15], a[4:7], v[44:47], v[12:15]
    buffer_load_dwordx4 v1, s[4:7], s20 offen offset:2048 sc1 lds
    v_mfma_f32_16x16x32_bf16 v[16:19], a[84:87], v[44:47], v[16:19]
    v_add_f32 v64, v64, v72
    v_add_f32 v65, v65, v73
    v_mov_b32 v125, v64
    ds_read_b128 v[40:43], v92 offset:23552
    s_waitcnt lgkmcnt(4)
    v_mfma_f32_16x16x32_bf16 v[20:23], a[4:7], v[48:51], v[20:23]
    buffer_load_dwordx4 v1, s[4:7], s20 offen offset:3072 sc1 lds
    v_mfma_f32_16x16x32_bf16 v[24:27], a[84:87], v[48:51], v[24:27]
    v_permlane16_swap_b32 v64, v125
    v_add_f32 v64, v64, v125
    v_mov_b32 v125, v64
    ds_read_b128 v[44:47], v92 offset:4096
    s_waitcnt lgkmcnt(4)
    v_mfma_f32_16x16x32_bf16 v[12:15], a[8:11], v[52:55], v[12:15]
    s_add_u32 s20, s20, 4096
    s_add_u32 s21, s21, 4096
    s_mov_b32 m0, s21
    s_nop 0
    buffer_load_dwordx4 v1, s[4:7], s20 offen offset:0 sc1 lds
    v_mfma_f32_16x16x32_bf16 v[16:19], a[88:91], v[52:55], v[16:19]
    v_permlane32_swap_b32 v64, v125
    v_add_f32 v64, v64, v125
    v_mov_b32 v125, v65
    ds_read_b128 v[48:51], v92 offset:24576
    s_waitcnt lgkmcnt(4)
    v_mfma_f32_16x16x32_bf16 v[20:23], a[8:11], v[56:59], v[20:23]
    buffer_load_dwordx4 v1, s[4:7], s20 offen offset:1024 sc1 lds
    v_mfma_f32_16x16x32_bf16 v[24:27], a[88:91], v[56:59], v[24:27]
    v_permlane16_swap_b32 v65, v125
    v_add_f32 v65, v65, v125
    v_mov_b32 v125, v65
    ds_read_b128 v[52:55], v92 offset:5120
    s_waitcnt lgkmcnt(4)
    v_mfma_f32_16x16x32_bf16 v[12:15], a[12:15], v[36:39], v[12:15]
    buffer_load_dwordx4 v1, s[4:7], s20 offen offset:2048 sc1 lds
    v_mfma_f32_16x16x32_bf16 v[16:19], a[92:95], v[36:39], v[16:19]
    v_permlane32_swap_b32 v65, v125
    v_add_f32 v65, v65, v125
    v_mul_f32 v64, 0x3acccccd, v64
    ds_read_b128 v[56:59], v92 offset:25600
    s_waitcnt lgkmcnt(4)
    v_mfma_f32_16x16x32_bf16 v[20:23], a[12:15], v[40:43], v[20:23]
    buffer_load_dwordx4 v1, s[4:7], s20 offen offset:3072 sc1 lds
    v_mfma_f32_16x16x32_bf16 v[24:27], a[92:95], v[40:43], v[24:27]
    v_mul_f32 v65, 0x3acccccd, v65
    v_fma_f32 v65, -v64, v64, v65
    v_max_f32 v65, 0, v65
    ds_read_b128 v[36:39], v92 offset:6144
    s_waitcnt lgkmcnt(4)
    v_mfma_f32_16x16x32_bf16 v[12:15], a[16:19], v[44:47], v[12:15]
    s_add_u32 s20, s20, 4096
    s_add_u32 s21, s21, 4096
    s_mov_b32 m0, s21
    s_nop 0
    buffer_load_dwordx4 v1, s[4:7], s20 offen offset:0 sc1 lds
    v_mfma_f32_16x16x32_bf16 v[16:19], a[96:99], v[44:47], v[16:19]
    v_mov_b32 v66, v64
    v_cvt_pk_bf16_f32 v66, v66, v66
    v_lshlrev_b32 v66, 16, v66
    ds_read_b128 v[40:43], v92 offset:26624
    s_waitcnt lgkmcnt(4)
    v_mfma_f32_16x16x32_bf16 v[20:23], a[16:19], v[48:51], v[20:23]
    buffer_load_dwordx4 v1, s[4:7], s20 offen offset:1024 sc1 lds
    v_mfma_f32_16x16x32_bf16 v[24:27], a[96:99], v[48:51], v[24:27]
    v_mov_b32 v67, v65
    v_cvt_pk_bf16_f32 v67, v67, v67
    v_lshlrev_b32 v67, 16, v67
    ds_read_b128 v[44:47], v92 offset:7168
    s_waitcnt lgkmcnt(4)
    v_mfma_f32_16x16x32_bf16 v[12:15], a[20:23], v[52:55], v[12:15]
    v_mul_u32_u24 v124, 640, v3
    v_lshl_add_u32 v124, v2, 3, v124
    s_mul_i32 s25, s27, 5120
    s_add_u32 s25, s25, 0xb100000
    buffer_load_dwordx2 v[96:97], v124, s[4:7], s25 offen offset:0 sc1
    v_mfma_f32_16x16x32_bf16 v[16:19], a[100:103], v[52:55], v[16:19]
    v_add_f32 v67, 0x3727c5ac, v67
    v_cvt_pk_bf16_f32 v67, v67, v67
    v_lshlrev_b32 v67, 16, v67
    ds_read_b128 v[48:51], v92 offset:27648
    s_waitcnt lgkmcnt(4)
    v_mfma_f32_16x16x32_bf16 v[20:23], a[20:23], v[56:59], v[20:23]
    buffer_load_dwordx2 v[98:99], v124, s[4:7], s25 offen offset:128 sc1
    v_mfma_f32_16x16x32_bf16 v[24:27], a[100:103], v[56:59], v[24:27]
    v_sqrt_f32 v67, v67
    s_nop 0
    v_cvt_pk_bf16_f32 v67, v67, v67
    v_lshlrev_b32 v67, 16, v67
    ds_read_b128 v[52:55], v92 offset:8192
    s_waitcnt lgkmcnt(4)
    v_mfma_f32_16x16x32_bf16 v[12:15], a[24:27], v[36:39], v[12:15]
    buffer_load_dwordx2 v[100:101], v124, s[4:7], s25 offen offset:256 sc1
    v_mfma_f32_16x16x32_bf16 v[16:19], a[104:107], v[36:39], v[16:19]
    v_rcp_f32 v62, v67
    v_sub_f32 v68, v64, v66
    v_mul_f32 v68, v68, v62
    s_cmp_ge_u32 s55, 64
    s_nop 2
    s_cbranch_scc1 Lsd_50192
    s_waitcnt vmcnt(13)
    s_lshl_b32 s46, s55, 6
    s_add_u32 s46, s46, 0xb204240
    v_mov_b32 v4, s46
    v_mov_b32 v5, 1
    s_mov_b64 exec, 1
    buffer_atomic_add v5, v4, s[4:7], 0 offen
    s_mov_b64 exec, -1
Lcs_50193:
    s_mov_b32 s55, 64
Lsd_50192:
    ds_read_b128 v[56:59], v92 offset:28672
    s_waitcnt lgkmcnt(4)
    v_mfma_f32_16x16x32_bf16 v[20:23], a[24:27], v[40:43], v[20:23]
    buffer_load_dwordx2 v[102:103], v124, s[4:7], s25 offen offset:384 sc1
    v_mfma_f32_16x16x32_bf16 v[24:27], a[104:107], v[40:43], v[24:27]
    v_cvt_pk_bf16_f32 v68, v68, v68
    v_lshlrev_b32 v68, 16, v68
    v_mul_f32 v69, v65, v62
    ds_read_b128 v[36:39], v92 offset:9216
    s_waitcnt lgkmcnt(4)
    v_mfma_f32_16x16x32_bf16 v[12:15], a[28:31], v[44:47], v[12:15]
    buffer_load_dwordx2 v[104:105], v124, s[4:7], s25 offen offset:512 sc1
    v_mfma_f32_16x16x32_bf16 v[16:19], a[108:111], v[44:47], v[16:19]
    v_mul_f32 v69, v69, v62
    v_cvt_pk_bf16_f32 v69, v69, v69
    v_lshlrev_b32 v69, 16, v69
    ds_read_b128 v[40:43], v92 offset:29696
    s_waitcnt lgkmcnt(4)
    v_mfma_f32_16x16x32_bf16 v[20:23], a[28:31], v[48:51], v[20:23]
    buffer_load_dwordx2 v[106:107], v124, s[4:7], s25 offen offset:2560 sc1
    v_mfma_f32_16x16x32_bf16 v[24:27], a[108:111], v[48:51], v[24:27]
    v_add_f32 v69, 0x3727c5ac, v69
    v_cvt_pk_bf16_f32 v69, v69, v69
    v_lshlrev_b32 v69, 16, v69
    ds_read_b128 v[44:47], v92 offset:10240
    s_waitcnt lgkmcnt(4)
    v_mfma_f32_16x16x32_bf16 v[12:15], a[32:35], v[52:55], v[12:15]
    buffer_load_dwordx2 v[108:109], v124, s[4:7], s25 offen offset:2688 sc1
    v_mfma_f32_16x16x32_bf16 v[16:19], a[112:115], v[52:55], v[16:19]
    v_sqrt_f32 v69, v69
    s_nop 0
    v_cvt_pk_bf16_f32 v69, v69, v69
    v_lshlrev_b32 v69, 16, v69
    ds_read_b128 v[48:51], v92 offset:30720
    s_waitcnt lgkmcnt(4)
    v_mfma_f32_16x16x32_bf16 v[20:23], a[32:35], v[56:59], v[20:23]
    buffer_load_dwordx2 v[110:111], v124, s[4:7], s25 offen offset:2816 sc1
    v_mfma_f32_16x16x32_bf16 v[24:27], a[112:115], v[56:59], v[24:27]
    v_rcp_f32 v69, v69
    v_fma_f32 v60, v68, v67, v66
    v_mul_f32 v62, v62, v69
    ds_read_b128 v[52:55], v92 offset:11264
    s_waitcnt lgkmcnt(4)
    v_mfma_f32_16x16x32_bf16 v[12:15], a[36:39], v[36:39], v[12:15]
    buffer_load_dwordx2 v[112:113], v124, s[4:7], s25 offen offset:2944 sc1
    v_mfma_f32_16x16x32_bf16 v[16:19], a[116:119], v[36:39], v[16:19]
    v_add_f32 v74, v74, v76
    v_add_f32 v75, v75, v77
    v_add_f32 v74, v74, v78
    ds_read_b128 v[56:59], v92 offset:31744
    s_waitcnt lgkmcnt(4)
    v_mfma_f32_16x16x32_bf16 v[20:23], a[36:39], v[40:43], v[20:23]
    buffer_load_dwordx2 v[114:115], v124, s[4:7], s25 offen offset:3072 sc1
    v_mfma_f32_16x16x32_bf16 v[24:27], a[116:119], v[40:43], v[24:27]
    v_add_f32 v75, v75, v79
    v_add_f32 v74, v74, v80
    v_add_f32 v75, v75, v81
    ds_read_b128 v[36:39], v92 offset:12288
    s_waitcnt lgkmcnt(4)
    v_mfma_f32_16x16x32_bf16 v[12:15], a[40:43], v[44:47], v[12:15]
    s_add_u32 s33, s27, s19
    v_add_u32 v8, s33, v0
    v_cmp_gt_u32 vcc, 64, v8
    s_and_b64 s[48:49], vcc, 1
    v_lshlrev_b32 v8, 6, v8
    v_add_u32 v8, 0xb203040, v8
    buffer_load_dword v9, v8, s[4:7], 0 offen sc1
    v_mfma_f32_16x16x32_bf16 v[16:19], a[120:123], v[44:47], v[16:19]
    v_add_f32 v74, v74, v82
    v_add_f32 v75, v75, v83
    v_mov_b32 v125, v74
    ds_read_b128 v[40:43], v92 offset:32768
    s_waitcnt lgkmcnt(4)
    v_mfma_f32_16x16x32_bf16 v[20:23], a[40:43], v[48:51], v[20:23]
    v_mfma_f32_16x16x32_bf16 v[24:27], a[120:123], v[48:51], v[24:27]
    v_permlane16_swap_b32 v74, v125
    v_add_f32 v74, v74, v125
    v_mov_b32 v125, v74
    ds_read_b128 v[44:47], v92 offset:13312
    s_waitcnt lgkmcnt(4)
    v_mfma_f32_16x16x32_bf16 v[12:15], a[44:47], v[52:55], v[12:15]
    v_mfma_f32_16x16x32_bf16 v[16:19], a[124:127], v[52:55], v[16:19]
    v_permlane32_swap_b32 v74, v125
    v_add_f32 v74, v74, v125
    v_mov_b32 v125, v75
    ds_read_b128 v[48:51], v92 offset:33792
    s_waitcnt lgkmcnt(4)
    v_mfma_f32_16x16x32_bf16 v[20:23], a[44:47], v[56:59], v[20:23]
    v_mfma_f32_16x16x32_bf16 v[24:27], a[124:127], v[56:59], v[24:27]
    v_permlane16_swap_b32 v75, v125
    v_add_f32 v75, v75, v125
    v_mov_b32 v125, v75
    ds_read_b128 v[52:55], v92 offset:14336
    s_waitcnt lgkmcnt(4)
    v_mfma_f32_16x16x32_bf16 v[12:15], a[48:51], v[36:39], v[12:15]
    v_mfma_f32_16x16x32_bf16 v[16:19], a[128:131], v[36:39], v[16:19]
    v_permlane32_swap_b32 v75, v125
    v_add_f32 v75, v75, v125
    v_mul_f32 v74, 0x3acccccd, v74
    ds_read_b128 v[56:59], v92 offset:34816
    s_waitcnt lgkmcnt(4)
    v_mfma_f32_16x16x32_bf16 v[20:23], a[48:51], v[40:43], v[20:23]
    v_mfma_f32_16x16x32_bf16 v[24:27], a[128:131], v[40:43], v[24:27]
    v_mul_f32 v75, 0x3acccccd, v75
    v_fma_f32 v75, -v74, v74, v75
    v_max_f32 v75, 0, v75
    ds_read_b128 v[36:39], v92 offset:15360
    s_waitcnt lgkmcnt(4)
    v_mfma_f32_16x16x32_bf16 v[12:15], a[52:55], v[44:47], v[12:15]
    v_mfma_f32_16x16x32_bf16 v[16:19], a[132:135], v[44:47], v[16:19]
    v_mov_b32 v76, v74
    v_cvt_pk_bf16_f32 v76, v76, v76
    v_lshlrev_b32 v76, 16, v76
    ds_read_b128 v[40:43], v92 offset:35840
    s_waitcnt lgkmcnt(4)
    v_mfma_f32_16x16x32_bf16 v[20:23], a[52:55], v[48:51], v[20:23]
    v_mfma_f32_16x16x32_bf16 v[24:27], a[132:135], v[48:51], v[24:27]
    v_mov_b32 v77, v75
    v_cvt_pk_bf16_f32 v77, v77, v77
    v_lshlrev_b32 v77, 16, v77
    ds_read_b128 v[44:47], v92 offset:16384
    s_waitcnt lgkmcnt(4)
    v_mfma_f32_16x16x32_bf16 v[12:15], a[56:59], v[52:55], v[12:15]
    v_mfma_f32_16x16x32_bf16 v[16:19], a[136:139], v[52:55], v[16:19]
    v_add_f32 v77, 0x3727c5ac, v77
    v_cvt_pk_bf16_f32 v77, v77, v77
    v_lshlrev_b32 v77, 16, v77
    ds_read_b128 v[48:51], v92 offset:36864
    s_waitcnt lgkmcnt(4)
    v_mfma_f32_16x16x32_bf16 v[20:23], a[56:59], v[56:59], v[20:23]
    v_mfma_f32_16x16x32_bf16 v[24:27], a[136:139], v[56:59], v[24:27]
    v_sqrt_f32 v77, v77
    s_nop 0
    v_cvt_pk_bf16_f32 v77, v77, v77
    v_lshlrev_b32 v77, 16, v77
    ds_read_b128 v[52:55], v92 offset:17408
    s_waitcnt lgkmcnt(4)
    v_mfma_f32_16x16x32_bf16 v[12:15], a[60:63], v[36:39], v[12:15]
    v_mfma_f32_16x16x32_bf16 v[16:19], a[140:143], v[36:39], v[16:19]
    v_rcp_f32 v63, v77
    v_sub_f32 v78, v74, v76
    v_mul_f32 v78, v78, v63
    ds_read_b128 v[56:59], v92 offset:37888
    s_waitcnt lgkmcnt(4)
    v_mfma_f32_16x16x32_bf16 v[20:23], a[60:63], v[40:43], v[20:23]
    v_mfma_f32_16x16x32_bf16 v[24:27], a[140:143], v[40:43], v[24:27]
    v_cvt_pk_bf16_f32 v78, v78, v78
    v_lshlrev_b32 v78, 16, v78
    v_mul_f32 v79, v75, v63
    ds_read_b128 v[36:39], v92 offset:18432
    s_waitcnt lgkmcnt(4)
    v_mfma_f32_16x16x32_bf16 v[12:15], a[64:67], v[44:47], v[12:15]
    v_mfma_f32_16x16x32_bf16 v[16:19], a[144:147], v[44:47], v[16:19]
    v_mul_f32 v79, v79, v63
    v_cvt_pk_bf16_f32 v79, v79, v79
    v_lshlrev_b32 v79, 16, v79
    ds_read_b128 v[40:43], v92 offset:38912
    s_waitcnt lgkmcnt(4)
    v_mfma_f32_16x16x32_bf16 v[20:23], a[64:67], v[48:51], v[20:23]
    v_mfma_f32_16x16x32_bf16 v[24:27], a[144:147], v[48:51], v[24:27]
    v_add_f32 v79, 0x3727c5ac, v79
    v_cvt_pk_bf16_f32 v79, v79, v79
    v_lshlrev_b32 v79, 16, v79
    ds_read_b128 v[44:47], v92 offset:19456
    s_waitcnt lgkmcnt(4)
    v_mfma_f32_16x16x32_bf16 v[12:15], a[68:71], v[52:55], v[12:15]
    v_mfma_f32_16x16x32_bf16 v[16:19], a[148:151], v[52:55], v[16:19]
    v_sqrt_f32 v79, v79
    s_nop 0
    v_cvt_pk_bf16_f32 v79, v79, v79
    v_lshlrev_b32 v79, 16, v79
    ds_read_b128 v[48:51], v92 offset:39936
    s_waitcnt lgkmcnt(4)
    v_mfma_f32_16x16x32_bf16 v[20:23], a[68:71], v[56:59], v[20:23]
    v_mfma_f32_16x16x32_bf16 v[24:27], a[148:151], v[56:59], v[24:27]
    v_rcp_f32 v79, v79
    v_fma_f32 v61, v78, v77, v76
    v_mul_f32 v63, v63, v79
    s_waitcnt lgkmcnt(3)
    v_mfma_f32_16x16x32_bf16 v[12:15], a[72:75], v[36:39], v[12:15]
    v_mfma_f32_16x16x32_bf16 v[16:19], a[152:155], v[36:39], v[16:19]
    s_waitcnt lgkmcnt(2)
    v_mfma_f32_16x16x32_bf16 v[20:23], a[72:75], v[40:43], v[20:23]
    v_mfma_f32_16x16x32_bf16 v[24:27], a[152:155], v[40:43], v[24:27]
    s_waitcnt lgkmcnt(1)
    v_mfma_f32_16x16x32_bf16 v[12:15], a[76:79], v[44:47], v[12:15]
    v_mfma_f32_16x16x32_bf16 v[16:19], a[156:159], v[44:47], v[16:19]
    s_waitcnt lgkmcnt(0)
    v_mfma_f32_16x16x32_bf16 v[20:23], a[76:79], v[48:51], v[20:23]
    v_mfma_f32_16x16x32_bf16 v[24:27], a[156:159], v[48:51], v[24:27]
    s_nop 6
    s_branch Lsj_50191
Lsp_50190:
    ds_read_b128 v[36:39], v92 offset:0
    ds_read_b128 v[40:43], v92 offset:20480
    ds_read_b128 v[44:47], v92 offset:1024
    ds_read_b128 v[48:51], v92 offset:21504
    ds_read_b128 v[52:55], v92 offset:2048
    s_waitcnt lgkmcnt(4)
    v_mfma_f32_16x16x32_bf16 v[12:15], a[0:3], v[36:39], 0
    v_mfma_f32_16x16x32_bf16 v[16:19], a[80:83], v[36:39], 0
    v_add_f32 v64, v64, v66
    v_add_f32 v65, v65, v67
    v_add_f32 v64, v64, v68
    ds_read_b128 v[56:59], v92 offset:22528
    s_waitcnt lgkmcnt(4)
    v_mfma_f32_16x16x32_bf16 v[20:23], a[0:3], v[40:43], 0
    v_mfma_f32_16x16x32_bf16 v[24:27], a[80:83], v[40:43], 0
    v_add_f32 v65, v65, v69
    v_add_f32 v64, v64, v70
    v_add_f32 v65, v65, v71
    ds_read_b128 v[36:39], v92 offset:3072
    s_waitcnt lgkmcnt(4)
    v_mfma_f32_16x16x32_bf16 v[12:15], a[4:7], v[44:47], v[12:15]
    v_mfma_f32_16x16x32_bf16 v[16:19], a[84:87], v[44:47], v[16:19]
    v_add_f32 v64, v64, v72
    v_add_f32 v65, v65, v73
    v_mov_b32 v125, v64
    ds_read_b128 v[40:43], v92 offset:23552
    s_waitcnt lgkmcnt(4)
    v_mfma_f32_16x16x32_bf16 v[20:23], a[4:7], v[48:51], v[20:23]
    v_mfma_f32_16x16x32_bf16 v[24:27], a[84:87], v[48:51], v[24:27]
    v_permlane16_swap_b32 v64, v125
    v_add_f32 v64, v64, v125
    v_mov_b32 v125, v64
    ds_read_b128 v[44:47], v92 offset:4096
    s_waitcnt lgkmcnt(4)
    v_mfma_f32_16x16x32_bf16 v[12:15], a[8:11], v[52:55], v[12:15]
    v_mfma_f32_16x16x32_bf16 v[16:19], a[88:91], v[52:55], v[16:19]
    v_permlane32_swap_b32 v64, v125
    v_add_f32 v64, v64, v125
    v_mov_b32 v125, v65
    ds_read_b128 v[48:51], v92 offset:24576
    s_waitcnt lgkmcnt(4)
    v_mfma_f32_16x16x32_bf16 v[20:23], a[8:11], v[56:59], v[20:23]
    v_mfma_f32_16x16x32_bf16 v[24:27], a[88:91], v[56:59], v[24:27]
    v_permlane16_swap_b32 v65, v125
    v_add_f32 v65, v65, v125
    v_mov_b32 v125, v65
    ds_read_b128 v[52:55], v92 offset:5120
    s_waitcnt lgkmcnt(4)
    v_mfma_f32_16x16x32_bf16 v[12:15], a[12:15], v[36:39], v[12:15]
    v_mfma_f32_16x16x32_bf16 v[16:19], a[92:95], v[36:39], v[16:19]
    v_permlane32_swap_b32 v65, v125
    v_add_f32 v65, v65, v125
    v_mul_f32 v64, 0x3acccccd, v64
    ds_read_b128 v[56:59], v92 offset:25600
    s_waitcnt lgkmcnt(4)
    v_mfma_f32_16x16x32_bf16 v[20:23], a[12:15], v[40:43], v[20:23]
    v_mfma_f32_16x16x32_bf16 v[24:27], a[92:95], v[40:43], v[24:27]
    v_mul_f32 v65, 0x3acccccd, v65
    v_fma_f32 v65, -v64, v64, v65
    v_max_f32 v65, 0, v65
    ds_read_b128 v[36:39], v92 offset:6144
    s_waitcnt lgkmcnt(4)
    v_mfma_f32_16x16x32_bf16 v[12:15], a[16:19], v[44:47], v[12:15]
    v_mfma_f32_16x16x32_bf16 v[16:19], a[96:99], v[44:47], v[16:19]
    v_mov_b32 v66, v64
    v_cvt_pk_bf16_f32 v66, v66, v66
    v_lshlrev_b32 v66, 16, v66
    ds_read_b128 v[40:43], v92 offset:26624
    s_waitcnt lgkmcnt(4)
    v_mfma_f32_16x16x32_bf16 v[20:23], a[16:19], v[48:51], v[20:23]
    v_mfma_f32_16x16x32_bf16 v[24:27], a[96:99], v[48:51], v[24:27]
    v_mov_b32 v67, v65
    v_cvt_pk_bf16_f32 v67, v67, v67
    v_lshlrev_b32 v67, 16, v67
    ds_read_b128 v[44:47], v92 offset:7168
    s_waitcnt lgkmcnt(4)
    v_mfma_f32_16x16x32_bf16 v[12:15], a[20:23], v[52:55], v[12:15]
    v_mfma_f32_16x16x32_bf16 v[16:19], a[100:103], v[52:55], v[16:19]
    v_add_f32 v67, 0x3727c5ac, v67
    v_cvt_pk_bf16_f32 v67, v67, v67
    v_lshlrev_b32 v67, 16, v67
    ds_read_b128 v[48:51], v92 offset:27648
    s_waitcnt lgkmcnt(4)
    v_mfma_f32_16x16x32_bf16 v[20:23], a[20:23], v[56:59], v[20:23]
    v_mfma_f32_16x16x32_bf16 v[24:27], a[100:103], v[56:59], v[24:27]
    v_sqrt_f32 v67, v67
    s_nop 0
    v_cvt_pk_bf16_f32 v67, v67, v67
    v_lshlrev_b32 v67, 16, v67
    ds_read_b128 v[52:55], v92 offset:8192
    s_waitcnt lgkmcnt(4)
    v_mfma_f32_16x16x32_bf16 v[12:15], a[24:27], v[36:39], v[12:15]
    v_mfma_f32_16x16x32_bf16 v[16:19], a[104:107], v[36:39], v[16:19]
    v_rcp_f32 v62, v67
    v_sub_f32 v68, v64, v66
    v_mul_f32 v68, v68, v62
    s_cmp_ge_u32 s55, 64
    s_nop 2
    s_cbranch_scc1 Lsd_50194
    s_waitcnt vmcnt(0)
    s_lshl_b32 s46, s55, 6
    s_add_u32 s46, s46, 0xb204240
    v_mov_b32 v4, s46
    v_mov_b32 v5, 1
    s_mov_b64 exec, 1
    buffer_atomic_add v5, v4, s[4:7], 0 offen
    s_mov_b64 exec, -1
Lcs_50195:
    s_mov_b32 s55, 64
Lsd_50194:
    ds_read_b128 v[56:59], v92 offset:28672
    s_waitcnt lgkmcnt(4)
    v_mfma_f32_16x16x32_bf16 v[20:23], a[24:27], v[40:43], v[20:23]
    v_mfma_f32_16x16x32_bf16 v[24:27], a[104:107], v[40:43], v[24:27]
    v_cvt_pk_bf16_f32 v68, v68, v68
    v_lshlrev_b32 v68, 16, v68
    v_mul_f32 v69, v65, v62
    ds_read_b128 v[36:39], v92 offset:9216
    s_waitcnt lgkmcnt(4)
    v_mfma_f32_16x16x32_bf16 v[12:15], a[28:31], v[44:47], v[12:15]
    v_mfma_f32_16x16x32_bf16 v[16:19], a[108:111], v[44:47], v[16:19]
    v_mul_f32 v69, v69, v62
    v_cvt_pk_bf16_f32 v69, v69, v69
    v_lshlrev_b32 v69, 16, v69
    ds_read_b128 v[40:43], v92 offset:29696
    s_waitcnt lgkmcnt(4)
    v_mfma_f32_16x16x32_bf16 v[20:23], a[28:31], v[48:51], v[20:23]
    v_mfma_f32_16x16x32_bf16 v[24:27], a[108:111], v[48:51], v[24:27]
    v_add_f32 v69, 0x3727c5ac, v69
    v_cvt_pk_bf16_f32 v69, v69, v69
    v_lshlrev_b32 v69, 16, v69
    ds_read_b128 v[44:47], v92 offset:10240
    s_waitcnt lgkmcnt(4)
    v_mfma_f32_16x16x32_bf16 v[12:15], a[32:35], v[52:55], v[12:15]
    v_mfma_f32_16x16x32_bf16 v[16:19], a[112:115], v[52:55], v[16:19]
    v_sqrt_f32 v69, v69
    s_nop 0
    v_cvt_pk_bf16_f32 v69, v69, v69
    v_lshlrev_b32 v69, 16, v69
    ds_read_b128 v[48:51], v92 offset:30720
    s_waitcnt lgkmcnt(4)
    v_mfma_f32_16x16x32_bf16 v[20:23], a[32:35], v[56:59], v[20:23]
    v_mfma_f32_16x16x32_bf16 v[24:27], a[112:115], v[56:59], v[24:27]
    v_rcp_f32 v69, v69
    v_fma_f32 v60, v68, v67, v66
    v_mul_f32 v62, v62, v69
    ds_read_b128 v[52:55], v92 offset:11264
    s_waitcnt lgkmcnt(4)
    v_mfma_f32_16x16x32_bf16 v[12:15], a[36:39], v[36:39], v[12:15]
    v_mfma_f32_16x16x32_bf16 v[16:19], a[116:119], v[36:39], v[16:19]
    v_add_f32 v74, v74, v76
    v_add_f32 v75, v75, v77
    v_add_f32 v74, v74, v78
    ds_read_b128 v[56:59], v92 offset:31744
    s_waitcnt lgkmcnt(4)
    v_mfma_f32_16x16x32_bf16 v[20:23], a[36:39], v[40:43], v[20:23]
    v_mfma_f32_16x16x32_bf16 v[24:27], a[116:119], v[40:43], v[24:27]
    v_add_f32 v75, v75, v79
    v_add_f32 v74, v74, v80
    v_add_f32 v75, v75, v81
    ds_read_b128 v[36:39], v92 offset:12288
    s_waitcnt lgkmcnt(4)
    v_mfma_f32_16x16x32_bf16 v[12:15], a[40:43], v[44:47], v[12:15]
    v_mfma_f32_16x16x32_bf16 v[16:19], a[120:123], v[44:47], v[16:19]
    v_add_f32 v74, v74, v82
    v_add_f32 v75, v75, v83
    v_mov_b32 v125, v74
    ds_read_b128 v[40:43], v92 offset:32768
    s_waitcnt lgkmcnt(4)
    v_mfma_f32_16x16x32_bf16 v[20:23], a[40:43], v[48:51], v[20:23]
    v_mfma_f32_16x16x32_bf16 v[24:27], a[120:123], v[48:51], v[24:27]
    v_permlane16_swap_b32 v74, v125
    v_add_f32 v74, v74, v125
    v_mov_b32 v125, v74
    ds_read_b128 v[44:47], v92 offset:13312
    s_waitcnt lgkmcnt(4)
    v_mfma_f32_16x16x32_bf16 v[12:15], a[44:47], v[52:55], v[12:15]
    v_mfma_f32_16x16x32_bf16 v[16:19], a[124:127], v[52:55], v[16:19]
    v_permlane32_swap_b32 v74, v125
    v_add_f32 v74, v74, v125
    v_mov_b32 v125, v75
    ds_read_b128 v[48:51], v92 offset:33792
    s_waitcnt lgkmcnt(4)
    v_mfma_f32_16x16x32_bf16 v[20:23], a[44:47], v[56:59], v[20:23]
    v_mfma_f32_16x16x32_bf16 v[24:27], a[124:127], v[56:59], v[24:27]
    v_permlane16_swap_b32 v75, v125
    v_add_f32 v75, v75, v125
    v_mov_b32 v125, v75
    ds_read_b128 v[52:55], v92 offset:14336
    s_waitcnt lgkmcnt(4)
    v_mfma_f32_16x16x32_bf16 v[12:15], a[48:51], v[36:39], v[12:15]
    v_mfma_f32_16x16x32_bf16 v[16:19], a[128:131], v[36:39], v[16:19]
    v_permlane32_swap_b32 v75, v125
    v_add_f32 v75, v75, v125
    v_mul_f32 v74, 0x3acccccd, v74
    ds_read_b128 v[56:59], v92 offset:34816
    s_waitcnt lgkmcnt(4)
    v_mfma_f32_16x16x32_bf16 v[20:23], a[48:51], v[40:43], v[20:23]
    v_mfma_f32_16x16x32_bf16 v[24:27], a[128:131], v[40:43], v[24:27]
    v_mul_f32 v75, 0x3acccccd, v75
    v_fma_f32 v75, -v74, v74, v75
    v_max_f32 v75, 0, v75
    ds_read_b128 v[36:39], v92 offset:15360
    s_waitcnt lgkmcnt(4)
    v_mfma_f32_16x16x32_bf16 v[12:15], a[52:55], v[44:47], v[12:15]
    v_mfma_f32_16x16x32_bf16 v[16:19], a[132:135], v[44:47], v[16:19]
    v_mov_b32 v76, v74
    v_cvt_pk_bf16_f32 v76, v76, v76
    v_lshlrev_b32 v76, 16, v76
    ds_read_b128 v[40:43], v92 offset:35840
    s_waitcnt lgkmcnt(4)
    v_mfma_f32_16x16x32_bf16 v[20:23], a[52:55], v[48:51], v[20:23]
    v_mfma_f32_16x16x32_bf16 v[24:27], a[132:135], v[48:51], v[24:27]
    v_mov_b32 v77, v75
    v_cvt_pk_bf16_f32 v77, v77, v77
    v_lshlrev_b32 v77, 16, v77
    ds_read_b128 v[44:47], v92 offset:16384
    s_waitcnt lgkmcnt(4)
    v_mfma_f32_16x16x32_bf16 v[12:15], a[56:59], v[52:55], v[12:15]
    v_mfma_f32_16x16x32_bf16 v[16:19], a[136:139], v[52:55], v[16:19]
    v_add_f32 v77, 0x3727c5ac, v77
    v_cvt_pk_bf16_f32 v77, v77, v77
    v_lshlrev_b32 v77, 16, v77
    ds_read_b128 v[48:51], v92 offset:36864
    s_waitcnt lgkmcnt(4)
    v_mfma_f32_16x16x32_bf16 v[20:23], a[56:59], v[56:59], v[20:23]
    v_mfma_f32_16x16x32_bf16 v[24:27], a[136:139], v[56:59], v[24:27]
    v_sqrt_f32 v77, v77
    s_nop 0
    v_cvt_pk_bf16_f32 v77, v77, v77
    v_lshlrev_b32 v77, 16, v77
    ds_read_b128 v[52:55], v92 offset:17408
    s_waitcnt lgkmcnt(4)
    v_mfma_f32_16x16x32_bf16 v[12:15], a[60:63], v[36:39], v[12:15]
    v_mfma_f32_16x16x32_bf16 v[16:19], a[140:143], v[36:39], v[16:19]
    v_rcp_f32 v63, v77
    v_sub_f32 v78, v74, v76
    v_mul_f32 v78, v78, v63
    ds_read_b128 v[56:59], v92 offset:37888
    s_waitcnt lgkmcnt(4)
    v_mfma_f32_16x16x32_bf16 v[20:23], a[60:63], v[40:43], v[20:23]
    v_mfma_f32_16x16x32_bf16 v[24:27], a[140:143], v[40:43], v[24:27]
    v_cvt_pk_bf16_f32 v78, v78, v78
    v_lshlrev_b32 v78, 16, v78
    v_mul_f32 v79, v75, v63
    ds_read_b128 v[36:39], v92 offset:18432
    s_waitcnt lgkmcnt(4)
    v_mfma_f32_16x16x32_bf16 v[12:15], a[64:67], v[44:47], v[12:15]
    v_mfma_f32_16x16x32_bf16 v[16:19], a[144:147], v[44:47], v[16:19]
    v_mul_f32 v79, v79, v63
    v_cvt_pk_bf16_f32 v79, v79, v79
    v_lshlrev_b32 v79, 16, v79
    ds_read_b128 v[40:43], v92 offset:38912
    s_waitcnt lgkmcnt(4)
    v_mfma_f32_16x16x32_bf16 v[20:23], a[64:67], v[48:51], v[20:23]
    v_mfma_f32_16x16x32_bf16 v[24:27], a[144:147], v[48:51], v[24:27]
    v_add_f32 v79, 0x3727c5ac, v79
    v_cvt_pk_bf16_f32 v79, v79, v79
    v_lshlrev_b32 v79, 16, v79
    ds_read_b128 v[44:47], v92 offset:19456
    s_waitcnt lgkmcnt(4)
    v_mfma_f32_16x16x32_bf16 v[12:15], a[68:71], v[52:55], v[12:15]
    v_mfma_f32_16x16x32_bf16 v[16:19], a[148:151], v[52:55], v[16:19]
    v_sqrt_f32 v79, v79
    s_nop 0
    v_cvt_pk_bf16_f32 v79, v79, v79
    v_lshlrev_b32 v79, 16, v79
    ds_read_b128 v[48:51], v92 offset:39936
    s_waitcnt lgkmcnt(4)
    v_mfma_f32_16x16x32_bf16 v[20:23], a[68:71], v[56:59], v[20:23]
    v_mfma_f32_16x16x32_bf16 v[24:27], a[148:151], v[56:59], v[24:27]
    v_rcp_f32 v79, v79
    v_fma_f32 v61, v78, v77, v76
    v_mul_f32 v63, v63, v79
    s_waitcnt lgkmcnt(3)
    v_mfma_f32_16x16x32_bf16 v[12:15], a[72:75], v[36:39], v[12:15]
    v_mfma_f32_16x16x32_bf16 v[16:19], a[152:155], v[36:39], v[16:19]
    s_waitcnt lgkmcnt(2)
    v_mfma_f32_16x16x32_bf16 v[20:23], a[72:75], v[40:43], v[20:23]
    v_mfma_f32_16x16x32_bf16 v[24:27], a[152:155], v[40:43], v[24:27]
    s_waitcnt lgkmcnt(1)
    v_mfma_f32_16x16x32_bf16 v[12:15], a[76:79], v[44:47], v[12:15]
    v_mfma_f32_16x16x32_bf16 v[16:19], a[156:159], v[44:47], v[16:19]
    s_waitcnt lgkmcnt(0)
    v_mfma_f32_16x16x32_bf16 v[20:23], a[76:79], v[48:51], v[20:23]
    v_mfma_f32_16x16x32_bf16 v[24:27], a[156:159], v[48:51], v[24:27]
    s_nop 7
Lsj_50191:
    v_fma_f32 v12, -v60, v28, v12
    v_mul_f32 v12, v12, v62
    v_fma_f32 v13, -v60, v29, v13
    v_mul_f32 v13, v13, v62
    v_cvt_pk_bf16_f32 v44, v12, v13
    v_lshlrev_b32 v12, 16, v44
    v_and_b32 v13, 0xffff0000, v44
    v_mul_f32 v44, v12, v12
    v_fma_f32 v44, v44, s51, v7
    v_mul_f32 v44, v44, v12
    v_exp_f32 v44, v44
    v_mul_f32 v45, v13, v13
    v_fma_f32 v45, v45, s51, v7
    v_mul_f32 v45, v45, v13
    v_exp_f32 v45, v45
    v_add_f32 v44, 1.0, v44
    v_rcp_f32 v44, v44
    v_add_f32 v45, 1.0, v45
    v_rcp_f32 v45, v45
    v_mul_f32 v12, v12, v44
    v_mul_f32 v13, v13, v45
    v_cvt_pk_bf16_f32 v36, v12, v13
    v_fma_f32 v14, -v60, v30, v14
    v_mul_f32 v14, v14, v62
    v_fma_f32 v15, -v60, v31, v15
    v_mul_f32 v15, v15, v62
    v_cvt_pk_bf16_f32 v44, v14, v15
    v_lshlrev_b32 v14, 16, v44
    v_and_b32 v15, 0xffff0000, v44
    v_mul_f32 v44, v14, v14
    v_fma_f32 v44, v44, s51, v7
    v_mul_f32 v44, v44, v14
    v_exp_f32 v44, v44
    v_mul_f32 v45, v15, v15
    v_fma_f32 v45, v45, s51, v7
    v_mul_f32 v45, v45, v15
    v_exp_f32 v45, v45
    v_add_f32 v44, 1.0, v44
    v_rcp_f32 v44, v44
    v_add_f32 v45, 1.0, v45
    v_rcp_f32 v45, v45
    v_mul_f32 v14, v14, v44
    v_mul_f32 v15, v15, v45
    v_cvt_pk_bf16_f32 v37, v14, v15
    v_fma_f32 v16, -v60, v32, v16
    v_mul_f32 v16, v16, v62
    v_fma_f32 v17, -v60, v33, v17
    v_mul_f32 v17, v17, v62
    v_cvt_pk_bf16_f32 v44, v16, v17
    v_lshlrev_b32 v16, 16, v44
    v_and_b32 v17, 0xffff0000, v44
    v_mul_f32 v44, v16, v16
    v_fma_f32 v44, v44, s51, v7
    v_mul_f32 v44, v44, v16
    v_exp_f32 v44, v44
    v_mul_f32 v45, v17, v17
    v_fma_f32 v45, v45, s51, v7
    v_mul_f32 v45, v45, v17
    v_exp_f32 v45, v45
    v_add_f32 v44, 1.0, v44
    v_rcp_f32 v44, v44
    v_add_f32 v45, 1.0, v45
    v_rcp_f32 v45, v45
    v_mul_f32 v16, v16, v44
    v_mul_f32 v17, v17, v45
    v_cvt_pk_bf16_f32 v38, v16, v17
    v_fma_f32 v18, -v60, v34, v18
    v_mul_f32 v18, v18, v62
    v_fma_f32 v19, -v60, v35, v19
    v_mul_f32 v19, v19, v62
    v_cvt_pk_bf16_f32 v44, v18, v19
    v_lshlrev_b32 v18, 16, v44
    v_and_b32 v19, 0xffff0000, v44
    v_mul_f32 v44, v18, v18
    v_fma_f32 v44, v44, s51, v7
    v_mul_f32 v44, v44, v18
    v_exp_f32 v44, v44
    v_mul_f32 v45, v19, v19
    v_fma_f32 v45, v45, s51, v7
    v_mul_f32 v45, v45, v19
    v_exp_f32 v45, v45
    v_add_f32 v44, 1.0, v44
    v_rcp_f32 v44, v44
    v_add_f32 v45, 1.0, v45
    v_rcp_f32 v45, v45
    v_mul_f32 v18, v18, v44
    v_mul_f32 v19, v19, v45
    v_cvt_pk_bf16_f32 v39, v18, v19
    s_lshl_b32 s34, s17, 1
    s_add_u32 s34, s34, 0
    s_mul_i32 s35, s34, 20
    s_add_u32 s35, s35, s29
    s_lshl_b32 s35, s35, 10
    s_add_u32 s35, s35, 0xa500000
    buffer_store_dwordx4 v[36:39], v1, s[4:7], s35 offen sc1
    v_fma_f32 v20, -v61, v28, v20
    v_mul_f32 v20, v20, v63
    v_fma_f32 v21, -v61, v29, v21
    v_mul_f32 v21, v21, v63
    v_cvt_pk_bf16_f32 v44, v20, v21
    v_lshlrev_b32 v20, 16, v44
    v_and_b32 v21, 0xffff0000, v44
    v_mul_f32 v44, v20, v20
    v_fma_f32 v44, v44, s51, v7
    v_mul_f32 v44, v44, v20
    v_exp_f32 v44, v44
    v_mul_f32 v45, v21, v21
    v_fma_f32 v45, v45, s51, v7
    v_mul_f32 v45, v45, v21
    v_exp_f32 v45, v45
    v_add_f32 v44, 1.0, v44
    v_rcp_f32 v44, v44
    v_add_f32 v45, 1.0, v45
    v_rcp_f32 v45, v45
    v_mul_f32 v20, v20, v44
    v_mul_f32 v21, v21, v45
    v_cvt_pk_bf16_f32 v40, v20, v21
    v_fma_f32 v22, -v61, v30, v22
    v_mul_f32 v22, v22, v63
    v_fma_f32 v23, -v61, v31, v23
    v_mul_f32 v23, v23, v63
    v_cvt_pk_bf16_f32 v44, v22, v23
    v_lshlrev_b32 v22, 16, v44
    v_and_b32 v23, 0xffff0000, v44
    v_mul_f32 v44, v22, v22
    v_fma_f32 v44, v44, s51, v7
    v_mul_f32 v44, v44, v22
    v_exp_f32 v44, v44
    v_mul_f32 v45, v23, v23
    v_fma_f32 v45, v45, s51, v7
    v_mul_f32 v45, v45, v23
    v_exp_f32 v45, v45
    v_add_f32 v44, 1.0, v44
    v_rcp_f32 v44, v44
    v_add_f32 v45, 1.0, v45
    v_rcp_f32 v45, v45
    v_mul_f32 v22, v22, v44
    v_mul_f32 v23, v23, v45
    v_cvt_pk_bf16_f32 v41, v22, v23
    v_fma_f32 v24, -v61, v32, v24
    v_mul_f32 v24, v24, v63
    v_fma_f32 v25, -v61, v33, v25
    v_mul_f32 v25, v25, v63
    v_cvt_pk_bf16_f32 v44, v24, v25
    v_lshlrev_b32 v24, 16, v44
    v_and_b32 v25, 0xffff0000, v44
    v_mul_f32 v44, v24, v24
    v_fma_f32 v44, v44, s51, v7
    v_mul_f32 v44, v44, v24
    v_exp_f32 v44, v44
    v_mul_f32 v45, v25, v25
    v_fma_f32 v45, v45, s51, v7
    v_mul_f32 v45, v45, v25
    v_exp_f32 v45, v45
    v_add_f32 v44, 1.0, v44
    v_rcp_f32 v44, v44
    v_add_f32 v45, 1.0, v45
    v_rcp_f32 v45, v45
    v_mul_f32 v24, v24, v44
    v_mul_f32 v25, v25, v45
    v_cvt_pk_bf16_f32 v42, v24, v25
    v_fma_f32 v26, -v61, v34, v26
    v_mul_f32 v26, v26, v63
    v_fma_f32 v27, -v61, v35, v27
    v_mul_f32 v27, v27, v63
    v_cvt_pk_bf16_f32 v44, v26, v27
    v_lshlrev_b32 v26, 16, v44
    v_and_b32 v27, 0xffff0000, v44
    v_mul_f32 v44, v26, v26
    v_fma_f32 v44, v44, s51, v7
    v_mul_f32 v44, v44, v26
    v_exp_f32 v44, v44
    v_mul_f32 v45, v27, v27
    v_fma_f32 v45, v45, s51, v7
    v_mul_f32 v45, v45, v27
    v_exp_f32 v45, v45
    v_add_f32 v44, 1.0, v44
    v_rcp_f32 v44, v44
    v_add_f32 v45, 1.0, v45
    v_rcp_f32 v45, v45
    v_mul_f32 v26, v26, v44
    v_mul_f32 v27, v27, v45
    v_cvt_pk_bf16_f32 v43, v26, v27
    s_lshl_b32 s34, s17, 1
    s_add_u32 s34, s34, 1
    s_mul_i32 s35, s34, 20
    s_add_u32 s35, s35, s29
    s_lshl_b32 s35, s35, 10
    s_add_u32 s35, s35, 0xa500000
    buffer_store_dwordx4 v[40:43], v1, s[4:7], s35 offen sc1
    s_mov_b32 s55, s17
    s_mov_b32 s17, s27
    s_cmp_eq_u32 s28, 0
    s_cbranch_scc1 Lsq_50196
    s_waitcnt vmcnt(0)
    s_lshl_b32 s46, s55, 6
    s_add_u32 s46, s46, 0xb204240
    v_mov_b32 v4, s46
    v_mov_b32 v5, 1
    s_mov_b64 exec, 1
    buffer_atomic_add v5, v4, s[4:7], 0 offen
    s_mov_b64 exec, -1
Lcs_50197:
    s_mov_b32 s55, 64
    s_cmp_ge_u32 s17, s50
    s_cbranch_scc1 Ls_end_50186
    v_add_u32 v8, s17, v0
    v_cmp_gt_u32 vcc, 64, v8
    s_and_b64 s[48:49], vcc, 1
    v_lshlrev_b32 v8, 6, v8
    v_add_u32 v8, 0xb203040, v8
    s_mov_b64 exec, s[48:49]
    s_nop 0
Lwp_50198:
    buffer_load_dword v9, v8, s[4:7], 0 offen sc1
    s_waitcnt vmcnt(0)
    v_cmp_gt_u32 vcc, 5, v9
    s_nop 0
    s_cbranch_vccz Lwpd_50199
    s_sleep 5
    s_add_u32 s30, s30, 1
    s_cmp_lt_u32 s30, s31
    s_cbranch_scc1 Lwp_50198
Lwpd_50199:
    s_mov_b64 exec, -1
    s_mul_i32 s20, s17, 40960
    s_add_u32 s20, s20, 0xa200000
    s_mul_i32 s21, s14, 10240
    s_add_u32 s20, s20, s21
    s_add_u32 s21, s21, 40960
    s_mov_b32 m0, s21
    s_nop 0
    buffer_load_dwordx4 v1, s[4:7], s20 offen offset:0 sc1 lds
    buffer_load_dwordx4 v1, s[4:7], s20 offen offset:1024 sc1 lds
    buffer_load_dwordx4 v1, s[4:7], s20 offen offset:2048 sc1 lds
    buffer_load_dwordx4 v1, s[4:7], s20 offen offset:3072 sc1 lds
    s_add_u32 s20, s20, 4096
    s_add_u32 s21, s21, 4096
    s_mov_b32 m0, s21
    s_nop 0
    buffer_load_dwordx4 v1, s[4:7], s20 offen offset:0 sc1 lds
    buffer_load_dwordx4 v1, s[4:7], s20 offen offset:1024 sc1 lds
    buffer_load_dwordx4 v1, s[4:7], s20 offen offset:2048 sc1 lds
    buffer_load_dwordx4 v1, s[4:7], s20 offen offset:3072 sc1 lds
    s_add_u32 s20, s20, 4096
    s_add_u32 s21, s21, 4096
    s_mov_b32 m0, s21
    s_nop 0
    buffer_load_dwordx4 v1, s[4:7], s20 offen offset:0 sc1 lds
    buffer_load_dwordx4 v1, s[4:7], s20 offen offset:1024 sc1 lds
    v_mul_u32_u24 v124, 640, v3
    v_lshl_add_u32 v124, v2, 3, v124
    s_mul_i32 s25, s17, 5120
    s_add_u32 s25, s25, 0xb100000
    buffer_load_dwordx2 v[96:97], v124, s[4:7], s25 offen offset:0 sc1
    buffer_load_dwordx2 v[98:99], v124, s[4:7], s25 offen offset:128 sc1
    buffer_load_dwordx2 v[100:101], v124, s[4:7], s25 offen offset:256 sc1
    buffer_load_dwordx2 v[102:103], v124, s[4:7], s25 offen offset:384 sc1
    buffer_load_dwordx2 v[104:105], v124, s[4:7], s25 offen offset:512 sc1
    buffer_load_dwordx2 v[106:107], v124, s[4:7], s25 offen offset:2560 sc1
    buffer_load_dwordx2 v[108:109], v124, s[4:7], s25 offen offset:2688 sc1
    buffer_load_dwordx2 v[110:111], v124, s[4:7], s25 offen offset:2816 sc1
    buffer_load_dwordx2 v[112:113], v124, s[4:7], s25 offen offset:2944 sc1
    buffer_load_dwordx2 v[114:115], v124, s[4:7], s25 offen offset:3072 sc1
    s_add_u32 s33, s17, s19
    v_add_u32 v8, s33, v0
    v_cmp_gt_u32 vcc, 64, v8
    s_and_b64 s[48:49], vcc, 1
    v_lshlrev_b32 v8, 6, v8
    v_add_u32 v8, 0xb203040, v8
    buffer_load_dword v9, v8, s[4:7], 0 offen sc1
    s_waitcnt vmcnt(0)
Lsq_50196:
    s_waitcnt vmcnt(2)
    s_barrier
    s_add_u32 s27, s17, s19
    s_mov_b32 s28, 1
    v_add_u32 v92, 40960, v1
    v_add_u32 v93, 65536, v1
    s_cmp_ge_u32 s27, s50
    s_cbranch_scc1 Lsp_50200
    v_cmp_gt_u32 vcc, 5, v9
    s_and_b64 vcc, vcc, s[48:49]
    s_cbranch_scc1 Lsp_50200
    s_mov_b32 s28, 0
    ds_read_b128 v[36:39], v92 offset:0
    ds_read_b128 v[40:43], v92 offset:20480
    ds_read_b128 v[44:47], v92 offset:1024
    ds_read_b128 v[48:51], v92 offset:21504
    ds_read_b128 v[52:55], v92 offset:2048
    s_waitcnt lgkmcnt(4)
    v_mfma_f32_16x16x32_bf16 v[12:15], a[0:3], v[36:39], 0
    s_mul_i32 s20, s27, 40960
    s_add_u32 s20, s20, 0xa200000
    s_mul_i32 s21, s14, 10240
    s_add_u32 s20, s20, s21
    s_add_u32 s21, s21, 0
    s_mov_b32 m0, s21
    s_nop 0
    buffer_load_dwordx4 v1, s[4:7], s20 offen offset:0 sc1 lds
    v_mfma_f32_16x16x32_bf16 v[16:19], a[80:83], v[36:39], 0
    v_add_f32 v96, v96, v98
    v_add_f32 v97, v97, v99
    v_add_f32 v96, v96, v100
    ds_read_b128 v[56:59], v92 offset:22528
    s_waitcnt lgkmcnt(4)
    v_mfma_f32_16x16x32_bf16 v[20:23], a[0:3], v[40:43], 0
    buffer_load_dwordx4 v1, s[4:7], s20 offen offset:1024 sc1 lds
    v_mfma_f32_16x16x32_bf16 v[24:27], a[80:83], v[40:43], 0
    v_add_f32 v97, v97, v101
    v_add_f32 v96, v96, v102
    v_add_f32 v97, v97, v103
    ds_read_b128 v[36:39], v92 offset:3072
    s_waitcnt lgkmcnt(4)
    v_mfma_f32_16x16x32_bf16 v[12:15], a[4:7], v[44:47], v[12:15]
    buffer_load_dwordx4 v1, s[4:7], s20 offen offset:2048 sc1 lds
    v_mfma_f32_16x16x32_bf16 v[16:19], a[84:87], v[44:47], v[16:19]
    v_add_f32 v96, v96, v104
    v_add_f32 v97, v97, v105
    v_mov_b32 v125, v96
    ds_read_b128 v[40:43], v92 offset:23552
    s_waitcnt lgkmcnt(4)
    v_mfma_f32_16x16x32_bf16 v[20:23], a[4:7], v[48:51], v[20:23]
    buffer_load_dwordx4 v1, s[4:7], s20 offen offset:3072 sc1 lds
    v_mfma_f32_16x16x32_bf16 v[24:27], a[84:87], v[48:51], v[24:27]
    v_permlane16_swap_b32 v96, v125
    v_add_f32 v96, v96, v125
    v_mov_b32 v125, v96
    ds_read_b128 v[44:47], v92 offset:4096
    s_waitcnt lgkmcnt(4)
    v_mfma_f32_16x16x32_bf16 v[12:15], a[8:11], v[52:55], v[12:15]
    s_add_u32 s20, s20, 4096
    s_add_u32 s21, s21, 4096
    s_mov_b32 m0, s21
    s_nop 0
    buffer_load_dwordx4 v1, s[4:7], s20 offen offset:0 sc1 lds
    v_mfma_f32_16x16x32_bf16 v[16:19], a[88:91], v[52:55], v[16:19]
    v_permlane32_swap_b32 v96, v125
    v_add_f32 v96, v96, v125
    v_mov_b32 v125, v97
    ds_read_b128 v[48:51], v92 offset:24576
    s_waitcnt lgkmcnt(4)
    v_mfma_f32_16x16x32_bf16 v[20:23], a[8:11], v[56:59], v[20:23]
    buffer_load_dwordx4 v1, s[4:7], s20 offen offset:1024 sc1 lds
    v_mfma_f32_16x16x32_bf16 v[24:27], a[88:91], v[56:59], v[24:27]
    v_permlane16_swap_b32 v97, v125
    v_add_f32 v97, v97, v125
    v_mov_b32 v125, v97
    ds_read_b128 v[52:55], v92 offset:5120
    s_waitcnt lgkmcnt(4)
    v_mfma_f32_16x16x32_bf16 v[12:15], a[12:15], v[36:39], v[12:15]
    buffer_load_dwordx4 v1, s[4:7], s20 offen offset:2048 sc1 lds
    v_mfma_f32_16x16x32_bf16 v[16:19], a[92:95], v[36:39], v[16:19]
    v_permlane32_swap_b32 v97, v125
    v_add_f32 v97, v97, v125
    v_mul_f32 v96, 0x3acccccd, v96
    ds_read_b128 v[56:59], v92 offset:25600
    s_waitcnt lgkmcnt(4)
    v_mfma_f32_16x16x32_bf16 v[20:23], a[12:15], v[40:43], v[20:23]
    buffer_load_dwordx4 v1, s[4:7], s20 offen offset:3072 sc1 lds
    v_mfma_f32_16x16x32_bf16 v[24:27], a[92:95], v[40:43], v[24:27]
    v_mul_f32 v97, 0x3acccccd, v97
    v_fma_f32 v97, -v96, v96, v97
    v_max_f32 v97, 0, v97
    ds_read_b128 v[36:39], v92 offset:6144
    s_waitcnt lgkmcnt(4)
    v_mfma_f32_16x16x32_bf16 v[12:15], a[16:19], v[44:47], v[12:15]
    s_add_u32 s20, s20, 4096
    s_add_u32 s21, s21, 4096
    s_mov_b32 m0, s21
    s_nop 0
    buffer_load_dwordx4 v1, s[4:7], s20 offen offset:0 sc1 lds
    v_mfma_f32_16x16x32_bf16 v[16:19], a[96:99], v[44:47], v[16:19]
    v_mov_b32 v98, v96
    v_cvt_pk_bf16_f32 v98, v98, v98
    v_lshlrev_b32 v98, 16, v98
    ds_read_b128 v[40:43], v92 offset:26624
    s_waitcnt lgkmcnt(4)
    v_mfma_f32_16x16x32_bf16 v[20:23], a[16:19], v[48:51], v[20:23]
    buffer_load_dwordx4 v1, s[4:7], s20 offen offset:1024 sc1 lds
    v_mfma_f32_16x16x32_bf16 v[24:27], a[96:99], v[48:51], v[24:27]
    v_mov_b32 v99, v97
    v_cvt_pk_bf16_f32 v99, v99, v99
    v_lshlrev_b32 v99, 16, v99
    ds_read_b128 v[44:47], v92 offset:7168
    s_waitcnt lgkmcnt(4)
    v_mfma_f32_16x16x32_bf16 v[12:15], a[20:23], v[52:55], v[12:15]
    v_mul_u32_u24 v124, 640, v3
    v_lshl_add_u32 v124, v2, 3, v124
    s_mul_i32 s25, s27, 5120
    s_add_u32 s25, s25, 0xb100000
    buffer_load_dwordx2 v[64:65], v124, s[4:7], s25 offen offset:0 sc1
    v_mfma_f32_16x16x32_bf16 v[16:19], a[100:103], v[52:55], v[16:19]
    v_add_f32 v99, 0x3727c5ac, v99
    v_cvt_pk_bf16_f32 v99, v99, v99
    v_lshlrev_b32 v99, 16, v99
    ds_read_b128 v[48:51], v92 offset:27648
    s_waitcnt lgkmcnt(4)
    v_mfma_f32_16x16x32_bf16 v[20:23], a[20:23], v[56:59], v[20:23]
    buffer_load_dwordx2 v[66:67], v124, s[4:7], s25 offen offset:128 sc1
    v_mfma_f32_16x16x32_bf16 v[24:27], a[100:103], v[56:59], v[24:27]
    v_sqrt_f32 v99, v99
    s_nop 0
    v_cvt_pk_bf16_f32 v99, v99, v99
    v_lshlrev_b32 v99, 16, v99
    ds_read_b128 v[52:55], v92 offset:8192
    s_waitcnt lgkmcnt(4)
    v_mfma_f32_16x16x32_bf16 v[12:15], a[24:27], v[36:39], v[12:15]
    buffer_load_dwordx2 v[68:69], v124, s[4:7], s25 offen offset:256 sc1
    v_mfma_f32_16x16x32_bf16 v[16:19], a[104:107], v[36:39], v[16:19]
    v_rcp_f32 v62, v99
    v_sub_f32 v100, v96, v98
    v_mul_f32 v100, v100, v62
    s_cmp_ge_u32 s55, 64
    s_nop 2
    s_cbranch_scc1 Lsd_50202
    s_waitcnt vmcnt(13)
    s_lshl_b32 s46, s55, 6
    s_add_u32 s46, s46, 0xb204240
    v_mov_b32 v4, s46
    v_mov_b32 v5, 1
    s_mov_b64 exec, 1
    buffer_atomic_add v5, v4, s[4:7], 0 offen
    s_mov_b64 exec, -1
Lcs_50203:
    s_mov_b32 s55, 64
Lsd_50202:
    ds_read_b128 v[56:59], v92 offset:28672
    s_waitcnt lgkmcnt(4)
    v_mfma_f32_16x16x32_bf16 v[20:23], a[24:27], v[40:43], v[20:23]
    buffer_load_dwordx2 v[70:71], v124, s[4:7], s25 offen offset:384 sc1
    v_mfma_f32_16x16x32_bf16 v[24:27], a[104:107], v[40:43], v[24:27]
    v_cvt_pk_bf16_f32 v100, v100, v100
    v_lshlrev_b32 v100, 16, v100
    v_mul_f32 v101, v97, v62
    ds_read_b128 v[36:39], v92 offset:9216
    s_waitcnt lgkmcnt(4)
    v_mfma_f32_16x16x32_bf16 v[12:15], a[28:31], v[44:47], v[12:15]
    buffer_load_dwordx2 v[72:73], v124, s[4:7], s25 offen offset:512 sc1
    v_mfma_f32_16x16x32_bf16 v[16:19], a[108:111], v[44:47], v[16:19]
    v_mul_f32 v101, v101, v62
    v_cvt_pk_bf16_f32 v101, v101, v101
    v_lshlrev_b32 v101, 16, v101
    ds_read_b128 v[40:43], v92 offset:29696
    s_waitcnt lgkmcnt(4)
    v_mfma_f32_16x16x32_bf16 v[20:23], a[28:31], v[48:51], v[20:23]
    buffer_load_dwordx2 v[74:75], v124, s[4:7], s25 offen offset:2560 sc1
    v_mfma_f32_16x16x32_bf16 v[24:27], a[108:111], v[48:51], v[24:27]
    v_add_f32 v101, 0x3727c5ac, v101
    v_cvt_pk_bf16_f32 v101, v101, v101
    v_lshlrev_b32 v101, 16, v101
    ds_read_b128 v[44:47], v92 offset:10240
    s_waitcnt lgkmcnt(4)
    v_mfma_f32_16x16x32_bf16 v[12:15], a[32:35], v[52:55], v[12:15]
    buffer_load_dwordx2 v[76:77], v124, s[4:7], s25 offen offset:2688 sc1
    v_mfma_f32_16x16x32_bf16 v[16:19], a[112:115], v[52:55], v[16:19]
    v_sqrt_f32 v101, v101
    s_nop 0
    v_cvt_pk_bf16_f32 v101, v101, v101
    v_lshlrev_b32 v101, 16, v101
    ds_read_b128 v[48:51], v92 offset:30720
    s_waitcnt lgkmcnt(4)
    v_mfma_f32_16x16x32_bf16 v[20:23], a[32:35], v[56:59], v[20:23]
    buffer_load_dwordx2 v[78:79], v124, s[4:7], s25 offen offset:2816 sc1
    v_mfma_f32_16x16x32_bf16 v[24:27], a[112:115], v[56:59], v[24:27]
    v_rcp_f32 v101, v101
    v_fma_f32 v60, v100, v99, v98
    v_mul_f32 v62, v62, v101
    ds_read_b128 v[52:55], v92 offset:11264
    s_waitcnt lgkmcnt(4)
    v_mfma_f32_16x16x32_bf16 v[12:15], a[36:39], v[36:39], v[12:15]
    buffer_load_dwordx2 v[80:81], v124, s[4:7], s25 offen offset:2944 sc1
    v_mfma_f32_16x16x32_bf16 v[16:19], a[116:119], v[36:39], v[16:19]
    v_add_f32 v106, v106, v108
    v_add_f32 v107, v107, v109
    v_add_f32 v106, v106, v110
    ds_read_b128 v[56:59], v92 offset:31744
    s_waitcnt lgkmcnt(4)
    v_mfma_f32_16x16x32_bf16 v[20:23], a[36:39], v[40:43], v[20:23]
    buffer_load_dwordx2 v[82:83], v124, s[4:7], s25 offen offset:3072 sc1
    v_mfma_f32_16x16x32_bf16 v[24:27], a[116:119], v[40:43], v[24:27]
    v_add_f32 v107, v107, v111
    v_add_f32 v106, v106, v112
    v_add_f32 v107, v107, v113
    ds_read_b128 v[36:39], v92 offset:12288
    s_waitcnt lgkmcnt(4)
    v_mfma_f32_16x16x32_bf16 v[12:15], a[40:43], v[44:47], v[12:15]
    s_add_u32 s33, s27, s19
    v_add_u32 v8, s33, v0
    v_cmp_gt_u32 vcc, 64, v8
    s_and_b64 s[48:49], vcc, 1
    v_lshlrev_b32 v8, 6, v8
    v_add_u32 v8, 0xb203040, v8
    buffer_load_dword v9, v8, s[4:7], 0 offen sc1
    v_mfma_f32_16x16x32_bf16 v[16:19], a[120:123], v[44:47], v[16:19]
    v_add_f32 v106, v106, v114
    v_add_f32 v107, v107, v115
    v_mov_b32 v125, v106
    ds_read_b128 v[40:43], v92 offset:32768
    s_waitcnt lgkmcnt(4)
    v_mfma_f32_16x16x32_bf16 v[20:23], a[40:43], v[48:51], v[20:23]
    v_mfma_f32_16x16x32_bf16 v[24:27], a[120:123], v[48:51], v[24:27]
    v_permlane16_swap_b32 v106, v125
    v_add_f32 v106, v106, v125
    v_mov_b32 v125, v106
    ds_read_b128 v[44:47], v92 offset:13312
    s_waitcnt lgkmcnt(4)
    v_mfma_f32_16x16x32_bf16 v[12:15], a[44:47], v[52:55], v[12:15]
    v_mfma_f32_16x16x32_bf16 v[16:19], a[124:127], v[52:55], v[16:19]
    v_permlane32_swap_b32 v106, v125
    v_add_f32 v106, v106, v125
    v_mov_b32 v125, v107
    ds_read_b128 v[48:51], v92 offset:33792
    s_waitcnt lgkmcnt(4)
    v_mfma_f32_16x16x32_bf16 v[20:23], a[44:47], v[56:59], v[20:23]
    v_mfma_f32_16x16x32_bf16 v[24:27], a[124:127], v[56:59], v[24:27]
    v_permlane16_swap_b32 v107, v125
    v_add_f32 v107, v107, v125
    v_mov_b32 v125, v107
    ds_read_b128 v[52:55], v92 offset:14336
    s_waitcnt lgkmcnt(4)
    v_mfma_f32_16x16x32_bf16 v[12:15], a[48:51], v[36:39], v[12:15]
    v_mfma_f32_16x16x32_bf16 v[16:19], a[128:131], v[36:39], v[16:19]
    v_permlane32_swap_b32 v107, v125
    v_add_f32 v107, v107, v125
    v_mul_f32 v106, 0x3acccccd, v106
    ds_read_b128 v[56:59], v92 offset:34816
    s_waitcnt lgkmcnt(4)
    v_mfma_f32_16x16x32_bf16 v[20:23], a[48:51], v[40:43], v[20:23]
    v_mfma_f32_16x16x32_bf16 v[24:27], a[128:131], v[40:43], v[24:27]
    v_mul_f32 v107, 0x3acccccd, v107
    v_fma_f32 v107, -v106, v106, v107
    v_max_f32 v107, 0, v107
    ds_read_b128 v[36:39], v92 offset:15360
    s_waitcnt lgkmcnt(4)
    v_mfma_f32_16x16x32_bf16 v[12:15], a[52:55], v[44:47], v[12:15]
    v_mfma_f32_16x16x32_bf16 v[16:19], a[132:135], v[44:47], v[16:19]
    v_mov_b32 v108, v106
    v_cvt_pk_bf16_f32 v108, v108, v108
    v_lshlrev_b32 v108, 16, v108
    ds_read_b128 v[40:43], v92 offset:35840
    s_waitcnt lgkmcnt(4)
    v_mfma_f32_16x16x32_bf16 v[20:23], a[52:55], v[48:51], v[20:23]
    v_mfma_f32_16x16x32_bf16 v[24:27], a[132:135], v[48:51], v[24:27]
    v_mov_b32 v109, v107
    v_cvt_pk_bf16_f32 v109, v109, v109
    v_lshlrev_b32 v109, 16, v109
    ds_read_b128 v[44:47], v92 offset:16384
    s_waitcnt lgkmcnt(4)
    v_mfma_f32_16x16x32_bf16 v[12:15], a[56:59], v[52:55], v[12:15]
    v_mfma_f32_16x16x32_bf16 v[16:19], a[136:139], v[52:55], v[16:19]
    v_add_f32 v109, 0x3727c5ac, v109
    v_cvt_pk_bf16_f32 v109, v109, v109
    v_lshlrev_b32 v109, 16, v109
    ds_read_b128 v[48:51], v92 offset:36864
    s_waitcnt lgkmcnt(4)
    v_mfma_f32_16x16x32_bf16 v[20:23], a[56:59], v[56:59], v[20:23]
    v_mfma_f32_16x16x32_bf16 v[24:27], a[136:139], v[56:59], v[24:27]
    v_sqrt_f32 v109, v109
    s_nop 0
    v_cvt_pk_bf16_f32 v109, v109, v109
    v_lshlrev_b32 v109, 16, v109
    ds_read_b128 v[52:55], v92 offset:17408
    s_waitcnt lgkmcnt(4)
    v_mfma_f32_16x16x32_bf16 v[12:15], a[60:63], v[36:39], v[12:15]
    v_mfma_f32_16x16x32_bf16 v[16:19], a[140:143], v[36:39], v[16:19]
    v_rcp_f32 v63, v109
    v_sub_f32 v110, v106, v108
    v_mul_f32 v110, v110, v63
    ds_read_b128 v[56:59], v92 offset:37888
    s_waitcnt lgkmcnt(4)
    v_mfma_f32_16x16x32_bf16 v[20:23], a[60:63], v[40:43], v[20:23]
    v_mfma_f32_16x16x32_bf16 v[24:27], a[140:143], v[40:43], v[24:27]
    v_cvt_pk_bf16_f32 v110, v110, v110
    v_lshlrev_b32 v110, 16, v110
    v_mul_f32 v111, v107, v63
    ds_read_b128 v[36:39], v92 offset:18432
    s_waitcnt lgkmcnt(4)
    v_mfma_f32_16x16x32_bf16 v[12:15], a[64:67], v[44:47], v[12:15]
    v_mfma_f32_16x16x32_bf16 v[16:19], a[144:147], v[44:47], v[16:19]
    v_mul_f32 v111, v111, v63
    v_cvt_pk_bf16_f32 v111, v111, v111
    v_lshlrev_b32 v111, 16, v111
    ds_read_b128 v[40:43], v92 offset:38912
    s_waitcnt lgkmcnt(4)
    v_mfma_f32_16x16x32_bf16 v[20:23], a[64:67], v[48:51], v[20:23]
    v_mfma_f32_16x16x32_bf16 v[24:27], a[144:147], v[48:51], v[24:27]
    v_add_f32 v111, 0x3727c5ac, v111
    v_cvt_pk_bf16_f32 v111, v111, v111
    v_lshlrev_b32 v111, 16, v111
    ds_read_b128 v[44:47], v92 offset:19456
    s_waitcnt lgkmcnt(4)
    v_mfma_f32_16x16x32_bf16 v[12:15], a[68:71], v[52:55], v[12:15]
    v_mfma_f32_16x16x32_bf16 v[16:19], a[148:151], v[52:55], v[16:19]
    v_sqrt_f32 v111, v111
    s_nop 0
    v_cvt_pk_bf16_f32 v111, v111, v111
    v_lshlrev_b32 v111, 16, v111
    ds_read_b128 v[48:51], v92 offset:39936
    s_waitcnt lgkmcnt(4)
    v_mfma_f32_16x16x32_bf16 v[20:23], a[68:71], v[56:59], v[20:23]
    v_mfma_f32_16x16x32_bf16 v[24:27], a[148:151], v[56:59], v[24:27]
    v_rcp_f32 v111, v111
    v_fma_f32 v61, v110, v109, v108
    v_mul_f32 v63, v63, v111
    s_waitcnt lgkmcnt(3)
    v_mfma_f32_16x16x32_bf16 v[12:15], a[72:75], v[36:39], v[12:15]
    v_mfma_f32_16x16x32_bf16 v[16:19], a[152:155], v[36:39], v[16:19]
    s_waitcnt lgkmcnt(2)
    v_mfma_f32_16x16x32_bf16 v[20:23], a[72:75], v[40:43], v[20:23]
    v_mfma_f32_16x16x32_bf16 v[24:27], a[152:155], v[40:43], v[24:27]
    s_waitcnt lgkmcnt(1)
    v_mfma_f32_16x16x32_bf16 v[12:15], a[76:79], v[44:47], v[12:15]
    v_mfma_f32_16x16x32_bf16 v[16:19], a[156:159], v[44:47], v[16:19]
    s_waitcnt lgkmcnt(0)
    v_mfma_f32_16x16x32_bf16 v[20:23], a[76:79], v[48:51], v[20:23]
    v_mfma_f32_16x16x32_bf16 v[24:27], a[156:159], v[48:51], v[24:27]
    s_nop 6
    s_branch Lsj_50201
Lsp_50200:
    ds_read_b128 v[36:39], v92 offset:0
    ds_read_b128 v[40:43], v92 offset:20480
    ds_read_b128 v[44:47], v92 offset:1024
    ds_read_b128 v[48:51], v92 offset:21504
    ds_read_b128 v[52:55], v92 offset:2048
    s_waitcnt lgkmcnt(4)
    v_mfma_f32_16x16x32_bf16 v[12:15], a[0:3], v[36:39], 0
    v_mfma_f32_16x16x32_bf16 v[16:19], a[80:83], v[36:39], 0
    v_add_f32 v96, v96, v98
    v_add_f32 v97, v97, v99
    v_add_f32 v96, v96, v100
    ds_read_b128 v[56:59], v92 offset:22528
    s_waitcnt lgkmcnt(4)
    v_mfma_f32_16x16x32_bf16 v[20:23], a[0:3], v[40:43], 0
    v_mfma_f32_16x16x32_bf16 v[24:27], a[80:83], v[40:43], 0
    v_add_f32 v97, v97, v101
    v_add_f32 v96, v96, v102
    v_add_f32 v97, v97, v103
    ds_read_b128 v[36:39], v92 offset:3072
    s_waitcnt lgkmcnt(4)
    v_mfma_f32_16x16x32_bf16 v[12:15], a[4:7], v[44:47], v[12:15]
    v_mfma_f32_16x16x32_bf16 v[16:19], a[84:87], v[44:47], v[16:19]
    v_add_f32 v96, v96, v104
    v_add_f32 v97, v97, v105
    v_mov_b32 v125, v96
    ds_read_b128 v[40:43], v92 offset:23552
    s_waitcnt lgkmcnt(4)
    v_mfma_f32_16x16x32_bf16 v[20:23], a[4:7], v[48:51], v[20:23]
    v_mfma_f32_16x16x32_bf16 v[24:27], a[84:87], v[48:51], v[24:27]
    v_permlane16_swap_b32 v96, v125
    v_add_f32 v96, v96, v125
    v_mov_b32 v125, v96
    ds_read_b128 v[44:47], v92 offset:4096
    s_waitcnt lgkmcnt(4)
    v_mfma_f32_16x16x32_bf16 v[12:15], a[8:11], v[52:55], v[12:15]
    v_mfma_f32_16x16x32_bf16 v[16:19], a[88:91], v[52:55], v[16:19]
    v_permlane32_swap_b32 v96, v125
    v_add_f32 v96, v96, v125
    v_mov_b32 v125, v97
    ds_read_b128 v[48:51], v92 offset:24576
    s_waitcnt lgkmcnt(4)
    v_mfma_f32_16x16x32_bf16 v[20:23], a[8:11], v[56:59], v[20:23]
    v_mfma_f32_16x16x32_bf16 v[24:27], a[88:91], v[56:59], v[24:27]
    v_permlane16_swap_b32 v97, v125
    v_add_f32 v97, v97, v125
    v_mov_b32 v125, v97
    ds_read_b128 v[52:55], v92 offset:5120
    s_waitcnt lgkmcnt(4)
    v_mfma_f32_16x16x32_bf16 v[12:15], a[12:15], v[36:39], v[12:15]
    v_mfma_f32_16x16x32_bf16 v[16:19], a[92:95], v[36:39], v[16:19]
    v_permlane32_swap_b32 v97, v125
    v_add_f32 v97, v97, v125
    v_mul_f32 v96, 0x3acccccd, v96
    ds_read_b128 v[56:59], v92 offset:25600
    s_waitcnt lgkmcnt(4)
    v_mfma_f32_16x16x32_bf16 v[20:23], a[12:15], v[40:43], v[20:23]
    v_mfma_f32_16x16x32_bf16 v[24:27], a[92:95], v[40:43], v[24:27]
    v_mul_f32 v97, 0x3acccccd, v97
    v_fma_f32 v97, -v96, v96, v97
    v_max_f32 v97, 0, v97
    ds_read_b128 v[36:39], v92 offset:6144
    s_waitcnt lgkmcnt(4)
    v_mfma_f32_16x16x32_bf16 v[12:15], a[16:19], v[44:47], v[12:15]
    v_mfma_f32_16x16x32_bf16 v[16:19], a[96:99], v[44:47], v[16:19]
    v_mov_b32 v98, v96
    v_cvt_pk_bf16_f32 v98, v98, v98
    v_lshlrev_b32 v98, 16, v98
    ds_read_b128 v[40:43], v92 offset:26624
    s_waitcnt lgkmcnt(4)
    v_mfma_f32_16x16x32_bf16 v[20:23], a[16:19], v[48:51], v[20:23]
    v_mfma_f32_16x16x32_bf16 v[24:27], a[96:99], v[48:51], v[24:27]
    v_mov_b32 v99, v97
    v_cvt_pk_bf16_f32 v99, v99, v99
    v_lshlrev_b32 v99, 16, v99
    ds_read_b128 v[44:47], v92 offset:7168
    s_waitcnt lgkmcnt(4)
    v_mfma_f32_16x16x32_bf16 v[12:15], a[20:23], v[52:55], v[12:15]
    v_mfma_f32_16x16x32_bf16 v[16:19], a[100:103], v[52:55], v[16:19]
    v_add_f32 v99, 0x3727c5ac, v99
    v_cvt_pk_bf16_f32 v99, v99, v99
    v_lshlrev_b32 v99, 16, v99
    ds_read_b128 v[48:51], v92 offset:27648
    s_waitcnt lgkmcnt(4)
    v_mfma_f32_16x16x32_bf16 v[20:23], a[20:23], v[56:59], v[20:23]
    v_mfma_f32_16x16x32_bf16 v[24:27], a[100:103], v[56:59], v[24:27]
    v_sqrt_f32 v99, v99
    s_nop 0
    v_cvt_pk_bf16_f32 v99, v99, v99
    v_lshlrev_b32 v99, 16, v99
    ds_read_b128 v[52:55], v92 offset:8192
    s_waitcnt lgkmcnt(4)
    v_mfma_f32_16x16x32_bf16 v[12:15], a[24:27], v[36:39], v[12:15]
    v_mfma_f32_16x16x32_bf16 v[16:19], a[104:107], v[36:39], v[16:19]
    v_rcp_f32 v62, v99
    v_sub_f32 v100, v96, v98
    v_mul_f32 v100, v100, v62
    s_cmp_ge_u32 s55, 64
    s_nop 2
    s_cbranch_scc1 Lsd_50204
    s_waitcnt vmcnt(0)
    s_lshl_b32 s46, s55, 6
    s_add_u32 s46, s46, 0xb204240
    v_mov_b32 v4, s46
    v_mov_b32 v5, 1
    s_mov_b64 exec, 1
    buffer_atomic_add v5, v4, s[4:7], 0 offen
    s_mov_b64 exec, -1
Lcs_50205:
    s_mov_b32 s55, 64
Lsd_50204:
    ds_read_b128 v[56:59], v92 offset:28672
    s_waitcnt lgkmcnt(4)
    v_mfma_f32_16x16x32_bf16 v[20:23], a[24:27], v[40:43], v[20:23]
    v_mfma_f32_16x16x32_bf16 v[24:27], a[104:107], v[40:43], v[24:27]
    v_cvt_pk_bf16_f32 v100, v100, v100
    v_lshlrev_b32 v100, 16, v100
    v_mul_f32 v101, v97, v62
    ds_read_b128 v[36:39], v92 offset:9216
    s_waitcnt lgkmcnt(4)
    v_mfma_f32_16x16x32_bf16 v[12:15], a[28:31], v[44:47], v[12:15]
    v_mfma_f32_16x16x32_bf16 v[16:19], a[108:111], v[44:47], v[16:19]
    v_mul_f32 v101, v101, v62
    v_cvt_pk_bf16_f32 v101, v101, v101
    v_lshlrev_b32 v101, 16, v101
    ds_read_b128 v[40:43], v92 offset:29696
    s_waitcnt lgkmcnt(4)
    v_mfma_f32_16x16x32_bf16 v[20:23], a[28:31], v[48:51], v[20:23]
    v_mfma_f32_16x16x32_bf16 v[24:27], a[108:111], v[48:51], v[24:27]
    v_add_f32 v101, 0x3727c5ac, v101
    v_cvt_pk_bf16_f32 v101, v101, v101
    v_lshlrev_b32 v101, 16, v101
    ds_read_b128 v[44:47], v92 offset:10240
    s_waitcnt lgkmcnt(4)
    v_mfma_f32_16x16x32_bf16 v[12:15], a[32:35], v[52:55], v[12:15]
    v_mfma_f32_16x16x32_bf16 v[16:19], a[112:115], v[52:55], v[16:19]
    v_sqrt_f32 v101, v101
    s_nop 0
    v_cvt_pk_bf16_f32 v101, v101, v101
    v_lshlrev_b32 v101, 16, v101
    ds_read_b128 v[48:51], v92 offset:30720
    s_waitcnt lgkmcnt(4)
    v_mfma_f32_16x16x32_bf16 v[20:23], a[32:35], v[56:59], v[20:23]
    v_mfma_f32_16x16x32_bf16 v[24:27], a[112:115], v[56:59], v[24:27]
    v_rcp_f32 v101, v101
    v_fma_f32 v60, v100, v99, v98
    v_mul_f32 v62, v62, v101
    ds_read_b128 v[52:55], v92 offset:11264
    s_waitcnt lgkmcnt(4)
    v_mfma_f32_16x16x32_bf16 v[12:15], a[36:39], v[36:39], v[12:15]
    v_mfma_f32_16x16x32_bf16 v[16:19], a[116:119], v[36:39], v[16:19]
    v_add_f32 v106, v106, v108
    v_add_f32 v107, v107, v109
    v_add_f32 v106, v106, v110
    ds_read_b128 v[56:59], v92 offset:31744
    s_waitcnt lgkmcnt(4)
    v_mfma_f32_16x16x32_bf16 v[20:23], a[36:39], v[40:43], v[20:23]
    v_mfma_f32_16x16x32_bf16 v[24:27], a[116:119], v[40:43], v[24:27]
    v_add_f32 v107, v107, v111
    v_add_f32 v106, v106, v112
    v_add_f32 v107, v107, v113
    ds_read_b128 v[36:39], v92 offset:12288
    s_waitcnt lgkmcnt(4)
    v_mfma_f32_16x16x32_bf16 v[12:15], a[40:43], v[44:47], v[12:15]
    v_mfma_f32_16x16x32_bf16 v[16:19], a[120:123], v[44:47], v[16:19]
    v_add_f32 v106, v106, v114
    v_add_f32 v107, v107, v115
    v_mov_b32 v125, v106
    ds_read_b128 v[40:43], v92 offset:32768
    s_waitcnt lgkmcnt(4)
    v_mfma_f32_16x16x32_bf16 v[20:23], a[40:43], v[48:51], v[20:23]
    v_mfma_f32_16x16x32_bf16 v[24:27], a[120:123], v[48:51], v[24:27]
    v_permlane16_swap_b32 v106, v125
    v_add_f32 v106, v106, v125
    v_mov_b32 v125, v106
    ds_read_b128 v[44:47], v92 offset:13312
    s_waitcnt lgkmcnt(4)
    v_mfma_f32_16x16x32_bf16 v[12:15], a[44:47], v[52:55], v[12:15]
    v_mfma_f32_16x16x32_bf16 v[16:19], a[124:127], v[52:55], v[16:19]
    v_permlane32_swap_b32 v106, v125
    v_add_f32 v106, v106, v125
    v_mov_b32 v125, v107
    ds_read_b128 v[48:51], v92 offset:33792
    s_waitcnt lgkmcnt(4)
    v_mfma_f32_16x16x32_bf16 v[20:23], a[44:47], v[56:59], v[20:23]
    v_mfma_f32_16x16x32_bf16 v[24:27], a[124:127], v[56:59], v[24:27]
    v_permlane16_swap_b32 v107, v125
    v_add_f32 v107, v107, v125
    v_mov_b32 v125, v107
    ds_read_b128 v[52:55], v92 offset:14336
    s_waitcnt lgkmcnt(4)
    v_mfma_f32_16x16x32_bf16 v[12:15], a[48:51], v[36:39], v[12:15]
    v_mfma_f32_16x16x32_bf16 v[16:19], a[128:131], v[36:39], v[16:19]
    v_permlane32_swap_b32 v107, v125
    v_add_f32 v107, v107, v125
    v_mul_f32 v106, 0x3acccccd, v106
    ds_read_b128 v[56:59], v92 offset:34816
    s_waitcnt lgkmcnt(4)
    v_mfma_f32_16x16x32_bf16 v[20:23], a[48:51], v[40:43], v[20:23]
    v_mfma_f32_16x16x32_bf16 v[24:27], a[128:131], v[40:43], v[24:27]
    v_mul_f32 v107, 0x3acccccd, v107
    v_fma_f32 v107, -v106, v106, v107
    v_max_f32 v107, 0, v107
    ds_read_b128 v[36:39], v92 offset:15360
    s_waitcnt lgkmcnt(4)
    v_mfma_f32_16x16x32_bf16 v[12:15], a[52:55], v[44:47], v[12:15]
    v_mfma_f32_16x16x32_bf16 v[16:19], a[132:135], v[44:47], v[16:19]
    v_mov_b32 v108, v106
    v_cvt_pk_bf16_f32 v108, v108, v108
    v_lshlrev_b32 v108, 16, v108
    ds_read_b128 v[40:43], v92 offset:35840
    s_waitcnt lgkmcnt(4)
    v_mfma_f32_16x16x32_bf16 v[20:23], a[52:55], v[48:51], v[20:23]
    v_mfma_f32_16x16x32_bf16 v[24:27], a[132:135], v[48:51], v[24:27]
    v_mov_b32 v109, v107
    v_cvt_pk_bf16_f32 v109, v109, v109
    v_lshlrev_b32 v109, 16, v109
    ds_read_b128 v[44:47], v92 offset:16384
    s_waitcnt lgkmcnt(4)
    v_mfma_f32_16x16x32_bf16 v[12:15], a[56:59], v[52:55], v[12:15]
    v_mfma_f32_16x16x32_bf16 v[16:19], a[136:139], v[52:55], v[16:19]
    v_add_f32 v109, 0x3727c5ac, v109
    v_cvt_pk_bf16_f32 v109, v109, v109
    v_lshlrev_b32 v109, 16, v109
    ds_read_b128 v[48:51], v92 offset:36864
    s_waitcnt lgkmcnt(4)
    v_mfma_f32_16x16x32_bf16 v[20:23], a[56:59], v[56:59], v[20:23]
    v_mfma_f32_16x16x32_bf16 v[24:27], a[136:139], v[56:59], v[24:27]
    v_sqrt_f32 v109, v109
    s_nop 0
    v_cvt_pk_bf16_f32 v109, v109, v109
    v_lshlrev_b32 v109, 16, v109
    ds_read_b128 v[52:55], v92 offset:17408
    s_waitcnt lgkmcnt(4)
    v_mfma_f32_16x16x32_bf16 v[12:15], a[60:63], v[36:39], v[12:15]
    v_mfma_f32_16x16x32_bf16 v[16:19], a[140:143], v[36:39], v[16:19]
    v_rcp_f32 v63, v109
    v_sub_f32 v110, v106, v108
    v_mul_f32 v110, v110, v63
    ds_read_b128 v[56:59], v92 offset:37888
    s_waitcnt lgkmcnt(4)
    v_mfma_f32_16x16x32_bf16 v[20:23], a[60:63], v[40:43], v[20:23]
    v_mfma_f32_16x16x32_bf16 v[24:27], a[140:143], v[40:43], v[24:27]
    v_cvt_pk_bf16_f32 v110, v110, v110
    v_lshlrev_b32 v110, 16, v110
    v_mul_f32 v111, v107, v63
    ds_read_b128 v[36:39], v92 offset:18432
    s_waitcnt lgkmcnt(4)
    v_mfma_f32_16x16x32_bf16 v[12:15], a[64:67], v[44:47], v[12:15]
    v_mfma_f32_16x16x32_bf16 v[16:19], a[144:147], v[44:47], v[16:19]
    v_mul_f32 v111, v111, v63
    v_cvt_pk_bf16_f32 v111, v111, v111
    v_lshlrev_b32 v111, 16, v111
    ds_read_b128 v[40:43], v92 offset:38912
    s_waitcnt lgkmcnt(4)
    v_mfma_f32_16x16x32_bf16 v[20:23], a[64:67], v[48:51], v[20:23]
    v_mfma_f32_16x16x32_bf16 v[24:27], a[144:147], v[48:51], v[24:27]
    v_add_f32 v111, 0x3727c5ac, v111
    v_cvt_pk_bf16_f32 v111, v111, v111
    v_lshlrev_b32 v111, 16, v111
    ds_read_b128 v[44:47], v92 offset:19456
    s_waitcnt lgkmcnt(4)
    v_mfma_f32_16x16x32_bf16 v[12:15], a[68:71], v[52:55], v[12:15]
    v_mfma_f32_16x16x32_bf16 v[16:19], a[148:151], v[52:55], v[16:19]
    v_sqrt_f32 v111, v111
    s_nop 0
    v_cvt_pk_bf16_f32 v111, v111, v111
    v_lshlrev_b32 v111, 16, v111
    ds_read_b128 v[48:51], v92 offset:39936
    s_waitcnt lgkmcnt(4)
    v_mfma_f32_16x16x32_bf16 v[20:23], a[68:71], v[56:59], v[20:23]
    v_mfma_f32_16x16x32_bf16 v[24:27], a[148:151], v[56:59], v[24:27]
    v_rcp_f32 v111, v111
    v_fma_f32 v61, v110, v109, v108
    v_mul_f32 v63, v63, v111
    s_waitcnt lgkmcnt(3)
    v_mfma_f32_16x16x32_bf16 v[12:15], a[72:75], v[36:39], v[12:15]
    v_mfma_f32_16x16x32_bf16 v[16:19], a[152:155], v[36:39], v[16:19]
    s_waitcnt lgkmcnt(2)
    v_mfma_f32_16x16x32_bf16 v[20:23], a[72:75], v[40:43], v[20:23]
    v_mfma_f32_16x16x32_bf16 v[24:27], a[152:155], v[40:43], v[24:27]
    s_waitcnt lgkmcnt(1)
    v_mfma_f32_16x16x32_bf16 v[12:15], a[76:79], v[44:47], v[12:15]
    v_mfma_f32_16x16x32_bf16 v[16:19], a[156:159], v[44:47], v[16:19]
    s_waitcnt lgkmcnt(0)
    v_mfma_f32_16x16x32_bf16 v[20:23], a[76:79], v[48:51], v[20:23]
    v_mfma_f32_16x16x32_bf16 v[24:27], a[156:159], v[48:51], v[24:27]
    s_nop 7
Lsj_50201:
    v_fma_f32 v12, -v60, v28, v12
    v_mul_f32 v12, v12, v62
    v_fma_f32 v13, -v60, v29, v13
    v_mul_f32 v13, v13, v62
    v_cvt_pk_bf16_f32 v44, v12, v13
    v_lshlrev_b32 v12, 16, v44
    v_and_b32 v13, 0xffff0000, v44
    v_mul_f32 v44, v12, v12
    v_fma_f32 v44, v44, s51, v7
    v_mul_f32 v44, v44, v12
    v_exp_f32 v44, v44
    v_mul_f32 v45, v13, v13
    v_fma_f32 v45, v45, s51, v7
    v_mul_f32 v45, v45, v13
    v_exp_f32 v45, v45
    v_add_f32 v44, 1.0, v44
    v_rcp_f32 v44, v44
    v_add_f32 v45, 1.0, v45
    v_rcp_f32 v45, v45
    v_mul_f32 v12, v12, v44
    v_mul_f32 v13, v13, v45
    v_cvt_pk_bf16_f32 v36, v12, v13
    v_fma_f32 v14, -v60, v30, v14
    v_mul_f32 v14, v14, v62
    v_fma_f32 v15, -v60, v31, v15
    v_mul_f32 v15, v15, v62
    v_cvt_pk_bf16_f32 v44, v14, v15
    v_lshlrev_b32 v14, 16, v44
    v_and_b32 v15, 0xffff0000, v44
    v_mul_f32 v44, v14, v14
    v_fma_f32 v44, v44, s51, v7
    v_mul_f32 v44, v44, v14
    v_exp_f32 v44, v44
    v_mul_f32 v45, v15, v15
    v_fma_f32 v45, v45, s51, v7
    v_mul_f32 v45, v45, v15
    v_exp_f32 v45, v45
    v_add_f32 v44, 1.0, v44
    v_rcp_f32 v44, v44
    v_add_f32 v45, 1.0, v45
    v_rcp_f32 v45, v45
    v_mul_f32 v14, v14, v44
    v_mul_f32 v15, v15, v45
    v_cvt_pk_bf16_f32 v37, v14, v15
    v_fma_f32 v16, -v60, v32, v16
    v_mul_f32 v16, v16, v62
    v_fma_f32 v17, -v60, v33, v17
    v_mul_f32 v17, v17, v62
    v_cvt_pk_bf16_f32 v44, v16, v17
    v_lshlrev_b32 v16, 16, v44
    v_and_b32 v17, 0xffff0000, v44
    v_mul_f32 v44, v16, v16
    v_fma_f32 v44, v44, s51, v7
    v_mul_f32 v44, v44, v16
    v_exp_f32 v44, v44
    v_mul_f32 v45, v17, v17
    v_fma_f32 v45, v45, s51, v7
    v_mul_f32 v45, v45, v17
    v_exp_f32 v45, v45
    v_add_f32 v44, 1.0, v44
    v_rcp_f32 v44, v44
    v_add_f32 v45, 1.0, v45
    v_rcp_f32 v45, v45
    v_mul_f32 v16, v16, v44
    v_mul_f32 v17, v17, v45
    v_cvt_pk_bf16_f32 v38, v16, v17
    v_fma_f32 v18, -v60, v34, v18
    v_mul_f32 v18, v18, v62
    v_fma_f32 v19, -v60, v35, v19
    v_mul_f32 v19, v19, v62
    v_cvt_pk_bf16_f32 v44, v18, v19
    v_lshlrev_b32 v18, 16, v44
    v_and_b32 v19, 0xffff0000, v44
    v_mul_f32 v44, v18, v18
    v_fma_f32 v44, v44, s51, v7
    v_mul_f32 v44, v44, v18
    v_exp_f32 v44, v44
    v_mul_f32 v45, v19, v19
    v_fma_f32 v45, v45, s51, v7
    v_mul_f32 v45, v45, v19
    v_exp_f32 v45, v45
    v_add_f32 v44, 1.0, v44
    v_rcp_f32 v44, v44
    v_add_f32 v45, 1.0, v45
    v_rcp_f32 v45, v45
    v_mul_f32 v18, v18, v44
    v_mul_f32 v19, v19, v45
    v_cvt_pk_bf16_f32 v39, v18, v19
    s_lshl_b32 s34, s17, 1
    s_add_u32 s34, s34, 0
    s_mul_i32 s35, s34, 20
    s_add_u32 s35, s35, s29
    s_lshl_b32 s35, s35, 10
    s_add_u32 s35, s35, 0xa500000
    buffer_store_dwordx4 v[36:39], v1, s[4:7], s35 offen sc1
    v_fma_f32 v20, -v61, v28, v20
    v_mul_f32 v20, v20, v63
    v_fma_f32 v21, -v61, v29, v21
    v_mul_f32 v21, v21, v63
    v_cvt_pk_bf16_f32 v44, v20, v21
    v_lshlrev_b32 v20, 16, v44
    v_and_b32 v21, 0xffff0000, v44
    v_mul_f32 v44, v20, v20
    v_fma_f32 v44, v44, s51, v7
    v_mul_f32 v44, v44, v20
    v_exp_f32 v44, v44
    v_mul_f32 v45, v21, v21
    v_fma_f32 v45, v45, s51, v7
    v_mul_f32 v45, v45, v21
    v_exp_f32 v45, v45
    v_add_f32 v44, 1.0, v44
    v_rcp_f32 v44, v44
    v_add_f32 v45, 1.0, v45
    v_rcp_f32 v45, v45
    v_mul_f32 v20, v20, v44
    v_mul_f32 v21, v21, v45
    v_cvt_pk_bf16_f32 v40, v20, v21
    v_fma_f32 v22, -v61, v30, v22
    v_mul_f32 v22, v22, v63
    v_fma_f32 v23, -v61, v31, v23
    v_mul_f32 v23, v23, v63
    v_cvt_pk_bf16_f32 v44, v22, v23
    v_lshlrev_b32 v22, 16, v44
    v_and_b32 v23, 0xffff0000, v44
    v_mul_f32 v44, v22, v22
    v_fma_f32 v44, v44, s51, v7
    v_mul_f32 v44, v44, v22
    v_exp_f32 v44, v44
    v_mul_f32 v45, v23, v23
    v_fma_f32 v45, v45, s51, v7
    v_mul_f32 v45, v45, v23
    v_exp_f32 v45, v45
    v_add_f32 v44, 1.0, v44
    v_rcp_f32 v44, v44
    v_add_f32 v45, 1.0, v45
    v_rcp_f32 v45, v45
    v_mul_f32 v22, v22, v44
    v_mul_f32 v23, v23, v45
    v_cvt_pk_bf16_f32 v41, v22, v23
    v_fma_f32 v24, -v61, v32, v24
    v_mul_f32 v24, v24, v63
    v_fma_f32 v25, -v61, v33, v25
    v_mul_f32 v25, v25, v63
    v_cvt_pk_bf16_f32 v44, v24, v25
    v_lshlrev_b32 v24, 16, v44
    v_and_b32 v25, 0xffff0000, v44
    v_mul_f32 v44, v24, v24
    v_fma_f32 v44, v44, s51, v7
    v_mul_f32 v44, v44, v24
    v_exp_f32 v44, v44
    v_mul_f32 v45, v25, v25
    v_fma_f32 v45, v45, s51, v7
    v_mul_f32 v45, v45, v25
    v_exp_f32 v45, v45
    v_add_f32 v44, 1.0, v44
    v_rcp_f32 v44, v44
    v_add_f32 v45, 1.0, v45
    v_rcp_f32 v45, v45
    v_mul_f32 v24, v24, v44
    v_mul_f32 v25, v25, v45
    v_cvt_pk_bf16_f32 v42, v24, v25
    v_fma_f32 v26, -v61, v34, v26
    v_mul_f32 v26, v26, v63
    v_fma_f32 v27, -v61, v35, v27
    v_mul_f32 v27, v27, v63
    v_cvt_pk_bf16_f32 v44, v26, v27
    v_lshlrev_b32 v26, 16, v44
    v_and_b32 v27, 0xffff0000, v44
    v_mul_f32 v44, v26, v26
    v_fma_f32 v44, v44, s51, v7
    v_mul_f32 v44, v44, v26
    v_exp_f32 v44, v44
    v_mul_f32 v45, v27, v27
    v_fma_f32 v45, v45, s51, v7
    v_mul_f32 v45, v45, v27
    v_exp_f32 v45, v45
    v_add_f32 v44, 1.0, v44
    v_rcp_f32 v44, v44
    v_add_f32 v45, 1.0, v45
    v_rcp_f32 v45, v45
    v_mul_f32 v26, v26, v44
    v_mul_f32 v27, v27, v45
    v_cvt_pk_bf16_f32 v43, v26, v27
    s_lshl_b32 s34, s17, 1
    s_add_u32 s34, s34, 1
    s_mul_i32 s35, s34, 20
    s_add_u32 s35, s35, s29
    s_lshl_b32 s35, s35, 10
    s_add_u32 s35, s35, 0xa500000
    buffer_store_dwordx4 v[40:43], v1, s[4:7], s35 offen sc1
    s_mov_b32 s55, s17
    s_mov_b32 s17, s27
    s_cmp_eq_u32 s28, 0
    s_cbranch_scc1 Lsq_50206
    s_waitcnt vmcnt(0)
    s_lshl_b32 s46, s55, 6
    s_add_u32 s46, s46, 0xb204240
    v_mov_b32 v4, s46
    v_mov_b32 v5, 1
    s_mov_b64 exec, 1
    buffer_atomic_add v5, v4, s[4:7], 0 offen
    s_mov_b64 exec, -1
Lcs_50207:
    s_mov_b32 s55, 64
    s_cmp_ge_u32 s17, s50
    s_cbranch_scc1 Ls_end_50186
    v_add_u32 v8, s17, v0
    v_cmp_gt_u32 vcc, 64, v8
    s_and_b64 s[48:49], vcc, 1
    v_lshlrev_b32 v8, 6, v8
    v_add_u32 v8, 0xb203040, v8
    s_mov_b64 exec, s[48:49]
    s_nop 0
Lwp_50208:
    buffer_load_dword v9, v8, s[4:7], 0 offen sc1
    s_waitcnt vmcnt(0)
    v_cmp_gt_u32 vcc, 5, v9
    s_nop 0
    s_cbranch_vccz Lwpd_50209
    s_sleep 5
    s_add_u32 s30, s30, 1
    s_cmp_lt_u32 s30, s31
    s_cbranch_scc1 Lwp_50208
Lwpd_50209:
    s_mov_b64 exec, -1
    s_mul_i32 s20, s17, 40960
    s_add_u32 s20, s20, 0xa200000
    s_mul_i32 s21, s14, 10240
    s_add_u32 s20, s20, s21
    s_add_u32 s21, s21, 0
    s_mov_b32 m0, s21
    s_nop 0
    buffer_load_dwordx4 v1, s[4:7], s20 offen offset:0 sc1 lds
    buffer_load_dwordx4 v1, s[4:7], s20 offen offset:1024 sc1 lds
    buffer_load_dwordx4 v1, s[4:7], s20 offen offset:2048 sc1 lds
    buffer_load_dwordx4 v1, s[4:7], s20 offen offset:3072 sc1 lds
    s_add_u32 s20, s20, 4096
    s_add_u32 s21, s21, 4096
    s_mov_b32 m0, s21
    s_nop 0
    buffer_load_dwordx4 v1, s[4:7], s20 offen offset:0 sc1 lds
    buffer_load_dwordx4 v1, s[4:7], s20 offen offset:1024 sc1 lds
    buffer_load_dwordx4 v1, s[4:7], s20 offen offset:2048 sc1 lds
    buffer_load_dwordx4 v1, s[4:7], s20 offen offset:3072 sc1 lds
    s_add_u32 s20, s20, 4096
    s_add_u32 s21, s21, 4096
    s_mov_b32 m0, s21
    s_nop 0
    buffer_load_dwordx4 v1, s[4:7], s20 offen offset:0 sc1 lds
    buffer_load_dwordx4 v1, s[4:7], s20 offen offset:1024 sc1 lds
    v_mul_u32_u24 v124, 640, v3
    v_lshl_add_u32 v124, v2, 3, v124
    s_mul_i32 s25, s17, 5120
    s_add_u32 s25, s25, 0xb100000
    buffer_load_dwordx2 v[64:65], v124, s[4:7], s25 offen offset:0 sc1
    buffer_load_dwordx2 v[66:67], v124, s[4:7], s25 offen offset:128 sc1
    buffer_load_dwordx2 v[68:69], v124, s[4:7], s25 offen offset:256 sc1
    buffer_load_dwordx2 v[70:71], v124, s[4:7], s25 offen offset:384 sc1
    buffer_load_dwordx2 v[72:73], v124, s[4:7], s25 offen offset:512 sc1
    buffer_load_dwordx2 v[74:75], v124, s[4:7], s25 offen offset:2560 sc1
    buffer_load_dwordx2 v[76:77], v124, s[4:7], s25 offen offset:2688 sc1
    buffer_load_dwordx2 v[78:79], v124, s[4:7], s25 offen offset:2816 sc1
    buffer_load_dwordx2 v[80:81], v124, s[4:7], s25 offen offset:2944 sc1
    buffer_load_dwordx2 v[82:83], v124, s[4:7], s25 offen offset:3072 sc1
    s_add_u32 s33, s17, s19
    v_add_u32 v8, s33, v0
    v_cmp_gt_u32 vcc, 64, v8
    s_and_b64 s[48:49], vcc, 1
    v_lshlrev_b32 v8, 6, v8
    v_add_u32 v8, 0xb203040, v8
    buffer_load_dword v9, v8, s[4:7], 0 offen sc1
    s_waitcnt vmcnt(0)
Lsq_50206:
    s_branch Ls_loop_50187
Ls_end_50186:
    s_branch Lmain_end
Lph_d2:
    s_sub_u32 s20, s26, 45
    s_mul_i32 s17, s20, 0x3334
    s_lshr_b32 s17, s17, 16
    s_mul_i32 s18, s17, 5
    s_sub_u32 s18, s20, s18
Lph_d2b:
    s_add_u32 s64, s56, 0xa500000
    s_addc_u32 s65, s57, 0
    s_mov_b32 s8, s64
    s_and_b32 s9, s65, 0xffff
    s_mov_b32 s10, 0x280000
    s_mov_b32 s11, 0x20000
    v_lshlrev_b32 v1, 4, v0
    v_and_b32 v2, 15, v0
    v_lshrrev_b32 v3, 4, v0
    s_lshl_b32 s29, s18, 2
    s_add_u32 s29, s29, s14
    s_mul_i32 s23, s29, 40960
    s_add_u32 s23, s23, 0xbb00000
    buffer_load_dwordx4 a[0:3], v1, s[4:7], s23 offen offset:0 sc1
    buffer_load_dwordx4 a[4:7], v1, s[4:7], s23 offen offset:1024 sc1
    buffer_load_dwordx4 a[8:11], v1, s[4:7], s23 offen offset:2048 sc1
    buffer_load_dwordx4 a[12:15], v1, s[4:7], s23 offen offset:3072 sc1
    s_add_u32 s23, s23, 4096
    buffer_load_dwordx4 a[16:19], v1, s[4:7], s23 offen offset:0 sc1
    buffer_load_dwordx4 a[20:23], v1, s[4:7], s23 offen offset:1024 sc1
    buffer_load_dwordx4 a[24:27], v1, s[4:7], s23 offen offset:2048 sc1
    buffer_load_dwordx4 a[28:31], v1, s[4:7], s23 offen offset:3072 sc1
    s_add_u32 s23, s23, 4096
    buffer_load_dwordx4 a[32:35], v1, s[4:7], s23 offen offset:0 sc1
    buffer_load_dwordx4 a[36:39], v1, s[4:7], s23 offen offset:1024 sc1
    buffer_load_dwordx4 a[40:43], v1, s[4:7], s23 offen offset:2048 sc1
    buffer_load_dwordx4 a[44:47], v1, s[4:7], s23 offen offset:3072 sc1
    s_add_u32 s23, s23, 4096
    buffer_load_dwordx4 a[48:51], v1, s[4:7], s23 offen offset:0 sc1
    buffer_load_dwordx4 a[52:55], v1, s[4:7], s23 offen offset:1024 sc1
    buffer_load_dwordx4 a[56:59], v1, s[4:7], s23 offen offset:2048 sc1
    buffer_load_dwordx4 a[60:63], v1, s[4:7], s23 offen offset:3072 sc1
    s_add_u32 s23, s23, 4096
    buffer_load_dwordx4 a[64:67], v1, s[4:7], s23 offen offset:0 sc1
    buffer_load_dwordx4 a[68:71], v1, s[4:7], s23 offen offset:1024 sc1
    buffer_load_dwordx4 a[72:75], v1, s[4:7], s23 offen offset:2048 sc1
    buffer_load_dwordx4 a[76:79], v1, s[4:7], s23 offen offset:3072 sc1
    s_add_u32 s23, s23, 4096
    buffer_load_dwordx4 a[80:83], v1, s[4:7], s23 offen offset:0 sc1
    buffer_load_dwordx4 a[84:87], v1, s[4:7], s23 offen offset:1024 sc1
    buffer_load_dwordx4 a[88:91], v1, s[4:7], s23 offen offset:2048 sc1
    buffer_load_dwordx4 a[92:95], v1, s[4:7], s23 offen offset:3072 sc1
    s_add_u32 s23, s23, 4096
    buffer_load_dwordx4 a[96:99], v1, s[4:7], s23 offen offset:0 sc1
    buffer_load_dwordx4 a[100:103], v1, s[4:7], s23 offen offset:1024 sc1
    buffer_load_dwordx4 a[104:107], v1, s[4:7], s23 offen offset:2048 sc1
    buffer_load_dwordx4 a[108:111], v1, s[4:7], s23 offen offset:3072 sc1
    s_add_u32 s23, s23, 4096
    buffer_load_dwordx4 a[112:115], v1, s[4:7], s23 offen offset:0 sc1
    buffer_load_dwordx4 a[116:119], v1, s[4:7], s23 offen offset:1024 sc1
    buffer_load_dwordx4 a[120:123], v1, s[4:7], s23 offen offset:2048 sc1
    buffer_load_dwordx4 a[124:127], v1, s[4:7], s23 offen offset:3072 sc1
    s_add_u32 s23, s23, 4096
    buffer_load_dwordx4 a[128:131], v1, s[4:7], s23 offen offset:0 sc1
    buffer_load_dwordx4 a[132:135], v1, s[4:7], s23 offen offset:1024 sc1
    buffer_load_dwordx4 a[136:139], v1, s[4:7], s23 offen offset:2048 sc1
    buffer_load_dwordx4 a[140:143], v1, s[4:7], s23 offen offset:3072 sc1
    s_add_u32 s23, s23, 4096
    buffer_load_dwordx4 a[144:147], v1, s[4:7], s23 offen offset:0 sc1
    buffer_load_dwordx4 a[148:151], v1, s[4:7], s23 offen offset:1024 sc1
    buffer_load_dwordx4 a[152:155], v1, s[4:7], s23 offen offset:2048 sc1
    buffer_load_dwordx4 a[156:159], v1, s[4:7], s23 offen offset:3072 sc1
    s_add_u32 s23, s23, 4096
    v_mov_b32 v7, 0xc0135761
    s_mov_b32 s51, 0xbdd2d3e8
    v_lshlrev_b32 v6, 3, v2
    s_waitcnt vmcnt(0)
    s_lshr_b32 s52, s14, 1
    s_add_u32 s52, s52, 1
    s_and_b32 s53, s14, 1
    s_sub_u32 s54, 0, s52
    s_cmp_eq_u32 s53, 0
    s_cselect_b32 s52, s54, s52
    s_mov_b32 s55, 64
    v_add_u32 v8, s17, v0
    v_add_u32 v8, -1, v8
    v_cmp_gt_u32 vcc, 64, v8
    s_and_b64 s[48:49], vcc, 7
    v_lshlrev_b32 v8, 6, v8
    v_add_u32 v8, 0xb204240, v8
    s_mov_b64 exec, s[48:49]
    s_nop 0
Lwp_50212:
    buffer_load_dword v9, v8, s[4:7], 0 offen sc1
    s_waitcnt vmcnt(0)
    v_cmp_gt_u32 vcc, 20, v9
    s_nop 0
    s_cbranch_vccz Lwpd_50213
    s_sleep 5
    s_add_u32 s30, s30, 1
    s_cmp_lt_u32 s30, s31
    s_cbranch_scc1 Lwp_50212
Lwpd_50213:
    s_mov_b64 exec, -1
    s_lshl_b32 s20, s17, 5
    s_add_u32 s20, s20, s52
    s_mul_i32 s22, s14, 5120
    v_add_u32 v10, s20, v2
    v_ashrrev_i32 v11, 4, v10
    v_mul_i32_i24 v11, 20480, v11
    v_and_b32 v10, 15, v10
    v_lshl_add_u32 v10, v3, 4, v10
    v_lshl_add_u32 v11, v10, 4, v11
    s_add_u32 m0, s22, 0
    s_nop 0
    buffer_load_dwordx4 v11, s[8:11], s22 offen offset:0 sc1 lds
    buffer_load_dwordx4 v11, s[8:11], s22 offen offset:1024 sc1 lds
    buffer_load_dwordx4 v11, s[8:11], s22 offen offset:2048 sc1 lds
    buffer_load_dwordx4 v11, s[8:11], s22 offen offset:3072 sc1 lds
    s_add_u32 m0, s22, 4096
    s_add_u32 s21, s22, 4096
    buffer_load_dwordx4 v11, s[8:11], s21 offen sc1 lds
    v_add_u32 v10, s20, v2
    v_add_u32 v10, 16, v10
    v_ashrrev_i32 v11, 4, v10
    v_mul_i32_i24 v11, 20480, v11
    v_and_b32 v10, 15, v10
    v_lshl_add_u32 v10, v3, 4, v10
    v_lshl_add_u32 v11, v10, 4, v11
    s_add_u32 m0, s22, 20480
    s_nop 0
    buffer_load_dwordx4 v11, s[8:11], s22 offen offset:0 sc1 lds
    buffer_load_dwordx4 v11, s[8:11], s22 offen offset:1024 sc1 lds
    buffer_load_dwordx4 v11, s[8:11], s22 offen offset:2048 sc1 lds
    buffer_load_dwordx4 v11, s[8:11], s22 offen offset:3072 sc1 lds
    s_add_u32 m0, s22, 24576
    s_add_u32 s21, s22, 4096
    buffer_load_dwordx4 v11, s[8:11], s21 offen sc1 lds
    v_mul_u32_u24 v124, 640, v3
    v_lshl_add_u32 v124, v2, 3, v124
    s_mul_i32 s25, s17, 5120
    s_add_u32 s25, s25, 0xb100000
    buffer_load_dwordx2 v[64:65], v124, s[4:7], s25 offen offset:0 sc1
    buffer_load_dwordx2 v[66:67], v124, s[4:7], s25 offen offset:128 sc1
    buffer_load_dwordx2 v[68:69], v124, s[4:7], s25 offen offset:256 sc1
    buffer_load_dwordx2 v[70:71], v124, s[4:7], s25 offen offset:384 sc1
    buffer_load_dwordx2 v[72:73], v124, s[4:7], s25 offen offset:512 sc1
    buffer_load_dwordx2 v[74:75], v124, s[4:7], s25 offen offset:2560 sc1
    buffer_load_dwordx2 v[76:77], v124, s[4:7], s25 offen offset:2688 sc1
    buffer_load_dwordx2 v[78:79], v124, s[4:7], s25 offen offset:2816 sc1
    buffer_load_dwordx2 v[80:81], v124, s[4:7], s25 offen offset:2944 sc1
    buffer_load_dwordx2 v[82:83], v124, s[4:7], s25 offen offset:3072 sc1
    s_mul_i32 s25, s17, 40
    s_add_u32 s25, s25, s29
    s_lshl_b32 s25, s25, 10
    s_add_u32 s25, s25, 0xa200000
    buffer_load_dwordx4 v[84:87], v1, s[4:7], s25 offen sc1
    s_add_u32 s25, s25, 20480
    buffer_load_dwordx4 v[88:91], v1, s[4:7], s25 offen sc1
    s_add_u32 s33, s17, s19
    v_add_u32 v8, s33, v0
    v_add_u32 v8, -1, v8
    v_cmp_gt_u32 vcc, 64, v8
    s_and_b64 s[48:49], vcc, 7
    v_lshlrev_b32 v8, 6, v8
    v_add_u32 v8, 0xb204240, v8
    buffer_load_dword v9, v8, s[4:7], 0 offen sc1
    s_waitcnt vmcnt(0)
Ls_loop_50211:
    s_waitcnt vmcnt(4)
    s_barrier
    s_add_u32 s27, s17, s19
    s_mov_b32 s28, 1
    v_add_u32 v92, 0, v1
    v_add_u32 v93, 65536, v1
    s_cmp_ge_u32 s27, s50
    s_cbranch_scc1 Lsp_50214
    v_cmp_gt_u32 vcc, 20, v9
    s_and_b64 vcc, vcc, s[48:49]
    s_cbranch_scc1 Lsp_50214
    s_mov_b32 s28, 0
    ds_read_b128 v[36:39], v92 offset:0
    ds_read_b128 v[40:43], v92 offset:20480
    ds_read_b128 v[44:47], v92 offset:1024
    ds_read_b128 v[48:51], v92 offset:21504
    ds_read_b128 v[52:55], v92 offset:2048
    s_waitcnt lgkmcnt(4)
    v_mfma_f32_16x16x32_bf16 v[12:15], a[0:3], v[36:39], 0
    s_lshl_b32 s20, s27, 5
    s_add_u32 s20, s20, s52
    s_mul_i32 s22, s14, 5120
    v_add_u32 v10, s20, v2
    v_ashrrev_i32 v11, 4, v10
    v_mul_i32_i24 v11, 20480, v11
    v_and_b32 v10, 15, v10
    v_lshl_add_u32 v10, v3, 4, v10
    v_lshl_add_u32 v11, v10, 4, v11
    s_add_u32 m0, s22, 40960
    s_nop 0
    buffer_load_dwordx4 v11, s[8:11], s22 offen offset:0 sc1 lds
    v_mfma_f32_16x16x32_bf16 v[16:19], a[80:83], v[36:39], 0
    v_add_f32 v64, v64, v66
    v_add_f32 v65, v65, v67
    v_add_f32 v64, v64, v68
    ds_read_b128 v[56:59], v92 offset:22528
    s_waitcnt lgkmcnt(4)
    v_mfma_f32_16x16x32_bf16 v[20:23], a[0:3], v[40:43], 0
    buffer_load_dwordx4 v11, s[8:11], s22 offen offset:1024 sc1 lds
    v_mfma_f32_16x16x32_bf16 v[24:27], a[80:83], v[40:43], 0
    v_add_f32 v65, v65, v69
    v_add_f32 v64, v64, v70
    v_add_f32 v65, v65, v71
    ds_read_b128 v[36:39], v92 offset:3072
    s_waitcnt lgkmcnt(4)
    v_mfma_f32_16x16x32_bf16 v[12:15], a[4:7], v[44:47], v[12:15]
    buffer_load_dwordx4 v11, s[8:11], s22 offen offset:2048 sc1 lds
    v_mfma_f32_16x16x32_bf16 v[16:19], a[84:87], v[44:47], v[16:19]
    v_add_f32 v64, v64, v72
    v_add_f32 v65, v65, v73
    v_mov_b32 v125, v64
    ds_read_b128 v[40:43], v92 offset:23552
    s_waitcnt lgkmcnt(4)
    v_mfma_f32_16x16x32_bf16 v[20:23], a[4:7], v[48:51], v[20:23]
    buffer_load_dwordx4 v11, s[8:11], s22 offen offset:3072 sc1 lds
    v_mfma_f32_16x16x32_bf16 v[24:27], a[84:87], v[48:51], v[24:27]
    v_permlane16_swap_b32 v64, v125
    v_add_f32 v64, v64, v125
    v_mov_b32 v125, v64
    ds_read_b128 v[44:47], v92 offset:4096
    s_waitcnt lgkmcnt(4)
    v_mfma_f32_16x16x32_bf16 v[12:15], a[8:11], v[52:55], v[12:15]
    s_add_u32 m0, s22, 45056
    s_add_u32 s21, s22, 4096
    buffer_load_dwordx4 v11, s[8:11], s21 offen sc1 lds
    v_mfma_f32_16x16x32_bf16 v[16:19], a[88:91], v[52:55], v[16:19]
    v_permlane32_swap_b32 v64, v125
    v_add_f32 v64, v64, v125
    v_mov_b32 v125, v65
    ds_read_b128 v[48:51], v92 offset:24576
    s_waitcnt lgkmcnt(4)
    v_mfma_f32_16x16x32_bf16 v[20:23], a[8:11], v[56:59], v[20:23]
    v_add_u32 v10, s20, v2
    v_add_u32 v10, 16, v10
    v_ashrrev_i32 v11, 4, v10
    v_mul_i32_i24 v11, 20480, v11
    v_and_b32 v10, 15, v10
    v_lshl_add_u32 v10, v3, 4, v10
    v_lshl_add_u32 v11, v10, 4, v11
    s_add_u32 m0, s22, 61440
    s_nop 0
    buffer_load_dwordx4 v11, s[8:11], s22 offen offset:0 sc1 lds
    v_mfma_f32_16x16x32_bf16 v[24:27], a[88:91], v[56:59], v[24:27]
    v_permlane16_swap_b32 v65, v125
    v_add_f32 v65, v65, v125
    v_mov_b32 v125, v65
    ds_read_b128 v[52:55], v92 offset:5120
    s_waitcnt lgkmcnt(4)
    v_mfma_f32_16x16x32_bf16 v[12:15], a[12:15], v[36:39], v[12:15]
    buffer_load_dwordx4 v11, s[8:11], s22 offen offset:1024 sc1 lds
    v_mfma_f32_16x16x32_bf16 v[16:19], a[92:95], v[36:39], v[16:19]
    v_permlane32_swap_b32 v65, v125
    v_add_f32 v65, v65, v125
    v_mul_f32 v64, 0x3acccccd, v64
    ds_read_b128 v[56:59], v92 offset:25600
    s_waitcnt lgkmcnt(4)
    v_mfma_f32_16x16x32_bf16 v[20:23], a[12:15], v[40:43], v[20:23]
    buffer_load_dwordx4 v11, s[8:11], s22 offen offset:2048 sc1 lds
    v_mfma_f32_16x16x32_bf16 v[24:27], a[92:95], v[40:43], v[24:27]
    v_mul_f32 v65, 0x3acccccd, v65
    v_fma_f32 v65, -v64, v64, v65
    v_max_f32 v65, 0, v65
    ds_read_b128 v[36:39], v92 offset:6144
    s_waitcnt lgkmcnt(4)
    v_mfma_f32_16x16x32_bf16 v[12:15], a[16:19], v[44:47], v[12:15]
    buffer_load_dwordx4 v11, s[8:11], s22 offen offset:3072 sc1 lds
    v_mfma_f32_16x16x32_bf16 v[16:19], a[96:99], v[44:47], v[16:19]
    v_mov_b32 v66, v64
    v_cvt_pk_bf16_f32 v66, v66, v66
    v_lshlrev_b32 v66, 16, v66
    ds_read_b128 v[40:43], v92 offset:26624
    s_waitcnt lgkmcnt(4)
    v_mfma_f32_16x16x32_bf16 v[20:23], a[16:19], v[48:51], v[20:23]
    s_add_u32 m0, s22, 65536
    s_add_u32 s21, s22, 4096
    buffer_load_dwordx4 v11, s[8:11], s21 offen sc1 lds
    v_mfma_f32_16x16x32_bf16 v[24:27], a[96:99], v[48:51], v[24:27]
    v_mov_b32 v67, v65
    v_cvt_pk_bf16_f32 v67, v67, v67
    v_lshlrev_b32 v67, 16, v67
    ds_read_b128 v[44:47], v92 offset:7168
    s_waitcnt lgkmcnt(4)
    v_mfma_f32_16x16x32_bf16 v[12:15], a[20:23], v[52:55], v[12:15]
    v_mul_u32_u24 v124, 640, v3
    v_lshl_add_u32 v124, v2, 3, v124
    s_mul_i32 s25, s27, 5120
    s_add_u32 s25, s25, 0xb100000
    buffer_load_dwordx2 v[96:97], v124, s[4:7], s25 offen offset:0 sc1
    v_mfma_f32_16x16x32_bf16 v[16:19], a[100:103], v[52:55], v[16:19]
    v_add_f32 v67, 0x3727c5ac, v67
    v_cvt_pk_bf16_f32 v67, v67, v67
    v_lshlrev_b32 v67, 16, v67
    ds_read_b128 v[48:51], v92 offset:27648
    s_waitcnt lgkmcnt(4)
    v_mfma_f32_16x16x32_bf16 v[20:23], a[20:23], v[56:59], v[20:23]
    buffer_load_dwordx2 v[98:99], v124, s[4:7], s25 offen offset:128 sc1
    v_mfma_f32_16x16x32_bf16 v[24:27], a[100:103], v[56:59], v[24:27]
    v_sqrt_f32 v67, v67
    s_nop 0
    v_cvt_pk_bf16_f32 v67, v67, v67
    v_lshlrev_b32 v67, 16, v67
    ds_read_b128 v[52:55], v92 offset:8192
    s_waitcnt lgkmcnt(4)
    v_mfma_f32_16x16x32_bf16 v[12:15], a[24:27], v[36:39], v[12:15]
    buffer_load_dwordx2 v[100:101], v124, s[4:7], s25 offen offset:256 sc1
    v_mfma_f32_16x16x32_bf16 v[16:19], a[104:107], v[36:39], v[16:19]
    v_rcp_f32 v62, v67
    v_mov_b32 v60, v66
    v_add_f32 v74, v74, v76
    s_cmp_ge_u32 s55, 64
    s_nop 2
    s_cbranch_scc1 Lsd_50216
    s_waitcnt vmcnt(13)
    s_lshl_b32 s46, s55, 6
    s_add_u32 s46, s46, 0xb205440
    v_mov_b32 v4, s46
    v_mov_b32 v5, 1
    s_mov_b64 exec, 1
    buffer_atomic_add v5, v4, s[4:7], 0 offen
    s_mov_b64 exec, -1
Lcs_50217:
    s_mov_b32 s55, 64
Lsd_50216:
    ds_read_b128 v[56:59], v92 offset:28672
    s_waitcnt lgkmcnt(4)
    v_mfma_f32_16x16x32_bf16 v[20:23], a[24:27], v[40:43], v[20:23]
    buffer_load_dwordx2 v[102:103], v124, s[4:7], s25 offen offset:384 sc1
    v_mfma_f32_16x16x32_bf16 v[24:27], a[104:107], v[40:43], v[24:27]
    v_add_f32 v75, v75, v77
    v_add_f32 v74, v74, v78
    v_add_f32 v75, v75, v79
    ds_read_b128 v[36:39], v92 offset:9216
    s_waitcnt lgkmcnt(4)
    v_mfma_f32_16x16x32_bf16 v[12:15], a[28:31], v[44:47], v[12:15]
    buffer_load_dwordx2 v[104:105], v124, s[4:7], s25 offen offset:512 sc1
    v_mfma_f32_16x16x32_bf16 v[16:19], a[108:111], v[44:47], v[16:19]
    v_add_f32 v74, v74, v80
    v_add_f32 v75, v75, v81
    v_add_f32 v74, v74, v82
    ds_read_b128 v[40:43], v92 offset:29696
    s_waitcnt lgkmcnt(4)
    v_mfma_f32_16x16x32_bf16 v[20:23], a[28:31], v[48:51], v[20:23]
    buffer_load_dwordx2 v[106:107], v124, s[4:7], s25 offen offset:2560 sc1
    v_mfma_f32_16x16x32_bf16 v[24:27], a[108:111], v[48:51], v[24:27]
    v_add_f32 v75, v75, v83
    v_mov_b32 v125, v74
    s_nop 1
    v_permlane16_swap_b32 v74, v125
    ds_read_b128 v[44:47], v92 offset:10240
    s_waitcnt lgkmcnt(4)
    v_mfma_f32_16x16x32_bf16 v[12:15], a[32:35], v[52:55], v[12:15]
    buffer_load_dwordx2 v[108:109], v124, s[4:7], s25 offen offset:2688 sc1
    v_mfma_f32_16x16x32_bf16 v[16:19], a[112:115], v[52:55], v[16:19]
    v_add_f32 v74, v74, v125
    v_mov_b32 v125, v74
    s_nop 1
    v_permlane32_swap_b32 v74, v125
    ds_read_b128 v[48:51], v92 offset:30720
    s_waitcnt lgkmcnt(4)
    v_mfma_f32_16x16x32_bf16 v[20:23], a[32:35], v[56:59], v[20:23]
    buffer_load_dwordx2 v[110:111], v124, s[4:7], s25 offen offset:2816 sc1
    v_mfma_f32_16x16x32_bf16 v[24:27], a[112:115], v[56:59], v[24:27]
    v_add_f32 v74, v74, v125
    v_mov_b32 v125, v75
    s_nop 1
    v_permlane16_swap_b32 v75, v125
    ds_read_b128 v[52:55], v92 offset:11264
    s_waitcnt lgkmcnt(4)
    v_mfma_f32_16x16x32_bf16 v[12:15], a[36:39], v[36:39], v[12:15]
    buffer_load_dwordx2 v[112:113], v124, s[4:7], s25 offen offset:2944 sc1
    v_mfma_f32_16x16x32_bf16 v[16:19], a[116:119], v[36:39], v[16:19]
    v_add_f32 v75, v75, v125
    v_mov_b32 v125, v75
    s_nop 1
    v_permlane32_swap_b32 v75, v125
    ds_read_b128 v[56:59], v92 offset:31744
    s_waitcnt lgkmcnt(4)
    v_mfma_f32_16x16x32_bf16 v[20:23], a[36:39], v[40:43], v[20:23]
    buffer_load_dwordx2 v[114:115], v124, s[4:7], s25 offen offset:3072 sc1
    v_mfma_f32_16x16x32_bf16 v[24:27], a[116:119], v[40:43], v[24:27]
    v_add_f32 v75, v75, v125
    v_mul_f32 v74, 0x3acccccd, v74
    v_mul_f32 v75, 0x3acccccd, v75
    ds_read_b128 v[36:39], v92 offset:12288
    s_waitcnt lgkmcnt(4)
    v_mfma_f32_16x16x32_bf16 v[12:15], a[40:43], v[44:47], v[12:15]
    s_mul_i32 s25, s27, 40
    s_add_u32 s25, s25, s29
    s_lshl_b32 s25, s25, 10
    s_add_u32 s25, s25, 0xa200000
    buffer_load_dwordx4 v[116:119], v1, s[4:7], s25 offen sc1
    v_mfma_f32_16x16x32_bf16 v[16:19], a[120:123], v[44:47], v[16:19]
    v_fma_f32 v75, -v74, v74, v75
    v_max_f32 v75, 0, v75
    v_mov_b32 v76, v74
    ds_read_b128 v[40:43], v92 offset:32768
    s_waitcnt lgkmcnt(4)
    v_mfma_f32_16x16x32_bf16 v[20:23], a[40:43], v[48:51], v[20:23]
    s_add_u32 s25, s25, 20480
    buffer_load_dwordx4 v[120:123], v1, s[4:7], s25 offen sc1
    v_mfma_f32_16x16x32_bf16 v[24:27], a[120:123], v[48:51], v[24:27]
    v_cvt_pk_bf16_f32 v76, v76, v76
    v_lshlrev_b32 v76, 16, v76
    v_mov_b32 v77, v75
    ds_read_b128 v[44:47], v92 offset:13312
    s_waitcnt lgkmcnt(4)
    v_mfma_f32_16x16x32_bf16 v[12:15], a[44:47], v[52:55], v[12:15]
    s_add_u32 s33, s27, s19
    v_add_u32 v8, s33, v0
    v_add_u32 v8, -1, v8
    v_cmp_gt_u32 vcc, 64, v8
    s_and_b64 s[48:49], vcc, 7
    v_lshlrev_b32 v8, 6, v8
    v_add_u32 v8, 0xb204240, v8
    buffer_load_dword v9, v8, s[4:7], 0 offen sc1
    v_mfma_f32_16x16x32_bf16 v[16:19], a[124:127], v[52:55], v[16:19]
    v_cvt_pk_bf16_f32 v77, v77, v77
    v_lshlrev_b32 v77, 16, v77
    v_add_f32 v77, 0x3727c5ac, v77
    ds_read_b128 v[48:51], v92 offset:33792
    s_waitcnt lgkmcnt(4)
    v_mfma_f32_16x16x32_bf16 v[20:23], a[44:47], v[56:59], v[20:23]
    v_mfma_f32_16x16x32_bf16 v[24:27], a[124:127], v[56:59], v[24:27]
    v_cvt_pk_bf16_f32 v77, v77, v77
    v_lshlrev_b32 v77, 16, v77
    v_sqrt_f32 v77, v77
    ds_read_b128 v[52:55], v92 offset:14336
    s_waitcnt lgkmcnt(4)
    v_mfma_f32_16x16x32_bf16 v[12:15], a[48:51], v[36:39], v[12:15]
    v_mfma_f32_16x16x32_bf16 v[16:19], a[128:131], v[36:39], v[16:19]
    v_cvt_pk_bf16_f32 v77, v77, v77
    v_lshlrev_b32 v77, 16, v77
    v_rcp_f32 v63, v77
    ds_read_b128 v[56:59], v92 offset:34816
    s_waitcnt lgkmcnt(4)
    v_mfma_f32_16x16x32_bf16 v[20:23], a[48:51], v[40:43], v[20:23]
    v_mfma_f32_16x16x32_bf16 v[24:27], a[128:131], v[40:43], v[24:27]
    v_mov_b32 v61, v76
    ds_read_b128 v[36:39], v92 offset:15360
    s_waitcnt lgkmcnt(4)
    v_mfma_f32_16x16x32_bf16 v[12:15], a[52:55], v[44:47], v[12:15]
    v_mfma_f32_16x16x32_bf16 v[16:19], a[132:135], v[44:47], v[16:19]
    ds_read_b128 v[40:43], v92 offset:35840
    s_waitcnt lgkmcnt(4)
    v_mfma_f32_16x16x32_bf16 v[20:23], a[52:55], v[48:51], v[20:23]
    v_mfma_f32_16x16x32_bf16 v[24:27], a[132:135], v[48:51], v[24:27]
    ds_read_b128 v[44:47], v92 offset:16384
    s_waitcnt lgkmcnt(4)
    v_mfma_f32_16x16x32_bf16 v[12:15], a[56:59], v[52:55], v[12:15]
    v_mfma_f32_16x16x32_bf16 v[16:19], a[136:139], v[52:55], v[16:19]
    ds_read_b128 v[48:51], v92 offset:36864
    s_waitcnt lgkmcnt(4)
    v_mfma_f32_16x16x32_bf16 v[20:23], a[56:59], v[56:59], v[20:23]
    v_mfma_f32_16x16x32_bf16 v[24:27], a[136:139], v[56:59], v[24:27]
    ds_read_b128 v[52:55], v92 offset:17408
    s_waitcnt lgkmcnt(4)
    v_mfma_f32_16x16x32_bf16 v[12:15], a[60:63], v[36:39], v[12:15]
    v_mfma_f32_16x16x32_bf16 v[16:19], a[140:143], v[36:39], v[16:19]
    ds_read_b128 v[56:59], v92 offset:37888
    s_waitcnt lgkmcnt(4)
    v_mfma_f32_16x16x32_bf16 v[20:23], a[60:63], v[40:43], v[20:23]
    v_mfma_f32_16x16x32_bf16 v[24:27], a[140:143], v[40:43], v[24:27]
    ds_read_b128 v[36:39], v92 offset:18432
    s_waitcnt lgkmcnt(4)
    v_mfma_f32_16x16x32_bf16 v[12:15], a[64:67], v[44:47], v[12:15]
    v_mfma_f32_16x16x32_bf16 v[16:19], a[144:147], v[44:47], v[16:19]
    ds_read_b128 v[40:43], v92 offset:38912
    s_waitcnt lgkmcnt(4)
    v_mfma_f32_16x16x32_bf16 v[20:23], a[64:67], v[48:51], v[20:23]
    v_mfma_f32_16x16x32_bf16 v[24:27], a[144:147], v[48:51], v[24:27]
    ds_read_b128 v[44:47], v92 offset:19456
    s_waitcnt lgkmcnt(4)
    v_mfma_f32_16x16x32_bf16 v[12:15], a[68:71], v[52:55], v[12:15]
    v_mfma_f32_16x16x32_bf16 v[16:19], a[148:151], v[52:55], v[16:19]
    ds_read_b128 v[48:51], v92 offset:39936
    s_waitcnt lgkmcnt(4)
    v_mfma_f32_16x16x32_bf16 v[20:23], a[68:71], v[56:59], v[20:23]
    v_mfma_f32_16x16x32_bf16 v[24:27], a[148:151], v[56:59], v[24:27]
    s_waitcnt lgkmcnt(3)
    v_mfma_f32_16x16x32_bf16 v[12:15], a[72:75], v[36:39], v[12:15]
    v_mfma_f32_16x16x32_bf16 v[16:19], a[152:155], v[36:39], v[16:19]
    s_waitcnt lgkmcnt(2)
    v_mfma_f32_16x16x32_bf16 v[20:23], a[72:75], v[40:43], v[20:23]
    v_mfma_f32_16x16x32_bf16 v[24:27], a[152:155], v[40:43], v[24:27]
    s_waitcnt lgkmcnt(1)
    v_mfma_f32_16x16x32_bf16 v[12:15], a[76:79], v[44:47], v[12:15]
    v_mfma_f32_16x16x32_bf16 v[16:19], a[156:159], v[44:47], v[16:19]
    s_waitcnt lgkmcnt(0)
    v_mfma_f32_16x16x32_bf16 v[20:23], a[76:79], v[48:51], v[20:23]
    v_mfma_f32_16x16x32_bf16 v[24:27], a[156:159], v[48:51], v[24:27]
    s_nop 6
    s_branch Lsj_50215
Lsp_50214:
    ds_read_b128 v[36:39], v92 offset:0
    ds_read_b128 v[40:43], v92 offset:20480
    ds_read_b128 v[44:47], v92 offset:1024
    ds_read_b128 v[48:51], v92 offset:21504
    ds_read_b128 v[52:55], v92 offset:2048
    s_waitcnt lgkmcnt(4)
    v_mfma_f32_16x16x32_bf16 v[12:15], a[0:3], v[36:39], 0
    v_mfma_f32_16x16x32_bf16 v[16:19], a[80:83], v[36:39], 0
    v_add_f32 v64, v64, v66
    v_add_f32 v65, v65, v67
    v_add_f32 v64, v64, v68
    ds_read_b128 v[56:59], v92 offset:22528
    s_waitcnt lgkmcnt(4)
    v_mfma_f32_16x16x32_bf16 v[20:23], a[0:3], v[40:43], 0
    v_mfma_f32_16x16x32_bf16 v[24:27], a[80:83], v[40:43], 0
    v_add_f32 v65, v65, v69
    v_add_f32 v64, v64, v70
    v_add_f32 v65, v65, v71
    ds_read_b128 v[36:39], v92 offset:3072
    s_waitcnt lgkmcnt(4)
    v_mfma_f32_16x16x32_bf16 v[12:15], a[4:7], v[44:47], v[12:15]
    v_mfma_f32_16x16x32_bf16 v[16:19], a[84:87], v[44:47], v[16:19]
    v_add_f32 v64, v64, v72
    v_add_f32 v65, v65, v73
    v_mov_b32 v125, v64
    ds_read_b128 v[40:43], v92 offset:23552
    s_waitcnt lgkmcnt(4)
    v_mfma_f32_16x16x32_bf16 v[20:23], a[4:7], v[48:51], v[20:23]
    v_mfma_f32_16x16x32_bf16 v[24:27], a[84:87], v[48:51], v[24:27]
    v_permlane16_swap_b32 v64, v125
    v_add_f32 v64, v64, v125
    v_mov_b32 v125, v64
    ds_read_b128 v[44:47], v92 offset:4096
    s_waitcnt lgkmcnt(4)
    v_mfma_f32_16x16x32_bf16 v[12:15], a[8:11], v[52:55], v[12:15]
    v_mfma_f32_16x16x32_bf16 v[16:19], a[88:91], v[52:55], v[16:19]
    v_permlane32_swap_b32 v64, v125
    v_add_f32 v64, v64, v125
    v_mov_b32 v125, v65
    ds_read_b128 v[48:51], v92 offset:24576
    s_waitcnt lgkmcnt(4)
    v_mfma_f32_16x16x32_bf16 v[20:23], a[8:11], v[56:59], v[20:23]
    v_mfma_f32_16x16x32_bf16 v[24:27], a[88:91], v[56:59], v[24:27]
    v_permlane16_swap_b32 v65, v125
    v_add_f32 v65, v65, v125
    v_mov_b32 v125, v65
    ds_read_b128 v[52:55], v92 offset:5120
    s_waitcnt lgkmcnt(4)
    v_mfma_f32_16x16x32_bf16 v[12:15], a[12:15], v[36:39], v[12:15]
    v_mfma_f32_16x16x32_bf16 v[16:19], a[92:95], v[36:39], v[16:19]
    v_permlane32_swap_b32 v65, v125
    v_add_f32 v65, v65, v125
    v_mul_f32 v64, 0x3acccccd, v64
    ds_read_b128 v[56:59], v92 offset:25600
    s_waitcnt lgkmcnt(4)
    v_mfma_f32_16x16x32_bf16 v[20:23], a[12:15], v[40:43], v[20:23]
    v_mfma_f32_16x16x32_bf16 v[24:27], a[92:95], v[40:43], v[24:27]
    v_mul_f32 v65, 0x3acccccd, v65
    v_fma_f32 v65, -v64, v64, v65
    v_max_f32 v65, 0, v65
    ds_read_b128 v[36:39], v92 offset:6144
    s_waitcnt lgkmcnt(4)
    v_mfma_f32_16x16x32_bf16 v[12:15], a[16:19], v[44:47], v[12:15]
    v_mfma_f32_16x16x32_bf16 v[16:19], a[96:99], v[44:47], v[16:19]
    v_mov_b32 v66, v64
    v_cvt_pk_bf16_f32 v66, v66, v66
    v_lshlrev_b32 v66, 16, v66
    ds_read_b128 v[40:43], v92 offset:26624
    s_waitcnt lgkmcnt(4)
    v_mfma_f32_16x16x32_bf16 v[20:23], a[16:19], v[48:51], v[20:23]
    v_mfma_f32_16x16x32_bf16 v[24:27], a[96:99], v[48:51], v[24:27]
    v_mov_b32 v67, v65
    v_cvt_pk_bf16_f32 v67, v67, v67
    v_lshlrev_b32 v67, 16, v67
    ds_read_b128 v[44:47], v92 offset:7168
    s_waitcnt lgkmcnt(4)
    v_mfma_f32_16x16x32_bf16 v[12:15], a[20:23], v[52:55], v[12:15]
    v_mfma_f32_16x16x32_bf16 v[16:19], a[100:103], v[52:55], v[16:19]
    v_add_f32 v67, 0x3727c5ac, v67
    v_cvt_pk_bf16_f32 v67, v67, v67
    v_lshlrev_b32 v67, 16, v67
    ds_read_b128 v[48:51], v92 offset:27648
    s_waitcnt lgkmcnt(4)
    v_mfma_f32_16x16x32_bf16 v[20:23], a[20:23], v[56:59], v[20:23]
    v_mfma_f32_16x16x32_bf16 v[24:27], a[100:103], v[56:59], v[24:27]
    v_sqrt_f32 v67, v67
    s_nop 0
    v_cvt_pk_bf16_f32 v67, v67, v67
    v_lshlrev_b32 v67, 16, v67
    ds_read_b128 v[52:55], v92 offset:8192
    s_waitcnt lgkmcnt(4)
    v_mfma_f32_16x16x32_bf16 v[12:15], a[24:27], v[36:39], v[12:15]
    v_mfma_f32_16x16x32_bf16 v[16:19], a[104:107], v[36:39], v[16:19]
    v_rcp_f32 v62, v67
    v_mov_b32 v60, v66
    v_add_f32 v74, v74, v76
    s_cmp_ge_u32 s55, 64
    s_nop 2
    s_cbranch_scc1 Lsd_50218
    s_waitcnt vmcnt(0)
    s_lshl_b32 s46, s55, 6
    s_add_u32 s46, s46, 0xb205440
    v_mov_b32 v4, s46
    v_mov_b32 v5, 1
    s_mov_b64 exec, 1
    buffer_atomic_add v5, v4, s[4:7], 0 offen
    s_mov_b64 exec, -1
Lcs_50219:
    s_mov_b32 s55, 64
Lsd_50218:
    ds_read_b128 v[56:59], v92 offset:28672
    s_waitcnt lgkmcnt(4)
    v_mfma_f32_16x16x32_bf16 v[20:23], a[24:27], v[40:43], v[20:23]
    v_mfma_f32_16x16x32_bf16 v[24:27], a[104:107], v[40:43], v[24:27]
    v_add_f32 v75, v75, v77
    v_add_f32 v74, v74, v78
    v_add_f32 v75, v75, v79
    ds_read_b128 v[36:39], v92 offset:9216
    s_waitcnt lgkmcnt(4)
    v_mfma_f32_16x16x32_bf16 v[12:15], a[28:31], v[44:47], v[12:15]
    v_mfma_f32_16x16x32_bf16 v[16:19], a[108:111], v[44:47], v[16:19]
    v_add_f32 v74, v74, v80
    v_add_f32 v75, v75, v81
    v_add_f32 v74, v74, v82
    ds_read_b128 v[40:43], v92 offset:29696
    s_waitcnt lgkmcnt(4)
    v_mfma_f32_16x16x32_bf16 v[20:23], a[28:31], v[48:51], v[20:23]
    v_mfma_f32_16x16x32_bf16 v[24:27], a[108:111], v[48:51], v[24:27]
    v_add_f32 v75, v75, v83
    v_mov_b32 v125, v74
    s_nop 1
    v_permlane16_swap_b32 v74, v125
    ds_read_b128 v[44:47], v92 offset:10240
    s_waitcnt lgkmcnt(4)
    v_mfma_f32_16x16x32_bf16 v[12:15], a[32:35], v[52:55], v[12:15]
    v_mfma_f32_16x16x32_bf16 v[16:19], a[112:115], v[52:55], v[16:19]
    v_add_f32 v74, v74, v125
    v_mov_b32 v125, v74
    s_nop 1
    v_permlane32_swap_b32 v74, v125
    ds_read_b128 v[48:51], v92 offset:30720
    s_waitcnt lgkmcnt(4)
    v_mfma_f32_16x16x32_bf16 v[20:23], a[32:35], v[56:59], v[20:23]
    v_mfma_f32_16x16x32_bf16 v[24:27], a[112:115], v[56:59], v[24:27]
    v_add_f32 v74, v74, v125
    v_mov_b32 v125, v75
    s_nop 1
    v_permlane16_swap_b32 v75, v125
    ds_read_b128 v[52:55], v92 offset:11264
    s_waitcnt lgkmcnt(4)
    v_mfma_f32_16x16x32_bf16 v[12:15], a[36:39], v[36:39], v[12:15]
    v_mfma_f32_16x16x32_bf16 v[16:19], a[116:119], v[36:39], v[16:19]
    v_add_f32 v75, v75, v125
    v_mov_b32 v125, v75
    s_nop 1
    v_permlane32_swap_b32 v75, v125
    ds_read_b128 v[56:59], v92 offset:31744
    s_waitcnt lgkmcnt(4)
    v_mfma_f32_16x16x32_bf16 v[20:23], a[36:39], v[40:43], v[20:23]
    v_mfma_f32_16x16x32_bf16 v[24:27], a[116:119], v[40:43], v[24:27]
    v_add_f32 v75, v75, v125
    v_mul_f32 v74, 0x3acccccd, v74
    v_mul_f32 v75, 0x3acccccd, v75
    ds_read_b128 v[36:39], v92 offset:12288
    s_waitcnt lgkmcnt(4)
    v_mfma_f32_16x16x32_bf16 v[12:15], a[40:43], v[44:47], v[12:15]
    v_mfma_f32_16x16x32_bf16 v[16:19], a[120:123], v[44:47], v[16:19]
    v_fma_f32 v75, -v74, v74, v75
    v_max_f32 v75, 0, v75
    v_mov_b32 v76, v74
    ds_read_b128 v[40:43], v92 offset:32768
    s_waitcnt lgkmcnt(4)
    v_mfma_f32_16x16x32_bf16 v[20:23], a[40:43], v[48:51], v[20:23]
    v_mfma_f32_16x16x32_bf16 v[24:27], a[120:123], v[48:51], v[24:27]
    v_cvt_pk_bf16_f32 v76, v76, v76
    v_lshlrev_b32 v76, 16, v76
    v_mov_b32 v77, v75
    ds_read_b128 v[44:47], v92 offset:13312
    s_waitcnt lgkmcnt(4)
    v_mfma_f32_16x16x32_bf16 v[12:15], a[44:47], v[52:55], v[12:15]
    v_mfma_f32_16x16x32_bf16 v[16:19], a[124:127], v[52:55], v[16:19]
    v_cvt_pk_bf16_f32 v77, v77, v77
    v_lshlrev_b32 v77, 16, v77
    v_add_f32 v77, 0x3727c5ac, v77
    ds_read_b128 v[48:51], v92 offset:33792
    s_waitcnt lgkmcnt(4)
    v_mfma_f32_16x16x32_bf16 v[20:23], a[44:47], v[56:59], v[20:23]
    v_mfma_f32_16x16x32_bf16 v[24:27], a[124:127], v[56:59], v[24:27]
    v_cvt_pk_bf16_f32 v77, v77, v77
    v_lshlrev_b32 v77, 16, v77
    v_sqrt_f32 v77, v77
    ds_read_b128 v[52:55], v92 offset:14336
    s_waitcnt lgkmcnt(4)
    v_mfma_f32_16x16x32_bf16 v[12:15], a[48:51], v[36:39], v[12:15]
    v_mfma_f32_16x16x32_bf16 v[16:19], a[128:131], v[36:39], v[16:19]
    v_cvt_pk_bf16_f32 v77, v77, v77
    v_lshlrev_b32 v77, 16, v77
    v_rcp_f32 v63, v77
    ds_read_b128 v[56:59], v92 offset:34816
    s_waitcnt lgkmcnt(4)
    v_mfma_f32_16x16x32_bf16 v[20:23], a[48:51], v[40:43], v[20:23]
    v_mfma_f32_16x16x32_bf16 v[24:27], a[128:131], v[40:43], v[24:27]
    v_mov_b32 v61, v76
    ds_read_b128 v[36:39], v92 offset:15360
    s_waitcnt lgkmcnt(4)
    v_mfma_f32_16x16x32_bf16 v[12:15], a[52:55], v[44:47], v[12:15]
    v_mfma_f32_16x16x32_bf16 v[16:19], a[132:135], v[44:47], v[16:19]
    ds_read_b128 v[40:43], v92 offset:35840
    s_waitcnt lgkmcnt(4)
    v_mfma_f32_16x16x32_bf16 v[20:23], a[52:55], v[48:51], v[20:23]
    v_mfma_f32_16x16x32_bf16 v[24:27], a[132:135], v[48:51], v[24:27]
    ds_read_b128 v[44:47], v92 offset:16384
    s_waitcnt lgkmcnt(4)
    v_mfma_f32_16x16x32_bf16 v[12:15], a[56:59], v[52:55], v[12:15]
    v_mfma_f32_16x16x32_bf16 v[16:19], a[136:139], v[52:55], v[16:19]
    ds_read_b128 v[48:51], v92 offset:36864
    s_waitcnt lgkmcnt(4)
    v_mfma_f32_16x16x32_bf16 v[20:23], a[56:59], v[56:59], v[20:23]
    v_mfma_f32_16x16x32_bf16 v[24:27], a[136:139], v[56:59], v[24:27]
    ds_read_b128 v[52:55], v92 offset:17408
    s_waitcnt lgkmcnt(4)
    v_mfma_f32_16x16x32_bf16 v[12:15], a[60:63], v[36:39], v[12:15]
    v_mfma_f32_16x16x32_bf16 v[16:19], a[140:143], v[36:39], v[16:19]
    ds_read_b128 v[56:59], v92 offset:37888
    s_waitcnt lgkmcnt(4)
    v_mfma_f32_16x16x32_bf16 v[20:23], a[60:63], v[40:43], v[20:23]
    v_mfma_f32_16x16x32_bf16 v[24:27], a[140:143], v[40:43], v[24:27]
    ds_read_b128 v[36:39], v92 offset:18432
    s_waitcnt lgkmcnt(4)
    v_mfma_f32_16x16x32_bf16 v[12:15], a[64:67], v[44:47], v[12:15]
    v_mfma_f32_16x16x32_bf16 v[16:19], a[144:147], v[44:47], v[16:19]
    ds_read_b128 v[40:43], v92 offset:38912
    s_waitcnt lgkmcnt(4)
    v_mfma_f32_16x16x32_bf16 v[20:23], a[64:67], v[48:51], v[20:23]
    v_mfma_f32_16x16x32_bf16 v[24:27], a[144:147], v[48:51], v[24:27]
    ds_read_b128 v[44:47], v92 offset:19456
    s_waitcnt lgkmcnt(4)
    v_mfma_f32_16x16x32_bf16 v[12:15], a[68:71], v[52:55], v[12:15]
    v_mfma_f32_16x16x32_bf16 v[16:19], a[148:151], v[52:55], v[16:19]
    ds_read_b128 v[48:51], v92 offset:39936
    s_waitcnt lgkmcnt(4)
    v_mfma_f32_16x16x32_bf16 v[20:23], a[68:71], v[56:59], v[20:23]
    v_mfma_f32_16x16x32_bf16 v[24:27], a[148:151], v[56:59], v[24:27]
    s_waitcnt lgkmcnt(3)
    v_mfma_f32_16x16x32_bf16 v[12:15], a[72:75], v[36:39], v[12:15]
    v_mfma_f32_16x16x32_bf16 v[16:19], a[152:155], v[36:39], v[16:19]
    s_waitcnt lgkmcnt(2)
    v_mfma_f32_16x16x32_bf16 v[20:23], a[72:75], v[40:43], v[20:23]
    v_mfma_f32_16x16x32_bf16 v[24:27], a[152:155], v[40:43], v[24:27]
    s_waitcnt lgkmcnt(1)
    v_mfma_f32_16x16x32_bf16 v[12:15], a[76:79], v[44:47], v[12:15]
    v_mfma_f32_16x16x32_bf16 v[16:19], a[156:159], v[44:47], v[16:19]
    s_waitcnt lgkmcnt(0)
    v_mfma_f32_16x16x32_bf16 v[20:23], a[76:79], v[48:51], v[20:23]
    v_mfma_f32_16x16x32_bf16 v[24:27], a[156:159], v[48:51], v[24:27]
    s_nop 7
Lsj_50215:
    v_cvt_pk_bf16_f32 v44, v12, v13
    v_lshlrev_b32 v12, 16, v44
    v_and_b32 v13, 0xffff0000, v44
    v_lshlrev_b32 v44, 16, v84
    v_and_b32 v45, 0xffff0000, v84
    v_sub_f32 v44, v44, v60
    v_sub_f32 v45, v45, v60
    v_cvt_pk_bf16_f32 v46, v44, v45
    v_lshlrev_b32 v44, 16, v46
    v_and_b32 v45, 0xffff0000, v46
    v_mul_f32 v44, v44, v62
    v_mul_f32 v45, v45, v62
    v_cvt_pk_bf16_f32 v46, v44, v45
    v_lshlrev_b32 v44, 16, v46
    v_and_b32 v45, 0xffff0000, v46
    v_add_f32 v44, v44, v12
    v_add_f32 v45, v45, v13
    v_cvt_pk_bf16_f32 v36, v44, v45
    v_lshlrev_b32 v12, 16, v36
    v_and_b32 v13, 0xffff0000, v36
    v_cvt_pk_bf16_f32 v44, v14, v15
    v_lshlrev_b32 v14, 16, v44
    v_and_b32 v15, 0xffff0000, v44
    v_lshlrev_b32 v44, 16, v85
    v_and_b32 v45, 0xffff0000, v85
    v_sub_f32 v44, v44, v60
    v_sub_f32 v45, v45, v60
    v_cvt_pk_bf16_f32 v46, v44, v45
    v_lshlrev_b32 v44, 16, v46
    v_and_b32 v45, 0xffff0000, v46
    v_mul_f32 v44, v44, v62
    v_mul_f32 v45, v45, v62
    v_cvt_pk_bf16_f32 v46, v44, v45
    v_lshlrev_b32 v44, 16, v46
    v_and_b32 v45, 0xffff0000, v46
    v_add_f32 v44, v44, v14
    v_add_f32 v45, v45, v15
    v_cvt_pk_bf16_f32 v37, v44, v45
    v_lshlrev_b32 v14, 16, v37
    v_and_b32 v15, 0xffff0000, v37
    v_cvt_pk_bf16_f32 v44, v16, v17
    v_lshlrev_b32 v16, 16, v44
    v_and_b32 v17, 0xffff0000, v44
    v_lshlrev_b32 v44, 16, v86
    v_and_b32 v45, 0xffff0000, v86
    v_sub_f32 v44, v44, v60
    v_sub_f32 v45, v45, v60
    v_cvt_pk_bf16_f32 v46, v44, v45
    v_lshlrev_b32 v44, 16, v46
    v_and_b32 v45, 0xffff0000, v46
    v_mul_f32 v44, v44, v62
    v_mul_f32 v45, v45, v62
    v_cvt_pk_bf16_f32 v46, v44, v45
    v_lshlrev_b32 v44, 16, v46
    v_and_b32 v45, 0xffff0000, v46
    v_add_f32 v44, v44, v16
    v_add_f32 v45, v45, v17
    v_cvt_pk_bf16_f32 v38, v44, v45
    v_lshlrev_b32 v16, 16, v38
    v_and_b32 v17, 0xffff0000, v38
    v_cvt_pk_bf16_f32 v44, v18, v19
    v_lshlrev_b32 v18, 16, v44
    v_and_b32 v19, 0xffff0000, v44
    v_lshlrev_b32 v44, 16, v87
    v_and_b32 v45, 0xffff0000, v87
    v_sub_f32 v44, v44, v60
    v_sub_f32 v45, v45, v60
    v_cvt_pk_bf16_f32 v46, v44, v45
    v_lshlrev_b32 v44, 16, v46
    v_and_b32 v45, 0xffff0000, v46
    v_mul_f32 v44, v44, v62
    v_mul_f32 v45, v45, v62
    v_cvt_pk_bf16_f32 v46, v44, v45
    v_lshlrev_b32 v44, 16, v46
    v_and_b32 v45, 0xffff0000, v46
    v_add_f32 v44, v44, v18
    v_add_f32 v45, v45, v19
    v_cvt_pk_bf16_f32 v39, v44, v45
    v_lshlrev_b32 v18, 16, v39
    v_and_b32 v19, 0xffff0000, v39
    s_lshl_b32 s34, s17, 1
    s_add_u32 s34, s34, 0
    s_mul_i32 s35, s34, 20
    s_add_u32 s35, s35, s29
    s_lshl_b32 s35, s35, 10
    s_add_u32 s35, s35, 0xa800000
    buffer_store_dwordx4 v[36:39], v1, s[4:7], s35 offen sc1
    s_mul_i32 s35, s34, 2560
    s_lshl_b32 s36, s29, 7
    s_add_u32 s35, s35, s36
    s_add_u32 s35, s35, 0xb180000
    v_add_f32 v50, v12, v13
    v_mul_f32 v51, v12, v12
    v_fmac_f32 v51, v13, v13
    v_add_f32 v50, v50, v14
    v_fmac_f32 v51, v14, v14
    v_add_f32 v50, v50, v15
    v_fmac_f32 v51, v15, v15
    v_add_f32 v50, v50, v16
    v_fmac_f32 v51, v16, v16
    v_add_f32 v50, v50, v17
    v_fmac_f32 v51, v17, v17
    v_add_f32 v50, v50, v18
    v_fmac_f32 v51, v18, v18
    v_add_f32 v50, v50, v19
    v_fmac_f32 v51, v19, v19
    v_mov_b32 v44, v50
    s_nop 1
    v_permlane16_swap_b32 v50, v44
    v_add_f32 v50, v50, v44
    v_mov_b32 v44, v50
    s_nop 1
    v_permlane32_swap_b32 v50, v44
    v_add_f32 v50, v50, v44
    v_mov_b32 v44, v51
    s_nop 1
    v_permlane16_swap_b32 v51, v44
    v_add_f32 v51, v51, v44
    v_mov_b32 v44, v51
    s_nop 1
    v_permlane32_swap_b32 v51, v44
    v_add_f32 v51, v51, v44
    s_mov_b64 exec, 0xffff
    buffer_store_dwordx2 v[50:51], v6, s[4:7], s35 offen sc1
    s_mov_b64 exec, -1
    v_cvt_pk_bf16_f32 v44, v20, v21
    v_lshlrev_b32 v20, 16, v44
    v_and_b32 v21, 0xffff0000, v44
    v_lshlrev_b32 v44, 16, v88
    v_and_b32 v45, 0xffff0000, v88
    v_sub_f32 v44, v44, v61
    v_sub_f32 v45, v45, v61
    v_cvt_pk_bf16_f32 v46, v44, v45
    v_lshlrev_b32 v44, 16, v46
    v_and_b32 v45, 0xffff0000, v46
    v_mul_f32 v44, v44, v63
    v_mul_f32 v45, v45, v63
    v_cvt_pk_bf16_f32 v46, v44, v45
    v_lshlrev_b32 v44, 16, v46
    v_and_b32 v45, 0xffff0000, v46
    v_add_f32 v44, v44, v20
    v_add_f32 v45, v45, v21
    v_cvt_pk_bf16_f32 v40, v44, v45
    v_lshlrev_b32 v20, 16, v40
    v_and_b32 v21, 0xffff0000, v40
    v_cvt_pk_bf16_f32 v44, v22, v23
    v_lshlrev_b32 v22, 16, v44
    v_and_b32 v23, 0xffff0000, v44
    v_lshlrev_b32 v44, 16, v89
    v_and_b32 v45, 0xffff0000, v89
    v_sub_f32 v44, v44, v61
    v_sub_f32 v45, v45, v61
    v_cvt_pk_bf16_f32 v46, v44, v45
    v_lshlrev_b32 v44, 16, v46
    v_and_b32 v45, 0xffff0000, v46
    v_mul_f32 v44, v44, v63
    v_mul_f32 v45, v45, v63
    v_cvt_pk_bf16_f32 v46, v44, v45
    v_lshlrev_b32 v44, 16, v46
    v_and_b32 v45, 0xffff0000, v46
    v_add_f32 v44, v44, v22
    v_add_f32 v45, v45, v23
    v_cvt_pk_bf16_f32 v41, v44, v45
    v_lshlrev_b32 v22, 16, v41
    v_and_b32 v23, 0xffff0000, v41
    v_cvt_pk_bf16_f32 v44, v24, v25
    v_lshlrev_b32 v24, 16, v44
    v_and_b32 v25, 0xffff0000, v44
    v_lshlrev_b32 v44, 16, v90
    v_and_b32 v45, 0xffff0000, v90
    v_sub_f32 v44, v44, v61
    v_sub_f32 v45, v45, v61
    v_cvt_pk_bf16_f32 v46, v44, v45
    v_lshlrev_b32 v44, 16, v46
    v_and_b32 v45, 0xffff0000, v46
    v_mul_f32 v44, v44, v63
    v_mul_f32 v45, v45, v63
    v_cvt_pk_bf16_f32 v46, v44, v45
    v_lshlrev_b32 v44, 16, v46
    v_and_b32 v45, 0xffff0000, v46
    v_add_f32 v44, v44, v24
    v_add_f32 v45, v45, v25
    v_cvt_pk_bf16_f32 v42, v44, v45
    v_lshlrev_b32 v24, 16, v42
    v_and_b32 v25, 0xffff0000, v42
    v_cvt_pk_bf16_f32 v44, v26, v27
    v_lshlrev_b32 v26, 16, v44
    v_and_b32 v27, 0xffff0000, v44
    v_lshlrev_b32 v44, 16, v91
    v_and_b32 v45, 0xffff0000, v91
    v_sub_f32 v44, v44, v61
    v_sub_f32 v45, v45, v61
    v_cvt_pk_bf16_f32 v46, v44, v45
    v_lshlrev_b32 v44, 16, v46
    v_and_b32 v45, 0xffff0000, v46
    v_mul_f32 v44, v44, v63
    v_mul_f32 v45, v45, v63
    v_cvt_pk_bf16_f32 v46, v44, v45
    v_lshlrev_b32 v44, 16, v46
    v_and_b32 v45, 0xffff0000, v46
    v_add_f32 v44, v44, v26
    v_add_f32 v45, v45, v27
    v_cvt_pk_bf16_f32 v43, v44, v45
    v_lshlrev_b32 v26, 16, v43
    v_and_b32 v27, 0xffff0000, v43
    s_lshl_b32 s34, s17, 1
    s_add_u32 s34, s34, 1
    s_mul_i32 s35, s34, 20
    s_add_u32 s35, s35, s29
    s_lshl_b32 s35, s35, 10
    s_add_u32 s35, s35, 0xa800000
    buffer_store_dwordx4 v[40:43], v1, s[4:7], s35 offen sc1
    s_mul_i32 s35, s34, 2560
    s_lshl_b32 s36, s29, 7
    s_add_u32 s35, s35, s36
    s_add_u32 s35, s35, 0xb180000
    v_add_f32 v52, v20, v21
    v_mul_f32 v53, v20, v20
    v_fmac_f32 v53, v21, v21
    v_add_f32 v52, v52, v22
    v_fmac_f32 v53, v22, v22
    v_add_f32 v52, v52, v23
    v_fmac_f32 v53, v23, v23
    v_add_f32 v52, v52, v24
    v_fmac_f32 v53, v24, v24
    v_add_f32 v52, v52, v25
    v_fmac_f32 v53, v25, v25
    v_add_f32 v52, v52, v26
    v_fmac_f32 v53, v26, v26
    v_add_f32 v52, v52, v27
    v_fmac_f32 v53, v27, v27
    v_mov_b32 v44, v52
    s_nop 1
    v_permlane16_swap_b32 v52, v44
    v_add_f32 v52, v52, v44
    v_mov_b32 v44, v52
    s_nop 1
    v_permlane32_swap_b32 v52, v44
    v_add_f32 v52, v52, v44
    v_mov_b32 v44, v53
    s_nop 1
    v_permlane16_swap_b32 v53, v44
    v_add_f32 v53, v53, v44
    v_mov_b32 v44, v53
    s_nop 1
    v_permlane32_swap_b32 v53, v44
    v_add_f32 v53, v53, v44
    s_mov_b64 exec, 0xffff
    buffer_store_dwordx2 v[52:53], v6, s[4:7], s35 offen sc1
    s_mov_b64 exec, -1
    s_mov_b32 s55, s17
    s_mov_b32 s17, s27
    s_cmp_eq_u32 s28, 0
    s_cbranch_scc1 Lsq_50220
    s_waitcnt vmcnt(0)
    s_lshl_b32 s46, s55, 6
    s_add_u32 s46, s46, 0xb205440
    v_mov_b32 v4, s46
    v_mov_b32 v5, 1
    s_mov_b64 exec, 1
    buffer_atomic_add v5, v4, s[4:7], 0 offen
    s_mov_b64 exec, -1
Lcs_50221:
    s_mov_b32 s55, 64
    s_cmp_ge_u32 s17, s50
    s_cbranch_scc1 Ls_end_50210
    v_add_u32 v8, s17, v0
    v_add_u32 v8, -1, v8
    v_cmp_gt_u32 vcc, 64, v8
    s_and_b64 s[48:49], vcc, 7
    v_lshlrev_b32 v8, 6, v8
    v_add_u32 v8, 0xb204240, v8
    s_mov_b64 exec, s[48:49]
    s_nop 0
Lwp_50222:
    buffer_load_dword v9, v8, s[4:7], 0 offen sc1
    s_waitcnt vmcnt(0)
    v_cmp_gt_u32 vcc, 20, v9
    s_nop 0
    s_cbranch_vccz Lwpd_50223
    s_sleep 5
    s_add_u32 s30, s30, 1
    s_cmp_lt_u32 s30, s31
    s_cbranch_scc1 Lwp_50222
Lwpd_50223:
    s_mov_b64 exec, -1
    s_lshl_b32 s20, s17, 5
    s_add_u32 s20, s20, s52
    s_mul_i32 s22, s14, 5120
    v_add_u32 v10, s20, v2
    v_ashrrev_i32 v11, 4, v10
    v_mul_i32_i24 v11, 20480, v11
    v_and_b32 v10, 15, v10
    v_lshl_add_u32 v10, v3, 4, v10
    v_lshl_add_u32 v11, v10, 4, v11
    s_add_u32 m0, s22, 40960
    s_nop 0
    buffer_load_dwordx4 v11, s[8:11], s22 offen offset:0 sc1 lds
    buffer_load_dwordx4 v11, s[8:11], s22 offen offset:1024 sc1 lds
    buffer_load_dwordx4 v11, s[8:11], s22 offen offset:2048 sc1 lds
    buffer_load_dwordx4 v11, s[8:11], s22 offen offset:3072 sc1 lds
    s_add_u32 m0, s22, 45056
    s_add_u32 s21, s22, 4096
    buffer_load_dwordx4 v11, s[8:11], s21 offen sc1 lds
    v_add_u32 v10, s20, v2
    v_add_u32 v10, 16, v10
    v_ashrrev_i32 v11, 4, v10
    v_mul_i32_i24 v11, 20480, v11
    v_and_b32 v10, 15, v10
    v_lshl_add_u32 v10, v3, 4, v10
    v_lshl_add_u32 v11, v10, 4, v11
    s_add_u32 m0, s22, 61440
    s_nop 0
    buffer_load_dwordx4 v11, s[8:11], s22 offen offset:0 sc1 lds
    buffer_load_dwordx4 v11, s[8:11], s22 offen offset:1024 sc1 lds
    buffer_load_dwordx4 v11, s[8:11], s22 offen offset:2048 sc1 lds
    buffer_load_dwordx4 v11, s[8:11], s22 offen offset:3072 sc1 lds
    s_add_u32 m0, s22, 65536
    s_add_u32 s21, s22, 4096
    buffer_load_dwordx4 v11, s[8:11], s21 offen sc1 lds
    v_mul_u32_u24 v124, 640, v3
    v_lshl_add_u32 v124, v2, 3, v124
    s_mul_i32 s25, s17, 5120
    s_add_u32 s25, s25, 0xb100000
    buffer_load_dwordx2 v[96:97], v124, s[4:7], s25 offen offset:0 sc1
    buffer_load_dwordx2 v[98:99], v124, s[4:7], s25 offen offset:128 sc1
    buffer_load_dwordx2 v[100:101], v124, s[4:7], s25 offen offset:256 sc1
    buffer_load_dwordx2 v[102:103], v124, s[4:7], s25 offen offset:384 sc1
    buffer_load_dwordx2 v[104:105], v124, s[4:7], s25 offen offset:512 sc1
    buffer_load_dwordx2 v[106:107], v124, s[4:7], s25 offen offset:2560 sc1
    buffer_load_dwordx2 v[108:109], v124, s[4:7], s25 offen offset:2688 sc1
    buffer_load_dwordx2 v[110:111], v124, s[4:7], s25 offen offset:2816 sc1
    buffer_load_dwordx2 v[112:113], v124, s[4:7], s25 offen offset:2944 sc1
    buffer_load_dwordx2 v[114:115], v124, s[4:7], s25 offen offset:3072 sc1
    s_mul_i32 s25, s17, 40
    s_add_u32 s25, s25, s29
    s_lshl_b32 s25, s25, 10
    s_add_u32 s25, s25, 0xa200000
    buffer_load_dwordx4 v[116:119], v1, s[4:7], s25 offen sc1
    s_add_u32 s25, s25, 20480
    buffer_load_dwordx4 v[120:123], v1, s[4:7], s25 offen sc1
    s_add_u32 s33, s17, s19
    v_add_u32 v8, s33, v0
    v_add_u32 v8, -1, v8
    v_cmp_gt_u32 vcc, 64, v8
    s_and_b64 s[48:49], vcc, 7
    v_lshlrev_b32 v8, 6, v8
    v_add_u32 v8, 0xb204240, v8
    buffer_load_dword v9, v8, s[4:7], 0 offen sc1
    s_waitcnt vmcnt(0)
Lsq_50220:
    s_waitcnt vmcnt(4)
    s_barrier
    s_add_u32 s27, s17, s19
    s_mov_b32 s28, 1
    v_add_u32 v92, 40960, v1
    v_add_u32 v93, 65536, v1
    s_cmp_ge_u32 s27, s50
    s_cbranch_scc1 Lsp_50224
    v_cmp_gt_u32 vcc, 20, v9
    s_and_b64 vcc, vcc, s[48:49]
    s_cbranch_scc1 Lsp_50224
    s_mov_b32 s28, 0
    ds_read_b128 v[36:39], v92 offset:0
    ds_read_b128 v[40:43], v92 offset:20480
    ds_read_b128 v[44:47], v92 offset:1024
    ds_read_b128 v[48:51], v92 offset:21504
    ds_read_b128 v[52:55], v92 offset:2048
    s_waitcnt lgkmcnt(4)
    v_mfma_f32_16x16x32_bf16 v[12:15], a[0:3], v[36:39], 0
    s_lshl_b32 s20, s27, 5
    s_add_u32 s20, s20, s52
    s_mul_i32 s22, s14, 5120
    v_add_u32 v10, s20, v2
    v_ashrrev_i32 v11, 4, v10
    v_mul_i32_i24 v11, 20480, v11
    v_and_b32 v10, 15, v10
    v_lshl_add_u32 v10, v3, 4, v10
    v_lshl_add_u32 v11, v10, 4, v11
    s_add_u32 m0, s22, 0
    s_nop 0
    buffer_load_dwordx4 v11, s[8:11], s22 offen offset:0 sc1 lds
    v_mfma_f32_16x16x32_bf16 v[16:19], a[80:83], v[36:39], 0
    v_add_f32 v96, v96, v98
    v_add_f32 v97, v97, v99
    v_add_f32 v96, v96, v100
    ds_read_b128 v[56:59], v92 offset:22528
    s_waitcnt lgkmcnt(4)
    v_mfma_f32_16x16x32_bf16 v[20:23], a[0:3], v[40:43], 0
    buffer_load_dwordx4 v11, s[8:11], s22 offen offset:1024 sc1 lds
    v_mfma_f32_16x16x32_bf16 v[24:27], a[80:83], v[40:43], 0
    v_add_f32 v97, v97, v101
    v_add_f32 v96, v96, v102
    v_add_f32 v97, v97, v103
    ds_read_b128 v[36:39], v92 offset:3072
    s_waitcnt lgkmcnt(4)
    v_mfma_f32_16x16x32_bf16 v[12:15], a[4:7], v[44:47], v[12:15]
    buffer_load_dwordx4 v11, s[8:11], s22 offen offset:2048 sc1 lds
    v_mfma_f32_16x16x32_bf16 v[16:19], a[84:87], v[44:47], v[16:19]
    v_add_f32 v96, v96, v104
    v_add_f32 v97, v97, v105
    v_mov_b32 v125, v96
    ds_read_b128 v[40:43], v92 offset:23552
    s_waitcnt lgkmcnt(4)
    v_mfma_f32_16x16x32_bf16 v[20:23], a[4:7], v[48:51], v[20:23]
    buffer_load_dwordx4 v11, s[8:11], s22 offen offset:3072 sc1 lds
    v_mfma_f32_16x16x32_bf16 v[24:27], a[84:87], v[48:51], v[24:27]
    v_permlane16_swap_b32 v96, v125
    v_add_f32 v96, v96, v125
    v_mov_b32 v125, v96
    ds_read_b128 v[44:47], v92 offset:4096
    s_waitcnt lgkmcnt(4)
    v_mfma_f32_16x16x32_bf16 v[12:15], a[8:11], v[52:55], v[12:15]
    s_add_u32 m0, s22, 4096
    s_add_u32 s21, s22, 4096
    buffer_load_dwordx4 v11, s[8:11], s21 offen sc1 lds
    v_mfma_f32_16x16x32_bf16 v[16:19], a[88:91], v[52:55], v[16:19]
    v_permlane32_swap_b32 v96, v125
    v_add_f32 v96, v96, v125
    v_mov_b32 v125, v97
    ds_read_b128 v[48:51], v92 offset:24576
    s_waitcnt lgkmcnt(4)
    v_mfma_f32_16x16x32_bf16 v[20:23], a[8:11], v[56:59], v[20:23]
    v_add_u32 v10, s20, v2
    v_add_u32 v10, 16, v10
    v_ashrrev_i32 v11, 4, v10
    v_mul_i32_i24 v11, 20480, v11
    v_and_b32 v10, 15, v10
    v_lshl_add_u32 v10, v3, 4, v10
    v_lshl_add_u32 v11, v10, 4, v11
    s_add_u32 m0, s22, 20480
    s_nop 0
    buffer_load_dwordx4 v11, s[8:11], s22 offen offset:0 sc1 lds
    v_mfma_f32_16x16x32_bf16 v[24:27], a[88:91], v[56:59], v[24:27]
    v_permlane16_swap_b32 v97, v125
    v_add_f32 v97, v97, v125
    v_mov_b32 v125, v97
    ds_read_b128 v[52:55], v92 offset:5120
    s_waitcnt lgkmcnt(4)
    v_mfma_f32_16x16x32_bf16 v[12:15], a[12:15], v[36:39], v[12:15]
    buffer_load_dwordx4 v11, s[8:11], s22 offen offset:1024 sc1 lds
    v_mfma_f32_16x16x32_bf16 v[16:19], a[92:95], v[36:39], v[16:19]
    v_permlane32_swap_b32 v97, v125
    v_add_f32 v97, v97, v125
    v_mul_f32 v96, 0x3acccccd, v96
    ds_read_b128 v[56:59], v92 offset:25600
    s_waitcnt lgkmcnt(4)
    v_mfma_f32_16x16x32_bf16 v[20:23], a[12:15], v[40:43], v[20:23]
    buffer_load_dwordx4 v11, s[8:11], s22 offen offset:2048 sc1 lds
    v_mfma_f32_16x16x32_bf16 v[24:27], a[92:95], v[40:43], v[24:27]
    v_mul_f32 v97, 0x3acccccd, v97
    v_fma_f32 v97, -v96, v96, v97
    v_max_f32 v97, 0, v97
    ds_read_b128 v[36:39], v92 offset:6144
    s_waitcnt lgkmcnt(4)
    v_mfma_f32_16x16x32_bf16 v[12:15], a[16:19], v[44:47], v[12:15]
    buffer_load_dwordx4 v11, s[8:11], s22 offen offset:3072 sc1 lds
    v_mfma_f32_16x16x32_bf16 v[16:19], a[96:99], v[44:47], v[16:19]
    v_mov_b32 v98, v96
    v_cvt_pk_bf16_f32 v98, v98, v98
    v_lshlrev_b32 v98, 16, v98
    ds_read_b128 v[40:43], v92 offset:26624
    s_waitcnt lgkmcnt(4)
    v_mfma_f32_16x16x32_bf16 v[20:23], a[16:19], v[48:51], v[20:23]
    s_add_u32 m0, s22, 24576
    s_add_u32 s21, s22, 4096
    buffer_load_dwordx4 v11, s[8:11], s21 offen sc1 lds
    v_mfma_f32_16x16x32_bf16 v[24:27], a[96:99], v[48:51], v[24:27]
    v_mov_b32 v99, v97
    v_cvt_pk_bf16_f32 v99, v99, v99
    v_lshlrev_b32 v99, 16, v99
    ds_read_b128 v[44:47], v92 offset:7168
    s_waitcnt lgkmcnt(4)
    v_mfma_f32_16x16x32_bf16 v[12:15], a[20:23], v[52:55], v[12:15]
    v_mul_u32_u24 v124, 640, v3
    v_lshl_add_u32 v124, v2, 3, v124
    s_mul_i32 s25, s27, 5120
    s_add_u32 s25, s25, 0xb100000
    buffer_load_dwordx2 v[64:65], v124, s[4:7], s25 offen offset:0 sc1
    v_mfma_f32_16x16x32_bf16 v[16:19], a[100:103], v[52:55], v[16:19]
    v_add_f32 v99, 0x3727c5ac, v99
    v_cvt_pk_bf16_f32 v99, v99, v99
    v_lshlrev_b32 v99, 16, v99
    ds_read_b128 v[48:51], v92 offset:27648
    s_waitcnt lgkmcnt(4)
    v_mfma_f32_16x16x32_bf16 v[20:23], a[20:23], v[56:59], v[20:23]
    buffer_load_dwordx2 v[66:67], v124, s[4:7], s25 offen offset:128 sc1
    v_mfma_f32_16x16x32_bf16 v[24:27], a[100:103], v[56:59], v[24:27]
    v_sqrt_f32 v99, v99
    s_nop 0
    v_cvt_pk_bf16_f32 v99, v99, v99
    v_lshlrev_b32 v99, 16, v99
    ds_read_b128 v[52:55], v92 offset:8192
    s_waitcnt lgkmcnt(4)
    v_mfma_f32_16x16x32_bf16 v[12:15], a[24:27], v[36:39], v[12:15]
    buffer_load_dwordx2 v[68:69], v124, s[4:7], s25 offen offset:256 sc1
    v_mfma_f32_16x16x32_bf16 v[16:19], a[104:107], v[36:39], v[16:19]
    v_rcp_f32 v62, v99
    v_mov_b32 v60, v98
    v_add_f32 v106, v106, v108
    s_cmp_ge_u32 s55, 64
    s_nop 2
    s_cbranch_scc1 Lsd_50226
    s_waitcnt vmcnt(13)
    s_lshl_b32 s46, s55, 6
    s_add_u32 s46, s46, 0xb205440
    v_mov_b32 v4, s46
    v_mov_b32 v5, 1
    s_mov_b64 exec, 1
    buffer_atomic_add v5, v4, s[4:7], 0 offen
    s_mov_b64 exec, -1
Lcs_50227:
    s_mov_b32 s55, 64
Lsd_50226:
    ds_read_b128 v[56:59], v92 offset:28672
    s_waitcnt lgkmcnt(4)
    v_mfma_f32_16x16x32_bf16 v[20:23], a[24:27], v[40:43], v[20:23]
    buffer_load_dwordx2 v[70:71], v124, s[4:7], s25 offen offset:384 sc1
    v_mfma_f32_16x16x32_bf16 v[24:27], a[104:107], v[40:43], v[24:27]
    v_add_f32 v107, v107, v109
    v_add_f32 v106, v106, v110
    v_add_f32 v107, v107, v111
    ds_read_b128 v[36:39], v92 offset:9216
    s_waitcnt lgkmcnt(4)
    v_mfma_f32_16x16x32_bf16 v[12:15], a[28:31], v[44:47], v[12:15]
    buffer_load_dwordx2 v[72:73], v124, s[4:7], s25 offen offset:512 sc1
    v_mfma_f32_16x16x32_bf16 v[16:19], a[108:111], v[44:47], v[16:19]
    v_add_f32 v106, v106, v112
    v_add_f32 v107, v107, v113
    v_add_f32 v106, v106, v114
    ds_read_b128 v[40:43], v92 offset:29696
    s_waitcnt lgkmcnt(4)
    v_mfma_f32_16x16x32_bf16 v[20:23], a[28:31], v[48:51], v[20:23]
    buffer_load_dwordx2 v[74:75], v124, s[4:7], s25 offen offset:2560 sc1
    v_mfma_f32_16x16x32_bf16 v[24:27], a[108:111], v[48:51], v[24:27]
    v_add_f32 v107, v107, v115
    v_mov_b32 v125, v106
    s_nop 1
    v_permlane16_swap_b32 v106, v125
    ds_read_b128 v[44:47], v92 offset:10240
    s_waitcnt lgkmcnt(4)
    v_mfma_f32_16x16x32_bf16 v[12:15], a[32:35], v[52:55], v[12:15]
    buffer_load_dwordx2 v[76:77], v124, s[4:7], s25 offen offset:2688 sc1
    v_mfma_f32_16x16x32_bf16 v[16:19], a[112:115], v[52:55], v[16:19]
    v_add_f32 v106, v106, v125
    v_mov_b32 v125, v106
    s_nop 1
    v_permlane32_swap_b32 v106, v125
    ds_read_b128 v[48:51], v92 offset:30720
    s_waitcnt lgkmcnt(4)
    v_mfma_f32_16x16x32_bf16 v[20:23], a[32:35], v[56:59], v[20:23]
    buffer_load_dwordx2 v[78:79], v124, s[4:7], s25 offen offset:2816 sc1
    v_mfma_f32_16x16x32_bf16 v[24:27], a[112:115], v[56:59], v[24:27]
    v_add_f32 v106, v106, v125
    v_mov_b32 v125, v107
    s_nop 1
    v_permlane16_swap_b32 v107, v125
    ds_read_b128 v[52:55], v92 offset:11264
    s_waitcnt lgkmcnt(4)
    v_mfma_f32_16x16x32_bf16 v[12:15], a[36:39], v[36:39], v[12:15]
    buffer_load_dwordx2 v[80:81], v124, s[4:7], s25 offen offset:2944 sc1
    v_mfma_f32_16x16x32_bf16 v[16:19], a[116:119], v[36:39], v[16:19]
    v_add_f32 v107, v107, v125
    v_mov_b32 v125, v107
    s_nop 1
    v_permlane32_swap_b32 v107, v125
    ds_read_b128 v[56:59], v92 offset:31744
    s_waitcnt lgkmcnt(4)
    v_mfma_f32_16x16x32_bf16 v[20:23], a[36:39], v[40:43], v[20:23]
    buffer_load_dwordx2 v[82:83], v124, s[4:7], s25 offen offset:3072 sc1
    v_mfma_f32_16x16x32_bf16 v[24:27], a[116:119], v[40:43], v[24:27]
    v_add_f32 v107, v107, v125
    v_mul_f32 v106, 0x3acccccd, v106
    v_mul_f32 v107, 0x3acccccd, v107
    ds_read_b128 v[36:39], v92 offset:12288
    s_waitcnt lgkmcnt(4)
    v_mfma_f32_16x16x32_bf16 v[12:15], a[40:43], v[44:47], v[12:15]
    s_mul_i32 s25, s27, 40
    s_add_u32 s25, s25, s29
    s_lshl_b32 s25, s25, 10
    s_add_u32 s25, s25, 0xa200000
    buffer_load_dwordx4 v[84:87], v1, s[4:7], s25 offen sc1
    v_mfma_f32_16x16x32_bf16 v[16:19], a[120:123], v[44:47], v[16:19]
    v_fma_f32 v107, -v106, v106, v107
    v_max_f32 v107, 0, v107
    v_mov_b32 v108, v106
    ds_read_b128 v[40:43], v92 offset:32768
    s_waitcnt lgkmcnt(4)
    v_mfma_f32_16x16x32_bf16 v[20:23], a[40:43], v[48:51], v[20:23]
    s_add_u32 s25, s25, 20480
    buffer_load_dwordx4 v[88:91], v1, s[4:7], s25 offen sc1
    v_mfma_f32_16x16x32_bf16 v[24:27], a[120:123], v[48:51], v[24:27]
    v_cvt_pk_bf16_f32 v108, v108, v108
    v_lshlrev_b32 v108, 16, v108
    v_mov_b32 v109, v107
    ds_read_b128 v[44:47], v92 offset:13312
    s_waitcnt lgkmcnt(4)
    v_mfma_f32_16x16x32_bf16 v[12:15], a[44:47], v[52:55], v[12:15]
    s_add_u32 s33, s27, s19
    v_add_u32 v8, s33, v0
    v_add_u32 v8, -1, v8
    v_cmp_gt_u32 vcc, 64, v8
    s_and_b64 s[48:49], vcc, 7
    v_lshlrev_b32 v8, 6, v8
    v_add_u32 v8, 0xb204240, v8
    buffer_load_dword v9, v8, s[4:7], 0 offen sc1
    v_mfma_f32_16x16x32_bf16 v[16:19], a[124:127], v[52:55], v[16:19]
    v_cvt_pk_bf16_f32 v109, v109, v109
    v_lshlrev_b32 v109, 16, v109
    v_add_f32 v109, 0x3727c5ac, v109
    ds_read_b128 v[48:51], v92 offset:33792
    s_waitcnt lgkmcnt(4)
    v_mfma_f32_16x16x32_bf16 v[20:23], a[44:47], v[56:59], v[20:23]
    v_mfma_f32_16x16x32_bf16 v[24:27], a[124:127], v[56:59], v[24:27]
    v_cvt_pk_bf16_f32 v109, v109, v109
    v_lshlrev_b32 v109, 16, v109
    v_sqrt_f32 v109, v109
    ds_read_b128 v[52:55], v92 offset:14336
    s_waitcnt lgkmcnt(4)
    v_mfma_f32_16x16x32_bf16 v[12:15], a[48:51], v[36:39], v[12:15]
    v_mfma_f32_16x16x32_bf16 v[16:19], a[128:131], v[36:39], v[16:19]
    v_cvt_pk_bf16_f32 v109, v109, v109
    v_lshlrev_b32 v109, 16, v109
    v_rcp_f32 v63, v109
    ds_read_b128 v[56:59], v92 offset:34816
    s_waitcnt lgkmcnt(4)
    v_mfma_f32_16x16x32_bf16 v[20:23], a[48:51], v[40:43], v[20:23]
    v_mfma_f32_16x16x32_bf16 v[24:27], a[128:131], v[40:43], v[24:27]
    v_mov_b32 v61, v108
    ds_read_b128 v[36:39], v92 offset:15360
    s_waitcnt lgkmcnt(4)
    v_mfma_f32_16x16x32_bf16 v[12:15], a[52:55], v[44:47], v[12:15]
    v_mfma_f32_16x16x32_bf16 v[16:19], a[132:135], v[44:47], v[16:19]
    ds_read_b128 v[40:43], v92 offset:35840
    s_waitcnt lgkmcnt(4)
    v_mfma_f32_16x16x32_bf16 v[20:23], a[52:55], v[48:51], v[20:23]
    v_mfma_f32_16x16x32_bf16 v[24:27], a[132:135], v[48:51], v[24:27]
    ds_read_b128 v[44:47], v92 offset:16384
    s_waitcnt lgkmcnt(4)
    v_mfma_f32_16x16x32_bf16 v[12:15], a[56:59], v[52:55], v[12:15]
    v_mfma_f32_16x16x32_bf16 v[16:19], a[136:139], v[52:55], v[16:19]
    ds_read_b128 v[48:51], v92 offset:36864
    s_waitcnt lgkmcnt(4)
    v_mfma_f32_16x16x32_bf16 v[20:23], a[56:59], v[56:59], v[20:23]
    v_mfma_f32_16x16x32_bf16 v[24:27], a[136:139], v[56:59], v[24:27]
    ds_read_b128 v[52:55], v92 offset:17408
    s_waitcnt lgkmcnt(4)
    v_mfma_f32_16x16x32_bf16 v[12:15], a[60:63], v[36:39], v[12:15]
    v_mfma_f32_16x16x32_bf16 v[16:19], a[140:143], v[36:39], v[16:19]
    ds_read_b128 v[56:59], v92 offset:37888
    s_waitcnt lgkmcnt(4)
    v_mfma_f32_16x16x32_bf16 v[20:23], a[60:63], v[40:43], v[20:23]
    v_mfma_f32_16x16x32_bf16 v[24:27], a[140:143], v[40:43], v[24:27]
    ds_read_b128 v[36:39], v92 offset:18432
    s_waitcnt lgkmcnt(4)
    v_mfma_f32_16x16x32_bf16 v[12:15], a[64:67], v[44:47], v[12:15]
    v_mfma_f32_16x16x32_bf16 v[16:19], a[144:147], v[44:47], v[16:19]
    ds_read_b128 v[40:43], v92 offset:38912
    s_waitcnt lgkmcnt(4)
    v_mfma_f32_16x16x32_bf16 v[20:23], a[64:67], v[48:51], v[20:23]
    v_mfma_f32_16x16x32_bf16 v[24:27], a[144:147], v[48:51], v[24:27]
    ds_read_b128 v[44:47], v92 offset:19456
    s_waitcnt lgkmcnt(4)
    v_mfma_f32_16x16x32_bf16 v[12:15], a[68:71], v[52:55], v[12:15]
    v_mfma_f32_16x16x32_bf16 v[16:19], a[148:151], v[52:55], v[16:19]
    ds_read_b128 v[48:51], v92 offset:39936
    s_waitcnt lgkmcnt(4)
    v_mfma_f32_16x16x32_bf16 v[20:23], a[68:71], v[56:59], v[20:23]
    v_mfma_f32_16x16x32_bf16 v[24:27], a[148:151], v[56:59], v[24:27]
    s_waitcnt lgkmcnt(3)
    v_mfma_f32_16x16x32_bf16 v[12:15], a[72:75], v[36:39], v[12:15]
    v_mfma_f32_16x16x32_bf16 v[16:19], a[152:155], v[36:39], v[16:19]
    s_waitcnt lgkmcnt(2)
    v_mfma_f32_16x16x32_bf16 v[20:23], a[72:75], v[40:43], v[20:23]
    v_mfma_f32_16x16x32_bf16 v[24:27], a[152:155], v[40:43], v[24:27]
    s_waitcnt lgkmcnt(1)
    v_mfma_f32_16x16x32_bf16 v[12:15], a[76:79], v[44:47], v[12:15]
    v_mfma_f32_16x16x32_bf16 v[16:19], a[156:159], v[44:47], v[16:19]
    s_waitcnt lgkmcnt(0)
    v_mfma_f32_16x16x32_bf16 v[20:23], a[76:79], v[48:51], v[20:23]
    v_mfma_f32_16x16x32_bf16 v[24:27], a[156:159], v[48:51], v[24:27]
    s_nop 6
    s_branch Lsj_50225
Lsp_50224:
    ds_read_b128 v[36:39], v92 offset:0
    ds_read_b128 v[40:43], v92 offset:20480
    ds_read_b128 v[44:47], v92 offset:1024
    ds_read_b128 v[48:51], v92 offset:21504
    ds_read_b128 v[52:55], v92 offset:2048
    s_waitcnt lgkmcnt(4)
    v_mfma_f32_16x16x32_bf16 v[12:15], a[0:3], v[36:39], 0
    v_mfma_f32_16x16x32_bf16 v[16:19], a[80:83], v[36:39], 0
    v_add_f32 v96, v96, v98
    v_add_f32 v97, v97, v99
    v_add_f32 v96, v96, v100
    ds_read_b128 v[56:59], v92 offset:22528
    s_waitcnt lgkmcnt(4)
    v_mfma_f32_16x16x32_bf16 v[20:23], a[0:3], v[40:43], 0
    v_mfma_f32_16x16x32_bf16 v[24:27], a[80:83], v[40:43], 0
    v_add_f32 v97, v97, v101
    v_add_f32 v96, v96, v102
    v_add_f32 v97, v97, v103
    ds_read_b128 v[36:39], v92 offset:3072
    s_waitcnt lgkmcnt(4)
    v_mfma_f32_16x16x32_bf16 v[12:15], a[4:7], v[44:47], v[12:15]
    v_mfma_f32_16x16x32_bf16 v[16:19], a[84:87], v[44:47], v[16:19]
    v_add_f32 v96, v96, v104
    v_add_f32 v97, v97, v105
    v_mov_b32 v125, v96
    ds_read_b128 v[40:43], v92 offset:23552
    s_waitcnt lgkmcnt(4)
    v_mfma_f32_16x16x32_bf16 v[20:23], a[4:7], v[48:51], v[20:23]
    v_mfma_f32_16x16x32_bf16 v[24:27], a[84:87], v[48:51], v[24:27]
    v_permlane16_swap_b32 v96, v125
    v_add_f32 v96, v96, v125
    v_mov_b32 v125, v96
    ds_read_b128 v[44:47], v92 offset:4096
    s_waitcnt lgkmcnt(4)
    v_mfma_f32_16x16x32_bf16 v[12:15], a[8:11], v[52:55], v[12:15]
    v_mfma_f32_16x16x32_bf16 v[16:19], a[88:91], v[52:55], v[16:19]
    v_permlane32_swap_b32 v96, v125
    v_add_f32 v96, v96, v125
    v_mov_b32 v125, v97
    ds_read_b128 v[48:51], v92 offset:24576
    s_waitcnt lgkmcnt(4)
    v_mfma_f32_16x16x32_bf16 v[20:23], a[8:11], v[56:59], v[20:23]
    v_mfma_f32_16x16x32_bf16 v[24:27], a[88:91], v[56:59], v[24:27]
    v_permlane16_swap_b32 v97, v125
    v_add_f32 v97, v97, v125
    v_mov_b32 v125, v97
    ds_read_b128 v[52:55], v92 offset:5120
    s_waitcnt lgkmcnt(4)
    v_mfma_f32_16x16x32_bf16 v[12:15], a[12:15], v[36:39], v[12:15]
    v_mfma_f32_16x16x32_bf16 v[16:19], a[92:95], v[36:39], v[16:19]
    v_permlane32_swap_b32 v97, v125
    v_add_f32 v97, v97, v125
    v_mul_f32 v96, 0x3acccccd, v96
    ds_read_b128 v[56:59], v92 offset:25600
    s_waitcnt lgkmcnt(4)
    v_mfma_f32_16x16x32_bf16 v[20:23], a[12:15], v[40:43], v[20:23]
    v_mfma_f32_16x16x32_bf16 v[24:27], a[92:95], v[40:43], v[24:27]
    v_mul_f32 v97, 0x3acccccd, v97
    v_fma_f32 v97, -v96, v96, v97
    v_max_f32 v97, 0, v97
    ds_read_b128 v[36:39], v92 offset:6144
    s_waitcnt lgkmcnt(4)
    v_mfma_f32_16x16x32_bf16 v[12:15], a[16:19], v[44:47], v[12:15]
    v_mfma_f32_16x16x32_bf16 v[16:19], a[96:99], v[44:47], v[16:19]
    v_mov_b32 v98, v96
    v_cvt_pk_bf16_f32 v98, v98, v98
    v_lshlrev_b32 v98, 16, v98
    ds_read_b128 v[40:43], v92 offset:26624
    s_waitcnt lgkmcnt(4)
    v_mfma_f32_16x16x32_bf16 v[20:23], a[16:19], v[48:51], v[20:23]
    v_mfma_f32_16x16x32_bf16 v[24:27], a[96:99], v[48:51], v[24:27]
    v_mov_b32 v99, v97
    v_cvt_pk_bf16_f32 v99, v99, v99
    v_lshlrev_b32 v99, 16, v99
    ds_read_b128 v[44:47], v92 offset:7168
    s_waitcnt lgkmcnt(4)
    v_mfma_f32_16x16x32_bf16 v[12:15], a[20:23], v[52:55], v[12:15]
    v_mfma_f32_16x16x32_bf16 v[16:19], a[100:103], v[52:55], v[16:19]
    v_add_f32 v99, 0x3727c5ac, v99
    v_cvt_pk_bf16_f32 v99, v99, v99
    v_lshlrev_b32 v99, 16, v99
    ds_read_b128 v[48:51], v92 offset:27648
    s_waitcnt lgkmcnt(4)
    v_mfma_f32_16x16x32_bf16 v[20:23], a[20:23], v[56:59], v[20:23]
    v_mfma_f32_16x16x32_bf16 v[24:27], a[100:103], v[56:59], v[24:27]
    v_sqrt_f32 v99, v99
    s_nop 0
    v_cvt_pk_bf16_f32 v99, v99, v99
    v_lshlrev_b32 v99, 16, v99
    ds_read_b128 v[52:55], v92 offset:8192
    s_waitcnt lgkmcnt(4)
    v_mfma_f32_16x16x32_bf16 v[12:15], a[24:27], v[36:39], v[12:15]
    v_mfma_f32_16x16x32_bf16 v[16:19], a[104:107], v[36:39], v[16:19]
    v_rcp_f32 v62, v99
    v_mov_b32 v60, v98
    v_add_f32 v106, v106, v108
    s_cmp_ge_u32 s55, 64
    s_nop 2
    s_cbranch_scc1 Lsd_50228
    s_waitcnt vmcnt(0)
    s_lshl_b32 s46, s55, 6
    s_add_u32 s46, s46, 0xb205440
    v_mov_b32 v4, s46
    v_mov_b32 v5, 1
    s_mov_b64 exec, 1
    buffer_atomic_add v5, v4, s[4:7], 0 offen
    s_mov_b64 exec, -1
Lcs_50229:
    s_mov_b32 s55, 64
Lsd_50228:
    ds_read_b128 v[56:59], v92 offset:28672
    s_waitcnt lgkmcnt(4)
    v_mfma_f32_16x16x32_bf16 v[20:23], a[24:27], v[40:43], v[20:23]
    v_mfma_f32_16x16x32_bf16 v[24:27], a[104:107], v[40:43], v[24:27]
    v_add_f32 v107, v107, v109
    v_add_f32 v106, v106, v110
    v_add_f32 v107, v107, v111
    ds_read_b128 v[36:39], v92 offset:9216
    s_waitcnt lgkmcnt(4)
    v_mfma_f32_16x16x32_bf16 v[12:15], a[28:31], v[44:47], v[12:15]
    v_mfma_f32_16x16x32_bf16 v[16:19], a[108:111], v[44:47], v[16:19]
    v_add_f32 v106, v106, v112
    v_add_f32 v107, v107, v113
    v_add_f32 v106, v106, v114
    ds_read_b128 v[40:43], v92 offset:29696
    s_waitcnt lgkmcnt(4)
    v_mfma_f32_16x16x32_bf16 v[20:23], a[28:31], v[48:51], v[20:23]
    v_mfma_f32_16x16x32_bf16 v[24:27], a[108:111], v[48:51], v[24:27]
    v_add_f32 v107, v107, v115
    v_mov_b32 v125, v106
    s_nop 1
    v_permlane16_swap_b32 v106, v125
    ds_read_b128 v[44:47], v92 offset:10240
    s_waitcnt lgkmcnt(4)
    v_mfma_f32_16x16x32_bf16 v[12:15], a[32:35], v[52:55], v[12:15]
    v_mfma_f32_16x16x32_bf16 v[16:19], a[112:115], v[52:55], v[16:19]
    v_add_f32 v106, v106, v125
    v_mov_b32 v125, v106
    s_nop 1
    v_permlane32_swap_b32 v106, v125
    ds_read_b128 v[48:51], v92 offset:30720
    s_waitcnt lgkmcnt(4)
    v_mfma_f32_16x16x32_bf16 v[20:23], a[32:35], v[56:59], v[20:23]
    v_mfma_f32_16x16x32_bf16 v[24:27], a[112:115], v[56:59], v[24:27]
    v_add_f32 v106, v106, v125
    v_mov_b32 v125, v107
    s_nop 1
    v_permlane16_swap_b32 v107, v125
    ds_read_b128 v[52:55], v92 offset:11264
    s_waitcnt lgkmcnt(4)
    v_mfma_f32_16x16x32_bf16 v[12:15], a[36:39], v[36:39], v[12:15]
    v_mfma_f32_16x16x32_bf16 v[16:19], a[116:119], v[36:39], v[16:19]
    v_add_f32 v107, v107, v125
    v_mov_b32 v125, v107
    s_nop 1
    v_permlane32_swap_b32 v107, v125
    ds_read_b128 v[56:59], v92 offset:31744
    s_waitcnt lgkmcnt(4)
    v_mfma_f32_16x16x32_bf16 v[20:23], a[36:39], v[40:43], v[20:23]
    v_mfma_f32_16x16x32_bf16 v[24:27], a[116:119], v[40:43], v[24:27]
    v_add_f32 v107, v107, v125
    v_mul_f32 v106, 0x3acccccd, v106
    v_mul_f32 v107, 0x3acccccd, v107
    ds_read_b128 v[36:39], v92 offset:12288
    s_waitcnt lgkmcnt(4)
    v_mfma_f32_16x16x32_bf16 v[12:15], a[40:43], v[44:47], v[12:15]
    v_mfma_f32_16x16x32_bf16 v[16:19], a[120:123], v[44:47], v[16:19]
    v_fma_f32 v107, -v106, v106, v107
    v_max_f32 v107, 0, v107
    v_mov_b32 v108, v106
    ds_read_b128 v[40:43], v92 offset:32768
    s_waitcnt lgkmcnt(4)
    v_mfma_f32_16x16x32_bf16 v[20:23], a[40:43], v[48:51], v[20:23]
    v_mfma_f32_16x16x32_bf16 v[24:27], a[120:123], v[48:51], v[24:27]
    v_cvt_pk_bf16_f32 v108, v108, v108
    v_lshlrev_b32 v108, 16, v108
    v_mov_b32 v109, v107
    ds_read_b128 v[44:47], v92 offset:13312
    s_waitcnt lgkmcnt(4)
    v_mfma_f32_16x16x32_bf16 v[12:15], a[44:47], v[52:55], v[12:15]
    v_mfma_f32_16x16x32_bf16 v[16:19], a[124:127], v[52:55], v[16:19]
    v_cvt_pk_bf16_f32 v109, v109, v109
    v_lshlrev_b32 v109, 16, v109
    v_add_f32 v109, 0x3727c5ac, v109
    ds_read_b128 v[48:51], v92 offset:33792
    s_waitcnt lgkmcnt(4)
    v_mfma_f32_16x16x32_bf16 v[20:23], a[44:47], v[56:59], v[20:23]
    v_mfma_f32_16x16x32_bf16 v[24:27], a[124:127], v[56:59], v[24:27]
    v_cvt_pk_bf16_f32 v109, v109, v109
    v_lshlrev_b32 v109, 16, v109
    v_sqrt_f32 v109, v109
    ds_read_b128 v[52:55], v92 offset:14336
    s_waitcnt lgkmcnt(4)
    v_mfma_f32_16x16x32_bf16 v[12:15], a[48:51], v[36:39], v[12:15]
    v_mfma_f32_16x16x32_bf16 v[16:19], a[128:131], v[36:39], v[16:19]
    v_cvt_pk_bf16_f32 v109, v109, v109
    v_lshlrev_b32 v109, 16, v109
    v_rcp_f32 v63, v109
    ds_read_b128 v[56:59], v92 offset:34816
    s_waitcnt lgkmcnt(4)
    v_mfma_f32_16x16x32_bf16 v[20:23], a[48:51], v[40:43], v[20:23]
    v_mfma_f32_16x16x32_bf16 v[24:27], a[128:131], v[40:43], v[24:27]
    v_mov_b32 v61, v108
    ds_read_b128 v[36:39], v92 offset:15360
    s_waitcnt lgkmcnt(4)
    v_mfma_f32_16x16x32_bf16 v[12:15], a[52:55], v[44:47], v[12:15]
    v_mfma_f32_16x16x32_bf16 v[16:19], a[132:135], v[44:47], v[16:19]
    ds_read_b128 v[40:43], v92 offset:35840
    s_waitcnt lgkmcnt(4)
    v_mfma_f32_16x16x32_bf16 v[20:23], a[52:55], v[48:51], v[20:23]
    v_mfma_f32_16x16x32_bf16 v[24:27], a[132:135], v[48:51], v[24:27]
    ds_read_b128 v[44:47], v92 offset:16384
    s_waitcnt lgkmcnt(4)
    v_mfma_f32_16x16x32_bf16 v[12:15], a[56:59], v[52:55], v[12:15]
    v_mfma_f32_16x16x32_bf16 v[16:19], a[136:139], v[52:55], v[16:19]
    ds_read_b128 v[48:51], v92 offset:36864
    s_waitcnt lgkmcnt(4)
    v_mfma_f32_16x16x32_bf16 v[20:23], a[56:59], v[56:59], v[20:23]
    v_mfma_f32_16x16x32_bf16 v[24:27], a[136:139], v[56:59], v[24:27]
    ds_read_b128 v[52:55], v92 offset:17408
    s_waitcnt lgkmcnt(4)
    v_mfma_f32_16x16x32_bf16 v[12:15], a[60:63], v[36:39], v[12:15]
    v_mfma_f32_16x16x32_bf16 v[16:19], a[140:143], v[36:39], v[16:19]
    ds_read_b128 v[56:59], v92 offset:37888
    s_waitcnt lgkmcnt(4)
    v_mfma_f32_16x16x32_bf16 v[20:23], a[60:63], v[40:43], v[20:23]
    v_mfma_f32_16x16x32_bf16 v[24:27], a[140:143], v[40:43], v[24:27]
    ds_read_b128 v[36:39], v92 offset:18432
    s_waitcnt lgkmcnt(4)
    v_mfma_f32_16x16x32_bf16 v[12:15], a[64:67], v[44:47], v[12:15]
    v_mfma_f32_16x16x32_bf16 v[16:19], a[144:147], v[44:47], v[16:19]
    ds_read_b128 v[40:43], v92 offset:38912
    s_waitcnt lgkmcnt(4)
    v_mfma_f32_16x16x32_bf16 v[20:23], a[64:67], v[48:51], v[20:23]
    v_mfma_f32_16x16x32_bf16 v[24:27], a[144:147], v[48:51], v[24:27]
    ds_read_b128 v[44:47], v92 offset:19456
    s_waitcnt lgkmcnt(4)
    v_mfma_f32_16x16x32_bf16 v[12:15], a[68:71], v[52:55], v[12:15]
    v_mfma_f32_16x16x32_bf16 v[16:19], a[148:151], v[52:55], v[16:19]
    ds_read_b128 v[48:51], v92 offset:39936
    s_waitcnt lgkmcnt(4)
    v_mfma_f32_16x16x32_bf16 v[20:23], a[68:71], v[56:59], v[20:23]
    v_mfma_f32_16x16x32_bf16 v[24:27], a[148:151], v[56:59], v[24:27]
    s_waitcnt lgkmcnt(3)
    v_mfma_f32_16x16x32_bf16 v[12:15], a[72:75], v[36:39], v[12:15]
    v_mfma_f32_16x16x32_bf16 v[16:19], a[152:155], v[36:39], v[16:19]
    s_waitcnt lgkmcnt(2)
    v_mfma_f32_16x16x32_bf16 v[20:23], a[72:75], v[40:43], v[20:23]
    v_mfma_f32_16x16x32_bf16 v[24:27], a[152:155], v[40:43], v[24:27]
    s_waitcnt lgkmcnt(1)
    v_mfma_f32_16x16x32_bf16 v[12:15], a[76:79], v[44:47], v[12:15]
    v_mfma_f32_16x16x32_bf16 v[16:19], a[156:159], v[44:47], v[16:19]
    s_waitcnt lgkmcnt(0)
    v_mfma_f32_16x16x32_bf16 v[20:23], a[76:79], v[48:51], v[20:23]
    v_mfma_f32_16x16x32_bf16 v[24:27], a[156:159], v[48:51], v[24:27]
    s_nop 7
Lsj_50225:
    v_cvt_pk_bf16_f32 v44, v12, v13
    v_lshlrev_b32 v12, 16, v44
    v_and_b32 v13, 0xffff0000, v44
    v_lshlrev_b32 v44, 16, v116
    v_and_b32 v45, 0xffff0000, v116
    v_sub_f32 v44, v44, v60
    v_sub_f32 v45, v45, v60
    v_cvt_pk_bf16_f32 v46, v44, v45
    v_lshlrev_b32 v44, 16, v46
    v_and_b32 v45, 0xffff0000, v46
    v_mul_f32 v44, v44, v62
    v_mul_f32 v45, v45, v62
    v_cvt_pk_bf16_f32 v46, v44, v45
    v_lshlrev_b32 v44, 16, v46
    v_and_b32 v45, 0xffff0000, v46
    v_add_f32 v44, v44, v12
    v_add_f32 v45, v45, v13
    v_cvt_pk_bf16_f32 v36, v44, v45
    v_lshlrev_b32 v12, 16, v36
    v_and_b32 v13, 0xffff0000, v36
    v_cvt_pk_bf16_f32 v44, v14, v15
    v_lshlrev_b32 v14, 16, v44
    v_and_b32 v15, 0xffff0000, v44
    v_lshlrev_b32 v44, 16, v117
    v_and_b32 v45, 0xffff0000, v117
    v_sub_f32 v44, v44, v60
    v_sub_f32 v45, v45, v60
    v_cvt_pk_bf16_f32 v46, v44, v45
    v_lshlrev_b32 v44, 16, v46
    v_and_b32 v45, 0xffff0000, v46
    v_mul_f32 v44, v44, v62
    v_mul_f32 v45, v45, v62
    v_cvt_pk_bf16_f32 v46, v44, v45
    v_lshlrev_b32 v44, 16, v46
    v_and_b32 v45, 0xffff0000, v46
    v_add_f32 v44, v44, v14
    v_add_f32 v45, v45, v15
    v_cvt_pk_bf16_f32 v37, v44, v45
    v_lshlrev_b32 v14, 16, v37
    v_and_b32 v15, 0xffff0000, v37
    v_cvt_pk_bf16_f32 v44, v16, v17
    v_lshlrev_b32 v16, 16, v44
    v_and_b32 v17, 0xffff0000, v44
    v_lshlrev_b32 v44, 16, v118
    v_and_b32 v45, 0xffff0000, v118
    v_sub_f32 v44, v44, v60
    v_sub_f32 v45, v45, v60
    v_cvt_pk_bf16_f32 v46, v44, v45
    v_lshlrev_b32 v44, 16, v46
    v_and_b32 v45, 0xffff0000, v46
    v_mul_f32 v44, v44, v62
    v_mul_f32 v45, v45, v62
    v_cvt_pk_bf16_f32 v46, v44, v45
    v_lshlrev_b32 v44, 16, v46
    v_and_b32 v45, 0xffff0000, v46
    v_add_f32 v44, v44, v16
    v_add_f32 v45, v45, v17
    v_cvt_pk_bf16_f32 v38, v44, v45
    v_lshlrev_b32 v16, 16, v38
    v_and_b32 v17, 0xffff0000, v38
    v_cvt_pk_bf16_f32 v44, v18, v19
    v_lshlrev_b32 v18, 16, v44
    v_and_b32 v19, 0xffff0000, v44
    v_lshlrev_b32 v44, 16, v119
    v_and_b32 v45, 0xffff0000, v119
    v_sub_f32 v44, v44, v60
    v_sub_f32 v45, v45, v60
    v_cvt_pk_bf16_f32 v46, v44, v45
    v_lshlrev_b32 v44, 16, v46
    v_and_b32 v45, 0xffff0000, v46
    v_mul_f32 v44, v44, v62
    v_mul_f32 v45, v45, v62
    v_cvt_pk_bf16_f32 v46, v44, v45
    v_lshlrev_b32 v44, 16, v46
    v_and_b32 v45, 0xffff0000, v46
    v_add_f32 v44, v44, v18
    v_add_f32 v45, v45, v19
    v_cvt_pk_bf16_f32 v39, v44, v45
    v_lshlrev_b32 v18, 16, v39
    v_and_b32 v19, 0xffff0000, v39
    s_lshl_b32 s34, s17, 1
    s_add_u32 s34, s34, 0
    s_mul_i32 s35, s34, 20
    s_add_u32 s35, s35, s29
    s_lshl_b32 s35, s35, 10
    s_add_u32 s35, s35, 0xa800000
    buffer_store_dwordx4 v[36:39], v1, s[4:7], s35 offen sc1
    s_mul_i32 s35, s34, 2560
    s_lshl_b32 s36, s29, 7
    s_add_u32 s35, s35, s36
    s_add_u32 s35, s35, 0xb180000
    v_add_f32 v50, v12, v13
    v_mul_f32 v51, v12, v12
    v_fmac_f32 v51, v13, v13
    v_add_f32 v50, v50, v14
    v_fmac_f32 v51, v14, v14
    v_add_f32 v50, v50, v15
    v_fmac_f32 v51, v15, v15
    v_add_f32 v50, v50, v16
    v_fmac_f32 v51, v16, v16
    v_add_f32 v50, v50, v17
    v_fmac_f32 v51, v17, v17
    v_add_f32 v50, v50, v18
    v_fmac_f32 v51, v18, v18
    v_add_f32 v50, v50, v19
    v_fmac_f32 v51, v19, v19
    v_mov_b32 v44, v50
    s_nop 1
    v_permlane16_swap_b32 v50, v44
    v_add_f32 v50, v50, v44
    v_mov_b32 v44, v50
    s_nop 1
    v_permlane32_swap_b32 v50, v44
    v_add_f32 v50, v50, v44
    v_mov_b32 v44, v51
    s_nop 1
    v_permlane16_swap_b32 v51, v44
    v_add_f32 v51, v51, v44
    v_mov_b32 v44, v51
    s_nop 1
    v_permlane32_swap_b32 v51, v44
    v_add_f32 v51, v51, v44
    s_mov_b64 exec, 0xffff
    buffer_store_dwordx2 v[50:51], v6, s[4:7], s35 offen sc1
    s_mov_b64 exec, -1
    v_cvt_pk_bf16_f32 v44, v20, v21
    v_lshlrev_b32 v20, 16, v44
    v_and_b32 v21, 0xffff0000, v44
    v_lshlrev_b32 v44, 16, v120
    v_and_b32 v45, 0xffff0000, v120
    v_sub_f32 v44, v44, v61
    v_sub_f32 v45, v45, v61
    v_cvt_pk_bf16_f32 v46, v44, v45
    v_lshlrev_b32 v44, 16, v46
    v_and_b32 v45, 0xffff0000, v46
    v_mul_f32 v44, v44, v63
    v_mul_f32 v45, v45, v63
    v_cvt_pk_bf16_f32 v46, v44, v45
    v_lshlrev_b32 v44, 16, v46
    v_and_b32 v45, 0xffff0000, v46
    v_add_f32 v44, v44, v20
    v_add_f32 v45, v45, v21
    v_cvt_pk_bf16_f32 v40, v44, v45
    v_lshlrev_b32 v20, 16, v40
    v_and_b32 v21, 0xffff0000, v40
    v_cvt_pk_bf16_f32 v44, v22, v23
    v_lshlrev_b32 v22, 16, v44
    v_and_b32 v23, 0xffff0000, v44
    v_lshlrev_b32 v44, 16, v121
    v_and_b32 v45, 0xffff0000, v121
    v_sub_f32 v44, v44, v61
    v_sub_f32 v45, v45, v61
    v_cvt_pk_bf16_f32 v46, v44, v45
    v_lshlrev_b32 v44, 16, v46
    v_and_b32 v45, 0xffff0000, v46
    v_mul_f32 v44, v44, v63
    v_mul_f32 v45, v45, v63
    v_cvt_pk_bf16_f32 v46, v44, v45
    v_lshlrev_b32 v44, 16, v46
    v_and_b32 v45, 0xffff0000, v46
    v_add_f32 v44, v44, v22
    v_add_f32 v45, v45, v23
    v_cvt_pk_bf16_f32 v41, v44, v45
    v_lshlrev_b32 v22, 16, v41
    v_and_b32 v23, 0xffff0000, v41
    v_cvt_pk_bf16_f32 v44, v24, v25
    v_lshlrev_b32 v24, 16, v44
    v_and_b32 v25, 0xffff0000, v44
    v_lshlrev_b32 v44, 16, v122
    v_and_b32 v45, 0xffff0000, v122
    v_sub_f32 v44, v44, v61
    v_sub_f32 v45, v45, v61
    v_cvt_pk_bf16_f32 v46, v44, v45
    v_lshlrev_b32 v44, 16, v46
    v_and_b32 v45, 0xffff0000, v46
    v_mul_f32 v44, v44, v63
    v_mul_f32 v45, v45, v63
    v_cvt_pk_bf16_f32 v46, v44, v45
    v_lshlrev_b32 v44, 16, v46
    v_and_b32 v45, 0xffff0000, v46
    v_add_f32 v44, v44, v24
    v_add_f32 v45, v45, v25
    v_cvt_pk_bf16_f32 v42, v44, v45
    v_lshlrev_b32 v24, 16, v42
    v_and_b32 v25, 0xffff0000, v42
    v_cvt_pk_bf16_f32 v44, v26, v27
    v_lshlrev_b32 v26, 16, v44
    v_and_b32 v27, 0xffff0000, v44
    v_lshlrev_b32 v44, 16, v123
    v_and_b32 v45, 0xffff0000, v123
    v_sub_f32 v44, v44, v61
    v_sub_f32 v45, v45, v61
    v_cvt_pk_bf16_f32 v46, v44, v45
    v_lshlrev_b32 v44, 16, v46
    v_and_b32 v45, 0xffff0000, v46
    v_mul_f32 v44, v44, v63
    v_mul_f32 v45, v45, v63
    v_cvt_pk_bf16_f32 v46, v44, v45
    v_lshlrev_b32 v44, 16, v46
    v_and_b32 v45, 0xffff0000, v46
    v_add_f32 v44, v44, v26
    v_add_f32 v45, v45, v27
    v_cvt_pk_bf16_f32 v43, v44, v45
    v_lshlrev_b32 v26, 16, v43
    v_and_b32 v27, 0xffff0000, v43
    s_lshl_b32 s34, s17, 1
    s_add_u32 s34, s34, 1
    s_mul_i32 s35, s34, 20
    s_add_u32 s35, s35, s29
    s_lshl_b32 s35, s35, 10
    s_add_u32 s35, s35, 0xa800000
    buffer_store_dwordx4 v[40:43], v1, s[4:7], s35 offen sc1
    s_mul_i32 s35, s34, 2560
    s_lshl_b32 s36, s29, 7
    s_add_u32 s35, s35, s36
    s_add_u32 s35, s35, 0xb180000
    v_add_f32 v52, v20, v21
    v_mul_f32 v53, v20, v20
    v_fmac_f32 v53, v21, v21
    v_add_f32 v52, v52, v22
    v_fmac_f32 v53, v22, v22
    v_add_f32 v52, v52, v23
    v_fmac_f32 v53, v23, v23
    v_add_f32 v52, v52, v24
    v_fmac_f32 v53, v24, v24
    v_add_f32 v52, v52, v25
    v_fmac_f32 v53, v25, v25
    v_add_f32 v52, v52, v26
    v_fmac_f32 v53, v26, v26
    v_add_f32 v52, v52, v27
    v_fmac_f32 v53, v27, v27
    v_mov_b32 v44, v52
    s_nop 1
    v_permlane16_swap_b32 v52, v44
    v_add_f32 v52, v52, v44
    v_mov_b32 v44, v52
    s_nop 1
    v_permlane32_swap_b32 v52, v44
    v_add_f32 v52, v52, v44
    v_mov_b32 v44, v53
    s_nop 1
    v_permlane16_swap_b32 v53, v44
    v_add_f32 v53, v53, v44
    v_mov_b32 v44, v53
    s_nop 1
    v_permlane32_swap_b32 v53, v44
    v_add_f32 v53, v53, v44
    s_mov_b64 exec, 0xffff
    buffer_store_dwordx2 v[52:53], v6, s[4:7], s35 offen sc1
    s_mov_b64 exec, -1
    s_mov_b32 s55, s17
    s_mov_b32 s17, s27
    s_cmp_eq_u32 s28, 0
    s_cbranch_scc1 Lsq_50230
    s_waitcnt vmcnt(0)
    s_lshl_b32 s46, s55, 6
    s_add_u32 s46, s46, 0xb205440
    v_mov_b32 v4, s46
    v_mov_b32 v5, 1
    s_mov_b64 exec, 1
    buffer_atomic_add v5, v4, s[4:7], 0 offen
    s_mov_b64 exec, -1
Lcs_50231:
    s_mov_b32 s55, 64
    s_cmp_ge_u32 s17, s50
    s_cbranch_scc1 Ls_end_50210
    v_add_u32 v8, s17, v0
    v_add_u32 v8, -1, v8
    v_cmp_gt_u32 vcc, 64, v8
    s_and_b64 s[48:49], vcc, 7
    v_lshlrev_b32 v8, 6, v8
    v_add_u32 v8, 0xb204240, v8
    s_mov_b64 exec, s[48:49]
    s_nop 0
Lwp_50232:
    buffer_load_dword v9, v8, s[4:7], 0 offen sc1
    s_waitcnt vmcnt(0)
    v_cmp_gt_u32 vcc, 20, v9
    s_nop 0
    s_cbranch_vccz Lwpd_50233
    s_sleep 5
    s_add_u32 s30, s30, 1
    s_cmp_lt_u32 s30, s31
    s_cbranch_scc1 Lwp_50232
Lwpd_50233:
    s_mov_b64 exec, -1
    s_lshl_b32 s20, s17, 5
    s_add_u32 s20, s20, s52
    s_mul_i32 s22, s14, 5120
    v_add_u32 v10, s20, v2
    v_ashrrev_i32 v11, 4, v10
    v_mul_i32_i24 v11, 20480, v11
    v_and_b32 v10, 15, v10
    v_lshl_add_u32 v10, v3, 4, v10
    v_lshl_add_u32 v11, v10, 4, v11
    s_add_u32 m0, s22, 0
    s_nop 0
    buffer_load_dwordx4 v11, s[8:11], s22 offen offset:0 sc1 lds
    buffer_load_dwordx4 v11, s[8:11], s22 offen offset:1024 sc1 lds
    buffer_load_dwordx4 v11, s[8:11], s22 offen offset:2048 sc1 lds
    buffer_load_dwordx4 v11, s[8:11], s22 offen offset:3072 sc1 lds
    s_add_u32 m0, s22, 4096
    s_add_u32 s21, s22, 4096
    buffer_load_dwordx4 v11, s[8:11], s21 offen sc1 lds
    v_add_u32 v10, s20, v2
    v_add_u32 v10, 16, v10
    v_ashrrev_i32 v11, 4, v10
    v_mul_i32_i24 v11, 20480, v11
    v_and_b32 v10, 15, v10
    v_lshl_add_u32 v10, v3, 4, v10
    v_lshl_add_u32 v11, v10, 4, v11
    s_add_u32 m0, s22, 20480
    s_nop 0
    buffer_load_dwordx4 v11, s[8:11], s22 offen offset:0 sc1 lds
    buffer_load_dwordx4 v11, s[8:11], s22 offen offset:1024 sc1 lds
    buffer_load_dwordx4 v11, s[8:11], s22 offen offset:2048 sc1 lds
    buffer_load_dwordx4 v11, s[8:11], s22 offen offset:3072 sc1 lds
    s_add_u32 m0, s22, 24576
    s_add_u32 s21, s22, 4096
    buffer_load_dwordx4 v11, s[8:11], s21 offen sc1 lds
    v_mul_u32_u24 v124, 640, v3
    v_lshl_add_u32 v124, v2, 3, v124
    s_mul_i32 s25, s17, 5120
    s_add_u32 s25, s25, 0xb100000
    buffer_load_dwordx2 v[64:65], v124, s[4:7], s25 offen offset:0 sc1
    buffer_load_dwordx2 v[66:67], v124, s[4:7], s25 offen offset:128 sc1
    buffer_load_dwordx2 v[68:69], v124, s[4:7], s25 offen offset:256 sc1
    buffer_load_dwordx2 v[70:71], v124, s[4:7], s25 offen offset:384 sc1
    buffer_load_dwordx2 v[72:73], v124, s[4:7], s25 offen offset:512 sc1
    buffer_load_dwordx2 v[74:75], v124, s[4:7], s25 offen offset:2560 sc1
    buffer_load_dwordx2 v[76:77], v124, s[4:7], s25 offen offset:2688 sc1
    buffer_load_dwordx2 v[78:79], v124, s[4:7], s25 offen offset:2816 sc1
    buffer_load_dwordx2 v[80:81], v124, s[4:7], s25 offen offset:2944 sc1
    buffer_load_dwordx2 v[82:83], v124, s[4:7], s25 offen offset:3072 sc1
    s_mul_i32 s25, s17, 40
    s_add_u32 s25, s25, s29
    s_lshl_b32 s25, s25, 10
    s_add_u32 s25, s25, 0xa200000
    buffer_load_dwordx4 v[84:87], v1, s[4:7], s25 offen sc1
    s_add_u32 s25, s25, 20480
    buffer_load_dwordx4 v[88:91], v1, s[4:7], s25 offen sc1
    s_add_u32 s33, s17, s19
    v_add_u32 v8, s33, v0
    v_add_u32 v8, -1, v8
    v_cmp_gt_u32 vcc, 64, v8
    s_and_b64 s[48:49], vcc, 7
    v_lshlrev_b32 v8, 6, v8
    v_add_u32 v8, 0xb204240, v8
    buffer_load_dword v9, v8, s[4:7], 0 offen sc1
    s_waitcnt vmcnt(0)
Lsq_50230:
    s_branch Ls_loop_50211
Ls_end_50210:
    s_branch Lmain_end
Lph_d3:
    s_sub_u32 s18, s26, 70
    s_mov_b32 s17, 0
    s_cmp_lt_u32 s18, 12
    s_cbranch_scc1 Lph_d3b
    s_sub_u32 s18, s18, 12
    s_mov_b32 s17, 1
Lph_d3b:
    v_lshlrev_b32 v1, 4, v0
    v_and_b32 v2, 15, v0
    v_lshrrev_b32 v3, 4, v0
    s_lshl_b32 s29, s18, 2
    s_add_u32 s29, s29, s14
    s_mul_i32 s23, s29, 40960
    s_add_u32 s23, s23, 0xbc00000
    buffer_load_dwordx4 a[0:3], v1, s[4:7], s23 offen offset:0 sc1
    buffer_load_dwordx4 a[4:7], v1, s[4:7], s23 offen offset:1024 sc1
    buffer_load_dwordx4 a[8:11], v1, s[4:7], s23 offen offset:2048 sc1
    buffer_load_dwordx4 a[12:15], v1, s[4:7], s23 offen offset:3072 sc1
    s_add_u32 s23, s23, 4096
    buffer_load_dwordx4 a[16:19], v1, s[4:7], s23 offen offset:0 sc1
    buffer_load_dwordx4 a[20:23], v1, s[4:7], s23 offen offset:1024 sc1
    buffer_load_dwordx4 a[24:27], v1, s[4:7], s23 offen offset:2048 sc1
    buffer_load_dwordx4 a[28:31], v1, s[4:7], s23 offen offset:3072 sc1
    s_add_u32 s23, s23, 4096
    buffer_load_dwordx4 a[32:35], v1, s[4:7], s23 offen offset:0 sc1
    buffer_load_dwordx4 a[36:39], v1, s[4:7], s23 offen offset:1024 sc1
    buffer_load_dwordx4 a[40:43], v1, s[4:7], s23 offen offset:2048 sc1
    buffer_load_dwordx4 a[44:47], v1, s[4:7], s23 offen offset:3072 sc1
    s_add_u32 s23, s23, 4096
    buffer_load_dwordx4 a[48:51], v1, s[4:7], s23 offen offset:0 sc1
    buffer_load_dwordx4 a[52:55], v1, s[4:7], s23 offen offset:1024 sc1
    buffer_load_dwordx4 a[56:59], v1, s[4:7], s23 offen offset:2048 sc1
    buffer_load_dwordx4 a[60:63], v1, s[4:7], s23 offen offset:3072 sc1
    s_add_u32 s23, s23, 4096
    buffer_load_dwordx4 a[64:67], v1, s[4:7], s23 offen offset:0 sc1
    buffer_load_dwordx4 a[68:71], v1, s[4:7], s23 offen offset:1024 sc1
    buffer_load_dwordx4 a[72:75], v1, s[4:7], s23 offen offset:2048 sc1
    buffer_load_dwordx4 a[76:79], v1, s[4:7], s23 offen offset:3072 sc1
    s_add_u32 s23, s23, 4096
    buffer_load_dwordx4 a[80:83], v1, s[4:7], s23 offen offset:0 sc1
    buffer_load_dwordx4 a[84:87], v1, s[4:7], s23 offen offset:1024 sc1
    buffer_load_dwordx4 a[88:91], v1, s[4:7], s23 offen offset:2048 sc1
    buffer_load_dwordx4 a[92:95], v1, s[4:7], s23 offen offset:3072 sc1
    s_add_u32 s23, s23, 4096
    buffer_load_dwordx4 a[96:99], v1, s[4:7], s23 offen offset:0 sc1
    buffer_load_dwordx4 a[100:103], v1, s[4:7], s23 offen offset:1024 sc1
    buffer_load_dwordx4 a[104:107], v1, s[4:7], s23 offen offset:2048 sc1
    buffer_load_dwordx4 a[108:111], v1, s[4:7], s23 offen offset:3072 sc1
    s_add_u32 s23, s23, 4096
    buffer_load_dwordx4 a[112:115], v1, s[4:7], s23 offen offset:0 sc1
    buffer_load_dwordx4 a[116:119], v1, s[4:7], s23 offen offset:1024 sc1
    buffer_load_dwordx4 a[120:123], v1, s[4:7], s23 offen offset:2048 sc1
    buffer_load_dwordx4 a[124:127], v1, s[4:7], s23 offen offset:3072 sc1
    s_add_u32 s23, s23, 4096
    buffer_load_dwordx4 a[128:131], v1, s[4:7], s23 offen offset:0 sc1
    buffer_load_dwordx4 a[132:135], v1, s[4:7], s23 offen offset:1024 sc1
    buffer_load_dwordx4 a[136:139], v1, s[4:7], s23 offen offset:2048 sc1
    buffer_load_dwordx4 a[140:143], v1, s[4:7], s23 offen offset:3072 sc1
    s_add_u32 s23, s23, 4096
    buffer_load_dwordx4 a[144:147], v1, s[4:7], s23 offen offset:0 sc1
    buffer_load_dwordx4 a[148:151], v1, s[4:7], s23 offen offset:1024 sc1
    buffer_load_dwordx4 a[152:155], v1, s[4:7], s23 offen offset:2048 sc1
    buffer_load_dwordx4 a[156:159], v1, s[4:7], s23 offen offset:3072 sc1
    s_add_u32 s23, s23, 4096
    v_mov_b32 v7, 0xc0135761
    s_mov_b32 s51, 0xbdd2d3e8
    s_waitcnt vmcnt(0)
    v_mov_b32 v36, 0x3f803f80
    v_mov_b32 v37, 0x3f803f80
    v_mov_b32 v38, 0x3f803f80
    v_mov_b32 v39, 0x3f803f80
    s_nop 1
    v_mfma_f32_16x16x32_bf16 v[28:31], a[0:3], v[36:39], 0
    v_mfma_f32_16x16x32_bf16 v[32:35], a[80:83], v[36:39], 0
    v_mfma_f32_16x16x32_bf16 v[28:31], a[4:7], v[36:39], v[28:31]
    v_mfma_f32_16x16x32_bf16 v[32:35], a[84:87], v[36:39], v[32:35]
    v_mfma_f32_16x16x32_bf16 v[28:31], a[8:11], v[36:39], v[28:31]
    v_mfma_f32_16x16x32_bf16 v[32:35], a[88:91], v[36:39], v[32:35]
    v_mfma_f32_16x16x32_bf16 v[28:31], a[12:15], v[36:39], v[28:31]
    v_mfma_f32_16x16x32_bf16 v[32:35], a[92:95], v[36:39], v[32:35]
    v_mfma_f32_16x16x32_bf16 v[28:31], a[16:19], v[36:39], v[28:31]
    v_mfma_f32_16x16x32_bf16 v[32:35], a[96:99], v[36:39], v[32:35]
    v_mfma_f32_16x16x32_bf16 v[28:31], a[20:23], v[36:39], v[28:31]
    v_mfma_f32_16x16x32_bf16 v[32:35], a[100:103], v[36:39], v[32:35]
    v_mfma_f32_16x16x32_bf16 v[28:31], a[24:27], v[36:39], v[28:31]
    v_mfma_f32_16x16x32_bf16 v[32:35], a[104:107], v[36:39], v[32:35]
    v_mfma_f32_16x16x32_bf16 v[28:31], a[28:31], v[36:39], v[28:31]
    v_mfma_f32_16x16x32_bf16 v[32:35], a[108:111], v[36:39], v[32:35]
    v_mfma_f32_16x16x32_bf16 v[28:31], a[32:35], v[36:39], v[28:31]
    v_mfma_f32_16x16x32_bf16 v[32:35], a[112:115], v[36:39], v[32:35]
    v_mfma_f32_16x16x32_bf16 v[28:31], a[36:39], v[36:39], v[28:31]
    v_mfma_f32_16x16x32_bf16 v[32:35], a[116:119], v[36:39], v[32:35]
    v_mfma_f32_16x16x32_bf16 v[28:31], a[40:43], v[36:39], v[28:31]
    v_mfma_f32_16x16x32_bf16 v[32:35], a[120:123], v[36:39], v[32:35]
    v_mfma_f32_16x16x32_bf16 v[28:31], a[44:47], v[36:39], v[28:31]
    v_mfma_f32_16x16x32_bf16 v[32:35], a[124:127], v[36:39], v[32:35]
    v_mfma_f32_16x16x32_bf16 v[28:31], a[48:51], v[36:39], v[28:31]
    v_mfma_f32_16x16x32_bf16 v[32:35], a[128:131], v[36:39], v[32:35]
    v_mfma_f32_16x16x32_bf16 v[28:31], a[52:55], v[36:39], v[28:31]
    v_mfma_f32_16x16x32_bf16 v[32:35], a[132:135], v[36:39], v[32:35]
    v_mfma_f32_16x16x32_bf16 v[28:31], a[56:59], v[36:39], v[28:31]
    v_mfma_f32_16x16x32_bf16 v[32:35], a[136:139], v[36:39], v[32:35]
    v_mfma_f32_16x16x32_bf16 v[28:31], a[60:63], v[36:39], v[28:31]
    v_mfma_f32_16x16x32_bf16 v[32:35], a[140:143], v[36:39], v[32:35]
    v_mfma_f32_16x16x32_bf16 v[28:31], a[64:67], v[36:39], v[28:31]
    v_mfma_f32_16x16x32_bf16 v[32:35], a[144:147], v[36:39], v[32:35]
    v_mfma_f32_16x16x32_bf16 v[28:31], a[68:71], v[36:39], v[28:31]
    v_mfma_f32_16x16x32_bf16 v[32:35], a[148:151], v[36:39], v[32:35]
    v_mfma_f32_16x16x32_bf16 v[28:31], a[72:75], v[36:39], v[28:31]
    v_mfma_f32_16x16x32_bf16 v[32:35], a[152:155], v[36:39], v[32:35]
    v_mfma_f32_16x16x32_bf16 v[28:31], a[76:79], v[36:39], v[28:31]
    v_mfma_f32_16x16x32_bf16 v[32:35], a[156:159], v[36:39], v[32:35]
    s_mov_b32 s55, 64
    v_add_u32 v8, s17, v0
    v_cmp_gt_u32 vcc, 64, v8
    s_and_b64 s[48:49], vcc, 1
    v_lshlrev_b32 v8, 6, v8
    v_add_u32 v8, 0xb205440, v8
    s_mov_b64 exec, s[48:49]
    s_nop 0
Lwp_50236:
    buffer_load_dword v9, v8, s[4:7], 0 offen sc1
    s_waitcnt vmcnt(0)
    v_cmp_gt_u32 vcc, 20, v9
    s_nop 0
    s_cbranch_vccz Lwpd_50237
    s_sleep 5
    s_add_u32 s30, s30, 1
    s_cmp_lt_u32 s30, s31
    s_cbranch_scc1 Lwp_50236
Lwpd_50237:
    s_mov_b64 exec, -1
    s_mul_i32 s20, s17, 40960
    s_add_u32 s20, s20, 0xa800000
    s_mul_i32 s21, s14, 10240
    s_add_u32 s20, s20, s21
    s_add_u32 s21, s21, 0
    s_mov_b32 m0, s21
    s_nop 0
    buffer_load_dwordx4 v1, s[4:7], s20 offen offset:0 sc1 lds
    buffer_load_dwordx4 v1, s[4:7], s20 offen offset:1024 sc1 lds
    buffer_load_dwordx4 v1, s[4:7], s20 offen offset:2048 sc1 lds
    buffer_load_dwordx4 v1, s[4:7], s20 offen offset:3072 sc1 lds
    s_add_u32 s20, s20, 4096
    s_add_u32 s21, s21, 4096
    s_mov_b32 m0, s21
    s_nop 0
    buffer_load_dwordx4 v1, s[4:7], s20 offen offset:0 sc1 lds
    buffer_load_dwordx4 v1, s[4:7], s20 offen offset:1024 sc1 lds
    buffer_load_dwordx4 v1, s[4:7], s20 offen offset:2048 sc1 lds
    buffer_load_dwordx4 v1, s[4:7], s20 offen offset:3072 sc1 lds
    s_add_u32 s20, s20, 4096
    s_add_u32 s21, s21, 4096
    s_mov_b32 m0, s21
    s_nop 0
    buffer_load_dwordx4 v1, s[4:7], s20 offen offset:0 sc1 lds
    buffer_load_dwordx4 v1, s[4:7], s20 offen offset:1024 sc1 lds
    v_mul_u32_u24 v124, 640, v3
    v_lshl_add_u32 v124, v2, 3, v124
    s_mul_i32 s25, s17, 5120
    s_add_u32 s25, s25, 0xb180000
    buffer_load_dwordx2 v[64:65], v124, s[4:7], s25 offen offset:0 sc1
    buffer_load_dwordx2 v[66:67], v124, s[4:7], s25 offen offset:128 sc1
    buffer_load_dwordx2 v[68:69], v124, s[4:7], s25 offen offset:256 sc1
    buffer_load_dwordx2 v[70:71], v124, s[4:7], s25 offen offset:384 sc1
    buffer_load_dwordx2 v[72:73], v124, s[4:7], s25 offen offset:512 sc1
    buffer_load_dwordx2 v[74:75], v124, s[4:7], s25 offen offset:2560 sc1
    buffer_load_dwordx2 v[76:77], v124, s[4:7], s25 offen offset:2688 sc1
    buffer_load_dwordx2 v[78:79], v124, s[4:7], s25 offen offset:2816 sc1
    buffer_load_dwordx2 v[80:81], v124, s[4:7], s25 offen offset:2944 sc1
    buffer_load_dwordx2 v[82:83], v124, s[4:7], s25 offen offset:3072 sc1
    s_add_u32 s33, s17, s19
    v_add_u32 v8, s33, v0
    v_cmp_gt_u32 vcc, 64, v8
    s_and_b64 s[48:49], vcc, 1
    v_lshlrev_b32 v8, 6, v8
    v_add_u32 v8, 0xb205440, v8
    buffer_load_dword v9, v8, s[4:7], 0 offen sc1
    s_waitcnt vmcnt(0)
Ls_loop_50235:
    s_waitcnt vmcnt(2)
    s_barrier
    s_add_u32 s27, s17, s19
    s_mov_b32 s28, 1
    v_add_u32 v92, 0, v1
    v_add_u32 v93, 65536, v1
    s_cmp_ge_u32 s27, s50
    s_cbranch_scc1 Lsp_50238
    v_cmp_gt_u32 vcc, 20, v9
    s_and_b64 vcc, vcc, s[48:49]
    s_cbranch_scc1 Lsp_50238
    s_mov_b32 s28, 0
    ds_read_b128 v[36:39], v92 offset:0
    ds_read_b128 v[40:43], v92 offset:20480
    ds_read_b128 v[44:47], v92 offset:1024
    ds_read_b128 v[48:51], v92 offset:21504
    ds_read_b128 v[52:55], v92 offset:2048
    s_waitcnt lgkmcnt(4)
    v_mfma_f32_16x16x32_bf16 v[12:15], a[0:3], v[36:39], 0
    s_mul_i32 s20, s27, 40960
    s_add_u32 s20, s20, 0xa800000
    s_mul_i32 s21, s14, 10240
    s_add_u32 s20, s20, s21
    s_add_u32 s21, s21, 40960
    s_mov_b32 m0, s21
    s_nop 0
    buffer_load_dwordx4 v1, s[4:7], s20 offen offset:0 sc1 lds
    v_mfma_f32_16x16x32_bf16 v[16:19], a[80:83], v[36:39], 0
    v_add_f32 v64, v64, v66
    v_add_f32 v65, v65, v67
    v_add_f32 v64, v64, v68
    ds_read_b128 v[56:59], v92 offset:22528
    s_waitcnt lgkmcnt(4)
    v_mfma_f32_16x16x32_bf16 v[20:23], a[0:3], v[40:43], 0
    buffer_load_dwordx4 v1, s[4:7], s20 offen offset:1024 sc1 lds
    v_mfma_f32_16x16x32_bf16 v[24:27], a[80:83], v[40:43], 0
    v_add_f32 v65, v65, v69
    v_add_f32 v64, v64, v70
    v_add_f32 v65, v65, v71
    ds_read_b128 v[36:39], v92 offset:3072
    s_waitcnt lgkmcnt(4)
    v_mfma_f32_16x16x32_bf16 v[12:15], a[4:7], v[44:47], v[12:15]
    buffer_load_dwordx4 v1, s[4:7], s20 offen offset:2048 sc1 lds
    v_mfma_f32_16x16x32_bf16 v[16:19], a[84:87], v[44:47], v[16:19]
    v_add_f32 v64, v64, v72
    v_add_f32 v65, v65, v73
    v_mov_b32 v125, v64
    ds_read_b128 v[40:43], v92 offset:23552
    s_waitcnt lgkmcnt(4)
    v_mfma_f32_16x16x32_bf16 v[20:23], a[4:7], v[48:51], v[20:23]
    buffer_load_dwordx4 v1, s[4:7], s20 offen offset:3072 sc1 lds
    v_mfma_f32_16x16x32_bf16 v[24:27], a[84:87], v[48:51], v[24:27]
    v_permlane16_swap_b32 v64, v125
    v_add_f32 v64, v64, v125
    v_mov_b32 v125, v64
    ds_read_b128 v[44:47], v92 offset:4096
    s_waitcnt lgkmcnt(4)
    v_mfma_f32_16x16x32_bf16 v[12:15], a[8:11], v[52:55], v[12:15]
    s_add_u32 s20, s20, 4096
    s_add_u32 s21, s21, 4096
    s_mov_b32 m0, s21
    s_nop 0
    buffer_load_dwordx4 v1, s[4:7], s20 offen offset:0 sc1 lds
    v_mfma_f32_16x16x32_bf16 v[16:19], a[88:91], v[52:55], v[16:19]
    v_permlane32_swap_b32 v64, v125
    v_add_f32 v64, v64, v125
    v_mov_b32 v125, v65
    ds_read_b128 v[48:51], v92 offset:24576
    s_waitcnt lgkmcnt(4)
    v_mfma_f32_16x16x32_bf16 v[20:23], a[8:11], v[56:59], v[20:23]
    buffer_load_dwordx4 v1, s[4:7], s20 offen offset:1024 sc1 lds
    v_mfma_f32_16x16x32_bf16 v[24:27], a[88:91], v[56:59], v[24:27]
    v_permlane16_swap_b32 v65, v125
    v_add_f32 v65, v65, v125
    v_mov_b32 v125, v65
    ds_read_b128 v[52:55], v92 offset:5120
    s_waitcnt lgkmcnt(4)
    v_mfma_f32_16x16x32_bf16 v[12:15], a[12:15], v[36:39], v[12:15]
    buffer_load_dwordx4 v1, s[4:7], s20 offen offset:2048 sc1 lds
    v_mfma_f32_16x16x32_bf16 v[16:19], a[92:95], v[36:39], v[16:19]
    v_permlane32_swap_b32 v65, v125
    v_add_f32 v65, v65, v125
    v_mul_f32 v64, 0x3acccccd, v64
    ds_read_b128 v[56:59], v92 offset:25600
    s_waitcnt lgkmcnt(4)
    v_mfma_f32_16x16x32_bf16 v[20:23], a[12:15], v[40:43], v[20:23]
    buffer_load_dwordx4 v1, s[4:7], s20 offen offset:3072 sc1 lds
    v_mfma_f32_16x16x32_bf16 v[24:27], a[92:95], v[40:43], v[24:27]
    v_mul_f32 v65, 0x3acccccd, v65
    v_fma_f32 v65, -v64, v64, v65
    v_max_f32 v65, 0, v65
    ds_read_b128 v[36:39], v92 offset:6144
    s_waitcnt lgkmcnt(4)
    v_mfma_f32_16x16x32_bf16 v[12:15], a[16:19], v[44:47], v[12:15]
    s_add_u32 s20, s20, 4096
    s_add_u32 s21, s21, 4096
    s_mov_b32 m0, s21
    s_nop 0
    buffer_load_dwordx4 v1, s[4:7], s20 offen offset:0 sc1 lds
    v_mfma_f32_16x16x32_bf16 v[16:19], a[96:99], v[44:47], v[16:19]
    v_mov_b32 v66, v64
    v_cvt_pk_bf16_f32 v66, v66, v66
    v_lshlrev_b32 v66, 16, v66
    ds_read_b128 v[40:43], v92 offset:26624
    s_waitcnt lgkmcnt(4)
    v_mfma_f32_16x16x32_bf16 v[20:23], a[16:19], v[48:51], v[20:23]
    buffer_load_dwordx4 v1, s[4:7], s20 offen offset:1024 sc1 lds
    v_mfma_f32_16x16x32_bf16 v[24:27], a[96:99], v[48:51], v[24:27]
    v_mov_b32 v67, v65
    v_cvt_pk_bf16_f32 v67, v67, v67
    v_lshlrev_b32 v67, 16, v67
    ds_read_b128 v[44:47], v92 offset:7168
    s_waitcnt lgkmcnt(4)
    v_mfma_f32_16x16x32_bf16 v[12:15], a[20:23], v[52:55], v[12:15]
    v_mul_u32_u24 v124, 640, v3
    v_lshl_add_u32 v124, v2, 3, v124
    s_mul_i32 s25, s27, 5120
    s_add_u32 s25, s25, 0xb180000
    buffer_load_dwordx2 v[96:97], v124, s[4:7], s25 offen offset:0 sc1
    v_mfma_f32_16x16x32_bf16 v[16:19], a[100:103], v[52:55], v[16:19]
    v_add_f32 v67, 0x3727c5ac, v67
    v_cvt_pk_bf16_f32 v67, v67, v67
    v_lshlrev_b32 v67, 16, v67
    ds_read_b128 v[48:51], v92 offset:27648
    s_waitcnt lgkmcnt(4)
    v_mfma_f32_16x16x32_bf16 v[20:23], a[20:23], v[56:59], v[20:23]
    buffer_load_dwordx2 v[98:99], v124, s[4:7], s25 offen offset:128 sc1
    v_mfma_f32_16x16x32_bf16 v[24:27], a[100:103], v[56:59], v[24:27]
    v_sqrt_f32 v67, v67
    s_nop 0
    v_cvt_pk_bf16_f32 v67, v67, v67
    v_lshlrev_b32 v67, 16, v67
    ds_read_b128 v[52:55], v92 offset:8192
    s_waitcnt lgkmcnt(4)
    v_mfma_f32_16x16x32_bf16 v[12:15], a[24:27], v[36:39], v[12:15]
    buffer_load_dwordx2 v[100:101], v124, s[4:7], s25 offen offset:256 sc1
    v_mfma_f32_16x16x32_bf16 v[16:19], a[104:107], v[36:39], v[16:19]
    v_rcp_f32 v62, v67
    v_mov_b32 v60, v66
    v_add_f32 v74, v74, v76
    s_cmp_ge_u32 s55, 64
    s_nop 2
    s_cbranch_scc1 Lsd_50240
    s_waitcnt vmcnt(13)
    s_lshl_b32 s46, s55, 6
    s_add_u32 s46, s46, 0xb206640
    v_mov_b32 v4, s46
    v_mov_b32 v5, 1
    s_mov_b64 exec, 1
    buffer_atomic_add v5, v4, s[4:7], 0 offen
    s_mov_b64 exec, -1
Lcs_50241:
    s_mov_b32 s55, 64
Lsd_50240:
    ds_read_b128 v[56:59], v92 offset:28672
    s_waitcnt lgkmcnt(4)
    v_mfma_f32_16x16x32_bf16 v[20:23], a[24:27], v[40:43], v[20:23]
    buffer_load_dwordx2 v[102:103], v124, s[4:7], s25 offen offset:384 sc1
    v_mfma_f32_16x16x32_bf16 v[24:27], a[104:107], v[40:43], v[24:27]
    v_add_f32 v75, v75, v77
    v_add_f32 v74, v74, v78
    v_add_f32 v75, v75, v79
    ds_read_b128 v[36:39], v92 offset:9216
    s_waitcnt lgkmcnt(4)
    v_mfma_f32_16x16x32_bf16 v[12:15], a[28:31], v[44:47], v[12:15]
    buffer_load_dwordx2 v[104:105], v124, s[4:7], s25 offen offset:512 sc1
    v_mfma_f32_16x16x32_bf16 v[16:19], a[108:111], v[44:47], v[16:19]
    v_add_f32 v74, v74, v80
    v_add_f32 v75, v75, v81
    v_add_f32 v74, v74, v82
    ds_read_b128 v[40:43], v92 offset:29696
    s_waitcnt lgkmcnt(4)
    v_mfma_f32_16x16x32_bf16 v[20:23], a[28:31], v[48:51], v[20:23]
    buffer_load_dwordx2 v[106:107], v124, s[4:7], s25 offen offset:2560 sc1
    v_mfma_f32_16x16x32_bf16 v[24:27], a[108:111], v[48:51], v[24:27]
    v_add_f32 v75, v75, v83
    v_mov_b32 v125, v74
    s_nop 1
    v_permlane16_swap_b32 v74, v125
    ds_read_b128 v[44:47], v92 offset:10240
    s_waitcnt lgkmcnt(4)
    v_mfma_f32_16x16x32_bf16 v[12:15], a[32:35], v[52:55], v[12:15]
    buffer_load_dwordx2 v[108:109], v124, s[4:7], s25 offen offset:2688 sc1
    v_mfma_f32_16x16x32_bf16 v[16:19], a[112:115], v[52:55], v[16:19]
    v_add_f32 v74, v74, v125
    v_mov_b32 v125, v74
    s_nop 1
    v_permlane32_swap_b32 v74, v125
    ds_read_b128 v[48:51], v92 offset:30720
    s_waitcnt lgkmcnt(4)
    v_mfma_f32_16x16x32_bf16 v[20:23], a[32:35], v[56:59], v[20:23]
    buffer_load_dwordx2 v[110:111], v124, s[4:7], s25 offen offset:2816 sc1
    v_mfma_f32_16x16x32_bf16 v[24:27], a[112:115], v[56:59], v[24:27]
    v_add_f32 v74, v74, v125
    v_mov_b32 v125, v75
    s_nop 1
    v_permlane16_swap_b32 v75, v125
    ds_read_b128 v[52:55], v92 offset:11264
    s_waitcnt lgkmcnt(4)
    v_mfma_f32_16x16x32_bf16 v[12:15], a[36:39], v[36:39], v[12:15]
    buffer_load_dwordx2 v[112:113], v124, s[4:7], s25 offen offset:2944 sc1
    v_mfma_f32_16x16x32_bf16 v[16:19], a[116:119], v[36:39], v[16:19]
    v_add_f32 v75, v75, v125
    v_mov_b32 v125, v75
    s_nop 1
    v_permlane32_swap_b32 v75, v125
    ds_read_b128 v[56:59], v92 offset:31744
    s_waitcnt lgkmcnt(4)
    v_mfma_f32_16x16x32_bf16 v[20:23], a[36:39], v[40:43], v[20:23]
    buffer_load_dwordx2 v[114:115], v124, s[4:7], s25 offen offset:3072 sc1
    v_mfma_f32_16x16x32_bf16 v[24:27], a[116:119], v[40:43], v[24:27]
    v_add_f32 v75, v75, v125
    v_mul_f32 v74, 0x3acccccd, v74
    v_mul_f32 v75, 0x3acccccd, v75
    ds_read_b128 v[36:39], v92 offset:12288
    s_waitcnt lgkmcnt(4)
    v_mfma_f32_16x16x32_bf16 v[12:15], a[40:43], v[44:47], v[12:15]
    s_add_u32 s33, s27, s19
    v_add_u32 v8, s33, v0
    v_cmp_gt_u32 vcc, 64, v8
    s_and_b64 s[48:49], vcc, 1
    v_lshlrev_b32 v8, 6, v8
    v_add_u32 v8, 0xb205440, v8
    buffer_load_dword v9, v8, s[4:7], 0 offen sc1
    v_mfma_f32_16x16x32_bf16 v[16:19], a[120:123], v[44:47], v[16:19]
    v_fma_f32 v75, -v74, v74, v75
    v_max_f32 v75, 0, v75
    v_mov_b32 v76, v74
    ds_read_b128 v[40:43], v92 offset:32768
    s_waitcnt lgkmcnt(4)
    v_mfma_f32_16x16x32_bf16 v[20:23], a[40:43], v[48:51], v[20:23]
    v_mfma_f32_16x16x32_bf16 v[24:27], a[120:123], v[48:51], v[24:27]
    v_cvt_pk_bf16_f32 v76, v76, v76
    v_lshlrev_b32 v76, 16, v76
    v_mov_b32 v77, v75
    ds_read_b128 v[44:47], v92 offset:13312
    s_waitcnt lgkmcnt(4)
    v_mfma_f32_16x16x32_bf16 v[12:15], a[44:47], v[52:55], v[12:15]
    v_mfma_f32_16x16x32_bf16 v[16:19], a[124:127], v[52:55], v[16:19]
    v_cvt_pk_bf16_f32 v77, v77, v77
    v_lshlrev_b32 v77, 16, v77
    v_add_f32 v77, 0x3727c5ac, v77
    ds_read_b128 v[48:51], v92 offset:33792
    s_waitcnt lgkmcnt(4)
    v_mfma_f32_16x16x32_bf16 v[20:23], a[44:47], v[56:59], v[20:23]
    v_mfma_f32_16x16x32_bf16 v[24:27], a[124:127], v[56:59], v[24:27]
    v_cvt_pk_bf16_f32 v77, v77, v77
    v_lshlrev_b32 v77, 16, v77
    v_sqrt_f32 v77, v77
    ds_read_b128 v[52:55], v92 offset:14336
    s_waitcnt lgkmcnt(4)
    v_mfma_f32_16x16x32_bf16 v[12:15], a[48:51], v[36:39], v[12:15]
    v_mfma_f32_16x16x32_bf16 v[16:19], a[128:131], v[36:39], v[16:19]
    v_cvt_pk_bf16_f32 v77, v77, v77
    v_lshlrev_b32 v77, 16, v77
    v_rcp_f32 v63, v77
    ds_read_b128 v[56:59], v92 offset:34816
    s_waitcnt lgkmcnt(4)
    v_mfma_f32_16x16x32_bf16 v[20:23], a[48:51], v[40:43], v[20:23]
    v_mfma_f32_16x16x32_bf16 v[24:27], a[128:131], v[40:43], v[24:27]
    v_mov_b32 v61, v76
    ds_read_b128 v[36:39], v92 offset:15360
    s_waitcnt lgkmcnt(4)
    v_mfma_f32_16x16x32_bf16 v[12:15], a[52:55], v[44:47], v[12:15]
    v_mfma_f32_16x16x32_bf16 v[16:19], a[132:135], v[44:47], v[16:19]
    ds_read_b128 v[40:43], v92 offset:35840
    s_waitcnt lgkmcnt(4)
    v_mfma_f32_16x16x32_bf16 v[20:23], a[52:55], v[48:51], v[20:23]
    v_mfma_f32_16x16x32_bf16 v[24:27], a[132:135], v[48:51], v[24:27]
    ds_read_b128 v[44:47], v92 offset:16384
    s_waitcnt lgkmcnt(4)
    v_mfma_f32_16x16x32_bf16 v[12:15], a[56:59], v[52:55], v[12:15]
    v_mfma_f32_16x16x32_bf16 v[16:19], a[136:139], v[52:55], v[16:19]
    ds_read_b128 v[48:51], v92 offset:36864
    s_waitcnt lgkmcnt(4)
    v_mfma_f32_16x16x32_bf16 v[20:23], a[56:59], v[56:59], v[20:23]
    v_mfma_f32_16x16x32_bf16 v[24:27], a[136:139], v[56:59], v[24:27]
    ds_read_b128 v[52:55], v92 offset:17408
    s_waitcnt lgkmcnt(4)
    v_mfma_f32_16x16x32_bf16 v[12:15], a[60:63], v[36:39], v[12:15]
    v_mfma_f32_16x16x32_bf16 v[16:19], a[140:143], v[36:39], v[16:19]
    ds_read_b128 v[56:59], v92 offset:37888
    s_waitcnt lgkmcnt(4)
    v_mfma_f32_16x16x32_bf16 v[20:23], a[60:63], v[40:43], v[20:23]
    v_mfma_f32_16x16x32_bf16 v[24:27], a[140:143], v[40:43], v[24:27]
    ds_read_b128 v[36:39], v92 offset:18432
    s_waitcnt lgkmcnt(4)
    v_mfma_f32_16x16x32_bf16 v[12:15], a[64:67], v[44:47], v[12:15]
    v_mfma_f32_16x16x32_bf16 v[16:19], a[144:147], v[44:47], v[16:19]
    ds_read_b128 v[40:43], v92 offset:38912
    s_waitcnt lgkmcnt(4)
    v_mfma_f32_16x16x32_bf16 v[20:23], a[64:67], v[48:51], v[20:23]
    v_mfma_f32_16x16x32_bf16 v[24:27], a[144:147], v[48:51], v[24:27]
    ds_read_b128 v[44:47], v92 offset:19456
    s_waitcnt lgkmcnt(4)
    v_mfma_f32_16x16x32_bf16 v[12:15], a[68:71], v[52:55], v[12:15]
    v_mfma_f32_16x16x32_bf16 v[16:19], a[148:151], v[52:55], v[16:19]
    ds_read_b128 v[48:51], v92 offset:39936
    s_waitcnt lgkmcnt(4)
    v_mfma_f32_16x16x32_bf16 v[20:23], a[68:71], v[56:59], v[20:23]
    v_mfma_f32_16x16x32_bf16 v[24:27], a[148:151], v[56:59], v[24:27]
    s_waitcnt lgkmcnt(3)
    v_mfma_f32_16x16x32_bf16 v[12:15], a[72:75], v[36:39], v[12:15]
    v_mfma_f32_16x16x32_bf16 v[16:19], a[152:155], v[36:39], v[16:19]
    s_waitcnt lgkmcnt(2)
    v_mfma_f32_16x16x32_bf16 v[20:23], a[72:75], v[40:43], v[20:23]
    v_mfma_f32_16x16x32_bf16 v[24:27], a[152:155], v[40:43], v[24:27]
    s_waitcnt lgkmcnt(1)
    v_mfma_f32_16x16x32_bf16 v[12:15], a[76:79], v[44:47], v[12:15]
    v_mfma_f32_16x16x32_bf16 v[16:19], a[156:159], v[44:47], v[16:19]
    s_waitcnt lgkmcnt(0)
    v_mfma_f32_16x16x32_bf16 v[20:23], a[76:79], v[48:51], v[20:23]
    v_mfma_f32_16x16x32_bf16 v[24:27], a[156:159], v[48:51], v[24:27]
    s_nop 6
    s_branch Lsj_50239
Lsp_50238:
    ds_read_b128 v[36:39], v92 offset:0
    ds_read_b128 v[40:43], v92 offset:20480
    ds_read_b128 v[44:47], v92 offset:1024
    ds_read_b128 v[48:51], v92 offset:21504
    ds_read_b128 v[52:55], v92 offset:2048
    s_waitcnt lgkmcnt(4)
    v_mfma_f32_16x16x32_bf16 v[12:15], a[0:3], v[36:39], 0
    v_mfma_f32_16x16x32_bf16 v[16:19], a[80:83], v[36:39], 0
    v_add_f32 v64, v64, v66
    v_add_f32 v65, v65, v67
    v_add_f32 v64, v64, v68
    ds_read_b128 v[56:59], v92 offset:22528
    s_waitcnt lgkmcnt(4)
    v_mfma_f32_16x16x32_bf16 v[20:23], a[0:3], v[40:43], 0
    v_mfma_f32_16x16x32_bf16 v[24:27], a[80:83], v[40:43], 0
    v_add_f32 v65, v65, v69
    v_add_f32 v64, v64, v70
    v_add_f32 v65, v65, v71
    ds_read_b128 v[36:39], v92 offset:3072
    s_waitcnt lgkmcnt(4)
    v_mfma_f32_16x16x32_bf16 v[12:15], a[4:7], v[44:47], v[12:15]
    v_mfma_f32_16x16x32_bf16 v[16:19], a[84:87], v[44:47], v[16:19]
    v_add_f32 v64, v64, v72
    v_add_f32 v65, v65, v73
    v_mov_b32 v125, v64
    ds_read_b128 v[40:43], v92 offset:23552
    s_waitcnt lgkmcnt(4)
    v_mfma_f32_16x16x32_bf16 v[20:23], a[4:7], v[48:51], v[20:23]
    v_mfma_f32_16x16x32_bf16 v[24:27], a[84:87], v[48:51], v[24:27]
    v_permlane16_swap_b32 v64, v125
    v_add_f32 v64, v64, v125
    v_mov_b32 v125, v64
    ds_read_b128 v[44:47], v92 offset:4096
    s_waitcnt lgkmcnt(4)
    v_mfma_f32_16x16x32_bf16 v[12:15], a[8:11], v[52:55], v[12:15]
    v_mfma_f32_16x16x32_bf16 v[16:19], a[88:91], v[52:55], v[16:19]
    v_permlane32_swap_b32 v64, v125
    v_add_f32 v64, v64, v125
    v_mov_b32 v125, v65
    ds_read_b128 v[48:51], v92 offset:24576
    s_waitcnt lgkmcnt(4)
    v_mfma_f32_16x16x32_bf16 v[20:23], a[8:11], v[56:59], v[20:23]
    v_mfma_f32_16x16x32_bf16 v[24:27], a[88:91], v[56:59], v[24:27]
    v_permlane16_swap_b32 v65, v125
    v_add_f32 v65, v65, v125
    v_mov_b32 v125, v65
    ds_read_b128 v[52:55], v92 offset:5120
    s_waitcnt lgkmcnt(4)
    v_mfma_f32_16x16x32_bf16 v[12:15], a[12:15], v[36:39], v[12:15]
    v_mfma_f32_16x16x32_bf16 v[16:19], a[92:95], v[36:39], v[16:19]
    v_permlane32_swap_b32 v65, v125
    v_add_f32 v65, v65, v125
    v_mul_f32 v64, 0x3acccccd, v64
    ds_read_b128 v[56:59], v92 offset:25600
    s_waitcnt lgkmcnt(4)
    v_mfma_f32_16x16x32_bf16 v[20:23], a[12:15], v[40:43], v[20:23]
    v_mfma_f32_16x16x32_bf16 v[24:27], a[92:95], v[40:43], v[24:27]
    v_mul_f32 v65, 0x3acccccd, v65
    v_fma_f32 v65, -v64, v64, v65
    v_max_f32 v65, 0, v65
    ds_read_b128 v[36:39], v92 offset:6144
    s_waitcnt lgkmcnt(4)
    v_mfma_f32_16x16x32_bf16 v[12:15], a[16:19], v[44:47], v[12:15]
    v_mfma_f32_16x16x32_bf16 v[16:19], a[96:99], v[44:47], v[16:19]
    v_mov_b32 v66, v64
    v_cvt_pk_bf16_f32 v66, v66, v66
    v_lshlrev_b32 v66, 16, v66
    ds_read_b128 v[40:43], v92 offset:26624
    s_waitcnt lgkmcnt(4)
    v_mfma_f32_16x16x32_bf16 v[20:23], a[16:19], v[48:51], v[20:23]
    v_mfma_f32_16x16x32_bf16 v[24:27], a[96:99], v[48:51], v[24:27]
    v_mov_b32 v67, v65
    v_cvt_pk_bf16_f32 v67, v67, v67
    v_lshlrev_b32 v67, 16, v67
    ds_read_b128 v[44:47], v92 offset:7168
    s_waitcnt lgkmcnt(4)
    v_mfma_f32_16x16x32_bf16 v[12:15], a[20:23], v[52:55], v[12:15]
    v_mfma_f32_16x16x32_bf16 v[16:19], a[100:103], v[52:55], v[16:19]
    v_add_f32 v67, 0x3727c5ac, v67
    v_cvt_pk_bf16_f32 v67, v67, v67
    v_lshlrev_b32 v67, 16, v67
    ds_read_b128 v[48:51], v92 offset:27648
    s_waitcnt lgkmcnt(4)
    v_mfma_f32_16x16x32_bf16 v[20:23], a[20:23], v[56:59], v[20:23]
    v_mfma_f32_16x16x32_bf16 v[24:27], a[100:103], v[56:59], v[24:27]
    v_sqrt_f32 v67, v67
    s_nop 0
    v_cvt_pk_bf16_f32 v67, v67, v67
    v_lshlrev_b32 v67, 16, v67
    ds_read_b128 v[52:55], v92 offset:8192
    s_waitcnt lgkmcnt(4)
    v_mfma_f32_16x16x32_bf16 v[12:15], a[24:27], v[36:39], v[12:15]
    v_mfma_f32_16x16x32_bf16 v[16:19], a[104:107], v[36:39], v[16:19]
    v_rcp_f32 v62, v67
    v_mov_b32 v60, v66
    v_add_f32 v74, v74, v76
    s_cmp_ge_u32 s55, 64
    s_nop 2
    s_cbranch_scc1 Lsd_50242
    s_waitcnt vmcnt(0)
    s_lshl_b32 s46, s55, 6
    s_add_u32 s46, s46, 0xb206640
    v_mov_b32 v4, s46
    v_mov_b32 v5, 1
    s_mov_b64 exec, 1
    buffer_atomic_add v5, v4, s[4:7], 0 offen
    s_mov_b64 exec, -1
Lcs_50243:
    s_mov_b32 s55, 64
Lsd_50242:
    ds_read_b128 v[56:59], v92 offset:28672
    s_waitcnt lgkmcnt(4)
    v_mfma_f32_16x16x32_bf16 v[20:23], a[24:27], v[40:43], v[20:23]
    v_mfma_f32_16x16x32_bf16 v[24:27], a[104:107], v[40:43], v[24:27]
    v_add_f32 v75, v75, v77
    v_add_f32 v74, v74, v78
    v_add_f32 v75, v75, v79
    ds_read_b128 v[36:39], v92 offset:9216
    s_waitcnt lgkmcnt(4)
    v_mfma_f32_16x16x32_bf16 v[12:15], a[28:31], v[44:47], v[12:15]
    v_mfma_f32_16x16x32_bf16 v[16:19], a[108:111], v[44:47], v[16:19]
    v_add_f32 v74, v74, v80
    v_add_f32 v75, v75, v81
    v_add_f32 v74, v74, v82
    ds_read_b128 v[40:43], v92 offset:29696
    s_waitcnt lgkmcnt(4)
    v_mfma_f32_16x16x32_bf16 v[20:23], a[28:31], v[48:51], v[20:23]
    v_mfma_f32_16x16x32_bf16 v[24:27], a[108:111], v[48:51], v[24:27]
    v_add_f32 v75, v75, v83
    v_mov_b32 v125, v74
    s_nop 1
    v_permlane16_swap_b32 v74, v125
    ds_read_b128 v[44:47], v92 offset:10240
    s_waitcnt lgkmcnt(4)
    v_mfma_f32_16x16x32_bf16 v[12:15], a[32:35], v[52:55], v[12:15]
    v_mfma_f32_16x16x32_bf16 v[16:19], a[112:115], v[52:55], v[16:19]
    v_add_f32 v74, v74, v125
    v_mov_b32 v125, v74
    s_nop 1
    v_permlane32_swap_b32 v74, v125
    ds_read_b128 v[48:51], v92 offset:30720
    s_waitcnt lgkmcnt(4)
    v_mfma_f32_16x16x32_bf16 v[20:23], a[32:35], v[56:59], v[20:23]
    v_mfma_f32_16x16x32_bf16 v[24:27], a[112:115], v[56:59], v[24:27]
    v_add_f32 v74, v74, v125
    v_mov_b32 v125, v75
    s_nop 1
    v_permlane16_swap_b32 v75, v125
    ds_read_b128 v[52:55], v92 offset:11264
    s_waitcnt lgkmcnt(4)
    v_mfma_f32_16x16x32_bf16 v[12:15], a[36:39], v[36:39], v[12:15]
    v_mfma_f32_16x16x32_bf16 v[16:19], a[116:119], v[36:39], v[16:19]
    v_add_f32 v75, v75, v125
    v_mov_b32 v125, v75
    s_nop 1
    v_permlane32_swap_b32 v75, v125
    ds_read_b128 v[56:59], v92 offset:31744
    s_waitcnt lgkmcnt(4)
    v_mfma_f32_16x16x32_bf16 v[20:23], a[36:39], v[40:43], v[20:23]
    v_mfma_f32_16x16x32_bf16 v[24:27], a[116:119], v[40:43], v[24:27]
    v_add_f32 v75, v75, v125
    v_mul_f32 v74, 0x3acccccd, v74
    v_mul_f32 v75, 0x3acccccd, v75
    ds_read_b128 v[36:39], v92 offset:12288
    s_waitcnt lgkmcnt(4)
    v_mfma_f32_16x16x32_bf16 v[12:15], a[40:43], v[44:47], v[12:15]
    v_mfma_f32_16x16x32_bf16 v[16:19], a[120:123], v[44:47], v[16:19]
    v_fma_f32 v75, -v74, v74, v75
    v_max_f32 v75, 0, v75
    v_mov_b32 v76, v74
    ds_read_b128 v[40:43], v92 offset:32768
    s_waitcnt lgkmcnt(4)
    v_mfma_f32_16x16x32_bf16 v[20:23], a[40:43], v[48:51], v[20:23]
    v_mfma_f32_16x16x32_bf16 v[24:27], a[120:123], v[48:51], v[24:27]
    v_cvt_pk_bf16_f32 v76, v76, v76
    v_lshlrev_b32 v76, 16, v76
    v_mov_b32 v77, v75
    ds_read_b128 v[44:47], v92 offset:13312
    s_waitcnt lgkmcnt(4)
    v_mfma_f32_16x16x32_bf16 v[12:15], a[44:47], v[52:55], v[12:15]
    v_mfma_f32_16x16x32_bf16 v[16:19], a[124:127], v[52:55], v[16:19]
    v_cvt_pk_bf16_f32 v77, v77, v77
    v_lshlrev_b32 v77, 16, v77
    v_add_f32 v77, 0x3727c5ac, v77
    ds_read_b128 v[48:51], v92 offset:33792
    s_waitcnt lgkmcnt(4)
    v_mfma_f32_16x16x32_bf16 v[20:23], a[44:47], v[56:59], v[20:23]
    v_mfma_f32_16x16x32_bf16 v[24:27], a[124:127], v[56:59], v[24:27]
    v_cvt_pk_bf16_f32 v77, v77, v77
    v_lshlrev_b32 v77, 16, v77
    v_sqrt_f32 v77, v77
    ds_read_b128 v[52:55], v92 offset:14336
    s_waitcnt lgkmcnt(4)
    v_mfma_f32_16x16x32_bf16 v[12:15], a[48:51], v[36:39], v[12:15]
    v_mfma_f32_16x16x32_bf16 v[16:19], a[128:131], v[36:39], v[16:19]
    v_cvt_pk_bf16_f32 v77, v77, v77
    v_lshlrev_b32 v77, 16, v77
    v_rcp_f32 v63, v77
    ds_read_b128 v[56:59], v92 offset:34816
    s_waitcnt lgkmcnt(4)
    v_mfma_f32_16x16x32_bf16 v[20:23], a[48:51], v[40:43], v[20:23]
    v_mfma_f32_16x16x32_bf16 v[24:27], a[128:131], v[40:43], v[24:27]
    v_mov_b32 v61, v76
    ds_read_b128 v[36:39], v92 offset:15360
    s_waitcnt lgkmcnt(4)
    v_mfma_f32_16x16x32_bf16 v[12:15], a[52:55], v[44:47], v[12:15]
    v_mfma_f32_16x16x32_bf16 v[16:19], a[132:135], v[44:47], v[16:19]
    ds_read_b128 v[40:43], v92 offset:35840
    s_waitcnt lgkmcnt(4)
    v_mfma_f32_16x16x32_bf16 v[20:23], a[52:55], v[48:51], v[20:23]
    v_mfma_f32_16x16x32_bf16 v[24:27], a[132:135], v[48:51], v[24:27]
    ds_read_b128 v[44:47], v92 offset:16384
    s_waitcnt lgkmcnt(4)
    v_mfma_f32_16x16x32_bf16 v[12:15], a[56:59], v[52:55], v[12:15]
    v_mfma_f32_16x16x32_bf16 v[16:19], a[136:139], v[52:55], v[16:19]
    ds_read_b128 v[48:51], v92 offset:36864
    s_waitcnt lgkmcnt(4)
    v_mfma_f32_16x16x32_bf16 v[20:23], a[56:59], v[56:59], v[20:23]
    v_mfma_f32_16x16x32_bf16 v[24:27], a[136:139], v[56:59], v[24:27]
    ds_read_b128 v[52:55], v92 offset:17408
    s_waitcnt lgkmcnt(4)
    v_mfma_f32_16x16x32_bf16 v[12:15], a[60:63], v[36:39], v[12:15]
    v_mfma_f32_16x16x32_bf16 v[16:19], a[140:143], v[36:39], v[16:19]
    ds_read_b128 v[56:59], v92 offset:37888
    s_waitcnt lgkmcnt(4)
    v_mfma_f32_16x16x32_bf16 v[20:23], a[60:63], v[40:43], v[20:23]
    v_mfma_f32_16x16x32_bf16 v[24:27], a[140:143], v[40:43], v[24:27]
    ds_read_b128 v[36:39], v92 offset:18432
    s_waitcnt lgkmcnt(4)
    v_mfma_f32_16x16x32_bf16 v[12:15], a[64:67], v[44:47], v[12:15]
    v_mfma_f32_16x16x32_bf16 v[16:19], a[144:147], v[44:47], v[16:19]
    ds_read_b128 v[40:43], v92 offset:38912
    s_waitcnt lgkmcnt(4)
    v_mfma_f32_16x16x32_bf16 v[20:23], a[64:67], v[48:51], v[20:23]
    v_mfma_f32_16x16x32_bf16 v[24:27], a[144:147], v[48:51], v[24:27]
    ds_read_b128 v[44:47], v92 offset:19456
    s_waitcnt lgkmcnt(4)
    v_mfma_f32_16x16x32_bf16 v[12:15], a[68:71], v[52:55], v[12:15]
    v_mfma_f32_16x16x32_bf16 v[16:19], a[148:151], v[52:55], v[16:19]
    ds_read_b128 v[48:51], v92 offset:39936
    s_waitcnt lgkmcnt(4)
    v_mfma_f32_16x16x32_bf16 v[20:23], a[68:71], v[56:59], v[20:23]
    v_mfma_f32_16x16x32_bf16 v[24:27], a[148:151], v[56:59], v[24:27]
    s_waitcnt lgkmcnt(3)
    v_mfma_f32_16x16x32_bf16 v[12:15], a[72:75], v[36:39], v[12:15]
    v_mfma_f32_16x16x32_bf16 v[16:19], a[152:155], v[36:39], v[16:19]
    s_waitcnt lgkmcnt(2)
    v_mfma_f32_16x16x32_bf16 v[20:23], a[72:75], v[40:43], v[20:23]
    v_mfma_f32_16x16x32_bf16 v[24:27], a[152:155], v[40:43], v[24:27]
    s_waitcnt lgkmcnt(1)
    v_mfma_f32_16x16x32_bf16 v[12:15], a[76:79], v[44:47], v[12:15]
    v_mfma_f32_16x16x32_bf16 v[16:19], a[156:159], v[44:47], v[16:19]
    s_waitcnt lgkmcnt(0)
    v_mfma_f32_16x16x32_bf16 v[20:23], a[76:79], v[48:51], v[20:23]
    v_mfma_f32_16x16x32_bf16 v[24:27], a[156:159], v[48:51], v[24:27]
    s_nop 7
Lsj_50239:
    v_fma_f32 v12, -v60, v28, v12
    v_mul_f32 v12, v12, v62
    v_fma_f32 v13, -v60, v29, v13
    v_mul_f32 v13, v13, v62
    v_cvt_pk_bf16_f32 v44, v12, v13
    v_lshlrev_b32 v12, 16, v44
    v_and_b32 v13, 0xffff0000, v44
    v_mul_f32 v44, v12, v12
    v_fma_f32 v44, v44, s51, v7
    v_mul_f32 v44, v44, v12
    v_exp_f32 v44, v44
    v_mul_f32 v45, v13, v13
    v_fma_f32 v45, v45, s51, v7
    v_mul_f32 v45, v45, v13
    v_exp_f32 v45, v45
    v_add_f32 v44, 1.0, v44
    v_rcp_f32 v44, v44
    v_add_f32 v45, 1.0, v45
    v_rcp_f32 v45, v45
    v_mul_f32 v12, v12, v44
    v_mul_f32 v13, v13, v45
    v_cvt_pk_bf16_f32 v36, v12, v13
    v_fma_f32 v14, -v60, v30, v14
    v_mul_f32 v14, v14, v62
    v_fma_f32 v15, -v60, v31, v15
    v_mul_f32 v15, v15, v62
    v_cvt_pk_bf16_f32 v44, v14, v15
    v_lshlrev_b32 v14, 16, v44
    v_and_b32 v15, 0xffff0000, v44
    v_mul_f32 v44, v14, v14
    v_fma_f32 v44, v44, s51, v7
    v_mul_f32 v44, v44, v14
    v_exp_f32 v44, v44
    v_mul_f32 v45, v15, v15
    v_fma_f32 v45, v45, s51, v7
    v_mul_f32 v45, v45, v15
    v_exp_f32 v45, v45
    v_add_f32 v44, 1.0, v44
    v_rcp_f32 v44, v44
    v_add_f32 v45, 1.0, v45
    v_rcp_f32 v45, v45
    v_mul_f32 v14, v14, v44
    v_mul_f32 v15, v15, v45
    v_cvt_pk_bf16_f32 v37, v14, v15
    v_fma_f32 v16, -v60, v32, v16
    v_mul_f32 v16, v16, v62
    v_fma_f32 v17, -v60, v33, v17
    v_mul_f32 v17, v17, v62
    v_cvt_pk_bf16_f32 v44, v16, v17
    v_lshlrev_b32 v16, 16, v44
    v_and_b32 v17, 0xffff0000, v44
    v_mul_f32 v44, v16, v16
    v_fma_f32 v44, v44, s51, v7
    v_mul_f32 v44, v44, v16
    v_exp_f32 v44, v44
    v_mul_f32 v45, v17, v17
    v_fma_f32 v45, v45, s51, v7
    v_mul_f32 v45, v45, v17
    v_exp_f32 v45, v45
    v_add_f32 v44, 1.0, v44
    v_rcp_f32 v44, v44
    v_add_f32 v45, 1.0, v45
    v_rcp_f32 v45, v45
    v_mul_f32 v16, v16, v44
    v_mul_f32 v17, v17, v45
    v_cvt_pk_bf16_f32 v38, v16, v17
    v_fma_f32 v18, -v60, v34, v18
    v_mul_f32 v18, v18, v62
    v_fma_f32 v19, -v60, v35, v19
    v_mul_f32 v19, v19, v62
    v_cvt_pk_bf16_f32 v44, v18, v19
    v_lshlrev_b32 v18, 16, v44
    v_and_b32 v19, 0xffff0000, v44
    v_mul_f32 v44, v18, v18
    v_fma_f32 v44, v44, s51, v7
    v_mul_f32 v44, v44, v18
    v_exp_f32 v44, v44
    v_mul_f32 v45, v19, v19
    v_fma_f32 v45, v45, s51, v7
    v_mul_f32 v45, v45, v19
    v_exp_f32 v45, v45
    v_add_f32 v44, 1.0, v44
    v_rcp_f32 v44, v44
    v_add_f32 v45, 1.0, v45
    v_rcp_f32 v45, v45
    v_mul_f32 v18, v18, v44
    v_mul_f32 v19, v19, v45
    v_cvt_pk_bf16_f32 v39, v18, v19
    s_lshl_b32 s34, s17, 1
    s_add_u32 s34, s34, 0
    s_mul_i32 s35, s34, 48
    s_add_u32 s35, s35, s29
    s_lshl_b32 s35, s35, 10
    s_add_u32 s35, s35, 0xab00000
    buffer_store_dwordx4 v[36:39], v1, s[4:7], s35 offen sc1
    v_fma_f32 v20, -v61, v28, v20
    v_mul_f32 v20, v20, v63
    v_fma_f32 v21, -v61, v29, v21
    v_mul_f32 v21, v21, v63
    v_cvt_pk_bf16_f32 v44, v20, v21
    v_lshlrev_b32 v20, 16, v44
    v_and_b32 v21, 0xffff0000, v44
    v_mul_f32 v44, v20, v20
    v_fma_f32 v44, v44, s51, v7
    v_mul_f32 v44, v44, v20
    v_exp_f32 v44, v44
    v_mul_f32 v45, v21, v21
    v_fma_f32 v45, v45, s51, v7
    v_mul_f32 v45, v45, v21
    v_exp_f32 v45, v45
    v_add_f32 v44, 1.0, v44
    v_rcp_f32 v44, v44
    v_add_f32 v45, 1.0, v45
    v_rcp_f32 v45, v45
    v_mul_f32 v20, v20, v44
    v_mul_f32 v21, v21, v45
    v_cvt_pk_bf16_f32 v40, v20, v21
    v_fma_f32 v22, -v61, v30, v22
    v_mul_f32 v22, v22, v63
    v_fma_f32 v23, -v61, v31, v23
    v_mul_f32 v23, v23, v63
    v_cvt_pk_bf16_f32 v44, v22, v23
    v_lshlrev_b32 v22, 16, v44
    v_and_b32 v23, 0xffff0000, v44
    v_mul_f32 v44, v22, v22
    v_fma_f32 v44, v44, s51, v7
    v_mul_f32 v44, v44, v22
    v_exp_f32 v44, v44
    v_mul_f32 v45, v23, v23
    v_fma_f32 v45, v45, s51, v7
    v_mul_f32 v45, v45, v23
    v_exp_f32 v45, v45
    v_add_f32 v44, 1.0, v44
    v_rcp_f32 v44, v44
    v_add_f32 v45, 1.0, v45
    v_rcp_f32 v45, v45
    v_mul_f32 v22, v22, v44
    v_mul_f32 v23, v23, v45
    v_cvt_pk_bf16_f32 v41, v22, v23
    v_fma_f32 v24, -v61, v32, v24
    v_mul_f32 v24, v24, v63
    v_fma_f32 v25, -v61, v33, v25
    v_mul_f32 v25, v25, v63
    v_cvt_pk_bf16_f32 v44, v24, v25
    v_lshlrev_b32 v24, 16, v44
    v_and_b32 v25, 0xffff0000, v44
    v_mul_f32 v44, v24, v24
    v_fma_f32 v44, v44, s51, v7
    v_mul_f32 v44, v44, v24
    v_exp_f32 v44, v44
    v_mul_f32 v45, v25, v25
    v_fma_f32 v45, v45, s51, v7
    v_mul_f32 v45, v45, v25
    v_exp_f32 v45, v45
    v_add_f32 v44, 1.0, v44
    v_rcp_f32 v44, v44
    v_add_f32 v45, 1.0, v45
    v_rcp_f32 v45, v45
    v_mul_f32 v24, v24, v44
    v_mul_f32 v25, v25, v45
    v_cvt_pk_bf16_f32 v42, v24, v25
    v_fma_f32 v26, -v61, v34, v26
    v_mul_f32 v26, v26, v63
    v_fma_f32 v27, -v61, v35, v27
    v_mul_f32 v27, v27, v63
    v_cvt_pk_bf16_f32 v44, v26, v27
    v_lshlrev_b32 v26, 16, v44
    v_and_b32 v27, 0xffff0000, v44
    v_mul_f32 v44, v26, v26
    v_fma_f32 v44, v44, s51, v7
    v_mul_f32 v44, v44, v26
    v_exp_f32 v44, v44
    v_mul_f32 v45, v27, v27
    v_fma_f32 v45, v45, s51, v7
    v_mul_f32 v45, v45, v27
    v_exp_f32 v45, v45
    v_add_f32 v44, 1.0, v44
    v_rcp_f32 v44, v44
    v_add_f32 v45, 1.0, v45
    v_rcp_f32 v45, v45
    v_mul_f32 v26, v26, v44
    v_mul_f32 v27, v27, v45
    v_cvt_pk_bf16_f32 v43, v26, v27
    s_lshl_b32 s34, s17, 1
    s_add_u32 s34, s34, 1
    s_mul_i32 s35, s34, 48
    s_add_u32 s35, s35, s29
    s_lshl_b32 s35, s35, 10
    s_add_u32 s35, s35, 0xab00000
    buffer_store_dwordx4 v[40:43], v1, s[4:7], s35 offen sc1
    s_mov_b32 s55, s17
    s_mov_b32 s17, s27
    s_cmp_eq_u32 s28, 0
    s_cbranch_scc1 Lsq_50244
    s_waitcnt vmcnt(0)
    s_lshl_b32 s46, s55, 6
    s_add_u32 s46, s46, 0xb206640
    v_mov_b32 v4, s46
    v_mov_b32 v5, 1
    s_mov_b64 exec, 1
    buffer_atomic_add v5, v4, s[4:7], 0 offen
    s_mov_b64 exec, -1
Lcs_50245:
    s_mov_b32 s55, 64
    s_cmp_ge_u32 s17, s50
    s_cbranch_scc1 Ls_end_50234
    v_add_u32 v8, s17, v0
    v_cmp_gt_u32 vcc, 64, v8
    s_and_b64 s[48:49], vcc, 1
    v_lshlrev_b32 v8, 6, v8
    v_add_u32 v8, 0xb205440, v8
    s_mov_b64 exec, s[48:49]
    s_nop 0
Lwp_50246:
    buffer_load_dword v9, v8, s[4:7], 0 offen sc1
    s_waitcnt vmcnt(0)
    v_cmp_gt_u32 vcc, 20, v9
    s_nop 0
    s_cbranch_vccz Lwpd_50247
    s_sleep 5
    s_add_u32 s30, s30, 1
    s_cmp_lt_u32 s30, s31
    s_cbranch_scc1 Lwp_50246
Lwpd_50247:
    s_mov_b64 exec, -1
    s_mul_i32 s20, s17, 40960
    s_add_u32 s20, s20, 0xa800000
    s_mul_i32 s21, s14, 10240
    s_add_u32 s20, s20, s21
    s_add_u32 s21, s21, 40960
    s_mov_b32 m0, s21
    s_nop 0
    buffer_load_dwordx4 v1, s[4:7], s20 offen offset:0 sc1 lds
    buffer_load_dwordx4 v1, s[4:7], s20 offen offset:1024 sc1 lds
    buffer_load_dwordx4 v1, s[4:7], s20 offen offset:2048 sc1 lds
    buffer_load_dwordx4 v1, s[4:7], s20 offen offset:3072 sc1 lds
    s_add_u32 s20, s20, 4096
    s_add_u32 s21, s21, 4096
    s_mov_b32 m0, s21
    s_nop 0
    buffer_load_dwordx4 v1, s[4:7], s20 offen offset:0 sc1 lds
    buffer_load_dwordx4 v1, s[4:7], s20 offen offset:1024 sc1 lds
    buffer_load_dwordx4 v1, s[4:7], s20 offen offset:2048 sc1 lds
    buffer_load_dwordx4 v1, s[4:7], s20 offen offset:3072 sc1 lds
    s_add_u32 s20, s20, 4096
    s_add_u32 s21, s21, 4096
    s_mov_b32 m0, s21
    s_nop 0
    buffer_load_dwordx4 v1, s[4:7], s20 offen offset:0 sc1 lds
    buffer_load_dwordx4 v1, s[4:7], s20 offen offset:1024 sc1 lds
    v_mul_u32_u24 v124, 640, v3
    v_lshl_add_u32 v124, v2, 3, v124
    s_mul_i32 s25, s17, 5120
    s_add_u32 s25, s25, 0xb180000
    buffer_load_dwordx2 v[96:97], v124, s[4:7], s25 offen offset:0 sc1
    buffer_load_dwordx2 v[98:99], v124, s[4:7], s25 offen offset:128 sc1
    buffer_load_dwordx2 v[100:101], v124, s[4:7], s25 offen offset:256 sc1
    buffer_load_dwordx2 v[102:103], v124, s[4:7], s25 offen offset:384 sc1
    buffer_load_dwordx2 v[104:105], v124, s[4:7], s25 offen offset:512 sc1
    buffer_load_dwordx2 v[106:107], v124, s[4:7], s25 offen offset:2560 sc1
    buffer_load_dwordx2 v[108:109], v124, s[4:7], s25 offen offset:2688 sc1
    buffer_load_dwordx2 v[110:111], v124, s[4:7], s25 offen offset:2816 sc1
    buffer_load_dwordx2 v[112:113], v124, s[4:7], s25 offen offset:2944 sc1
    buffer_load_dwordx2 v[114:115], v124, s[4:7], s25 offen offset:3072 sc1
    s_add_u32 s33, s17, s19
    v_add_u32 v8, s33, v0
    v_cmp_gt_u32 vcc, 64, v8
    s_and_b64 s[48:49], vcc, 1
    v_lshlrev_b32 v8, 6, v8
    v_add_u32 v8, 0xb205440, v8
    buffer_load_dword v9, v8, s[4:7], 0 offen sc1
    s_waitcnt vmcnt(0)
Lsq_50244:
    s_waitcnt vmcnt(2)
    s_barrier
    s_add_u32 s27, s17, s19
    s_mov_b32 s28, 1
    v_add_u32 v92, 40960, v1
    v_add_u32 v93, 65536, v1
    s_cmp_ge_u32 s27, s50
    s_cbranch_scc1 Lsp_50248
    v_cmp_gt_u32 vcc, 20, v9
    s_and_b64 vcc, vcc, s[48:49]
    s_cbranch_scc1 Lsp_50248
    s_mov_b32 s28, 0
    ds_read_b128 v[36:39], v92 offset:0
    ds_read_b128 v[40:43], v92 offset:20480
    ds_read_b128 v[44:47], v92 offset:1024
    ds_read_b128 v[48:51], v92 offset:21504
    ds_read_b128 v[52:55], v92 offset:2048
    s_waitcnt lgkmcnt(4)
    v_mfma_f32_16x16x32_bf16 v[12:15], a[0:3], v[36:39], 0
    s_mul_i32 s20, s27, 40960
    s_add_u32 s20, s20, 0xa800000
    s_mul_i32 s21, s14, 10240
    s_add_u32 s20, s20, s21
    s_add_u32 s21, s21, 0
    s_mov_b32 m0, s21
    s_nop 0
    buffer_load_dwordx4 v1, s[4:7], s20 offen offset:0 sc1 lds
    v_mfma_f32_16x16x32_bf16 v[16:19], a[80:83], v[36:39], 0
    v_add_f32 v96, v96, v98
    v_add_f32 v97, v97, v99
    v_add_f32 v96, v96, v100
    ds_read_b128 v[56:59], v92 offset:22528
    s_waitcnt lgkmcnt(4)
    v_mfma_f32_16x16x32_bf16 v[20:23], a[0:3], v[40:43], 0
    buffer_load_dwordx4 v1, s[4:7], s20 offen offset:1024 sc1 lds
    v_mfma_f32_16x16x32_bf16 v[24:27], a[80:83], v[40:43], 0
    v_add_f32 v97, v97, v101
    v_add_f32 v96, v96, v102
    v_add_f32 v97, v97, v103
    ds_read_b128 v[36:39], v92 offset:3072
    s_waitcnt lgkmcnt(4)
    v_mfma_f32_16x16x32_bf16 v[12:15], a[4:7], v[44:47], v[12:15]
    buffer_load_dwordx4 v1, s[4:7], s20 offen offset:2048 sc1 lds
    v_mfma_f32_16x16x32_bf16 v[16:19], a[84:87], v[44:47], v[16:19]
    v_add_f32 v96, v96, v104
    v_add_f32 v97, v97, v105
    v_mov_b32 v125, v96
    ds_read_b128 v[40:43], v92 offset:23552
    s_waitcnt lgkmcnt(4)
    v_mfma_f32_16x16x32_bf16 v[20:23], a[4:7], v[48:51], v[20:23]
    buffer_load_dwordx4 v1, s[4:7], s20 offen offset:3072 sc1 lds
    v_mfma_f32_16x16x32_bf16 v[24:27], a[84:87], v[48:51], v[24:27]
    v_permlane16_swap_b32 v96, v125
    v_add_f32 v96, v96, v125
    v_mov_b32 v125, v96
    ds_read_b128 v[44:47], v92 offset:4096
    s_waitcnt lgkmcnt(4)
    v_mfma_f32_16x16x32_bf16 v[12:15], a[8:11], v[52:55], v[12:15]
    s_add_u32 s20, s20, 4096
    s_add_u32 s21, s21, 4096
    s_mov_b32 m0, s21
    s_nop 0
    buffer_load_dwordx4 v1, s[4:7], s20 offen offset:0 sc1 lds
    v_mfma_f32_16x16x32_bf16 v[16:19], a[88:91], v[52:55], v[16:19]
    v_permlane32_swap_b32 v96, v125
    v_add_f32 v96, v96, v125
    v_mov_b32 v125, v97
    ds_read_b128 v[48:51], v92 offset:24576
    s_waitcnt lgkmcnt(4)
    v_mfma_f32_16x16x32_bf16 v[20:23], a[8:11], v[56:59], v[20:23]
    buffer_load_dwordx4 v1, s[4:7], s20 offen offset:1024 sc1 lds
    v_mfma_f32_16x16x32_bf16 v[24:27], a[88:91], v[56:59], v[24:27]
    v_permlane16_swap_b32 v97, v125
    v_add_f32 v97, v97, v125
    v_mov_b32 v125, v97
    ds_read_b128 v[52:55], v92 offset:5120
    s_waitcnt lgkmcnt(4)
    v_mfma_f32_16x16x32_bf16 v[12:15], a[12:15], v[36:39], v[12:15]
    buffer_load_dwordx4 v1, s[4:7], s20 offen offset:2048 sc1 lds
    v_mfma_f32_16x16x32_bf16 v[16:19], a[92:95], v[36:39], v[16:19]
    v_permlane32_swap_b32 v97, v125
    v_add_f32 v97, v97, v125
    v_mul_f32 v96, 0x3acccccd, v96
    ds_read_b128 v[56:59], v92 offset:25600
    s_waitcnt lgkmcnt(4)
    v_mfma_f32_16x16x32_bf16 v[20:23], a[12:15], v[40:43], v[20:23]
    buffer_load_dwordx4 v1, s[4:7], s20 offen offset:3072 sc1 lds
    v_mfma_f32_16x16x32_bf16 v[24:27], a[92:95], v[40:43], v[24:27]
    v_mul_f32 v97, 0x3acccccd, v97
    v_fma_f32 v97, -v96, v96, v97
    v_max_f32 v97, 0, v97
    ds_read_b128 v[36:39], v92 offset:6144
    s_waitcnt lgkmcnt(4)
    v_mfma_f32_16x16x32_bf16 v[12:15], a[16:19], v[44:47], v[12:15]
    s_add_u32 s20, s20, 4096
    s_add_u32 s21, s21, 4096
    s_mov_b32 m0, s21
    s_nop 0
    buffer_load_dwordx4 v1, s[4:7], s20 offen offset:0 sc1 lds
    v_mfma_f32_16x16x32_bf16 v[16:19], a[96:99], v[44:47], v[16:19]
    v_mov_b32 v98, v96
    v_cvt_pk_bf16_f32 v98, v98, v98
    v_lshlrev_b32 v98, 16, v98
    ds_read_b128 v[40:43], v92 offset:26624
    s_waitcnt lgkmcnt(4)
    v_mfma_f32_16x16x32_bf16 v[20:23], a[16:19], v[48:51], v[20:23]
    buffer_load_dwordx4 v1, s[4:7], s20 offen offset:1024 sc1 lds
    v_mfma_f32_16x16x32_bf16 v[24:27], a[96:99], v[48:51], v[24:27]
    v_mov_b32 v99, v97
    v_cvt_pk_bf16_f32 v99, v99, v99
    v_lshlrev_b32 v99, 16, v99
    ds_read_b128 v[44:47], v92 offset:7168
    s_waitcnt lgkmcnt(4)
    v_mfma_f32_16x16x32_bf16 v[12:15], a[20:23], v[52:55], v[12:15]
    v_mul_u32_u24 v124, 640, v3
    v_lshl_add_u32 v124, v2, 3, v124
    s_mul_i32 s25, s27, 5120
    s_add_u32 s25, s25, 0xb180000
    buffer_load_dwordx2 v[64:65], v124, s[4:7], s25 offen offset:0 sc1
    v_mfma_f32_16x16x32_bf16 v[16:19], a[100:103], v[52:55], v[16:19]
    v_add_f32 v99, 0x3727c5ac, v99
    v_cvt_pk_bf16_f32 v99, v99, v99
    v_lshlrev_b32 v99, 16, v99
    ds_read_b128 v[48:51], v92 offset:27648
    s_waitcnt lgkmcnt(4)
    v_mfma_f32_16x16x32_bf16 v[20:23], a[20:23], v[56:59], v[20:23]
    buffer_load_dwordx2 v[66:67], v124, s[4:7], s25 offen offset:128 sc1
    v_mfma_f32_16x16x32_bf16 v[24:27], a[100:103], v[56:59], v[24:27]
    v_sqrt_f32 v99, v99
    s_nop 0
    v_cvt_pk_bf16_f32 v99, v99, v99
    v_lshlrev_b32 v99, 16, v99
    ds_read_b128 v[52:55], v92 offset:8192
    s_waitcnt lgkmcnt(4)
    v_mfma_f32_16x16x32_bf16 v[12:15], a[24:27], v[36:39], v[12:15]
    buffer_load_dwordx2 v[68:69], v124, s[4:7], s25 offen offset:256 sc1
    v_mfma_f32_16x16x32_bf16 v[16:19], a[104:107], v[36:39], v[16:19]
    v_rcp_f32 v62, v99
    v_mov_b32 v60, v98
    v_add_f32 v106, v106, v108
    s_cmp_ge_u32 s55, 64
    s_nop 2
    s_cbranch_scc1 Lsd_50250
    s_waitcnt vmcnt(13)
    s_lshl_b32 s46, s55, 6
    s_add_u32 s46, s46, 0xb206640
    v_mov_b32 v4, s46
    v_mov_b32 v5, 1
    s_mov_b64 exec, 1
    buffer_atomic_add v5, v4, s[4:7], 0 offen
    s_mov_b64 exec, -1
Lcs_50251:
    s_mov_b32 s55, 64
Lsd_50250:
    ds_read_b128 v[56:59], v92 offset:28672
    s_waitcnt lgkmcnt(4)
    v_mfma_f32_16x16x32_bf16 v[20:23], a[24:27], v[40:43], v[20:23]
    buffer_load_dwordx2 v[70:71], v124, s[4:7], s25 offen offset:384 sc1
    v_mfma_f32_16x16x32_bf16 v[24:27], a[104:107], v[40:43], v[24:27]
    v_add_f32 v107, v107, v109
    v_add_f32 v106, v106, v110
    v_add_f32 v107, v107, v111
    ds_read_b128 v[36:39], v92 offset:9216
    s_waitcnt lgkmcnt(4)
    v_mfma_f32_16x16x32_bf16 v[12:15], a[28:31], v[44:47], v[12:15]
    buffer_load_dwordx2 v[72:73], v124, s[4:7], s25 offen offset:512 sc1
    v_mfma_f32_16x16x32_bf16 v[16:19], a[108:111], v[44:47], v[16:19]
    v_add_f32 v106, v106, v112
    v_add_f32 v107, v107, v113
    v_add_f32 v106, v106, v114
    ds_read_b128 v[40:43], v92 offset:29696
    s_waitcnt lgkmcnt(4)
    v_mfma_f32_16x16x32_bf16 v[20:23], a[28:31], v[48:51], v[20:23]
    buffer_load_dwordx2 v[74:75], v124, s[4:7], s25 offen offset:2560 sc1
    v_mfma_f32_16x16x32_bf16 v[24:27], a[108:111], v[48:51], v[24:27]
    v_add_f32 v107, v107, v115
    v_mov_b32 v125, v106
    s_nop 1
    v_permlane16_swap_b32 v106, v125
    ds_read_b128 v[44:47], v92 offset:10240
    s_waitcnt lgkmcnt(4)
    v_mfma_f32_16x16x32_bf16 v[12:15], a[32:35], v[52:55], v[12:15]
    buffer_load_dwordx2 v[76:77], v124, s[4:7], s25 offen offset:2688 sc1
    v_mfma_f32_16x16x32_bf16 v[16:19], a[112:115], v[52:55], v[16:19]
    v_add_f32 v106, v106, v125
    v_mov_b32 v125, v106
    s_nop 1
    v_permlane32_swap_b32 v106, v125
    ds_read_b128 v[48:51], v92 offset:30720
    s_waitcnt lgkmcnt(4)
    v_mfma_f32_16x16x32_bf16 v[20:23], a[32:35], v[56:59], v[20:23]
    buffer_load_dwordx2 v[78:79], v124, s[4:7], s25 offen offset:2816 sc1
    v_mfma_f32_16x16x32_bf16 v[24:27], a[112:115], v[56:59], v[24:27]
    v_add_f32 v106, v106, v125
    v_mov_b32 v125, v107
    s_nop 1
    v_permlane16_swap_b32 v107, v125
    ds_read_b128 v[52:55], v92 offset:11264
    s_waitcnt lgkmcnt(4)
    v_mfma_f32_16x16x32_bf16 v[12:15], a[36:39], v[36:39], v[12:15]
    buffer_load_dwordx2 v[80:81], v124, s[4:7], s25 offen offset:2944 sc1
    v_mfma_f32_16x16x32_bf16 v[16:19], a[116:119], v[36:39], v[16:19]
    v_add_f32 v107, v107, v125
    v_mov_b32 v125, v107
    s_nop 1
    v_permlane32_swap_b32 v107, v125
    ds_read_b128 v[56:59], v92 offset:31744
    s_waitcnt lgkmcnt(4)
    v_mfma_f32_16x16x32_bf16 v[20:23], a[36:39], v[40:43], v[20:23]
    buffer_load_dwordx2 v[82:83], v124, s[4:7], s25 offen offset:3072 sc1
    v_mfma_f32_16x16x32_bf16 v[24:27], a[116:119], v[40:43], v[24:27]
    v_add_f32 v107, v107, v125
    v_mul_f32 v106, 0x3acccccd, v106
    v_mul_f32 v107, 0x3acccccd, v107
    ds_read_b128 v[36:39], v92 offset:12288
    s_waitcnt lgkmcnt(4)
    v_mfma_f32_16x16x32_bf16 v[12:15], a[40:43], v[44:47], v[12:15]
    s_add_u32 s33, s27, s19
    v_add_u32 v8, s33, v0
    v_cmp_gt_u32 vcc, 64, v8
    s_and_b64 s[48:49], vcc, 1
    v_lshlrev_b32 v8, 6, v8
    v_add_u32 v8, 0xb205440, v8
    buffer_load_dword v9, v8, s[4:7], 0 offen sc1
    v_mfma_f32_16x16x32_bf16 v[16:19], a[120:123], v[44:47], v[16:19]
    v_fma_f32 v107, -v106, v106, v107
    v_max_f32 v107, 0, v107
    v_mov_b32 v108, v106
    ds_read_b128 v[40:43], v92 offset:32768
    s_waitcnt lgkmcnt(4)
    v_mfma_f32_16x16x32_bf16 v[20:23], a[40:43], v[48:51], v[20:23]
    v_mfma_f32_16x16x32_bf16 v[24:27], a[120:123], v[48:51], v[24:27]
    v_cvt_pk_bf16_f32 v108, v108, v108
    v_lshlrev_b32 v108, 16, v108
    v_mov_b32 v109, v107
    ds_read_b128 v[44:47], v92 offset:13312
    s_waitcnt lgkmcnt(4)
    v_mfma_f32_16x16x32_bf16 v[12:15], a[44:47], v[52:55], v[12:15]
    v_mfma_f32_16x16x32_bf16 v[16:19], a[124:127], v[52:55], v[16:19]
    v_cvt_pk_bf16_f32 v109, v109, v109
    v_lshlrev_b32 v109, 16, v109
    v_add_f32 v109, 0x3727c5ac, v109
    ds_read_b128 v[48:51], v92 offset:33792
    s_waitcnt lgkmcnt(4)
    v_mfma_f32_16x16x32_bf16 v[20:23], a[44:47], v[56:59], v[20:23]
    v_mfma_f32_16x16x32_bf16 v[24:27], a[124:127], v[56:59], v[24:27]
    v_cvt_pk_bf16_f32 v109, v109, v109
    v_lshlrev_b32 v109, 16, v109
    v_sqrt_f32 v109, v109
    ds_read_b128 v[52:55], v92 offset:14336
    s_waitcnt lgkmcnt(4)
    v_mfma_f32_16x16x32_bf16 v[12:15], a[48:51], v[36:39], v[12:15]
    v_mfma_f32_16x16x32_bf16 v[16:19], a[128:131], v[36:39], v[16:19]
    v_cvt_pk_bf16_f32 v109, v109, v109
    v_lshlrev_b32 v109, 16, v109
    v_rcp_f32 v63, v109
    ds_read_b128 v[56:59], v92 offset:34816
    s_waitcnt lgkmcnt(4)
    v_mfma_f32_16x16x32_bf16 v[20:23], a[48:51], v[40:43], v[20:23]
    v_mfma_f32_16x16x32_bf16 v[24:27], a[128:131], v[40:43], v[24:27]
    v_mov_b32 v61, v108
    ds_read_b128 v[36:39], v92 offset:15360
    s_waitcnt lgkmcnt(4)
    v_mfma_f32_16x16x32_bf16 v[12:15], a[52:55], v[44:47], v[12:15]
    v_mfma_f32_16x16x32_bf16 v[16:19], a[132:135], v[44:47], v[16:19]
    ds_read_b128 v[40:43], v92 offset:35840
    s_waitcnt lgkmcnt(4)
    v_mfma_f32_16x16x32_bf16 v[20:23], a[52:55], v[48:51], v[20:23]
    v_mfma_f32_16x16x32_bf16 v[24:27], a[132:135], v[48:51], v[24:27]
    ds_read_b128 v[44:47], v92 offset:16384
    s_waitcnt lgkmcnt(4)
    v_mfma_f32_16x16x32_bf16 v[12:15], a[56:59], v[52:55], v[12:15]
    v_mfma_f32_16x16x32_bf16 v[16:19], a[136:139], v[52:55], v[16:19]
    ds_read_b128 v[48:51], v92 offset:36864
    s_waitcnt lgkmcnt(4)
    v_mfma_f32_16x16x32_bf16 v[20:23], a[56:59], v[56:59], v[20:23]
    v_mfma_f32_16x16x32_bf16 v[24:27], a[136:139], v[56:59], v[24:27]
    ds_read_b128 v[52:55], v92 offset:17408
    s_waitcnt lgkmcnt(4)
    v_mfma_f32_16x16x32_bf16 v[12:15], a[60:63], v[36:39], v[12:15]
    v_mfma_f32_16x16x32_bf16 v[16:19], a[140:143], v[36:39], v[16:19]
    ds_read_b128 v[56:59], v92 offset:37888
    s_waitcnt lgkmcnt(4)
    v_mfma_f32_16x16x32_bf16 v[20:23], a[60:63], v[40:43], v[20:23]
    v_mfma_f32_16x16x32_bf16 v[24:27], a[140:143], v[40:43], v[24:27]
    ds_read_b128 v[36:39], v92 offset:18432
    s_waitcnt lgkmcnt(4)
    v_mfma_f32_16x16x32_bf16 v[12:15], a[64:67], v[44:47], v[12:15]
    v_mfma_f32_16x16x32_bf16 v[16:19], a[144:147], v[44:47], v[16:19]
    ds_read_b128 v[40:43], v92 offset:38912
    s_waitcnt lgkmcnt(4)
    v_mfma_f32_16x16x32_bf16 v[20:23], a[64:67], v[48:51], v[20:23]
    v_mfma_f32_16x16x32_bf16 v[24:27], a[144:147], v[48:51], v[24:27]
    ds_read_b128 v[44:47], v92 offset:19456
    s_waitcnt lgkmcnt(4)
    v_mfma_f32_16x16x32_bf16 v[12:15], a[68:71], v[52:55], v[12:15]
    v_mfma_f32_16x16x32_bf16 v[16:19], a[148:151], v[52:55], v[16:19]
    ds_read_b128 v[48:51], v92 offset:39936
    s_waitcnt lgkmcnt(4)
    v_mfma_f32_16x16x32_bf16 v[20:23], a[68:71], v[56:59], v[20:23]
    v_mfma_f32_16x16x32_bf16 v[24:27], a[148:151], v[56:59], v[24:27]
    s_waitcnt lgkmcnt(3)
    v_mfma_f32_16x16x32_bf16 v[12:15], a[72:75], v[36:39], v[12:15]
    v_mfma_f32_16x16x32_bf16 v[16:19], a[152:155], v[36:39], v[16:19]
    s_waitcnt lgkmcnt(2)
    v_mfma_f32_16x16x32_bf16 v[20:23], a[72:75], v[40:43], v[20:23]
    v_mfma_f32_16x16x32_bf16 v[24:27], a[152:155], v[40:43], v[24:27]
    s_waitcnt lgkmcnt(1)
    v_mfma_f32_16x16x32_bf16 v[12:15], a[76:79], v[44:47], v[12:15]
    v_mfma_f32_16x16x32_bf16 v[16:19], a[156:159], v[44:47], v[16:19]
    s_waitcnt lgkmcnt(0)
    v_mfma_f32_16x16x32_bf16 v[20:23], a[76:79], v[48:51], v[20:23]
    v_mfma_f32_16x16x32_bf16 v[24:27], a[156:159], v[48:51], v[24:27]
    s_nop 6
    s_branch Lsj_50249
Lsp_50248:
    ds_read_b128 v[36:39], v92 offset:0
    ds_read_b128 v[40:43], v92 offset:20480
    ds_read_b128 v[44:47], v92 offset:1024
    ds_read_b128 v[48:51], v92 offset:21504
    ds_read_b128 v[52:55], v92 offset:2048
    s_waitcnt lgkmcnt(4)
    v_mfma_f32_16x16x32_bf16 v[12:15], a[0:3], v[36:39], 0
    v_mfma_f32_16x16x32_bf16 v[16:19], a[80:83], v[36:39], 0
    v_add_f32 v96, v96, v98
    v_add_f32 v97, v97, v99
    v_add_f32 v96, v96, v100
    ds_read_b128 v[56:59], v92 offset:22528
    s_waitcnt lgkmcnt(4)
    v_mfma_f32_16x16x32_bf16 v[20:23], a[0:3], v[40:43], 0
    v_mfma_f32_16x16x32_bf16 v[24:27], a[80:83], v[40:43], 0
    v_add_f32 v97, v97, v101
    v_add_f32 v96, v96, v102
    v_add_f32 v97, v97, v103
    ds_read_b128 v[36:39], v92 offset:3072
    s_waitcnt lgkmcnt(4)
    v_mfma_f32_16x16x32_bf16 v[12:15], a[4:7], v[44:47], v[12:15]
    v_mfma_f32_16x16x32_bf16 v[16:19], a[84:87], v[44:47], v[16:19]
    v_add_f32 v96, v96, v104
    v_add_f32 v97, v97, v105
    v_mov_b32 v125, v96
    ds_read_b128 v[40:43], v92 offset:23552
    s_waitcnt lgkmcnt(4)
    v_mfma_f32_16x16x32_bf16 v[20:23], a[4:7], v[48:51], v[20:23]
    v_mfma_f32_16x16x32_bf16 v[24:27], a[84:87], v[48:51], v[24:27]
    v_permlane16_swap_b32 v96, v125
    v_add_f32 v96, v96, v125
    v_mov_b32 v125, v96
    ds_read_b128 v[44:47], v92 offset:4096
    s_waitcnt lgkmcnt(4)
    v_mfma_f32_16x16x32_bf16 v[12:15], a[8:11], v[52:55], v[12:15]
    v_mfma_f32_16x16x32_bf16 v[16:19], a[88:91], v[52:55], v[16:19]
    v_permlane32_swap_b32 v96, v125
    v_add_f32 v96, v96, v125
    v_mov_b32 v125, v97
    ds_read_b128 v[48:51], v92 offset:24576
    s_waitcnt lgkmcnt(4)
    v_mfma_f32_16x16x32_bf16 v[20:23], a[8:11], v[56:59], v[20:23]
    v_mfma_f32_16x16x32_bf16 v[24:27], a[88:91], v[56:59], v[24:27]
    v_permlane16_swap_b32 v97, v125
    v_add_f32 v97, v97, v125
    v_mov_b32 v125, v97
    ds_read_b128 v[52:55], v92 offset:5120
    s_waitcnt lgkmcnt(4)
    v_mfma_f32_16x16x32_bf16 v[12:15], a[12:15], v[36:39], v[12:15]
    v_mfma_f32_16x16x32_bf16 v[16:19], a[92:95], v[36:39], v[16:19]
    v_permlane32_swap_b32 v97, v125
    v_add_f32 v97, v97, v125
    v_mul_f32 v96, 0x3acccccd, v96
    ds_read_b128 v[56:59], v92 offset:25600
    s_waitcnt lgkmcnt(4)
    v_mfma_f32_16x16x32_bf16 v[20:23], a[12:15], v[40:43], v[20:23]
    v_mfma_f32_16x16x32_bf16 v[24:27], a[92:95], v[40:43], v[24:27]
    v_mul_f32 v97, 0x3acccccd, v97
    v_fma_f32 v97, -v96, v96, v97
    v_max_f32 v97, 0, v97
    ds_read_b128 v[36:39], v92 offset:6144
    s_waitcnt lgkmcnt(4)
    v_mfma_f32_16x16x32_bf16 v[12:15], a[16:19], v[44:47], v[12:15]
    v_mfma_f32_16x16x32_bf16 v[16:19], a[96:99], v[44:47], v[16:19]
    v_mov_b32 v98, v96
    v_cvt_pk_bf16_f32 v98, v98, v98
    v_lshlrev_b32 v98, 16, v98
    ds_read_b128 v[40:43], v92 offset:26624
    s_waitcnt lgkmcnt(4)
    v_mfma_f32_16x16x32_bf16 v[20:23], a[16:19], v[48:51], v[20:23]
    v_mfma_f32_16x16x32_bf16 v[24:27], a[96:99], v[48:51], v[24:27]
    v_mov_b32 v99, v97
    v_cvt_pk_bf16_f32 v99, v99, v99
    v_lshlrev_b32 v99, 16, v99
    ds_read_b128 v[44:47], v92 offset:7168
    s_waitcnt lgkmcnt(4)
    v_mfma_f32_16x16x32_bf16 v[12:15], a[20:23], v[52:55], v[12:15]
    v_mfma_f32_16x16x32_bf16 v[16:19], a[100:103], v[52:55], v[16:19]
    v_add_f32 v99, 0x3727c5ac, v99
    v_cvt_pk_bf16_f32 v99, v99, v99
    v_lshlrev_b32 v99, 16, v99
    ds_read_b128 v[48:51], v92 offset:27648
    s_waitcnt lgkmcnt(4)
    v_mfma_f32_16x16x32_bf16 v[20:23], a[20:23], v[56:59], v[20:23]
    v_mfma_f32_16x16x32_bf16 v[24:27], a[100:103], v[56:59], v[24:27]
    v_sqrt_f32 v99, v99
    s_nop 0
    v_cvt_pk_bf16_f32 v99, v99, v99
    v_lshlrev_b32 v99, 16, v99
    ds_read_b128 v[52:55], v92 offset:8192
    s_waitcnt lgkmcnt(4)
    v_mfma_f32_16x16x32_bf16 v[12:15], a[24:27], v[36:39], v[12:15]
    v_mfma_f32_16x16x32_bf16 v[16:19], a[104:107], v[36:39], v[16:19]
    v_rcp_f32 v62, v99
    v_mov_b32 v60, v98
    v_add_f32 v106, v106, v108
    s_cmp_ge_u32 s55, 64
    s_nop 2
    s_cbranch_scc1 Lsd_50252
    s_waitcnt vmcnt(0)
    s_lshl_b32 s46, s55, 6
    s_add_u32 s46, s46, 0xb206640
    v_mov_b32 v4, s46
    v_mov_b32 v5, 1
    s_mov_b64 exec, 1
    buffer_atomic_add v5, v4, s[4:7], 0 offen
    s_mov_b64 exec, -1
Lcs_50253:
    s_mov_b32 s55, 64
Lsd_50252:
    ds_read_b128 v[56:59], v92 offset:28672
    s_waitcnt lgkmcnt(4)
    v_mfma_f32_16x16x32_bf16 v[20:23], a[24:27], v[40:43], v[20:23]
    v_mfma_f32_16x16x32_bf16 v[24:27], a[104:107], v[40:43], v[24:27]
    v_add_f32 v107, v107, v109
    v_add_f32 v106, v106, v110
    v_add_f32 v107, v107, v111
    ds_read_b128 v[36:39], v92 offset:9216
    s_waitcnt lgkmcnt(4)
    v_mfma_f32_16x16x32_bf16 v[12:15], a[28:31], v[44:47], v[12:15]
    v_mfma_f32_16x16x32_bf16 v[16:19], a[108:111], v[44:47], v[16:19]
    v_add_f32 v106, v106, v112
    v_add_f32 v107, v107, v113
    v_add_f32 v106, v106, v114
    ds_read_b128 v[40:43], v92 offset:29696
    s_waitcnt lgkmcnt(4)
    v_mfma_f32_16x16x32_bf16 v[20:23], a[28:31], v[48:51], v[20:23]
    v_mfma_f32_16x16x32_bf16 v[24:27], a[108:111], v[48:51], v[24:27]
    v_add_f32 v107, v107, v115
    v_mov_b32 v125, v106
    s_nop 1
    v_permlane16_swap_b32 v106, v125
    ds_read_b128 v[44:47], v92 offset:10240
    s_waitcnt lgkmcnt(4)
    v_mfma_f32_16x16x32_bf16 v[12:15], a[32:35], v[52:55], v[12:15]
    v_mfma_f32_16x16x32_bf16 v[16:19], a[112:115], v[52:55], v[16:19]
    v_add_f32 v106, v106, v125
    v_mov_b32 v125, v106
    s_nop 1
    v_permlane32_swap_b32 v106, v125
    ds_read_b128 v[48:51], v92 offset:30720
    s_waitcnt lgkmcnt(4)
    v_mfma_f32_16x16x32_bf16 v[20:23], a[32:35], v[56:59], v[20:23]
    v_mfma_f32_16x16x32_bf16 v[24:27], a[112:115], v[56:59], v[24:27]
    v_add_f32 v106, v106, v125
    v_mov_b32 v125, v107
    s_nop 1
    v_permlane16_swap_b32 v107, v125
    ds_read_b128 v[52:55], v92 offset:11264
    s_waitcnt lgkmcnt(4)
    v_mfma_f32_16x16x32_bf16 v[12:15], a[36:39], v[36:39], v[12:15]
    v_mfma_f32_16x16x32_bf16 v[16:19], a[116:119], v[36:39], v[16:19]
    v_add_f32 v107, v107, v125
    v_mov_b32 v125, v107
    s_nop 1
    v_permlane32_swap_b32 v107, v125
    ds_read_b128 v[56:59], v92 offset:31744
    s_waitcnt lgkmcnt(4)
    v_mfma_f32_16x16x32_bf16 v[20:23], a[36:39], v[40:43], v[20:23]
    v_mfma_f32_16x16x32_bf16 v[24:27], a[116:119], v[40:43], v[24:27]
    v_add_f32 v107, v107, v125
    v_mul_f32 v106, 0x3acccccd, v106
    v_mul_f32 v107, 0x3acccccd, v107
    ds_read_b128 v[36:39], v92 offset:12288
    s_waitcnt lgkmcnt(4)
    v_mfma_f32_16x16x32_bf16 v[12:15], a[40:43], v[44:47], v[12:15]
    v_mfma_f32_16x16x32_bf16 v[16:19], a[120:123], v[44:47], v[16:19]
    v_fma_f32 v107, -v106, v106, v107
    v_max_f32 v107, 0, v107
    v_mov_b32 v108, v106
    ds_read_b128 v[40:43], v92 offset:32768
    s_waitcnt lgkmcnt(4)
    v_mfma_f32_16x16x32_bf16 v[20:23], a[40:43], v[48:51], v[20:23]
    v_mfma_f32_16x16x32_bf16 v[24:27], a[120:123], v[48:51], v[24:27]
    v_cvt_pk_bf16_f32 v108, v108, v108
    v_lshlrev_b32 v108, 16, v108
    v_mov_b32 v109, v107
    ds_read_b128 v[44:47], v92 offset:13312
    s_waitcnt lgkmcnt(4)
    v_mfma_f32_16x16x32_bf16 v[12:15], a[44:47], v[52:55], v[12:15]
    v_mfma_f32_16x16x32_bf16 v[16:19], a[124:127], v[52:55], v[16:19]
    v_cvt_pk_bf16_f32 v109, v109, v109
    v_lshlrev_b32 v109, 16, v109
    v_add_f32 v109, 0x3727c5ac, v109
    ds_read_b128 v[48:51], v92 offset:33792
    s_waitcnt lgkmcnt(4)
    v_mfma_f32_16x16x32_bf16 v[20:23], a[44:47], v[56:59], v[20:23]
    v_mfma_f32_16x16x32_bf16 v[24:27], a[124:127], v[56:59], v[24:27]
    v_cvt_pk_bf16_f32 v109, v109, v109
    v_lshlrev_b32 v109, 16, v109
    v_sqrt_f32 v109, v109
    ds_read_b128 v[52:55], v92 offset:14336
    s_waitcnt lgkmcnt(4)
    v_mfma_f32_16x16x32_bf16 v[12:15], a[48:51], v[36:39], v[12:15]
    v_mfma_f32_16x16x32_bf16 v[16:19], a[128:131], v[36:39], v[16:19]
    v_cvt_pk_bf16_f32 v109, v109, v109
    v_lshlrev_b32 v109, 16, v109
    v_rcp_f32 v63, v109
    ds_read_b128 v[56:59], v92 offset:34816
    s_waitcnt lgkmcnt(4)
    v_mfma_f32_16x16x32_bf16 v[20:23], a[48:51], v[40:43], v[20:23]
    v_mfma_f32_16x16x32_bf16 v[24:27], a[128:131], v[40:43], v[24:27]
    v_mov_b32 v61, v108
    ds_read_b128 v[36:39], v92 offset:15360
    s_waitcnt lgkmcnt(4)
    v_mfma_f32_16x16x32_bf16 v[12:15], a[52:55], v[44:47], v[12:15]
    v_mfma_f32_16x16x32_bf16 v[16:19], a[132:135], v[44:47], v[16:19]
    ds_read_b128 v[40:43], v92 offset:35840
    s_waitcnt lgkmcnt(4)
    v_mfma_f32_16x16x32_bf16 v[20:23], a[52:55], v[48:51], v[20:23]
    v_mfma_f32_16x16x32_bf16 v[24:27], a[132:135], v[48:51], v[24:27]
    ds_read_b128 v[44:47], v92 offset:16384
    s_waitcnt lgkmcnt(4)
    v_mfma_f32_16x16x32_bf16 v[12:15], a[56:59], v[52:55], v[12:15]
    v_mfma_f32_16x16x32_bf16 v[16:19], a[136:139], v[52:55], v[16:19]
    ds_read_b128 v[48:51], v92 offset:36864
    s_waitcnt lgkmcnt(4)
    v_mfma_f32_16x16x32_bf16 v[20:23], a[56:59], v[56:59], v[20:23]
    v_mfma_f32_16x16x32_bf16 v[24:27], a[136:139], v[56:59], v[24:27]
    ds_read_b128 v[52:55], v92 offset:17408
    s_waitcnt lgkmcnt(4)
    v_mfma_f32_16x16x32_bf16 v[12:15], a[60:63], v[36:39], v[12:15]
    v_mfma_f32_16x16x32_bf16 v[16:19], a[140:143], v[36:39], v[16:19]
    ds_read_b128 v[56:59], v92 offset:37888
    s_waitcnt lgkmcnt(4)
    v_mfma_f32_16x16x32_bf16 v[20:23], a[60:63], v[40:43], v[20:23]
    v_mfma_f32_16x16x32_bf16 v[24:27], a[140:143], v[40:43], v[24:27]
    ds_read_b128 v[36:39], v92 offset:18432
    s_waitcnt lgkmcnt(4)
    v_mfma_f32_16x16x32_bf16 v[12:15], a[64:67], v[44:47], v[12:15]
    v_mfma_f32_16x16x32_bf16 v[16:19], a[144:147], v[44:47], v[16:19]
    ds_read_b128 v[40:43], v92 offset:38912
    s_waitcnt lgkmcnt(4)
    v_mfma_f32_16x16x32_bf16 v[20:23], a[64:67], v[48:51], v[20:23]
    v_mfma_f32_16x16x32_bf16 v[24:27], a[144:147], v[48:51], v[24:27]
    ds_read_b128 v[44:47], v92 offset:19456
    s_waitcnt lgkmcnt(4)
    v_mfma_f32_16x16x32_bf16 v[12:15], a[68:71], v[52:55], v[12:15]
    v_mfma_f32_16x16x32_bf16 v[16:19], a[148:151], v[52:55], v[16:19]
    ds_read_b128 v[48:51], v92 offset:39936
    s_waitcnt lgkmcnt(4)
    v_mfma_f32_16x16x32_bf16 v[20:23], a[68:71], v[56:59], v[20:23]
    v_mfma_f32_16x16x32_bf16 v[24:27], a[148:151], v[56:59], v[24:27]
    s_waitcnt lgkmcnt(3)
    v_mfma_f32_16x16x32_bf16 v[12:15], a[72:75], v[36:39], v[12:15]
    v_mfma_f32_16x16x32_bf16 v[16:19], a[152:155], v[36:39], v[16:19]
    s_waitcnt lgkmcnt(2)
    v_mfma_f32_16x16x32_bf16 v[20:23], a[72:75], v[40:43], v[20:23]
    v_mfma_f32_16x16x32_bf16 v[24:27], a[152:155], v[40:43], v[24:27]
    s_waitcnt lgkmcnt(1)
    v_mfma_f32_16x16x32_bf16 v[12:15], a[76:79], v[44:47], v[12:15]
    v_mfma_f32_16x16x32_bf16 v[16:19], a[156:159], v[44:47], v[16:19]
    s_waitcnt lgkmcnt(0)
    v_mfma_f32_16x16x32_bf16 v[20:23], a[76:79], v[48:51], v[20:23]
    v_mfma_f32_16x16x32_bf16 v[24:27], a[156:159], v[48:51], v[24:27]
    s_nop 7
Lsj_50249:
    v_fma_f32 v12, -v60, v28, v12
    v_mul_f32 v12, v12, v62
    v_fma_f32 v13, -v60, v29, v13
    v_mul_f32 v13, v13, v62
    v_cvt_pk_bf16_f32 v44, v12, v13
    v_lshlrev_b32 v12, 16, v44
    v_and_b32 v13, 0xffff0000, v44
    v_mul_f32 v44, v12, v12
    v_fma_f32 v44, v44, s51, v7
    v_mul_f32 v44, v44, v12
    v_exp_f32 v44, v44
    v_mul_f32 v45, v13, v13
    v_fma_f32 v45, v45, s51, v7
    v_mul_f32 v45, v45, v13
    v_exp_f32 v45, v45
    v_add_f32 v44, 1.0, v44
    v_rcp_f32 v44, v44
    v_add_f32 v45, 1.0, v45
    v_rcp_f32 v45, v45
    v_mul_f32 v12, v12, v44
    v_mul_f32 v13, v13, v45
    v_cvt_pk_bf16_f32 v36, v12, v13
    v_fma_f32 v14, -v60, v30, v14
    v_mul_f32 v14, v14, v62
    v_fma_f32 v15, -v60, v31, v15
    v_mul_f32 v15, v15, v62
    v_cvt_pk_bf16_f32 v44, v14, v15
    v_lshlrev_b32 v14, 16, v44
    v_and_b32 v15, 0xffff0000, v44
    v_mul_f32 v44, v14, v14
    v_fma_f32 v44, v44, s51, v7
    v_mul_f32 v44, v44, v14
    v_exp_f32 v44, v44
    v_mul_f32 v45, v15, v15
    v_fma_f32 v45, v45, s51, v7
    v_mul_f32 v45, v45, v15
    v_exp_f32 v45, v45
    v_add_f32 v44, 1.0, v44
    v_rcp_f32 v44, v44
    v_add_f32 v45, 1.0, v45
    v_rcp_f32 v45, v45
    v_mul_f32 v14, v14, v44
    v_mul_f32 v15, v15, v45
    v_cvt_pk_bf16_f32 v37, v14, v15
    v_fma_f32 v16, -v60, v32, v16
    v_mul_f32 v16, v16, v62
    v_fma_f32 v17, -v60, v33, v17
    v_mul_f32 v17, v17, v62
    v_cvt_pk_bf16_f32 v44, v16, v17
    v_lshlrev_b32 v16, 16, v44
    v_and_b32 v17, 0xffff0000, v44
    v_mul_f32 v44, v16, v16
    v_fma_f32 v44, v44, s51, v7
    v_mul_f32 v44, v44, v16
    v_exp_f32 v44, v44
    v_mul_f32 v45, v17, v17
    v_fma_f32 v45, v45, s51, v7
    v_mul_f32 v45, v45, v17
    v_exp_f32 v45, v45
    v_add_f32 v44, 1.0, v44
    v_rcp_f32 v44, v44
    v_add_f32 v45, 1.0, v45
    v_rcp_f32 v45, v45
    v_mul_f32 v16, v16, v44
    v_mul_f32 v17, v17, v45
    v_cvt_pk_bf16_f32 v38, v16, v17
    v_fma_f32 v18, -v60, v34, v18
    v_mul_f32 v18, v18, v62
    v_fma_f32 v19, -v60, v35, v19
    v_mul_f32 v19, v19, v62
    v_cvt_pk_bf16_f32 v44, v18, v19
    v_lshlrev_b32 v18, 16, v44
    v_and_b32 v19, 0xffff0000, v44
    v_mul_f32 v44, v18, v18
    v_fma_f32 v44, v44, s51, v7
    v_mul_f32 v44, v44, v18
    v_exp_f32 v44, v44
    v_mul_f32 v45, v19, v19
    v_fma_f32 v45, v45, s51, v7
    v_mul_f32 v45, v45, v19
    v_exp_f32 v45, v45
    v_add_f32 v44, 1.0, v44
    v_rcp_f32 v44, v44
    v_add_f32 v45, 1.0, v45
    v_rcp_f32 v45, v45
    v_mul_f32 v18, v18, v44
    v_mul_f32 v19, v19, v45
    v_cvt_pk_bf16_f32 v39, v18, v19
    s_lshl_b32 s34, s17, 1
    s_add_u32 s34, s34, 0
    s_mul_i32 s35, s34, 48
    s_add_u32 s35, s35, s29
    s_lshl_b32 s35, s35, 10
    s_add_u32 s35, s35, 0xab00000
    buffer_store_dwordx4 v[36:39], v1, s[4:7], s35 offen sc1
    v_fma_f32 v20, -v61, v28, v20
    v_mul_f32 v20, v20, v63
    v_fma_f32 v21, -v61, v29, v21
    v_mul_f32 v21, v21, v63
    v_cvt_pk_bf16_f32 v44, v20, v21
    v_lshlrev_b32 v20, 16, v44
    v_and_b32 v21, 0xffff0000, v44
    v_mul_f32 v44, v20, v20
    v_fma_f32 v44, v44, s51, v7
    v_mul_f32 v44, v44, v20
    v_exp_f32 v44, v44
    v_mul_f32 v45, v21, v21
    v_fma_f32 v45, v45, s51, v7
    v_mul_f32 v45, v45, v21
    v_exp_f32 v45, v45
    v_add_f32 v44, 1.0, v44
    v_rcp_f32 v44, v44
    v_add_f32 v45, 1.0, v45
    v_rcp_f32 v45, v45
    v_mul_f32 v20, v20, v44
    v_mul_f32 v21, v21, v45
    v_cvt_pk_bf16_f32 v40, v20, v21
    v_fma_f32 v22, -v61, v30, v22
    v_mul_f32 v22, v22, v63
    v_fma_f32 v23, -v61, v31, v23
    v_mul_f32 v23, v23, v63
    v_cvt_pk_bf16_f32 v44, v22, v23
    v_lshlrev_b32 v22, 16, v44
    v_and_b32 v23, 0xffff0000, v44
    v_mul_f32 v44, v22, v22
    v_fma_f32 v44, v44, s51, v7
    v_mul_f32 v44, v44, v22
    v_exp_f32 v44, v44
    v_mul_f32 v45, v23, v23
    v_fma_f32 v45, v45, s51, v7
    v_mul_f32 v45, v45, v23
    v_exp_f32 v45, v45
    v_add_f32 v44, 1.0, v44
    v_rcp_f32 v44, v44
    v_add_f32 v45, 1.0, v45
    v_rcp_f32 v45, v45
    v_mul_f32 v22, v22, v44
    v_mul_f32 v23, v23, v45
    v_cvt_pk_bf16_f32 v41, v22, v23
    v_fma_f32 v24, -v61, v32, v24
    v_mul_f32 v24, v24, v63
    v_fma_f32 v25, -v61, v33, v25
    v_mul_f32 v25, v25, v63
    v_cvt_pk_bf16_f32 v44, v24, v25
    v_lshlrev_b32 v24, 16, v44
    v_and_b32 v25, 0xffff0000, v44
    v_mul_f32 v44, v24, v24
    v_fma_f32 v44, v44, s51, v7
    v_mul_f32 v44, v44, v24
    v_exp_f32 v44, v44
    v_mul_f32 v45, v25, v25
    v_fma_f32 v45, v45, s51, v7
    v_mul_f32 v45, v45, v25
    v_exp_f32 v45, v45
    v_add_f32 v44, 1.0, v44
    v_rcp_f32 v44, v44
    v_add_f32 v45, 1.0, v45
    v_rcp_f32 v45, v45
    v_mul_f32 v24, v24, v44
    v_mul_f32 v25, v25, v45
    v_cvt_pk_bf16_f32 v42, v24, v25
    v_fma_f32 v26, -v61, v34, v26
    v_mul_f32 v26, v26, v63
    v_fma_f32 v27, -v61, v35, v27
    v_mul_f32 v27, v27, v63
    v_cvt_pk_bf16_f32 v44, v26, v27
    v_lshlrev_b32 v26, 16, v44
    v_and_b32 v27, 0xffff0000, v44
    v_mul_f32 v44, v26, v26
    v_fma_f32 v44, v44, s51, v7
    v_mul_f32 v44, v44, v26
    v_exp_f32 v44, v44
    v_mul_f32 v45, v27, v27
    v_fma_f32 v45, v45, s51, v7
    v_mul_f32 v45, v45, v27
    v_exp_f32 v45, v45
    v_add_f32 v44, 1.0, v44
    v_rcp_f32 v44, v44
    v_add_f32 v45, 1.0, v45
    v_rcp_f32 v45, v45
    v_mul_f32 v26, v26, v44
    v_mul_f32 v27, v27, v45
    v_cvt_pk_bf16_f32 v43, v26, v27
    s_lshl_b32 s34, s17, 1
    s_add_u32 s34, s34, 1
    s_mul_i32 s35, s34, 48
    s_add_u32 s35, s35, s29
    s_lshl_b32 s35, s35, 10
    s_add_u32 s35, s35, 0xab00000
    buffer_store_dwordx4 v[40:43], v1, s[4:7], s35 offen sc1
    s_mov_b32 s55, s17
    s_mov_b32 s17, s27
    s_cmp_eq_u32 s28, 0
    s_cbranch_scc1 Lsq_50254
    s_waitcnt vmcnt(0)
    s_lshl_b32 s46, s55, 6
    s_add_u32 s46, s46, 0xb206640
    v_mov_b32 v4, s46
    v_mov_b32 v5, 1
    s_mov_b64 exec, 1
    buffer_atomic_add v5, v4, s[4:7], 0 offen
    s_mov_b64 exec, -1
Lcs_50255:
    s_mov_b32 s55, 64
    s_cmp_ge_u32 s17, s50
    s_cbranch_scc1 Ls_end_50234
    v_add_u32 v8, s17, v0
    v_cmp_gt_u32 vcc, 64, v8
    s_and_b64 s[48:49], vcc, 1
    v_lshlrev_b32 v8, 6, v8
    v_add_u32 v8, 0xb205440, v8
    s_mov_b64 exec, s[48:49]
    s_nop 0
Lwp_50256:
    buffer_load_dword v9, v8, s[4:7], 0 offen sc1
    s_waitcnt vmcnt(0)
    v_cmp_gt_u32 vcc, 20, v9
    s_nop 0
    s_cbranch_vccz Lwpd_50257
    s_sleep 5
    s_add_u32 s30, s30, 1
    s_cmp_lt_u32 s30, s31
    s_cbranch_scc1 Lwp_50256
Lwpd_50257:
    s_mov_b64 exec, -1
    s_mul_i32 s20, s17, 40960
    s_add_u32 s20, s20, 0xa800000
    s_mul_i32 s21, s14, 10240
    s_add_u32 s20, s20, s21
    s_add_u32 s21, s21, 0
    s_mov_b32 m0, s21
    s_nop 0
    buffer_load_dwordx4 v1, s[4:7], s20 offen offset:0 sc1 lds
    buffer_load_dwordx4 v1, s[4:7], s20 offen offset:1024 sc1 lds
    buffer_load_dwordx4 v1, s[4:7], s20 offen offset:2048 sc1 lds
    buffer_load_dwordx4 v1, s[4:7], s20 offen offset:3072 sc1 lds
    s_add_u32 s20, s20, 4096
    s_add_u32 s21, s21, 4096
    s_mov_b32 m0, s21
    s_nop 0
    buffer_load_dwordx4 v1, s[4:7], s20 offen offset:0 sc1 lds
    buffer_load_dwordx4 v1, s[4:7], s20 offen offset:1024 sc1 lds
    buffer_load_dwordx4 v1, s[4:7], s20 offen offset:2048 sc1 lds
    buffer_load_dwordx4 v1, s[4:7], s20 offen offset:3072 sc1 lds
    s_add_u32 s20, s20, 4096
    s_add_u32 s21, s21, 4096
    s_mov_b32 m0, s21
    s_nop 0
    buffer_load_dwordx4 v1, s[4:7], s20 offen offset:0 sc1 lds
    buffer_load_dwordx4 v1, s[4:7], s20 offen offset:1024 sc1 lds
    v_mul_u32_u24 v124, 640, v3
    v_lshl_add_u32 v124, v2, 3, v124
    s_mul_i32 s25, s17, 5120
    s_add_u32 s25, s25, 0xb180000
    buffer_load_dwordx2 v[64:65], v124, s[4:7], s25 offen offset:0 sc1
    buffer_load_dwordx2 v[66:67], v124, s[4:7], s25 offen offset:128 sc1
    buffer_load_dwordx2 v[68:69], v124, s[4:7], s25 offen offset:256 sc1
    buffer_load_dwordx2 v[70:71], v124, s[4:7], s25 offen offset:384 sc1
    buffer_load_dwordx2 v[72:73], v124, s[4:7], s25 offen offset:512 sc1
    buffer_load_dwordx2 v[74:75], v124, s[4:7], s25 offen offset:2560 sc1
    buffer_load_dwordx2 v[76:77], v124, s[4:7], s25 offen offset:2688 sc1
    buffer_load_dwordx2 v[78:79], v124, s[4:7], s25 offen offset:2816 sc1
    buffer_load_dwordx2 v[80:81], v124, s[4:7], s25 offen offset:2944 sc1
    buffer_load_dwordx2 v[82:83], v124, s[4:7], s25 offen offset:3072 sc1
    s_add_u32 s33, s17, s19
    v_add_u32 v8, s33, v0
    v_cmp_gt_u32 vcc, 64, v8
    s_and_b64 s[48:49], vcc, 1
    v_lshlrev_b32 v8, 6, v8
    v_add_u32 v8, 0xb205440, v8
    buffer_load_dword v9, v8, s[4:7], 0 offen sc1
    s_waitcnt vmcnt(0)
Lsq_50254:
    s_branch Ls_loop_50235
Ls_end_50234:
    s_branch Lmain_end
Lph_d4:
    s_sub_u32 s20, s26, 55
    s_mul_i32 s17, s20, 0x3334
    s_lshr_b32 s17, s17, 16
    s_mul_i32 s18, s17, 5
    s_sub_u32 s18, s20, s18
    s_mov_b32 s19, 3
Lph_d4b:
    s_mov_b32 s8, s60
    s_and_b32 s9, s61, 0xffff
    s_mov_b32 s10, 0x280000
    s_mov_b32 s11, 0x20000
    v_lshlrev_b32 v1, 4, v0
    v_and_b32 v2, 15, v0
    v_lshrrev_b32 v3, 4, v0
    s_lshl_b32 s29, s18, 2
    s_add_u32 s29, s29, s14
    s_mul_i32 s23, s29, 98304
    s_add_u32 s23, s23, 0xbe00000
    buffer_load_dwordx4 a[0:3], v1, s[4:7], s23 offen offset:0 sc1
    buffer_load_dwordx4 a[4:7], v1, s[4:7], s23 offen offset:1024 sc1
    buffer_load_dwordx4 a[8:11], v1, s[4:7], s23 offen offset:2048 sc1
    buffer_load_dwordx4 a[12:15], v1, s[4:7], s23 offen offset:3072 sc1
    s_add_u32 s23, s23, 4096
    buffer_load_dwordx4 a[16:19], v1, s[4:7], s23 offen offset:0 sc1
    buffer_load_dwordx4 a[20:23], v1, s[4:7], s23 offen offset:1024 sc1
    buffer_load_dwordx4 a[24:27], v1, s[4:7], s23 offen offset:2048 sc1
    buffer_load_dwordx4 a[28:31], v1, s[4:7], s23 offen offset:3072 sc1
    s_add_u32 s23, s23, 4096
    buffer_load_dwordx4 a[32:35], v1, s[4:7], s23 offen offset:0 sc1
    buffer_load_dwordx4 a[36:39], v1, s[4:7], s23 offen offset:1024 sc1
    buffer_load_dwordx4 a[40:43], v1, s[4:7], s23 offen offset:2048 sc1
    buffer_load_dwordx4 a[44:47], v1, s[4:7], s23 offen offset:3072 sc1
    s_add_u32 s23, s23, 4096
    buffer_load_dwordx4 a[48:51], v1, s[4:7], s23 offen offset:0 sc1
    buffer_load_dwordx4 a[52:55], v1, s[4:7], s23 offen offset:1024 sc1
    buffer_load_dwordx4 a[56:59], v1, s[4:7], s23 offen offset:2048 sc1
    buffer_load_dwordx4 a[60:63], v1, s[4:7], s23 offen offset:3072 sc1
    s_add_u32 s23, s23, 4096
    buffer_load_dwordx4 a[64:67], v1, s[4:7], s23 offen offset:0 sc1
    buffer_load_dwordx4 a[68:71], v1, s[4:7], s23 offen offset:1024 sc1
    buffer_load_dwordx4 a[72:75], v1, s[4:7], s23 offen offset:2048 sc1
    buffer_load_dwordx4 a[76:79], v1, s[4:7], s23 offen offset:3072 sc1
    s_add_u32 s23, s23, 4096
    buffer_load_dwordx4 a[80:83], v1, s[4:7], s23 offen offset:0 sc1
    buffer_load_dwordx4 a[84:87], v1, s[4:7], s23 offen offset:1024 sc1
    buffer_load_dwordx4 a[88:91], v1, s[4:7], s23 offen offset:2048 sc1
    buffer_load_dwordx4 a[92:95], v1, s[4:7], s23 offen offset:3072 sc1
    s_add_u32 s23, s23, 4096
    buffer_load_dwordx4 a[96:99], v1, s[4:7], s23 offen offset:0 sc1
    buffer_load_dwordx4 a[100:103], v1, s[4:7], s23 offen offset:1024 sc1
    buffer_load_dwordx4 a[104:107], v1, s[4:7], s23 offen offset:2048 sc1
    buffer_load_dwordx4 a[108:111], v1, s[4:7], s23 offen offset:3072 sc1
    s_add_u32 s23, s23, 4096
    buffer_load_dwordx4 a[112:115], v1, s[4:7], s23 offen offset:0 sc1
    buffer_load_dwordx4 a[116:119], v1, s[4:7], s23 offen offset:1024 sc1
    buffer_load_dwordx4 a[120:123], v1, s[4:7], s23 offen offset:2048 sc1
    buffer_load_dwordx4 a[124:127], v1, s[4:7], s23 offen offset:3072 sc1
    s_add_u32 s23, s23, 4096
    buffer_load_dwordx4 a[128:131], v1, s[4:7], s23 offen offset:0 sc1
    buffer_load_dwordx4 a[132:135], v1, s[4:7], s23 offen offset:1024 sc1
    buffer_load_dwordx4 a[136:139], v1, s[4:7], s23 offen offset:2048 sc1
    buffer_load_dwordx4 a[140:143], v1, s[4:7], s23 offen offset:3072 sc1
    s_add_u32 s23, s23, 4096
    buffer_load_dwordx4 a[144:147], v1, s[4:7], s23 offen offset:0 sc1
    buffer_load_dwordx4 a[148:151], v1, s[4:7], s23 offen offset:1024 sc1
    buffer_load_dwordx4 a[152:155], v1, s[4:7], s23 offen offset:2048 sc1
    buffer_load_dwordx4 a[156:159], v1, s[4:7], s23 offen offset:3072 sc1
    s_add_u32 s23, s23, 4096
    buffer_load_dwordx4 a[160:163], v1, s[4:7], s23 offen offset:0 sc1
    buffer_load_dwordx4 a[164:167], v1, s[4:7], s23 offen offset:1024 sc1
    buffer_load_dwordx4 a[168:171], v1, s[4:7], s23 offen offset:2048 sc1
    buffer_load_dwordx4 a[172:175], v1, s[4:7], s23 offen offset:3072 sc1
    s_add_u32 s23, s23, 4096
    buffer_load_dwordx4 a[176:179], v1, s[4:7], s23 offen offset:0 sc1
    buffer_load_dwordx4 a[180:183], v1, s[4:7], s23 offen offset:1024 sc1
    buffer_load_dwordx4 a[184:187], v1, s[4:7], s23 offen offset:2048 sc1
    buffer_load_dwordx4 a[188:191], v1, s[4:7], s23 offen offset:3072 sc1
    s_add_u32 s23, s23, 4096
    buffer_load_dwordx4 a[192:195], v1, s[4:7], s23 offen offset:0 sc1
    buffer_load_dwordx4 a[196:199], v1, s[4:7], s23 offen offset:1024 sc1
    buffer_load_dwordx4 a[200:203], v1, s[4:7], s23 offen offset:2048 sc1
    buffer_load_dwordx4 a[204:207], v1, s[4:7], s23 offen offset:3072 sc1
    s_add_u32 s23, s23, 4096
    buffer_load_dwordx4 a[208:211], v1, s[4:7], s23 offen offset:0 sc1
    buffer_load_dwordx4 a[212:215], v1, s[4:7], s23 offen offset:1024 sc1
    buffer_load_dwordx4 a[216:219], v1, s[4:7], s23 offen offset:2048 sc1
    buffer_load_dwordx4 a[220:223], v1, s[4:7], s23 offen offset:3072 sc1
    s_add_u32 s23, s23, 4096
    buffer_load_dwordx4 a[224:227], v1, s[4:7], s23 offen offset:0 sc1
    buffer_load_dwordx4 a[228:231], v1, s[4:7], s23 offen offset:1024 sc1
    buffer_load_dwordx4 a[232:235], v1, s[4:7], s23 offen offset:2048 sc1
    buffer_load_dwordx4 a[236:239], v1, s[4:7], s23 offen offset:3072 sc1
    s_add_u32 s23, s23, 4096
    buffer_load_dwordx4 a[240:243], v1, s[4:7], s23 offen offset:0 sc1
    buffer_load_dwordx4 a[244:247], v1, s[4:7], s23 offen offset:1024 sc1
    buffer_load_dwordx4 a[248:251], v1, s[4:7], s23 offen offset:2048 sc1
    buffer_load_dwordx4 a[252:255], v1, s[4:7], s23 offen offset:3072 sc1
    s_add_u32 s23, s23, 4096
    buffer_load_dwordx4 v[128:131], v1, s[4:7], s23 offen offset:0 sc1
    buffer_load_dwordx4 v[132:135], v1, s[4:7], s23 offen offset:1024 sc1
    buffer_load_dwordx4 v[136:139], v1, s[4:7], s23 offen offset:2048 sc1
    buffer_load_dwordx4 v[140:143], v1, s[4:7], s23 offen offset:3072 sc1
    s_add_u32 s23, s23, 4096
    buffer_load_dwordx4 v[144:147], v1, s[4:7], s23 offen offset:0 sc1
    buffer_load_dwordx4 v[148:151], v1, s[4:7], s23 offen offset:1024 sc1
    buffer_load_dwordx4 v[152:155], v1, s[4:7], s23 offen offset:2048 sc1
    buffer_load_dwordx4 v[156:159], v1, s[4:7], s23 offen offset:3072 sc1
    s_add_u32 s23, s23, 4096
    buffer_load_dwordx4 v[160:163], v1, s[4:7], s23 offen offset:0 sc1
    buffer_load_dwordx4 v[164:167], v1, s[4:7], s23 offen offset:1024 sc1
    buffer_load_dwordx4 v[168:171], v1, s[4:7], s23 offen offset:2048 sc1
    buffer_load_dwordx4 v[172:175], v1, s[4:7], s23 offen offset:3072 sc1
    s_add_u32 s23, s23, 4096
    buffer_load_dwordx4 v[176:179], v1, s[4:7], s23 offen offset:0 sc1
    buffer_load_dwordx4 v[180:183], v1, s[4:7], s23 offen offset:1024 sc1
    buffer_load_dwordx4 v[184:187], v1, s[4:7], s23 offen offset:2048 sc1
    buffer_load_dwordx4 v[188:191], v1, s[4:7], s23 offen offset:3072 sc1
    s_add_u32 s23, s23, 4096
    buffer_load_dwordx4 v[192:195], v1, s[4:7], s23 offen offset:0 sc1
    buffer_load_dwordx4 v[196:199], v1, s[4:7], s23 offen offset:1024 sc1
    buffer_load_dwordx4 v[200:203], v1, s[4:7], s23 offen offset:2048 sc1
    buffer_load_dwordx4 v[204:207], v1, s[4:7], s23 offen offset:3072 sc1
    s_add_u32 s23, s23, 4096
    buffer_load_dwordx4 v[208:211], v1, s[4:7], s23 offen offset:0 sc1
    buffer_load_dwordx4 v[212:215], v1, s[4:7], s23 offen offset:1024 sc1
    buffer_load_dwordx4 v[216:219], v1, s[4:7], s23 offen offset:2048 sc1
    buffer_load_dwordx4 v[220:223], v1, s[4:7], s23 offen offset:3072 sc1
    s_add_u32 s23, s23, 4096
    buffer_load_dwordx4 v[224:227], v1, s[4:7], s23 offen offset:0 sc1
    buffer_load_dwordx4 v[228:231], v1, s[4:7], s23 offen offset:1024 sc1
    buffer_load_dwordx4 v[232:235], v1, s[4:7], s23 offen offset:2048 sc1
    buffer_load_dwordx4 v[236:239], v1, s[4:7], s23 offen offset:3072 sc1
    s_add_u32 s23, s23, 4096
    buffer_load_dwordx4 v[240:243], v1, s[4:7], s23 offen offset:0 sc1
    buffer_load_dwordx4 v[244:247], v1, s[4:7], s23 offen offset:1024 sc1
    buffer_load_dwordx4 v[248:251], v1, s[4:7], s23 offen offset:2048 sc1
    buffer_load_dwordx4 v[252:255], v1, s[4:7], s23 offen offset:3072 sc1
    s_add_u32 s23, s23, 4096
    v_mul_u32_u24 v6, 1280, v2
    v_lshl_add_u32 v6, v3, 3, v6
    s_lshr_b32 s52, s14, 1
    s_mul_i32 s52, s52, 49152
    s_and_b32 s53, s14, 1
    s_mul_i32 s53, s53, 12288
    s_add_u32 s52, s52, s53
    s_add_u32 s52, s52, 0xab00000
    s_mul_i32 s53, s14, 12288
L4_pend_50260:
    s_lshl_b32 s33, s17, 6
    s_add_u32 s33, s33, 0xb206640
    v_mov_b32 v8, s33
    s_mov_b64 exec, 1
    s_nop 0
Lwp_50261:
    buffer_load_dword v9, v8, s[4:7], 0 offen sc1
    s_waitcnt vmcnt(0)
    v_cmp_gt_u32 vcc, 48, v9
    s_nop 0
    s_cbranch_vccz Lwpd_50262
    s_sleep 5
    s_add_u32 s30, s30, 1
    s_cmp_lt_u32 s30, s31
    s_cbranch_scc1 Lwp_50261
Lwpd_50262:
    s_mov_b64 exec, -1
    s_mul_i32 s20, s17, 98304
    s_add_u32 s20, s20, s52
    s_add_u32 s21, s53, 0
    s_mov_b32 m0, s21
    s_nop 0
    buffer_load_dwordx4 v1, s[4:7], s20 offen offset:0 sc1 lds
    buffer_load_dwordx4 v1, s[4:7], s20 offen offset:1024 sc1 lds
    buffer_load_dwordx4 v1, s[4:7], s20 offen offset:2048 sc1 lds
    buffer_load_dwordx4 v1, s[4:7], s20 offen offset:3072 sc1 lds
    s_add_u32 s20, s20, 4096
    s_add_u32 s21, s21, 4096
    s_mov_b32 m0, s21
    s_nop 0
    buffer_load_dwordx4 v1, s[4:7], s20 offen offset:0 sc1 lds
    buffer_load_dwordx4 v1, s[4:7], s20 offen offset:1024 sc1 lds
    buffer_load_dwordx4 v1, s[4:7], s20 offen offset:2048 sc1 lds
    buffer_load_dwordx4 v1, s[4:7], s20 offen offset:3072 sc1 lds
    s_add_u32 s20, s20, 4096
    s_add_u32 s21, s21, 4096
    s_mov_b32 m0, s21
    s_nop 0
    buffer_load_dwordx4 v1, s[4:7], s20 offen offset:0 sc1 lds
    buffer_load_dwordx4 v1, s[4:7], s20 offen offset:1024 sc1 lds
    buffer_load_dwordx4 v1, s[4:7], s20 offen offset:2048 sc1 lds
    buffer_load_dwordx4 v1, s[4:7], s20 offen offset:3072 sc1 lds
    s_waitcnt vmcnt(0)
L4_loop_50258:
    s_add_u32 s27, s17, s19
    s_waitcnt vmcnt(4)
    s_barrier
    v_add_u32 v10, 0, v1
    ds_read_b128 v[36:39], v10 offset:0
    ds_read_b128 v[40:43], v10 offset:24576
    ds_read_b128 v[44:47], v10 offset:1024
    ds_read_b128 v[48:51], v10 offset:25600
    ds_read_b128 v[52:55], v10 offset:2048
    s_waitcnt lgkmcnt(4)
    v_mfma_f32_16x16x32_bf16 v[12:15], a[0:3], v[36:39], 0
    v_mfma_f32_16x16x32_bf16 v[16:19], a[192:195], v[36:39], 0
    s_mul_i32 s20, s17, 98304
    s_add_u32 s20, s20, s52
    s_add_u32 s20, s20, 24576
    s_add_u32 s21, s53, 49152
    s_mov_b32 m0, s21
    s_nop 0
    buffer_load_dwordx4 v1, s[4:7], s20 offen offset:0 sc1 lds
    ds_read_b128 v[56:59], v10 offset:26624
    s_waitcnt lgkmcnt(4)
    v_mfma_f32_16x16x32_bf16 v[20:23], a[0:3], v[40:43], 0
    v_mfma_f32_16x16x32_bf16 v[24:27], a[192:195], v[40:43], 0
    ds_read_b128 v[36:39], v10 offset:3072
    s_waitcnt lgkmcnt(4)
    v_mfma_f32_16x16x32_bf16 v[12:15], a[4:7], v[44:47], v[12:15]
    v_mfma_f32_16x16x32_bf16 v[16:19], a[196:199], v[44:47], v[16:19]
    buffer_load_dwordx4 v1, s[4:7], s20 offen offset:1024 sc1 lds
    ds_read_b128 v[40:43], v10 offset:27648
    s_waitcnt lgkmcnt(4)
    v_mfma_f32_16x16x32_bf16 v[20:23], a[4:7], v[48:51], v[20:23]
    v_mfma_f32_16x16x32_bf16 v[24:27], a[196:199], v[48:51], v[24:27]
    ds_read_b128 v[44:47], v10 offset:4096
    s_waitcnt lgkmcnt(4)
    v_mfma_f32_16x16x32_bf16 v[12:15], a[8:11], v[52:55], v[12:15]
    v_mfma_f32_16x16x32_bf16 v[16:19], a[200:203], v[52:55], v[16:19]
    buffer_load_dwordx4 v1, s[4:7], s20 offen offset:2048 sc1 lds
    ds_read_b128 v[48:51], v10 offset:28672
    s_waitcnt lgkmcnt(4)
    v_mfma_f32_16x16x32_bf16 v[20:23], a[8:11], v[56:59], v[20:23]
    v_mfma_f32_16x16x32_bf16 v[24:27], a[200:203], v[56:59], v[24:27]
    ds_read_b128 v[52:55], v10 offset:5120
    s_waitcnt lgkmcnt(4)
    v_mfma_f32_16x16x32_bf16 v[12:15], a[12:15], v[36:39], v[12:15]
    v_mfma_f32_16x16x32_bf16 v[16:19], a[204:207], v[36:39], v[16:19]
    buffer_load_dwordx4 v1, s[4:7], s20 offen offset:3072 sc1 lds
    ds_read_b128 v[56:59], v10 offset:29696
    s_waitcnt lgkmcnt(4)
    v_mfma_f32_16x16x32_bf16 v[20:23], a[12:15], v[40:43], v[20:23]
    v_mfma_f32_16x16x32_bf16 v[24:27], a[204:207], v[40:43], v[24:27]
    ds_read_b128 v[36:39], v10 offset:6144
    s_waitcnt lgkmcnt(4)
    v_mfma_f32_16x16x32_bf16 v[12:15], a[16:19], v[44:47], v[12:15]
    v_mfma_f32_16x16x32_bf16 v[16:19], a[208:211], v[44:47], v[16:19]
    s_add_u32 s20, s20, 4096
    s_add_u32 s21, s21, 4096
    s_mov_b32 m0, s21
    s_nop 0
    buffer_load_dwordx4 v1, s[4:7], s20 offen offset:0 sc1 lds
    ds_read_b128 v[40:43], v10 offset:30720
    s_waitcnt lgkmcnt(4)
    v_mfma_f32_16x16x32_bf16 v[20:23], a[16:19], v[48:51], v[20:23]
    v_mfma_f32_16x16x32_bf16 v[24:27], a[208:211], v[48:51], v[24:27]
    ds_read_b128 v[44:47], v10 offset:7168
    s_waitcnt lgkmcnt(4)
    v_mfma_f32_16x16x32_bf16 v[12:15], a[20:23], v[52:55], v[12:15]
    v_mfma_f32_16x16x32_bf16 v[16:19], a[212:215], v[52:55], v[16:19]
    buffer_load_dwordx4 v1, s[4:7], s20 offen offset:1024 sc1 lds
    ds_read_b128 v[48:51], v10 offset:31744
    s_waitcnt lgkmcnt(4)
    v_mfma_f32_16x16x32_bf16 v[20:23], a[20:23], v[56:59], v[20:23]
    v_mfma_f32_16x16x32_bf16 v[24:27], a[212:215], v[56:59], v[24:27]
    ds_read_b128 v[52:55], v10 offset:8192
    s_waitcnt lgkmcnt(4)
    v_mfma_f32_16x16x32_bf16 v[12:15], a[24:27], v[36:39], v[12:15]
    v_mfma_f32_16x16x32_bf16 v[16:19], a[216:219], v[36:39], v[16:19]
    buffer_load_dwordx4 v1, s[4:7], s20 offen offset:2048 sc1 lds
    ds_read_b128 v[56:59], v10 offset:32768
    s_waitcnt lgkmcnt(4)
    v_mfma_f32_16x16x32_bf16 v[20:23], a[24:27], v[40:43], v[20:23]
    v_mfma_f32_16x16x32_bf16 v[24:27], a[216:219], v[40:43], v[24:27]
    ds_read_b128 v[36:39], v10 offset:9216
    s_waitcnt lgkmcnt(4)
    v_mfma_f32_16x16x32_bf16 v[12:15], a[28:31], v[44:47], v[12:15]
    v_mfma_f32_16x16x32_bf16 v[16:19], a[220:223], v[44:47], v[16:19]
    buffer_load_dwordx4 v1, s[4:7], s20 offen offset:3072 sc1 lds
    ds_read_b128 v[40:43], v10 offset:33792
    s_waitcnt lgkmcnt(4)
    v_mfma_f32_16x16x32_bf16 v[20:23], a[28:31], v[48:51], v[20:23]
    v_mfma_f32_16x16x32_bf16 v[24:27], a[220:223], v[48:51], v[24:27]
    ds_read_b128 v[44:47], v10 offset:10240
    s_waitcnt lgkmcnt(4)
    v_mfma_f32_16x16x32_bf16 v[12:15], a[32:35], v[52:55], v[12:15]
    v_mfma_f32_16x16x32_bf16 v[16:19], a[224:227], v[52:55], v[16:19]
    s_add_u32 s20, s20, 4096
    s_add_u32 s21, s21, 4096
    s_mov_b32 m0, s21
    s_nop 0
    buffer_load_dwordx4 v1, s[4:7], s20 offen offset:0 sc1 lds
    ds_read_b128 v[48:51], v10 offset:34816
    s_waitcnt lgkmcnt(4)
    v_mfma_f32_16x16x32_bf16 v[20:23], a[32:35], v[56:59], v[20:23]
    v_mfma_f32_16x16x32_bf16 v[24:27], a[224:227], v[56:59], v[24:27]
    ds_read_b128 v[52:55], v10 offset:11264
    s_waitcnt lgkmcnt(4)
    v_mfma_f32_16x16x32_bf16 v[12:15], a[36:39], v[36:39], v[12:15]
    v_mfma_f32_16x16x32_bf16 v[16:19], a[228:231], v[36:39], v[16:19]
    buffer_load_dwordx4 v1, s[4:7], s20 offen offset:1024 sc1 lds
    ds_read_b128 v[56:59], v10 offset:35840
    s_waitcnt lgkmcnt(4)
    v_mfma_f32_16x16x32_bf16 v[20:23], a[36:39], v[40:43], v[20:23]
    v_mfma_f32_16x16x32_bf16 v[24:27], a[228:231], v[40:43], v[24:27]
    ds_read_b128 v[36:39], v10 offset:12288
    s_waitcnt lgkmcnt(4)
    v_mfma_f32_16x16x32_bf16 v[12:15], a[40:43], v[44:47], v[12:15]
    v_mfma_f32_16x16x32_bf16 v[16:19], a[232:235], v[44:47], v[16:19]
    buffer_load_dwordx4 v1, s[4:7], s20 offen offset:2048 sc1 lds
    ds_read_b128 v[40:43], v10 offset:36864
    s_waitcnt lgkmcnt(4)
    v_mfma_f32_16x16x32_bf16 v[20:23], a[40:43], v[48:51], v[20:23]
    v_mfma_f32_16x16x32_bf16 v[24:27], a[232:235], v[48:51], v[24:27]
    ds_read_b128 v[44:47], v10 offset:13312
    s_waitcnt lgkmcnt(4)
    v_mfma_f32_16x16x32_bf16 v[12:15], a[44:47], v[52:55], v[12:15]
    v_mfma_f32_16x16x32_bf16 v[16:19], a[236:239], v[52:55], v[16:19]
    buffer_load_dwordx4 v1, s[4:7], s20 offen offset:3072 sc1 lds
    ds_read_b128 v[48:51], v10 offset:37888
    s_waitcnt lgkmcnt(4)
    v_mfma_f32_16x16x32_bf16 v[20:23], a[44:47], v[56:59], v[20:23]
    v_mfma_f32_16x16x32_bf16 v[24:27], a[236:239], v[56:59], v[24:27]
    ds_read_b128 v[52:55], v10 offset:14336
    s_waitcnt lgkmcnt(4)
    v_mfma_f32_16x16x32_bf16 v[12:15], a[48:51], v[36:39], v[12:15]
    v_mfma_f32_16x16x32_bf16 v[16:19], a[240:243], v[36:39], v[16:19]
    s_mul_i32 s25, s17, 40
    s_add_u32 s25, s25, s29
    s_lshl_b32 s25, s25, 10
    s_add_u32 s25, s25, 0xa200000
    buffer_load_dwordx4 v[64:67], v1, s[4:7], s25 offen sc1
    ds_read_b128 v[56:59], v10 offset:38912
    s_waitcnt lgkmcnt(4)
    v_mfma_f32_16x16x32_bf16 v[20:23], a[48:51], v[40:43], v[20:23]
    v_mfma_f32_16x16x32_bf16 v[24:27], a[240:243], v[40:43], v[24:27]
    ds_read_b128 v[36:39], v10 offset:15360
    s_waitcnt lgkmcnt(4)
    v_mfma_f32_16x16x32_bf16 v[12:15], a[52:55], v[44:47], v[12:15]
    v_mfma_f32_16x16x32_bf16 v[16:19], a[244:247], v[44:47], v[16:19]
    s_add_u32 s25, s25, 20480
    buffer_load_dwordx4 v[68:71], v1, s[4:7], s25 offen sc1
    ds_read_b128 v[40:43], v10 offset:39936
    s_waitcnt lgkmcnt(4)
    v_mfma_f32_16x16x32_bf16 v[20:23], a[52:55], v[48:51], v[20:23]
    v_mfma_f32_16x16x32_bf16 v[24:27], a[244:247], v[48:51], v[24:27]
    ds_read_b128 v[44:47], v10 offset:16384
    s_waitcnt lgkmcnt(4)
    v_mfma_f32_16x16x32_bf16 v[12:15], a[56:59], v[52:55], v[12:15]
    v_mfma_f32_16x16x32_bf16 v[16:19], a[248:251], v[52:55], v[16:19]
    s_mul_i32 s25, s17, 40
    s_add_u32 s25, s25, s29
    s_lshl_b32 s25, s25, 10
    s_add_u32 s25, s25, 0xa800000
    buffer_load_dwordx4 v[72:75], v1, s[4:7], s25 offen sc1
    ds_read_b128 v[48:51], v10 offset:40960
    s_waitcnt lgkmcnt(4)
    v_mfma_f32_16x16x32_bf16 v[20:23], a[56:59], v[56:59], v[20:23]
    v_mfma_f32_16x16x32_bf16 v[24:27], a[248:251], v[56:59], v[24:27]
    ds_read_b128 v[52:55], v10 offset:17408
    s_waitcnt lgkmcnt(4)
    v_mfma_f32_16x16x32_bf16 v[12:15], a[60:63], v[36:39], v[12:15]
    v_mfma_f32_16x16x32_bf16 v[16:19], a[252:255], v[36:39], v[16:19]
    s_add_u32 s25, s25, 20480
    buffer_load_dwordx4 v[76:79], v1, s[4:7], s25 offen sc1
    ds_read_b128 v[56:59], v10 offset:41984
    s_waitcnt lgkmcnt(4)
    v_mfma_f32_16x16x32_bf16 v[20:23], a[60:63], v[40:43], v[20:23]
    v_mfma_f32_16x16x32_bf16 v[24:27], a[252:255], v[40:43], v[24:27]
    ds_read_b128 v[36:39], v10 offset:18432
    s_waitcnt lgkmcnt(4)
    v_mfma_f32_16x16x32_bf16 v[12:15], a[64:67], v[44:47], v[12:15]
    v_mfma_f32_16x16x32_bf16 v[16:19], v[128:131], v[44:47], v[16:19]
    s_lshl_b32 s33, s27, 6
    s_add_u32 s33, s33, 0xb206640
    v_mov_b32 v8, s33
    buffer_load_dword v9, v8, s[4:7], 0 offen sc1
    ds_read_b128 v[40:43], v10 offset:43008
    s_waitcnt lgkmcnt(4)
    v_mfma_f32_16x16x32_bf16 v[20:23], a[64:67], v[48:51], v[20:23]
    v_mfma_f32_16x16x32_bf16 v[24:27], v[128:131], v[48:51], v[24:27]
    ds_read_b128 v[44:47], v10 offset:19456
    s_waitcnt lgkmcnt(4)
    v_mfma_f32_16x16x32_bf16 v[12:15], a[68:71], v[52:55], v[12:15]
    v_mfma_f32_16x16x32_bf16 v[16:19], v[132:135], v[52:55], v[16:19]
    ds_read_b128 v[48:51], v10 offset:44032
    s_waitcnt lgkmcnt(4)
    v_mfma_f32_16x16x32_bf16 v[20:23], a[68:71], v[56:59], v[20:23]
    v_mfma_f32_16x16x32_bf16 v[24:27], v[132:135], v[56:59], v[24:27]
    ds_read_b128 v[52:55], v10 offset:20480
    s_waitcnt lgkmcnt(4)
    v_mfma_f32_16x16x32_bf16 v[12:15], a[72:75], v[36:39], v[12:15]
    v_mfma_f32_16x16x32_bf16 v[16:19], v[136:139], v[36:39], v[16:19]
    ds_read_b128 v[56:59], v10 offset:45056
    s_waitcnt lgkmcnt(4)
    v_mfma_f32_16x16x32_bf16 v[20:23], a[72:75], v[40:43], v[20:23]
    v_mfma_f32_16x16x32_bf16 v[24:27], v[136:139], v[40:43], v[24:27]
    ds_read_b128 v[36:39], v10 offset:21504
    s_waitcnt lgkmcnt(4)
    v_mfma_f32_16x16x32_bf16 v[12:15], a[76:79], v[44:47], v[12:15]
    v_mfma_f32_16x16x32_bf16 v[16:19], v[140:143], v[44:47], v[16:19]
    ds_read_b128 v[40:43], v10 offset:46080
    s_waitcnt lgkmcnt(4)
    v_mfma_f32_16x16x32_bf16 v[20:23], a[76:79], v[48:51], v[20:23]
    v_mfma_f32_16x16x32_bf16 v[24:27], v[140:143], v[48:51], v[24:27]
    ds_read_b128 v[44:47], v10 offset:22528
    s_waitcnt lgkmcnt(4)
    v_mfma_f32_16x16x32_bf16 v[12:15], a[80:83], v[52:55], v[12:15]
    v_mfma_f32_16x16x32_bf16 v[16:19], v[144:147], v[52:55], v[16:19]
    ds_read_b128 v[48:51], v10 offset:47104
    s_waitcnt lgkmcnt(4)
    v_mfma_f32_16x16x32_bf16 v[20:23], a[80:83], v[56:59], v[20:23]
    v_mfma_f32_16x16x32_bf16 v[24:27], v[144:147], v[56:59], v[24:27]
    ds_read_b128 v[52:55], v10 offset:23552
    s_waitcnt lgkmcnt(4)
    v_mfma_f32_16x16x32_bf16 v[12:15], a[84:87], v[36:39], v[12:15]
    v_mfma_f32_16x16x32_bf16 v[16:19], v[148:151], v[36:39], v[16:19]
    ds_read_b128 v[56:59], v10 offset:48128
    s_waitcnt lgkmcnt(4)
    v_mfma_f32_16x16x32_bf16 v[20:23], a[84:87], v[40:43], v[20:23]
    v_mfma_f32_16x16x32_bf16 v[24:27], v[148:151], v[40:43], v[24:27]
    s_waitcnt lgkmcnt(3)
    v_mfma_f32_16x16x32_bf16 v[12:15], a[88:91], v[44:47], v[12:15]
    v_mfma_f32_16x16x32_bf16 v[16:19], v[152:155], v[44:47], v[16:19]
    s_waitcnt lgkmcnt(2)
    v_mfma_f32_16x16x32_bf16 v[20:23], a[88:91], v[48:51], v[20:23]
    v_mfma_f32_16x16x32_bf16 v[24:27], v[152:155], v[48:51], v[24:27]
    s_waitcnt lgkmcnt(1)
    v_mfma_f32_16x16x32_bf16 v[12:15], a[92:95], v[52:55], v[12:15]
    v_mfma_f32_16x16x32_bf16 v[16:19], v[156:159], v[52:55], v[16:19]
    s_waitcnt lgkmcnt(0)
    v_mfma_f32_16x16x32_bf16 v[20:23], a[92:95], v[56:59], v[20:23]
    v_mfma_f32_16x16x32_bf16 v[24:27], v[156:159], v[56:59], v[24:27]
    s_waitcnt vmcnt(0)
    s_barrier
    s_mov_b32 s28, 1
    s_cmp_ge_u32 s27, s50
    s_nop 2
    s_cbranch_scc1 L4p_50263
    v_cmp_gt_u32 vcc, 48, v9
    s_nop 0
    s_cbranch_vccnz L4p_50263
    s_mov_b32 s28, 0
    v_add_u32 v10, 49152, v1
    ds_read_b128 v[36:39], v10 offset:0
    ds_read_b128 v[40:43], v10 offset:24576
    ds_read_b128 v[44:47], v10 offset:1024
    ds_read_b128 v[48:51], v10 offset:25600
    ds_read_b128 v[52:55], v10 offset:2048
    s_waitcnt lgkmcnt(4)
    v_mfma_f32_16x16x32_bf16 v[12:15], a[96:99], v[36:39], v[12:15]
    v_mfma_f32_16x16x32_bf16 v[16:19], v[160:163], v[36:39], v[16:19]
    s_mul_i32 s20, s27, 98304
    s_add_u32 s20, s20, s52
    s_add_u32 s21, s53, 0
    s_mov_b32 m0, s21
    s_nop 0
    buffer_load_dwordx4 v1, s[4:7], s20 offen offset:0 sc1 lds
    ds_read_b128 v[56:59], v10 offset:26624
    s_waitcnt lgkmcnt(4)
    v_mfma_f32_16x16x32_bf16 v[20:23], a[96:99], v[40:43], v[20:23]
    v_mfma_f32_16x16x32_bf16 v[24:27], v[160:163], v[40:43], v[24:27]
    ds_read_b128 v[36:39], v10 offset:3072
    s_waitcnt lgkmcnt(4)
    v_mfma_f32_16x16x32_bf16 v[12:15], a[100:103], v[44:47], v[12:15]
    v_mfma_f32_16x16x32_bf16 v[16:19], v[164:167], v[44:47], v[16:19]
    buffer_load_dwordx4 v1, s[4:7], s20 offen offset:1024 sc1 lds
    ds_read_b128 v[40:43], v10 offset:27648
    s_waitcnt lgkmcnt(4)
    v_mfma_f32_16x16x32_bf16 v[20:23], a[100:103], v[48:51], v[20:23]
    v_mfma_f32_16x16x32_bf16 v[24:27], v[164:167], v[48:51], v[24:27]
    ds_read_b128 v[44:47], v10 offset:4096
    s_waitcnt lgkmcnt(4)
    v_mfma_f32_16x16x32_bf16 v[12:15], a[104:107], v[52:55], v[12:15]
    v_mfma_f32_16x16x32_bf16 v[16:19], v[168:171], v[52:55], v[16:19]
    buffer_load_dwordx4 v1, s[4:7], s20 offen offset:2048 sc1 lds
    ds_read_b128 v[48:51], v10 offset:28672
    s_waitcnt lgkmcnt(4)
    v_mfma_f32_16x16x32_bf16 v[20:23], a[104:107], v[56:59], v[20:23]
    v_mfma_f32_16x16x32_bf16 v[24:27], v[168:171], v[56:59], v[24:27]
    ds_read_b128 v[52:55], v10 offset:5120
    s_waitcnt lgkmcnt(4)
    v_mfma_f32_16x16x32_bf16 v[12:15], a[108:111], v[36:39], v[12:15]
    v_mfma_f32_16x16x32_bf16 v[16:19], v[172:175], v[36:39], v[16:19]
    buffer_load_dwordx4 v1, s[4:7], s20 offen offset:3072 sc1 lds
    ds_read_b128 v[56:59], v10 offset:29696
    s_waitcnt lgkmcnt(4)
    v_mfma_f32_16x16x32_bf16 v[20:23], a[108:111], v[40:43], v[20:23]
    v_mfma_f32_16x16x32_bf16 v[24:27], v[172:175], v[40:43], v[24:27]
    ds_read_b128 v[36:39], v10 offset:6144
    s_waitcnt lgkmcnt(4)
    v_mfma_f32_16x16x32_bf16 v[12:15], a[112:115], v[44:47], v[12:15]
    v_mfma_f32_16x16x32_bf16 v[16:19], v[176:179], v[44:47], v[16:19]
    s_add_u32 s20, s20, 4096
    s_add_u32 s21, s21, 4096
    s_mov_b32 m0, s21
    s_nop 0
    buffer_load_dwordx4 v1, s[4:7], s20 offen offset:0 sc1 lds
    ds_read_b128 v[40:43], v10 offset:30720
    s_waitcnt lgkmcnt(4)
    v_mfma_f32_16x16x32_bf16 v[20:23], a[112:115], v[48:51], v[20:23]
    v_mfma_f32_16x16x32_bf16 v[24:27], v[176:179], v[48:51], v[24:27]
    ds_read_b128 v[44:47], v10 offset:7168
    s_waitcnt lgkmcnt(4)
    v_mfma_f32_16x16x32_bf16 v[12:15], a[116:119], v[52:55], v[12:15]
    v_mfma_f32_16x16x32_bf16 v[16:19], v[180:183], v[52:55], v[16:19]
    buffer_load_dwordx4 v1, s[4:7], s20 offen offset:1024 sc1 lds
    ds_read_b128 v[48:51], v10 offset:31744
    s_waitcnt lgkmcnt(4)
    v_mfma_f32_16x16x32_bf16 v[20:23], a[116:119], v[56:59], v[20:23]
    v_mfma_f32_16x16x32_bf16 v[24:27], v[180:183], v[56:59], v[24:27]
    ds_read_b128 v[52:55], v10 offset:8192
    s_waitcnt lgkmcnt(4)
    v_mfma_f32_16x16x32_bf16 v[12:15], a[120:123], v[36:39], v[12:15]
    v_mfma_f32_16x16x32_bf16 v[16:19], v[184:187], v[36:39], v[16:19]
    buffer_load_dwordx4 v1, s[4:7], s20 offen offset:2048 sc1 lds
    ds_read_b128 v[56:59], v10 offset:32768
    s_waitcnt lgkmcnt(4)
    v_mfma_f32_16x16x32_bf16 v[20:23], a[120:123], v[40:43], v[20:23]
    v_mfma_f32_16x16x32_bf16 v[24:27], v[184:187], v[40:43], v[24:27]
    ds_read_b128 v[36:39], v10 offset:9216
    s_waitcnt lgkmcnt(4)
    v_mfma_f32_16x16x32_bf16 v[12:15], a[124:127], v[44:47], v[12:15]
    v_mfma_f32_16x16x32_bf16 v[16:19], v[188:191], v[44:47], v[16:19]
    buffer_load_dwordx4 v1, s[4:7], s20 offen offset:3072 sc1 lds
    ds_read_b128 v[40:43], v10 offset:33792
    s_waitcnt lgkmcnt(4)
    v_mfma_f32_16x16x32_bf16 v[20:23], a[124:127], v[48:51], v[20:23]
    v_mfma_f32_16x16x32_bf16 v[24:27], v[188:191], v[48:51], v[24:27]
    ds_read_b128 v[44:47], v10 offset:10240
    s_waitcnt lgkmcnt(4)
    v_mfma_f32_16x16x32_bf16 v[12:15], a[128:131], v[52:55], v[12:15]
    v_mfma_f32_16x16x32_bf16 v[16:19], v[192:195], v[52:55], v[16:19]
    s_add_u32 s20, s20, 4096
    s_add_u32 s21, s21, 4096
    s_mov_b32 m0, s21
    s_nop 0
    buffer_load_dwordx4 v1, s[4:7], s20 offen offset:0 sc1 lds
    ds_read_b128 v[48:51], v10 offset:34816
    s_waitcnt lgkmcnt(4)
    v_mfma_f32_16x16x32_bf16 v[20:23], a[128:131], v[56:59], v[20:23]
    v_mfma_f32_16x16x32_bf16 v[24:27], v[192:195], v[56:59], v[24:27]
    ds_read_b128 v[52:55], v10 offset:11264
    s_waitcnt lgkmcnt(4)
    v_mfma_f32_16x16x32_bf16 v[12:15], a[132:135], v[36:39], v[12:15]
    v_mfma_f32_16x16x32_bf16 v[16:19], v[196:199], v[36:39], v[16:19]
    buffer_load_dwordx4 v1, s[4:7], s20 offen offset:1024 sc1 lds
    ds_read_b128 v[56:59], v10 offset:35840
    s_waitcnt lgkmcnt(4)
    v_mfma_f32_16x16x32_bf16 v[20:23], a[132:135], v[40:43], v[20:23]
    v_mfma_f32_16x16x32_bf16 v[24:27], v[196:199], v[40:43], v[24:27]
    ds_read_b128 v[36:39], v10 offset:12288
    s_waitcnt lgkmcnt(4)
    v_mfma_f32_16x16x32_bf16 v[12:15], a[136:139], v[44:47], v[12:15]
    v_mfma_f32_16x16x32_bf16 v[16:19], v[200:203], v[44:47], v[16:19]
    buffer_load_dwordx4 v1, s[4:7], s20 offen offset:2048 sc1 lds
    ds_read_b128 v[40:43], v10 offset:36864
    s_waitcnt lgkmcnt(4)
    v_mfma_f32_16x16x32_bf16 v[20:23], a[136:139], v[48:51], v[20:23]
    v_mfma_f32_16x16x32_bf16 v[24:27], v[200:203], v[48:51], v[24:27]
    ds_read_b128 v[44:47], v10 offset:13312
    s_waitcnt lgkmcnt(4)
    v_mfma_f32_16x16x32_bf16 v[12:15], a[140:143], v[52:55], v[12:15]
    v_mfma_f32_16x16x32_bf16 v[16:19], v[204:207], v[52:55], v[16:19]
    buffer_load_dwordx4 v1, s[4:7], s20 offen offset:3072 sc1 lds
    ds_read_b128 v[48:51], v10 offset:37888
    s_waitcnt lgkmcnt(4)
    v_mfma_f32_16x16x32_bf16 v[20:23], a[140:143], v[56:59], v[20:23]
    v_mfma_f32_16x16x32_bf16 v[24:27], v[204:207], v[56:59], v[24:27]
    ds_read_b128 v[52:55], v10 offset:14336
    s_waitcnt lgkmcnt(4)
    v_mfma_f32_16x16x32_bf16 v[12:15], a[144:147], v[36:39], v[12:15]
    v_mfma_f32_16x16x32_bf16 v[16:19], v[208:211], v[36:39], v[16:19]
    ds_read_b128 v[56:59], v10 offset:38912
    s_waitcnt lgkmcnt(4)
    v_mfma_f32_16x16x32_bf16 v[20:23], a[144:147], v[40:43], v[20:23]
    v_mfma_f32_16x16x32_bf16 v[24:27], v[208:211], v[40:43], v[24:27]
    ds_read_b128 v[36:39], v10 offset:15360
    s_waitcnt lgkmcnt(4)
    v_mfma_f32_16x16x32_bf16 v[12:15], a[148:151], v[44:47], v[12:15]
    v_mfma_f32_16x16x32_bf16 v[16:19], v[212:215], v[44:47], v[16:19]
    ds_read_b128 v[40:43], v10 offset:39936
    s_waitcnt lgkmcnt(4)
    v_mfma_f32_16x16x32_bf16 v[20:23], a[148:151], v[48:51], v[20:23]
    v_mfma_f32_16x16x32_bf16 v[24:27], v[212:215], v[48:51], v[24:27]
    ds_read_b128 v[44:47], v10 offset:16384
    s_waitcnt lgkmcnt(4)
    v_mfma_f32_16x16x32_bf16 v[12:15], a[152:155], v[52:55], v[12:15]
    v_mfma_f32_16x16x32_bf16 v[16:19], v[216:219], v[52:55], v[16:19]
    ds_read_b128 v[48:51], v10 offset:40960
    s_waitcnt lgkmcnt(4)
    v_mfma_f32_16x16x32_bf16 v[20:23], a[152:155], v[56:59], v[20:23]
    v_mfma_f32_16x16x32_bf16 v[24:27], v[216:219], v[56:59], v[24:27]
    ds_read_b128 v[52:55], v10 offset:17408
    s_waitcnt lgkmcnt(4)
    v_mfma_f32_16x16x32_bf16 v[12:15], a[156:159], v[36:39], v[12:15]
    v_mfma_f32_16x16x32_bf16 v[16:19], v[220:223], v[36:39], v[16:19]
    ds_read_b128 v[56:59], v10 offset:41984
    s_waitcnt lgkmcnt(4)
    v_mfma_f32_16x16x32_bf16 v[20:23], a[156:159], v[40:43], v[20:23]
    v_mfma_f32_16x16x32_bf16 v[24:27], v[220:223], v[40:43], v[24:27]
    ds_read_b128 v[36:39], v10 offset:18432
    s_waitcnt lgkmcnt(4)
    v_mfma_f32_16x16x32_bf16 v[12:15], a[160:163], v[44:47], v[12:15]
    v_mfma_f32_16x16x32_bf16 v[16:19], v[224:227], v[44:47], v[16:19]
    ds_read_b128 v[40:43], v10 offset:43008
    s_waitcnt lgkmcnt(4)
    v_mfma_f32_16x16x32_bf16 v[20:23], a[160:163], v[48:51], v[20:23]
    v_mfma_f32_16x16x32_bf16 v[24:27], v[224:227], v[48:51], v[24:27]
    ds_read_b128 v[44:47], v10 offset:19456
    s_waitcnt lgkmcnt(4)
    v_mfma_f32_16x16x32_bf16 v[12:15], a[164:167], v[52:55], v[12:15]
    v_mfma_f32_16x16x32_bf16 v[16:19], v[228:231], v[52:55], v[16:19]
    ds_read_b128 v[48:51], v10 offset:44032
    s_waitcnt lgkmcnt(4)
    v_mfma_f32_16x16x32_bf16 v[20:23], a[164:167], v[56:59], v[20:23]
    v_mfma_f32_16x16x32_bf16 v[24:27], v[228:231], v[56:59], v[24:27]
    ds_read_b128 v[52:55], v10 offset:20480
    s_waitcnt lgkmcnt(4)
    v_mfma_f32_16x16x32_bf16 v[12:15], a[168:171], v[36:39], v[12:15]
    v_mfma_f32_16x16x32_bf16 v[16:19], v[232:235], v[36:39], v[16:19]
    ds_read_b128 v[56:59], v10 offset:45056
    s_waitcnt lgkmcnt(4)
    v_mfma_f32_16x16x32_bf16 v[20:23], a[168:171], v[40:43], v[20:23]
    v_mfma_f32_16x16x32_bf16 v[24:27], v[232:235], v[40:43], v[24:27]
    ds_read_b128 v[36:39], v10 offset:21504
    s_waitcnt lgkmcnt(4)
    v_mfma_f32_16x16x32_bf16 v[12:15], a[172:175], v[44:47], v[12:15]
    v_mfma_f32_16x16x32_bf16 v[16:19], v[236:239], v[44:47], v[16:19]
    ds_read_b128 v[40:43], v10 offset:46080
    s_waitcnt lgkmcnt(4)
    v_mfma_f32_16x16x32_bf16 v[20:23], a[172:175], v[48:51], v[20:23]
    v_mfma_f32_16x16x32_bf16 v[24:27], v[236:239], v[48:51], v[24:27]
    ds_read_b128 v[44:47], v10 offset:22528
    s_waitcnt lgkmcnt(4)
    v_mfma_f32_16x16x32_bf16 v[12:15], a[176:179], v[52:55], v[12:15]
    v_mfma_f32_16x16x32_bf16 v[16:19], v[240:243], v[52:55], v[16:19]
    ds_read_b128 v[48:51], v10 offset:47104
    s_waitcnt lgkmcnt(4)
    v_mfma_f32_16x16x32_bf16 v[20:23], a[176:179], v[56:59], v[20:23]
    v_mfma_f32_16x16x32_bf16 v[24:27], v[240:243], v[56:59], v[24:27]
    ds_read_b128 v[52:55], v10 offset:23552
    s_waitcnt lgkmcnt(4)
    v_mfma_f32_16x16x32_bf16 v[12:15], a[180:183], v[36:39], v[12:15]
    v_mfma_f32_16x16x32_bf16 v[16:19], v[244:247], v[36:39], v[16:19]
    ds_read_b128 v[56:59], v10 offset:48128
    s_waitcnt lgkmcnt(4)
    v_mfma_f32_16x16x32_bf16 v[20:23], a[180:183], v[40:43], v[20:23]
    v_mfma_f32_16x16x32_bf16 v[24:27], v[244:247], v[40:43], v[24:27]
    s_waitcnt lgkmcnt(3)
    v_mfma_f32_16x16x32_bf16 v[12:15], a[184:187], v[44:47], v[12:15]
    v_mfma_f32_16x16x32_bf16 v[16:19], v[248:251], v[44:47], v[16:19]
    s_waitcnt lgkmcnt(2)
    v_mfma_f32_16x16x32_bf16 v[20:23], a[184:187], v[48:51], v[20:23]
    v_mfma_f32_16x16x32_bf16 v[24:27], v[248:251], v[48:51], v[24:27]
    s_waitcnt lgkmcnt(1)
    v_mfma_f32_16x16x32_bf16 v[12:15], a[188:191], v[52:55], v[12:15]
    v_mfma_f32_16x16x32_bf16 v[16:19], v[252:255], v[52:55], v[16:19]
    s_waitcnt lgkmcnt(0)
    v_mfma_f32_16x16x32_bf16 v[20:23], a[188:191], v[56:59], v[20:23]
    v_mfma_f32_16x16x32_bf16 v[24:27], v[252:255], v[56:59], v[24:27]
    s_nop 6
    s_branch L4j_50264
L4p_50263:
    v_add_u32 v10, 49152, v1
    ds_read_b128 v[36:39], v10 offset:0
    ds_read_b128 v[40:43], v10 offset:24576
    ds_read_b128 v[44:47], v10 offset:1024
    ds_read_b128 v[48:51], v10 offset:25600
    ds_read_b128 v[52:55], v10 offset:2048
    s_waitcnt lgkmcnt(4)
    v_mfma_f32_16x16x32_bf16 v[12:15], a[96:99], v[36:39], v[12:15]
    v_mfma_f32_16x16x32_bf16 v[16:19], v[160:163], v[36:39], v[16:19]
    ds_read_b128 v[56:59], v10 offset:26624
    s_waitcnt lgkmcnt(4)
    v_mfma_f32_16x16x32_bf16 v[20:23], a[96:99], v[40:43], v[20:23]
    v_mfma_f32_16x16x32_bf16 v[24:27], v[160:163], v[40:43], v[24:27]
    ds_read_b128 v[36:39], v10 offset:3072
    s_waitcnt lgkmcnt(4)
    v_mfma_f32_16x16x32_bf16 v[12:15], a[100:103], v[44:47], v[12:15]
    v_mfma_f32_16x16x32_bf16 v[16:19], v[164:167], v[44:47], v[16:19]
    ds_read_b128 v[40:43], v10 offset:27648
    s_waitcnt lgkmcnt(4)
    v_mfma_f32_16x16x32_bf16 v[20:23], a[100:103], v[48:51], v[20:23]
    v_mfma_f32_16x16x32_bf16 v[24:27], v[164:167], v[48:51], v[24:27]
    ds_read_b128 v[44:47], v10 offset:4096
    s_waitcnt lgkmcnt(4)
    v_mfma_f32_16x16x32_bf16 v[12:15], a[104:107], v[52:55], v[12:15]
    v_mfma_f32_16x16x32_bf16 v[16:19], v[168:171], v[52:55], v[16:19]
    ds_read_b128 v[48:51], v10 offset:28672
    s_waitcnt lgkmcnt(4)
    v_mfma_f32_16x16x32_bf16 v[20:23], a[104:107], v[56:59], v[20:23]
    v_mfma_f32_16x16x32_bf16 v[24:27], v[168:171], v[56:59], v[24:27]
    ds_read_b128 v[52:55], v10 offset:5120
    s_waitcnt lgkmcnt(4)
    v_mfma_f32_16x16x32_bf16 v[12:15], a[108:111], v[36:39], v[12:15]
    v_mfma_f32_16x16x32_bf16 v[16:19], v[172:175], v[36:39], v[16:19]
    ds_read_b128 v[56:59], v10 offset:29696
    s_waitcnt lgkmcnt(4)
    v_mfma_f32_16x16x32_bf16 v[20:23], a[108:111], v[40:43], v[20:23]
    v_mfma_f32_16x16x32_bf16 v[24:27], v[172:175], v[40:43], v[24:27]
    ds_read_b128 v[36:39], v10 offset:6144
    s_waitcnt lgkmcnt(4)
    v_mfma_f32_16x16x32_bf16 v[12:15], a[112:115], v[44:47], v[12:15]
    v_mfma_f32_16x16x32_bf16 v[16:19], v[176:179], v[44:47], v[16:19]
    ds_read_b128 v[40:43], v10 offset:30720
    s_waitcnt lgkmcnt(4)
    v_mfma_f32_16x16x32_bf16 v[20:23], a[112:115], v[48:51], v[20:23]
    v_mfma_f32_16x16x32_bf16 v[24:27], v[176:179], v[48:51], v[24:27]
    ds_read_b128 v[44:47], v10 offset:7168
    s_waitcnt lgkmcnt(4)
    v_mfma_f32_16x16x32_bf16 v[12:15], a[116:119], v[52:55], v[12:15]
    v_mfma_f32_16x16x32_bf16 v[16:19], v[180:183], v[52:55], v[16:19]
    ds_read_b128 v[48:51], v10 offset:31744
    s_waitcnt lgkmcnt(4)
    v_mfma_f32_16x16x32_bf16 v[20:23], a[116:119], v[56:59], v[20:23]
    v_mfma_f32_16x16x32_bf16 v[24:27], v[180:183], v[56:59], v[24:27]
    ds_read_b128 v[52:55], v10 offset:8192
    s_waitcnt lgkmcnt(4)
    v_mfma_f32_16x16x32_bf16 v[12:15], a[120:123], v[36:39], v[12:15]
    v_mfma_f32_16x16x32_bf16 v[16:19], v[184:187], v[36:39], v[16:19]
    ds_read_b128 v[56:59], v10 offset:32768
    s_waitcnt lgkmcnt(4)
    v_mfma_f32_16x16x32_bf16 v[20:23], a[120:123], v[40:43], v[20:23]
    v_mfma_f32_16x16x32_bf16 v[24:27], v[184:187], v[40:43], v[24:27]
    ds_read_b128 v[36:39], v10 offset:9216
    s_waitcnt lgkmcnt(4)
    v_mfma_f32_16x16x32_bf16 v[12:15], a[124:127], v[44:47], v[12:15]
    v_mfma_f32_16x16x32_bf16 v[16:19], v[188:191], v[44:47], v[16:19]
    ds_read_b128 v[40:43], v10 offset:33792
    s_waitcnt lgkmcnt(4)
    v_mfma_f32_16x16x32_bf16 v[20:23], a[124:127], v[48:51], v[20:23]
    v_mfma_f32_16x16x32_bf16 v[24:27], v[188:191], v[48:51], v[24:27]
    ds_read_b128 v[44:47], v10 offset:10240
    s_waitcnt lgkmcnt(4)
    v_mfma_f32_16x16x32_bf16 v[12:15], a[128:131], v[52:55], v[12:15]
    v_mfma_f32_16x16x32_bf16 v[16:19], v[192:195], v[52:55], v[16:19]
    ds_read_b128 v[48:51], v10 offset:34816
    s_waitcnt lgkmcnt(4)
    v_mfma_f32_16x16x32_bf16 v[20:23], a[128:131], v[56:59], v[20:23]
    v_mfma_f32_16x16x32_bf16 v[24:27], v[192:195], v[56:59], v[24:27]
    ds_read_b128 v[52:55], v10 offset:11264
    s_waitcnt lgkmcnt(4)
    v_mfma_f32_16x16x32_bf16 v[12:15], a[132:135], v[36:39], v[12:15]
    v_mfma_f32_16x16x32_bf16 v[16:19], v[196:199], v[36:39], v[16:19]
    ds_read_b128 v[56:59], v10 offset:35840
    s_waitcnt lgkmcnt(4)
    v_mfma_f32_16x16x32_bf16 v[20:23], a[132:135], v[40:43], v[20:23]
    v_mfma_f32_16x16x32_bf16 v[24:27], v[196:199], v[40:43], v[24:27]
    ds_read_b128 v[36:39], v10 offset:12288
    s_waitcnt lgkmcnt(4)
    v_mfma_f32_16x16x32_bf16 v[12:15], a[136:139], v[44:47], v[12:15]
    v_mfma_f32_16x16x32_bf16 v[16:19], v[200:203], v[44:47], v[16:19]
    ds_read_b128 v[40:43], v10 offset:36864
    s_waitcnt lgkmcnt(4)
    v_mfma_f32_16x16x32_bf16 v[20:23], a[136:139], v[48:51], v[20:23]
    v_mfma_f32_16x16x32_bf16 v[24:27], v[200:203], v[48:51], v[24:27]
    ds_read_b128 v[44:47], v10 offset:13312
    s_waitcnt lgkmcnt(4)
    v_mfma_f32_16x16x32_bf16 v[12:15], a[140:143], v[52:55], v[12:15]
    v_mfma_f32_16x16x32_bf16 v[16:19], v[204:207], v[52:55], v[16:19]
    ds_read_b128 v[48:51], v10 offset:37888
    s_waitcnt lgkmcnt(4)
    v_mfma_f32_16x16x32_bf16 v[20:23], a[140:143], v[56:59], v[20:23]
    v_mfma_f32_16x16x32_bf16 v[24:27], v[204:207], v[56:59], v[24:27]
    ds_read_b128 v[52:55], v10 offset:14336
    s_waitcnt lgkmcnt(4)
    v_mfma_f32_16x16x32_bf16 v[12:15], a[144:147], v[36:39], v[12:15]
    v_mfma_f32_16x16x32_bf16 v[16:19], v[208:211], v[36:39], v[16:19]
    ds_read_b128 v[56:59], v10 offset:38912
    s_waitcnt lgkmcnt(4)
    v_mfma_f32_16x16x32_bf16 v[20:23], a[144:147], v[40:43], v[20:23]
    v_mfma_f32_16x16x32_bf16 v[24:27], v[208:211], v[40:43], v[24:27]
    ds_read_b128 v[36:39], v10 offset:15360
    s_waitcnt lgkmcnt(4)
    v_mfma_f32_16x16x32_bf16 v[12:15], a[148:151], v[44:47], v[12:15]
    v_mfma_f32_16x16x32_bf16 v[16:19], v[212:215], v[44:47], v[16:19]
    ds_read_b128 v[40:43], v10 offset:39936
    s_waitcnt lgkmcnt(4)
    v_mfma_f32_16x16x32_bf16 v[20:23], a[148:151], v[48:51], v[20:23]
    v_mfma_f32_16x16x32_bf16 v[24:27], v[212:215], v[48:51], v[24:27]
    ds_read_b128 v[44:47], v10 offset:16384
    s_waitcnt lgkmcnt(4)
    v_mfma_f32_16x16x32_bf16 v[12:15], a[152:155], v[52:55], v[12:15]
    v_mfma_f32_16x16x32_bf16 v[16:19], v[216:219], v[52:55], v[16:19]
    ds_read_b128 v[48:51], v10 offset:40960
    s_waitcnt lgkmcnt(4)
    v_mfma_f32_16x16x32_bf16 v[20:23], a[152:155], v[56:59], v[20:23]
    v_mfma_f32_16x16x32_bf16 v[24:27], v[216:219], v[56:59], v[24:27]
    ds_read_b128 v[52:55], v10 offset:17408
    s_waitcnt lgkmcnt(4)
    v_mfma_f32_16x16x32_bf16 v[12:15], a[156:159], v[36:39], v[12:15]
    v_mfma_f32_16x16x32_bf16 v[16:19], v[220:223], v[36:39], v[16:19]
    ds_read_b128 v[56:59], v10 offset:41984
    s_waitcnt lgkmcnt(4)
    v_mfma_f32_16x16x32_bf16 v[20:23], a[156:159], v[40:43], v[20:23]
    v_mfma_f32_16x16x32_bf16 v[24:27], v[220:223], v[40:43], v[24:27]
    ds_read_b128 v[36:39], v10 offset:18432
    s_waitcnt lgkmcnt(4)
    v_mfma_f32_16x16x32_bf16 v[12:15], a[160:163], v[44:47], v[12:15]
    v_mfma_f32_16x16x32_bf16 v[16:19], v[224:227], v[44:47], v[16:19]
    ds_read_b128 v[40:43], v10 offset:43008
    s_waitcnt lgkmcnt(4)
    v_mfma_f32_16x16x32_bf16 v[20:23], a[160:163], v[48:51], v[20:23]
    v_mfma_f32_16x16x32_bf16 v[24:27], v[224:227], v[48:51], v[24:27]
    ds_read_b128 v[44:47], v10 offset:19456
    s_waitcnt lgkmcnt(4)
    v_mfma_f32_16x16x32_bf16 v[12:15], a[164:167], v[52:55], v[12:15]
    v_mfma_f32_16x16x32_bf16 v[16:19], v[228:231], v[52:55], v[16:19]
    ds_read_b128 v[48:51], v10 offset:44032
    s_waitcnt lgkmcnt(4)
    v_mfma_f32_16x16x32_bf16 v[20:23], a[164:167], v[56:59], v[20:23]
    v_mfma_f32_16x16x32_bf16 v[24:27], v[228:231], v[56:59], v[24:27]
    ds_read_b128 v[52:55], v10 offset:20480
    s_waitcnt lgkmcnt(4)
    v_mfma_f32_16x16x32_bf16 v[12:15], a[168:171], v[36:39], v[12:15]
    v_mfma_f32_16x16x32_bf16 v[16:19], v[232:235], v[36:39], v[16:19]
    ds_read_b128 v[56:59], v10 offset:45056
    s_waitcnt lgkmcnt(4)
    v_mfma_f32_16x16x32_bf16 v[20:23], a[168:171], v[40:43], v[20:23]
    v_mfma_f32_16x16x32_bf16 v[24:27], v[232:235], v[40:43], v[24:27]
    ds_read_b128 v[36:39], v10 offset:21504
    s_waitcnt lgkmcnt(4)
    v_mfma_f32_16x16x32_bf16 v[12:15], a[172:175], v[44:47], v[12:15]
    v_mfma_f32_16x16x32_bf16 v[16:19], v[236:239], v[44:47], v[16:19]
    ds_read_b128 v[40:43], v10 offset:46080
    s_waitcnt lgkmcnt(4)
    v_mfma_f32_16x16x32_bf16 v[20:23], a[172:175], v[48:51], v[20:23]
    v_mfma_f32_16x16x32_bf16 v[24:27], v[236:239], v[48:51], v[24:27]
    ds_read_b128 v[44:47], v10 offset:22528
    s_waitcnt lgkmcnt(4)
    v_mfma_f32_16x16x32_bf16 v[12:15], a[176:179], v[52:55], v[12:15]
    v_mfma_f32_16x16x32_bf16 v[16:19], v[240:243], v[52:55], v[16:19]
    ds_read_b128 v[48:51], v10 offset:47104
    s_waitcnt lgkmcnt(4)
    v_mfma_f32_16x16x32_bf16 v[20:23], a[176:179], v[56:59], v[20:23]
    v_mfma_f32_16x16x32_bf16 v[24:27], v[240:243], v[56:59], v[24:27]
    ds_read_b128 v[52:55], v10 offset:23552
    s_waitcnt lgkmcnt(4)
    v_mfma_f32_16x16x32_bf16 v[12:15], a[180:183], v[36:39], v[12:15]
    v_mfma_f32_16x16x32_bf16 v[16:19], v[244:247], v[36:39], v[16:19]
    ds_read_b128 v[56:59], v10 offset:48128
    s_waitcnt lgkmcnt(4)
    v_mfma_f32_16x16x32_bf16 v[20:23], a[180:183], v[40:43], v[20:23]
    v_mfma_f32_16x16x32_bf16 v[24:27], v[244:247], v[40:43], v[24:27]
    s_waitcnt lgkmcnt(3)
    v_mfma_f32_16x16x32_bf16 v[12:15], a[184:187], v[44:47], v[12:15]
    v_mfma_f32_16x16x32_bf16 v[16:19], v[248:251], v[44:47], v[16:19]
    s_waitcnt lgkmcnt(2)
    v_mfma_f32_16x16x32_bf16 v[20:23], a[184:187], v[48:51], v[20:23]
    v_mfma_f32_16x16x32_bf16 v[24:27], v[248:251], v[48:51], v[24:27]
    s_waitcnt lgkmcnt(1)
    v_mfma_f32_16x16x32_bf16 v[12:15], a[188:191], v[52:55], v[12:15]
    v_mfma_f32_16x16x32_bf16 v[16:19], v[252:255], v[52:55], v[16:19]
    s_waitcnt lgkmcnt(0)
    v_mfma_f32_16x16x32_bf16 v[20:23], a[188:191], v[56:59], v[20:23]
    v_mfma_f32_16x16x32_bf16 v[24:27], v[252:255], v[56:59], v[24:27]
    s_nop 7
L4j_50264:
    v_cvt_pk_bf16_f32 v44, v12, v13
    v_lshlrev_b32 v12, 16, v44
    v_and_b32 v13, 0xffff0000, v44
    v_lshlrev_b32 v44, 16, v72
    v_and_b32 v45, 0xffff0000, v72
    v_add_f32 v44, v44, v12
    v_add_f32 v45, v45, v13
    v_cvt_pk_bf16_f32 v46, v44, v45
    v_lshlrev_b32 v12, 16, v46
    v_and_b32 v13, 0xffff0000, v46
    v_lshlrev_b32 v44, 16, v64
    v_and_b32 v45, 0xffff0000, v64
    v_add_f32 v44, v44, v12
    v_add_f32 v45, v45, v13
    v_cvt_pk_bf16_f32 v36, v44, v45
    v_cvt_pk_bf16_f32 v44, v14, v15
    v_lshlrev_b32 v14, 16, v44
    v_and_b32 v15, 0xffff0000, v44
    v_lshlrev_b32 v44, 16, v73
    v_and_b32 v45, 0xffff0000, v73
    v_add_f32 v44, v44, v14
    v_add_f32 v45, v45, v15
    v_cvt_pk_bf16_f32 v46, v44, v45
    v_lshlrev_b32 v14, 16, v46
    v_and_b32 v15, 0xffff0000, v46
    v_lshlrev_b32 v44, 16, v65
    v_and_b32 v45, 0xffff0000, v65
    v_add_f32 v44, v44, v14
    v_add_f32 v45, v45, v15
    v_cvt_pk_bf16_f32 v37, v44, v45
    v_cvt_pk_bf16_f32 v44, v16, v17
    v_lshlrev_b32 v16, 16, v44
    v_and_b32 v17, 0xffff0000, v44
    v_lshlrev_b32 v44, 16, v74
    v_and_b32 v45, 0xffff0000, v74
    v_add_f32 v44, v44, v16
    v_add_f32 v45, v45, v17
    v_cvt_pk_bf16_f32 v46, v44, v45
    v_lshlrev_b32 v16, 16, v46
    v_and_b32 v17, 0xffff0000, v46
    v_lshlrev_b32 v44, 16, v66
    v_and_b32 v45, 0xffff0000, v66
    v_add_f32 v44, v44, v16
    v_add_f32 v45, v45, v17
    v_cvt_pk_bf16_f32 v38, v44, v45
    v_cvt_pk_bf16_f32 v44, v18, v19
    v_lshlrev_b32 v18, 16, v44
    v_and_b32 v19, 0xffff0000, v44
    v_lshlrev_b32 v44, 16, v75
    v_and_b32 v45, 0xffff0000, v75
    v_add_f32 v44, v44, v18
    v_add_f32 v45, v45, v19
    v_cvt_pk_bf16_f32 v46, v44, v45
    v_lshlrev_b32 v18, 16, v46
    v_and_b32 v19, 0xffff0000, v46
    v_lshlrev_b32 v44, 16, v67
    v_and_b32 v45, 0xffff0000, v67
    v_add_f32 v44, v44, v18
    v_add_f32 v45, v45, v19
    v_cvt_pk_bf16_f32 v39, v44, v45
    s_lshl_b32 s34, s17, 1
    s_add_u32 s34, s34, 0
    s_mul_i32 s35, s34, 20480
    s_lshl_b32 s36, s29, 6
    s_add_u32 s35, s35, s36
    buffer_store_dwordx2 v[36:37], v6, s[8:11], s35 offen
    buffer_store_dwordx2 v[38:39], v6, s[8:11], s35 offen offset:32
    v_cvt_pk_bf16_f32 v44, v20, v21
    v_lshlrev_b32 v20, 16, v44
    v_and_b32 v21, 0xffff0000, v44
    v_lshlrev_b32 v44, 16, v76
    v_and_b32 v45, 0xffff0000, v76
    v_add_f32 v44, v44, v20
    v_add_f32 v45, v45, v21
    v_cvt_pk_bf16_f32 v46, v44, v45
    v_lshlrev_b32 v20, 16, v46
    v_and_b32 v21, 0xffff0000, v46
    v_lshlrev_b32 v44, 16, v68
    v_and_b32 v45, 0xffff0000, v68
    v_add_f32 v44, v44, v20
    v_add_f32 v45, v45, v21
    v_cvt_pk_bf16_f32 v40, v44, v45
    v_cvt_pk_bf16_f32 v44, v22, v23
    v_lshlrev_b32 v22, 16, v44
    v_and_b32 v23, 0xffff0000, v44
    v_lshlrev_b32 v44, 16, v77
    v_and_b32 v45, 0xffff0000, v77
    v_add_f32 v44, v44, v22
    v_add_f32 v45, v45, v23
    v_cvt_pk_bf16_f32 v46, v44, v45
    v_lshlrev_b32 v22, 16, v46
    v_and_b32 v23, 0xffff0000, v46
    v_lshlrev_b32 v44, 16, v69
    v_and_b32 v45, 0xffff0000, v69
    v_add_f32 v44, v44, v22
    v_add_f32 v45, v45, v23
    v_cvt_pk_bf16_f32 v41, v44, v45
    v_cvt_pk_bf16_f32 v44, v24, v25
    v_lshlrev_b32 v24, 16, v44
    v_and_b32 v25, 0xffff0000, v44
    v_lshlrev_b32 v44, 16, v78
    v_and_b32 v45, 0xffff0000, v78
    v_add_f32 v44, v44, v24
    v_add_f32 v45, v45, v25
    v_cvt_pk_bf16_f32 v46, v44, v45
    v_lshlrev_b32 v24, 16, v46
    v_and_b32 v25, 0xffff0000, v46
    v_lshlrev_b32 v44, 16, v70
    v_and_b32 v45, 0xffff0000, v70
    v_add_f32 v44, v44, v24
    v_add_f32 v45, v45, v25
    v_cvt_pk_bf16_f32 v42, v44, v45
    v_cvt_pk_bf16_f32 v44, v26, v27
    v_lshlrev_b32 v26, 16, v44
    v_and_b32 v27, 0xffff0000, v44
    v_lshlrev_b32 v44, 16, v79
    v_and_b32 v45, 0xffff0000, v79
    v_add_f32 v44, v44, v26
    v_add_f32 v45, v45, v27
    v_cvt_pk_bf16_f32 v46, v44, v45
    v_lshlrev_b32 v26, 16, v46
    v_and_b32 v27, 0xffff0000, v46
    v_lshlrev_b32 v44, 16, v71
    v_and_b32 v45, 0xffff0000, v71
    v_add_f32 v44, v44, v26
    v_add_f32 v45, v45, v27
    v_cvt_pk_bf16_f32 v43, v44, v45
    s_lshl_b32 s34, s17, 1
    s_add_u32 s34, s34, 1
    s_mul_i32 s35, s34, 20480
    s_lshl_b32 s36, s29, 6
    s_add_u32 s35, s35, s36
    buffer_store_dwordx2 v[40:41], v6, s[8:11], s35 offen
    buffer_store_dwordx2 v[42:43], v6, s[8:11], s35 offen offset:32
    s_mov_b32 s17, s27
    s_cmp_ge_u32 s17, s50
    s_cbranch_scc1 L4_end_50259
    s_cmp_eq_u32 s28, 0
    s_cbranch_scc1 L4_loop_50258
    s_branch L4_pend_50260
L4_end_50259:
    s_branch Lmain_end
Lph_late:
    s_mul_i32 s18, s26, 0x3334
    s_lshr_b32 s18, s18, 16
    s_mul_i32 s17, s18, 5
    s_sub_u32 s17, s26, s17
    s_add_u32 s17, s17, 54
    s_mov_b32 s19, 5
    s_mov_b32 s50, 64
    s_cmp_lt_u32 s18, 5
    s_cbranch_scc1 Lph_d2b
    s_sub_u32 s18, s18, 5
    s_cmp_lt_u32 s18, 12
    s_cbranch_scc1 Lph_d3b
    s_sub_u32 s18, s18, 12
    s_cmp_lt_u32 s18, 5
    s_cbranch_scc1 Lph_d4b
Lmain_end:
    s_endpgm
.section .rodata,"a"
.p2align 6
.amdhsa_kernel main_kernel
  .amdhsa_next_free_vgpr 512
  .amdhsa_next_free_sgpr 102
  .amdhsa_accum_offset 256
  .amdhsa_group_segment_fixed_size 0
  .amdhsa_kernarg_size 120
  .amdhsa_user_sgpr_count 2
  .amdhsa_user_sgpr_kernarg_segment_ptr 1
  .amdhsa_system_sgpr_workgroup_id_x 1
.end_amdhsa_kernel
```
